```python
import torch

def _softmax(x, axis=-1):
    return torch.softmax(x, dim=axis)
def _gelu(x):
    return torch.nn.functional.gelu(x, approximate="tanh")
def _silu(x):
    return torch.nn.functional.silu(x)
def _sigmoid(x):
    return torch.sigmoid(x)
def _layernorm(x, axis=-1, eps=1e-5):
    m = x.mean(dim=axis, keepdim=True)
    v = x.var(dim=axis, keepdim=True, unbiased=False)
    return (x - m) / torch.sqrt(v + eps)
def _scatter_add(tgt, idx, src, axis=0):
    return tgt.clone().index_add_(axis, idx, src)
def _segment_sum(src, seg, n):
    out = torch.zeros((n,) + src.shape[1:], dtype=src.dtype)
    return out.index_add_(0, seg, src)
def _pad(x, pw):
    flat = tuple(v for pair in reversed(pw) for v in pair)
    return torch.nn.functional.pad(x, flat)

kernel_name = 'gated_mix__softmax_full_mha__compressed_kv_cla__prompt'

def setup_inputs():

    _w = (lambda a: (lambda t: t.to(torch.bfloat16) if t.is_floating_point() else t)(torch.as_tensor(a)))
    def _A_setup():
        B, S, D = 1, 2048, 512
        return {
            "x": _w((lambda *s: torch.randn(*s, dtype=torch.bfloat16) * 0.05)(B, S, D)),
            "wqkv": _w((lambda *s: torch.randn(*s, dtype=torch.bfloat16) * 1.6)(D, 3 * D)),
            "wo": _w((lambda *s: torch.randn(*s, dtype=torch.bfloat16) * 0.05)(D, D)),
        }
    _A_in = _A_setup()

    def _B_setup():
        B, H, Sq, Sk, D, M = 1, 32, 2048, 2048, 128, 512
        Dc = 4 * D
        return {
            "x": _w((lambda *s: torch.randn(*s, dtype=torch.bfloat16) * 0.05)(B, Sq, M)),
            "c_kv": _w((lambda *s: torch.randn(*s, dtype=torch.bfloat16) * 1.6)(B, Sk, Dc)),
            "w_q": _w((lambda *s: torch.randn(*s, dtype=torch.bfloat16) * 6.4)(M, H, D) * (M ** -0.5)),
            "w_uk": _w((lambda *s: torch.randn(*s, dtype=torch.bfloat16) * 6.4)(Dc, H, D) * (Dc ** -0.5)),
            "w_uv": _w((lambda *s: torch.randn(*s, dtype=torch.bfloat16) * 1.6)(Dc, H, D) * (Dc ** -0.5)),
            "w_o": _w((lambda *s: torch.randn(*s, dtype=torch.bfloat16) * 1.6)(H, D, M) * ((H * D) ** -0.5)),
        }
    _B_in = _B_setup()

    return {
        "A_x": _A_in["x"],
        "A_wqkv": _A_in["wqkv"],
        "A_wo": _A_in["wo"],
        "B_x": _B_in["x"],
        "B_c_kv": _B_in["c_kv"],
        "B_w_q": _B_in["w_q"],
        "B_w_uk": _B_in["w_uk"],
        "B_w_uv": _B_in["w_uv"],
        "B_w_o": _B_in["w_o"],
        "gate_w": _w((lambda *s: torch.randn(*s, dtype=torch.bfloat16) * 0.05)(512) * 16.0),
    }

def reference(A_x, A_wqkv, A_wo, B_x, B_c_kv, B_w_q, B_w_uk, B_w_uv, B_w_o, gate_w):
    def _A_ref(x, wqkv, wo):
        B, S, D = x.shape
        H = 32; Dh = D // H
        qkv = (lambda x, *d: x.permute(*d))((x @ wqkv).reshape(B, S, 3, H, Dh), 2, 0, 3, 1, 4)
        q, k, v = qkv[0], qkv[1], qkv[2]
        scale = Dh ** -0.5
        scores = torch.einsum("bhqd,bhkd->bhqk", q, k) * scale
        p = _softmax(scores, axis=-1)
        o = torch.einsum("bhqk,bhkd->bhqd", p, v)
        return (lambda x, *d: x.permute(*d))(o, 0, 2, 1, 3).reshape(B, S, D) @ wo

    def _B_ref(x, c_kv, w_q, w_uk, w_uv, w_o):
        B, Sq, M = x.shape[0], x.shape[1], x.shape[2]
        Sk = c_kv.shape[1]
        H, D = w_q.shape[1], w_q.shape[2]
        q = torch.einsum("bqm,mhd->bhqd", x, w_q)
        k = torch.einsum("bkc,chd->bhkd", c_kv, w_uk)
        v = torch.einsum("bkc,chd->bhkd", c_kv, w_uv)
        scores = torch.einsum("bhqd,bhkd->bhqk", q, k) * (D ** -0.5)
        off = Sk - Sq
        qi = torch.arange(Sq)[:, None]
        kj = torch.arange(Sk)[None, :]
        cmask = kj <= (qi + off)
        scores = torch.where(cmask[None, None], scores, -1e9)
        p = _softmax(scores, axis=-1)
        ctx = torch.einsum("bhqk,bhkd->bhqd", p, v)
        return torch.einsum("bhqd,hdm->bqm", ctx, w_o)

    x = A_x
    g = _sigmoid((x * gate_w).sum(-1, keepdims=True))
    a = _A_ref(x, A_wqkv, A_wo)
    b = _B_ref(x, B_c_kv, B_w_q, B_w_uk, B_w_uv, B_w_o)
    return g * a + (1 - g) * b
```

```asm
; @launch grid=(256,1,1) block=(256,1,1) lds=163840
.amdgcn_target "amdgcn-amd-amdhsa--gfx950"
.text
.globl gated_mix__softmax_full_mha__compressed_kv_cla__prompt_kernel
.p2align 8
.type gated_mix__softmax_full_mha__compressed_kv_cla__prompt_kernel,@function
gated_mix__softmax_full_mha__compressed_kv_cla__prompt_kernel:
    s_cmp_ge_u32 s2, 256
    s_cbranch_scc1 ALL_EXIT
    s_load_dwordx4 s[4:7], s[0:1], 0
    s_load_dwordx8 s[8:15], s[0:1], 32
    s_load_dwordx2 s[16:17], s[0:1], 72
    s_load_dwordx2 s[18:19], s[0:1], 96
    s_load_dwordx2 s[68:69], s[0:1], 16
    s_load_dwordx2 s[70:71], s[0:1], 64
    s_load_dwordx4 s[72:75], s[0:1], 80
    v_lshrrev_b32 v1, 6, v0
    s_nop 0
    v_readfirstlane_b32 s3, v1
    s_getpc_b64 s[20:21]
CT_1a:
    s_add_u32 s20, s20, CODE0-CT_1a
    s_addc_u32 s21, s21, 0
    s_lshr_b32 s22, s2, 3
    s_mul_i32 s22, s22, 2304
    v_mbcnt_lo_u32_b32 v250, -1, 0
    v_mbcnt_hi_u32_b32 v250, -1, v250
    v_min_u32 v250, 17, v250
    v_lshl_add_u32 v250, v250, 7, s22
    global_load_dword v251, v250, s[20:21]
CODE0:
    v_mbcnt_lo_u32_b32 v140, -1, 0
    v_mbcnt_hi_u32_b32 v140, -1, v140
    s_and_b32 s49, s2, 7
    s_lshr_b32 s50, s2, 3
    s_and_b32 s59, s49, 1
    s_lshl_b32 s59, s59, 2
    s_and_b32 s33, s50, 3
    s_add_u32 s59, s59, s33
    s_lshr_b32 s60, s49, 1
    s_xor_b32 s60, s60, 3
    s_lshl_b32 s60, s60, 3
    s_lshr_b32 s50, s50, 2
    s_add_u32 s60, s60, s50
    s_lshl_b32 s61, s59, 2
    s_add_u32 s61, s61, s3
    s_lshl_b32 s63, s61, 16
    s_lshl_b32 s64, s3, 13
    s_add_u32 s51, s64, 98304
    s_add_u32 s64, s64, 32768
    v_and_b32 v129, 15, v140
    v_lshrrev_b32 v130, 4, v140
    v_lshrrev_b32 v131, 3, v140
    v_and_b32 v132, 7, v140
    v_xor_b32 v128, v132, v130
    v_lshlrev_b32 v128, 4, v128
    v_lshl_add_u32 v112, v131, 10, v128
    v_xor_b32 v113, 64, v112
    s_waitcnt lgkmcnt(0)
    s_cmp_ge_u32 s60, 6
    s_cselect_b64 s[20:21], s[8:9], s[4:5]
    s_mov_b32 s22, 0x200000
    s_mov_b32 s23, 0x20000
    s_add_u32 s62, s63, 0
    s_add_u32 m0, s64, 32768
    s_nop 0
    buffer_load_dwordx4 v112, s[20:23], s62 offen offset:0 lds
    s_add_u32 s62, s62, 7168
    buffer_load_dwordx4 v113, s[20:23], s62 offen offset:1024 lds
    s_add_u32 s62, s62, 7168
    buffer_load_dwordx4 v112, s[20:23], s62 offen offset:2048 lds
    s_add_u32 s62, s62, 7168
    buffer_load_dwordx4 v113, s[20:23], s62 offen offset:3072 lds
    s_add_u32 m0, s64, 36864
    s_add_u32 s62, s62, 11264
    buffer_load_dwordx4 v112, s[20:23], s62 offen offset:0 lds
    s_add_u32 s62, s62, 7168
    buffer_load_dwordx4 v113, s[20:23], s62 offen offset:1024 lds
    s_add_u32 s62, s62, 7168
    buffer_load_dwordx4 v112, s[20:23], s62 offen offset:2048 lds
    s_add_u32 s62, s62, 7168
    buffer_load_dwordx4 v113, s[20:23], s62 offen offset:3072 lds
    s_lshr_b32 s48, s60, 1
    s_and_b32 s33, s60, 1
    s_lshl_b32 s33, s33, 2
    s_mov_b32 s34, 8
    s_mov_b32 s100, 128
    s_cmp_lt_u32 s60, 6
    s_cbranch_scc1 K1_TYPED
    s_sub_u32 s48, s60, 3
    s_mov_b32 s33, 0
    s_cmp_lt_u32 s60, 8
    s_cbranch_scc1 K1_TYPED
    s_mov_b32 s34, 10
    s_cmp_ge_u32 s60, 20
    s_cselect_b32 s48, 4, 3
    s_cselect_b32 s33, 20, 8
    s_sub_u32 s33, s60, s33
    s_mul_i32 s33, s33, 5
    s_add_u32 s33, s33, 4
    s_mov_b32 s100, 128
K1_TYPED:
    s_cmp_lg_u32 s48, 0
    s_cbranch_scc1 K1_NT0
    s_mov_b64 s[24:25], s[6:7]
    s_mov_b32 s38, 1024
    s_mov_b32 s39, 3072
    s_mov_b32 s52, 52428800
    s_mov_b32 s54, 1048576
    s_mov_b32 s53, 524288
    s_mov_b32 s45, 128
    s_mov_b32 s42, 2048
    s_mov_b32 s43, 262144
    s_mov_b32 s46, 131072
    s_mov_b32 s44, 0x3f800000
    s_branch K1_PAR
K1_NT0:
    s_cmp_lg_u32 s48, 1
    s_cbranch_scc1 K1_NT1
    s_mov_b64 s[24:25], s[6:7]
    s_mov_b32 s38, 2048
    s_mov_b32 s39, 3072
    s_mov_b32 s52, 52429824
    s_mov_b32 s54, 1048576
    s_mov_b32 s53, 524288
    s_mov_b32 s45, 131072
    s_mov_b32 s42, 2048
    s_mov_b32 s43, 262144
    s_mov_b32 s46, 512
    s_mov_b32 s44, 0x3f800000
    s_branch K1_PAR
K1_NT1:
    s_cmp_lg_u32 s48, 2
    s_cbranch_scc1 K1_NT2
    s_mov_b64 s[24:25], s[6:7]
    s_mov_b32 s38, 0
    s_mov_b32 s39, 3072
    s_mov_b32 s52, 50331648
    s_mov_b32 s54, 524288
    s_mov_b32 s53, 262144
    s_mov_b32 s45, 256
    s_mov_b32 s42, 1024
    s_mov_b32 s43, 131072
    s_mov_b32 s46, 65536
    s_mov_b32 s44, 0x3eb8aa3b
    s_branch K1_PAR
K1_NT2:
    s_cmp_lg_u32 s48, 3
    s_cbranch_scc1 K1_NT3
    s_mov_b64 s[24:25], s[14:15]
    s_mov_b32 s38, 0
    s_mov_b32 s39, 8192
    s_mov_b32 s52, 16785408
    s_mov_b32 s54, 1048576
    s_mov_b32 s53, 4096
    s_mov_b32 s45, 1024
    s_mov_b32 s42, 16384
    s_mov_b32 s43, 2048
    s_mov_b32 s46, 512
    s_mov_b32 s44, 0x3f800000
    s_branch K1_PAR
K1_NT3:
    s_mov_b64 s[24:25], s[12:13]
    s_mov_b32 s38, 0
    s_mov_b32 s39, 8192
    s_mov_b32 s52, 16777216
    s_mov_b32 s54, 1048576
    s_mov_b32 s53, 2048
    s_mov_b32 s45, 4096
    s_mov_b32 s42, 16384
    s_mov_b32 s43, 1024
    s_mov_b32 s46, 512
    s_mov_b32 s44, 0x3e0293ee
K1_PAR:
    s_lshl_b32 s26, s39, 9
    s_mov_b32 s27, 0x20000
    v_lshlrev_b32 v128, 1, v130
    v_xor_b32 v108, v132, v128
    v_lshrrev_b32 v128, 1, v108
    v_xor_b32 v128, v128, v108
    v_and_b32 v128, 1, v128
    s_cmp_eq_u32 s48, 1
    s_cselect_b32 s49, 0, 3
    v_mul_u32_u24 v128, s49, v128
    v_xor_b32 v108, v128, v108
    v_lshlrev_b32 v108, 4, v108
    v_lshrrev_b32 v128, 2, v131
    v_lshl_add_u32 v128, v128, 2, v131
    v_mad_u32_u24 v108, v128, s39, v108
    s_lshl_b32 s36, s39, 4
    v_mov_b32 v109, v108
    s_sub_u32 s36, s36, 1024
    s_mul_i32 s37, s39, 12
    s_add_u32 s47, s37, 3072
    s_add_u32 s37, s37, 1024
    s_mul_i32 s49, s39, s3
    s_lshl_b32 s49, s49, 6
    s_add_u32 s38, s38, s49
    s_lshl_b32 s49, s33, 7
    s_add_u32 s38, s38, s49
    s_lshl_b32 s65, s39, 8
    s_add_u32 m0, s64, 98304
    s_mul_i32 s35, s100, 0
    s_add_u32 s35, s35, s38
    buffer_load_dwordx4 v108, s[24:27], s35 offen offset:0 lds
    s_add_u32 s35, s35, s36
    buffer_load_dwordx4 v109, s[24:27], s35 offen offset:1024 lds
    s_sub_u32 s35, s35, s37
    buffer_load_dwordx4 v108, s[24:27], s35 offen offset:2048 lds
    s_add_u32 s35, s35, s36
    buffer_load_dwordx4 v109, s[24:27], s35 offen offset:3072 lds
    s_add_u32 m0, m0, 4096
    s_add_u32 s35, s35, s47
    buffer_load_dwordx4 v108, s[24:27], s35 offen offset:0 lds
    s_add_u32 s35, s35, s36
    buffer_load_dwordx4 v109, s[24:27], s35 offen offset:1024 lds
    s_sub_u32 s35, s35, s37
    buffer_load_dwordx4 v108, s[24:27], s35 offen offset:2048 lds
    s_add_u32 s35, s35, s36
    buffer_load_dwordx4 v109, s[24:27], s35 offen offset:3072 lds
    s_add_u32 s62, s63, 128
    s_add_u32 m0, s64, 65536
    s_nop 0
    buffer_load_dwordx4 v112, s[20:23], s62 offen offset:0 lds
    s_add_u32 s62, s62, 7168
    buffer_load_dwordx4 v113, s[20:23], s62 offen offset:1024 lds
    s_add_u32 s62, s62, 7168
    buffer_load_dwordx4 v112, s[20:23], s62 offen offset:2048 lds
    s_add_u32 s62, s62, 7168
    buffer_load_dwordx4 v113, s[20:23], s62 offen offset:3072 lds
    s_add_u32 m0, s64, 69632
    s_add_u32 s62, s62, 11264
    buffer_load_dwordx4 v112, s[20:23], s62 offen offset:0 lds
    s_add_u32 s62, s62, 7168
    buffer_load_dwordx4 v113, s[20:23], s62 offen offset:1024 lds
    s_add_u32 s62, s62, 7168
    buffer_load_dwordx4 v112, s[20:23], s62 offen offset:2048 lds
    s_add_u32 s62, s62, 7168
    buffer_load_dwordx4 v113, s[20:23], s62 offen offset:3072 lds
    s_add_u32 m0, s64, 4294934528
    s_mul_i32 s35, s100, 1
    s_add_u32 s35, s35, s38
    buffer_load_dwordx4 v108, s[24:27], s35 offen offset:0 lds
    s_add_u32 s35, s35, s36
    buffer_load_dwordx4 v109, s[24:27], s35 offen offset:1024 lds
    s_sub_u32 s35, s35, s37
    buffer_load_dwordx4 v108, s[24:27], s35 offen offset:2048 lds
    s_add_u32 s35, s35, s36
    buffer_load_dwordx4 v109, s[24:27], s35 offen offset:3072 lds
    s_add_u32 m0, m0, 4096
    s_add_u32 s35, s35, s47
    buffer_load_dwordx4 v108, s[24:27], s35 offen offset:0 lds
    s_add_u32 s35, s35, s36
    buffer_load_dwordx4 v109, s[24:27], s35 offen offset:1024 lds
    s_sub_u32 s35, s35, s37
    buffer_load_dwordx4 v108, s[24:27], s35 offen offset:2048 lds
    s_add_u32 s35, s35, s36
    buffer_load_dwordx4 v109, s[24:27], s35 offen offset:3072 lds
    s_lshl_b32 s49, s3, 6
    s_mul_i32 s49, s49, s39
    s_sub_u32 s49, s38, s49
    v_and_b32 v128, 1, v140
    v_mul_u32_u24 v128, s100, v128
    v_add_u32 v128, s49, v128
    s_lshl_b32 s50, s61, 3
    s_add_u32 s50, s50, 256
    v_bfe_u32 v137, v140, 1, 3
    v_add_u32 v137, s50, v137
    v_mad_u32_u24 v137, v137, s39, v128
    s_lshl_b32 s50, s61, 4
    v_and_b32 v138, 15, v140
    v_add_u32 v138, s50, v138
    v_mul_u32_u24 v138, s39, v138
    s_add_u32 s49, s49, s100
    s_add_u32 s49, s49, s100
    v_cmp_gt_u32 vcc, 16, v140
    v_add_u32 v138, s49, v138
    s_nop 0
    v_cndmask_b32 v137, v138, v137, vcc
    v_bfe_u32 v138, v140, 1, 4
    v_add_u32 v138, s50, v138
    v_mad_u32_u24 v138, v138, s39, v128
    s_mul_i32 s50, s100, 3
    v_add_u32 v138, s50, v138
    s_lshr_b32 s50, s2, 3
    s_lshl_b32 s50, s50, 2
    s_add_u32 s50, s50, s3
    s_lshl_b32 s50, s50, 15
    s_and_b32 s49, s2, 7
    s_lshl_b32 s49, s49, 10
    s_add_u32 s50, s50, s49
    v_bfe_u32 v128, v140, 3, 2
    v_lshlrev_b32 v128, 13, v128
    v_and_b32 v139, 7, v140
    v_lshl_add_u32 v139, v139, 7, v128
    v_add_u32 v139, s50, v139
    buffer_load_dword v136, v137, s[24:27], 0 offen
    s_mov_b64 s[28:29], s[18:19]
    s_mov_b32 s30, 87031808
    s_mov_b32 s31, 0x20000
    s_lshr_b32 s49, s33, 1
    s_mul_i32 s49, s49, s54
    s_add_u32 s52, s52, s49
    s_lshl_b32 s49, s61, 1
    s_mul_i32 s49, s49, s42
    s_add_u32 s52, s52, s49
    s_sub_u32 s50, s54, s53
    s_xor_b32 s54, s50, s53
    s_bitcmp1_b32 s33, 0
    s_cselect_b32 s49, s53, 0
    s_cselect_b32 s53, s50, s53
    s_add_u32 s52, s52, s49
    s_cmp_eq_u32 s100, 128
    s_cselect_b32 s53, s53, 6291456
    s_cselect_b32 s54, s54, 0
    s_mov_b32 s33, 4
    s_mov_b32 s55, 8
    s_mov_b32 s66, 4
    s_mov_b32 s67, 32768
    v_lshrrev_b32 v128, 1, v129
    v_xor_b32 v128, v128, v130
    v_lshlrev_b32 v128, 4, v128
    v_lshl_add_u32 v114, v129, 7, v128
    v_add_u32 v114, s64, v114
    v_xor_b32 v115, 64, v114
    v_add_u32 v116, 0x10000, v114
    v_add_u32 v117, 0x10000, v115
    v_lshrrev_b32 v131, 2, v140
    v_and_b32 v132, 3, v140
    v_and_b32 v128, 6, v131
    v_lshrrev_b32 v118, 1, v132
    v_xor_b32 v118, v118, v128
    v_lshlrev_b32 v118, 4, v118
    v_lshl_add_u32 v118, v131, 7, v118
    v_and_b32 v132, 1, v132
    v_lshl_add_u32 v118, v132, 3, v118
    v_xor_b32 v119, 32, v118
    v_xor_b32 v120, 64, v118
    v_xor_b32 v121, 96, v118
    v_add_u32 v122, 0x10000, v118
    v_add_u32 v104, 0x20000, v118
    v_add_u32 v123, 0x10000, v119
    v_add_u32 v105, 0x20000, v119
    v_add_u32 v124, 0x10000, v120
    v_add_u32 v106, 0x20000, v120
    v_add_u32 v125, 0x10000, v121
    v_add_u32 v107, 0x20000, v121
    s_and_b32 s49, s48, 5
    s_cmp_eq_u32 s49, 0
    s_cselect_b32 s49, 9, 8
    s_cmp_eq_u32 s48, 0
    s_cselect_b32 s50, 128, 0
    v_and_b32 v133, 1, v130
    v_lshlrev_b32 v133, s49, v133
    v_lshl_add_u32 v133, v129, 4, v133
    v_lshrrev_b32 v128, 3, v129
    v_mad_u32_u24 v133, v128, s50, v133
    v_lshrrev_b32 v128, 1, v130
    v_mad_u32_u24 v110, v128, s46, v133
    v_add_u32 v111, s45, v110
    s_mov_b32 s40, s52
    s_add_u32 s41, s52, s42
    s_add_u32 s45, s52, s43
    s_add_u32 s46, s41, s43
    s_and_b32 s49, s2, 7
    s_lshl_b32 s49, s49, 2
    s_lshr_b32 s50, s2, 6
    s_add_u32 s49, s49, s50
    s_lshl_b32 s49, s49, 8
    s_lshl_b32 s56, s3, 18
    s_add_u32 s56, s56, s49
    s_and_b32 s49, s2, 56
    s_add_u32 s57, s49, s3
    s_lshl_b32 s57, s57, 14
    s_lshl_b32 s50, s3, 15
    s_sub_u32 s59, s50, 105472
    s_lshl_b32 s49, s49, 15
    s_sub_u32 s58, 1846272, s49
    s_add_u32 s58, s58, s50
    v_lshlrev_b32 v128, 1, v130
    v_xor_b32 v126, v129, v128
    v_lshrrev_b32 v128, 1, v126
    v_xor_b32 v128, v128, v126
    v_and_b32 v128, 1, v128
    v_mul_u32_u24 v128, 3, v128
    v_xor_b32 v126, v126, v128
    v_lshlrev_b32 v126, 4, v126
    v_lshl_add_u32 v126, v130, 13, v126
    s_waitcnt vmcnt(25)
    ds_read_b128 a[0:3], v114 offset:32768
    ds_read_b128 a[64:67], v114 offset:34816
    ds_read_b128 a[128:131], v114 offset:36864
    ds_read_b128 a[192:195], v114 offset:38912
    ds_read_b128 a[4:7], v115 offset:32768
    ds_read_b128 a[68:71], v115 offset:34816
    ds_read_b128 a[132:135], v115 offset:36864
    ds_read_b128 a[196:199], v115 offset:38912
    s_waitcnt vmcnt(9)
    ds_read_b128 a[8:11], v116 offset:0
    ds_read_b128 a[72:75], v116 offset:2048
    ds_read_b128 a[136:139], v116 offset:4096
    ds_read_b128 a[200:203], v116 offset:6144
    ds_read_b128 a[12:15], v117 offset:0
    ds_read_b128 a[76:79], v117 offset:2048
    ds_read_b128 a[140:143], v117 offset:4096
    s_waitcnt lgkmcnt(7)
    ds_read_b128 a[204:207], v117 offset:6144
    s_waitcnt vmcnt(17)
    s_barrier
    ds_read_b64_tr_b16 v[64:65], v104 offset:0
    ds_read_b64_tr_b16 v[66:67], v104 offset:2048
    ds_read_b64_tr_b16 v[68:69], v104 offset:4096
    ds_read_b64_tr_b16 v[70:71], v104 offset:6144
    ds_read_b64_tr_b16 v[72:73], v104 offset:8192
    ds_read_b64_tr_b16 v[74:75], v104 offset:10240
    ds_read_b64_tr_b16 v[76:77], v104 offset:12288
    ds_read_b64_tr_b16 v[78:79], v104 offset:14336
    s_bitcmp1_b32 s48, 0
    s_waitcnt lgkmcnt(0)
    s_cbranch_scc1 K1_FN
    v_mfma_f32_16x16x32_bf16 v[144:147], v[64:67], a[0:3], 0
    ds_read_b64_tr_b16 v[80:81], v105 offset:0
    v_mfma_f32_16x16x32_bf16 v[144:147], v[68:71], a[4:7], v[144:147]
    ds_read_b64_tr_b16 v[82:83], v105 offset:2048
    s_add_u32 s62, s63, 256
    v_mfma_f32_16x16x32_bf16 v[144:147], v[72:75], a[8:11], v[144:147]
    ds_read_b64_tr_b16 v[84:85], v105 offset:4096
    s_add_u32 m0, s64, 0
    v_mfma_f32_16x16x32_bf16 v[144:147], v[76:79], a[12:15], v[144:147]
    s_nop 0
    v_mfma_f32_16x16x32_bf16 v[152:155], v[64:67], a[64:67], 0
    ds_read_b64_tr_b16 v[86:87], v105 offset:6144
    v_mfma_f32_16x16x32_bf16 v[152:155], v[68:71], a[68:71], v[152:155]
    ds_read_b64_tr_b16 v[88:89], v105 offset:8192
    v_mfma_f32_16x16x32_bf16 v[152:155], v[72:75], a[72:75], v[152:155]
    ds_read_b64_tr_b16 v[90:91], v105 offset:10240
    v_mfma_f32_16x16x32_bf16 v[152:155], v[76:79], a[76:79], v[152:155]
    buffer_load_dwordx4 v112, s[20:23], s62 offen offset:0 lds
    v_mfma_f32_16x16x32_bf16 v[160:163], v[64:67], a[128:131], 0
    ds_read_b64_tr_b16 v[92:93], v105 offset:12288
    s_add_u32 s62, s62, 7168
    v_mfma_f32_16x16x32_bf16 v[160:163], v[68:71], a[132:135], v[160:163]
    ds_read_b64_tr_b16 v[94:95], v105 offset:14336
    v_mfma_f32_16x16x32_bf16 v[160:163], v[72:75], a[136:139], v[160:163]
    v_mfma_f32_16x16x32_bf16 v[160:163], v[76:79], a[140:143], v[160:163]
    buffer_load_dwordx4 v113, s[20:23], s62 offen offset:1024 lds
    v_mfma_f32_16x16x32_bf16 v[168:171], v[64:67], a[192:195], 0
    s_add_u32 s62, s62, 7168
    v_mfma_f32_16x16x32_bf16 v[168:171], v[68:71], a[196:199], v[168:171]
    v_mfma_f32_16x16x32_bf16 v[168:171], v[72:75], a[200:203], v[168:171]
    v_mfma_f32_16x16x32_bf16 v[168:171], v[76:79], a[204:207], v[168:171]
    s_waitcnt lgkmcnt(0)
    buffer_load_dwordx4 v112, s[20:23], s62 offen offset:2048 lds
    v_mfma_f32_16x16x32_bf16 v[148:151], v[80:83], a[0:3], 0
    ds_read_b64_tr_b16 v[64:65], v106 offset:0
    s_add_u32 s62, s62, 7168
    v_mfma_f32_16x16x32_bf16 v[148:151], v[84:87], a[4:7], v[148:151]
    ds_read_b64_tr_b16 v[66:67], v106 offset:2048
    v_mfma_f32_16x16x32_bf16 v[148:151], v[88:91], a[8:11], v[148:151]
    ds_read_b64_tr_b16 v[68:69], v106 offset:4096
    v_mfma_f32_16x16x32_bf16 v[148:151], v[92:95], a[12:15], v[148:151]
    buffer_load_dwordx4 v113, s[20:23], s62 offen offset:3072 lds
    v_mfma_f32_16x16x32_bf16 v[156:159], v[80:83], a[64:67], 0
    ds_read_b64_tr_b16 v[70:71], v106 offset:6144
    s_add_u32 m0, s64, 4096
    v_mfma_f32_16x16x32_bf16 v[156:159], v[84:87], a[68:71], v[156:159]
    ds_read_b64_tr_b16 v[72:73], v106 offset:8192
    s_add_u32 s62, s62, 11264
    v_mfma_f32_16x16x32_bf16 v[156:159], v[88:91], a[72:75], v[156:159]
    ds_read_b64_tr_b16 v[74:75], v106 offset:10240
    v_mfma_f32_16x16x32_bf16 v[156:159], v[92:95], a[76:79], v[156:159]
    buffer_load_dwordx4 v112, s[20:23], s62 offen offset:0 lds
    v_mfma_f32_16x16x32_bf16 v[164:167], v[80:83], a[128:131], 0
    ds_read_b64_tr_b16 v[76:77], v106 offset:12288
    s_add_u32 s62, s62, 7168
    v_mfma_f32_16x16x32_bf16 v[164:167], v[84:87], a[132:135], v[164:167]
    ds_read_b64_tr_b16 v[78:79], v106 offset:14336
    v_mfma_f32_16x16x32_bf16 v[164:167], v[88:91], a[136:139], v[164:167]
    v_mfma_f32_16x16x32_bf16 v[164:167], v[92:95], a[140:143], v[164:167]
    buffer_load_dwordx4 v113, s[20:23], s62 offen offset:1024 lds
    v_mfma_f32_16x16x32_bf16 v[172:175], v[80:83], a[192:195], 0
    s_add_u32 s62, s62, 7168
    v_mfma_f32_16x16x32_bf16 v[172:175], v[84:87], a[196:199], v[172:175]
    v_mfma_f32_16x16x32_bf16 v[172:175], v[88:91], a[200:203], v[172:175]
    v_mfma_f32_16x16x32_bf16 v[172:175], v[92:95], a[204:207], v[172:175]
    s_waitcnt lgkmcnt(0)
    buffer_load_dwordx4 v112, s[20:23], s62 offen offset:2048 lds
    v_mfma_f32_16x16x32_bf16 v[176:179], v[64:67], a[0:3], 0
    ds_read_b64_tr_b16 v[80:81], v107 offset:0
    s_add_u32 s62, s62, 7168
    v_mfma_f32_16x16x32_bf16 v[176:179], v[68:71], a[4:7], v[176:179]
    ds_read_b64_tr_b16 v[82:83], v107 offset:2048
    v_mfma_f32_16x16x32_bf16 v[176:179], v[72:75], a[8:11], v[176:179]
    ds_read_b64_tr_b16 v[84:85], v107 offset:4096
    v_mfma_f32_16x16x32_bf16 v[176:179], v[76:79], a[12:15], v[176:179]
    buffer_load_dwordx4 v113, s[20:23], s62 offen offset:3072 lds
    v_mfma_f32_16x16x32_bf16 v[184:187], v[64:67], a[64:67], 0
    ds_read_b64_tr_b16 v[86:87], v107 offset:6144
    s_add_u32 s62, s63, 384
    v_mfma_f32_16x16x32_bf16 v[184:187], v[68:71], a[68:71], v[184:187]
    ds_read_b64_tr_b16 v[88:89], v107 offset:8192
    s_add_u32 m0, s64, 32768
    v_mfma_f32_16x16x32_bf16 v[184:187], v[72:75], a[72:75], v[184:187]
    ds_read_b64_tr_b16 v[90:91], v107 offset:10240
    s_nop 0
    v_mfma_f32_16x16x32_bf16 v[184:187], v[76:79], a[76:79], v[184:187]
    buffer_load_dwordx4 v112, s[20:23], s62 offen offset:0 lds
    v_mfma_f32_16x16x32_bf16 v[192:195], v[64:67], a[128:131], 0
    ds_read_b64_tr_b16 v[92:93], v107 offset:12288
    s_add_u32 s62, s62, 7168
    v_mfma_f32_16x16x32_bf16 v[192:195], v[68:71], a[132:135], v[192:195]
    ds_read_b64_tr_b16 v[94:95], v107 offset:14336
    v_mfma_f32_16x16x32_bf16 v[192:195], v[72:75], a[136:139], v[192:195]
    s_waitcnt vmcnt(10)
    s_barrier
    v_mfma_f32_16x16x32_bf16 v[192:195], v[76:79], a[140:143], v[192:195]
    buffer_load_dwordx4 v113, s[20:23], s62 offen offset:1024 lds
    v_mfma_f32_16x16x32_bf16 v[200:203], v[64:67], a[192:195], 0
    s_add_u32 s62, s62, 7168
    v_mfma_f32_16x16x32_bf16 v[200:203], v[68:71], a[196:199], v[200:203]
    v_mfma_f32_16x16x32_bf16 v[200:203], v[72:75], a[200:203], v[200:203]
    v_mfma_f32_16x16x32_bf16 v[200:203], v[76:79], a[204:207], v[200:203]
    s_waitcnt lgkmcnt(0)
    buffer_load_dwordx4 v112, s[20:23], s62 offen offset:2048 lds
    v_mfma_f32_16x16x32_bf16 v[180:183], v[80:83], a[0:3], 0
    ds_read_b64_tr_b16 v[64:65], v118 offset:0
    s_add_u32 s62, s62, 7168
    v_mfma_f32_16x16x32_bf16 v[180:183], v[84:87], a[4:7], v[180:183]
    ds_read_b64_tr_b16 v[66:67], v118 offset:2048
    v_mfma_f32_16x16x32_bf16 v[180:183], v[88:91], a[8:11], v[180:183]
    ds_read_b64_tr_b16 v[68:69], v118 offset:4096
    v_mfma_f32_16x16x32_bf16 v[180:183], v[92:95], a[12:15], v[180:183]
    buffer_load_dwordx4 v113, s[20:23], s62 offen offset:3072 lds
    v_mfma_f32_16x16x32_bf16 v[188:191], v[80:83], a[64:67], 0
    ds_read_b64_tr_b16 v[70:71], v118 offset:6144
    s_add_u32 m0, s64, 36864
    v_mfma_f32_16x16x32_bf16 v[188:191], v[84:87], a[68:71], v[188:191]
    ds_read_b64_tr_b16 v[72:73], v118 offset:8192
    s_add_u32 s62, s62, 11264
    v_mfma_f32_16x16x32_bf16 v[188:191], v[88:91], a[72:75], v[188:191]
    ds_read_b64_tr_b16 v[74:75], v118 offset:10240
    v_mfma_f32_16x16x32_bf16 v[188:191], v[92:95], a[76:79], v[188:191]
    buffer_load_dwordx4 v112, s[20:23], s62 offen offset:0 lds
    v_mfma_f32_16x16x32_bf16 v[196:199], v[80:83], a[128:131], 0
    ds_read_b64_tr_b16 v[76:77], v118 offset:12288
    s_add_u32 s62, s62, 7168
    v_mfma_f32_16x16x32_bf16 v[196:199], v[84:87], a[132:135], v[196:199]
    ds_read_b64_tr_b16 v[78:79], v118 offset:14336
    v_mfma_f32_16x16x32_bf16 v[196:199], v[88:91], a[136:139], v[196:199]
    v_mfma_f32_16x16x32_bf16 v[196:199], v[92:95], a[140:143], v[196:199]
    buffer_load_dwordx4 v113, s[20:23], s62 offen offset:1024 lds
    v_mfma_f32_16x16x32_bf16 v[204:207], v[80:83], a[192:195], 0
    s_add_u32 s62, s62, 7168
    v_mfma_f32_16x16x32_bf16 v[204:207], v[84:87], a[196:199], v[204:207]
    v_mfma_f32_16x16x32_bf16 v[204:207], v[88:91], a[200:203], v[204:207]
    v_mfma_f32_16x16x32_bf16 v[204:207], v[92:95], a[204:207], v[204:207]
    s_waitcnt lgkmcnt(0)
    buffer_load_dwordx4 v112, s[20:23], s62 offen offset:2048 lds
    v_mfma_f32_16x16x32_bf16 v[0:3], v[64:67], a[0:3], 0
    ds_read_b64_tr_b16 v[80:81], v119 offset:0
    s_add_u32 s62, s62, 7168
    v_mfma_f32_16x16x32_bf16 v[0:3], v[68:71], a[4:7], v[0:3]
    ds_read_b64_tr_b16 v[82:83], v119 offset:2048
    v_mfma_f32_16x16x32_bf16 v[0:3], v[72:75], a[8:11], v[0:3]
    ds_read_b64_tr_b16 v[84:85], v119 offset:4096
    v_mfma_f32_16x16x32_bf16 v[0:3], v[76:79], a[12:15], v[0:3]
    buffer_load_dwordx4 v113, s[20:23], s62 offen offset:3072 lds
    v_mfma_f32_16x16x32_bf16 v[8:11], v[64:67], a[64:67], 0
    ds_read_b64_tr_b16 v[86:87], v119 offset:6144
    s_add_u32 s62, s63, 512
    v_mfma_f32_16x16x32_bf16 v[8:11], v[68:71], a[68:71], v[8:11]
    ds_read_b64_tr_b16 v[88:89], v119 offset:8192
    s_add_u32 m0, s64, 65536
    v_mfma_f32_16x16x32_bf16 v[8:11], v[72:75], a[72:75], v[8:11]
    ds_read_b64_tr_b16 v[90:91], v119 offset:10240
    s_nop 0
    v_mfma_f32_16x16x32_bf16 v[8:11], v[76:79], a[76:79], v[8:11]
    buffer_load_dwordx4 v112, s[20:23], s62 offen offset:0 lds
    v_mfma_f32_16x16x32_bf16 v[16:19], v[64:67], a[128:131], 0
    ds_read_b64_tr_b16 v[92:93], v119 offset:12288
    s_add_u32 s62, s62, 7168
    v_mfma_f32_16x16x32_bf16 v[16:19], v[68:71], a[132:135], v[16:19]
    ds_read_b64_tr_b16 v[94:95], v119 offset:14336
    v_mfma_f32_16x16x32_bf16 v[16:19], v[72:75], a[136:139], v[16:19]
    v_mfma_f32_16x16x32_bf16 v[16:19], v[76:79], a[140:143], v[16:19]
    buffer_load_dwordx4 v113, s[20:23], s62 offen offset:1024 lds
    v_mfma_f32_16x16x32_bf16 v[24:27], v[64:67], a[192:195], 0
    s_add_u32 s62, s62, 7168
    v_mfma_f32_16x16x32_bf16 v[24:27], v[68:71], a[196:199], v[24:27]
    v_mfma_f32_16x16x32_bf16 v[24:27], v[72:75], a[200:203], v[24:27]
    v_mfma_f32_16x16x32_bf16 v[24:27], v[76:79], a[204:207], v[24:27]
    s_waitcnt lgkmcnt(0)
    buffer_load_dwordx4 v112, s[20:23], s62 offen offset:2048 lds
    v_mfma_f32_16x16x32_bf16 v[4:7], v[80:83], a[0:3], 0
    ds_read_b64_tr_b16 v[64:65], v120 offset:0
    s_add_u32 s62, s62, 7168
    v_mfma_f32_16x16x32_bf16 v[4:7], v[84:87], a[4:7], v[4:7]
    ds_read_b64_tr_b16 v[66:67], v120 offset:2048
    v_mfma_f32_16x16x32_bf16 v[4:7], v[88:91], a[8:11], v[4:7]
    ds_read_b64_tr_b16 v[68:69], v120 offset:4096
    s_waitcnt vmcnt(11)
    v_mfma_f32_16x16x32_bf16 v[4:7], v[92:95], a[12:15], v[4:7]
    ds_read_b128 a[16:19], v114 offset:0
    ds_read_b128 a[80:83], v114 offset:2048
    v_mfma_f32_16x16x32_bf16 v[12:15], v[80:83], a[64:67], 0
    ds_read_b64_tr_b16 v[70:71], v120 offset:6144
    v_mfma_f32_16x16x32_bf16 v[12:15], v[84:87], a[68:71], v[12:15]
    ds_read_b64_tr_b16 v[72:73], v120 offset:8192
    v_mfma_f32_16x16x32_bf16 v[12:15], v[88:91], a[72:75], v[12:15]
    ds_read_b64_tr_b16 v[74:75], v120 offset:10240
    v_mfma_f32_16x16x32_bf16 v[12:15], v[92:95], a[76:79], v[12:15]
    ds_read_b128 a[144:147], v114 offset:4096
    ds_read_b128 a[208:211], v114 offset:6144
    v_mfma_f32_16x16x32_bf16 v[20:23], v[80:83], a[128:131], 0
    ds_read_b64_tr_b16 v[76:77], v120 offset:12288
    v_mfma_f32_16x16x32_bf16 v[20:23], v[84:87], a[132:135], v[20:23]
    ds_read_b64_tr_b16 v[78:79], v120 offset:14336
    v_mfma_f32_16x16x32_bf16 v[20:23], v[88:91], a[136:139], v[20:23]
    ds_read_b128 a[20:23], v115 offset:0
    ds_read_b128 a[84:87], v115 offset:2048
    v_mfma_f32_16x16x32_bf16 v[20:23], v[92:95], a[140:143], v[20:23]
    ds_read_b128 a[148:151], v115 offset:4096
    ds_read_b128 a[212:215], v115 offset:6144
    v_mfma_f32_16x16x32_bf16 v[28:31], v[80:83], a[192:195], 0
    buffer_load_dwordx4 v113, s[20:23], s62 offen offset:3072 lds
    v_mfma_f32_16x16x32_bf16 v[28:31], v[84:87], a[196:199], v[28:31]
    s_add_u32 m0, s64, 69632
    s_add_u32 s62, s62, 11264
    v_mfma_f32_16x16x32_bf16 v[28:31], v[88:91], a[200:203], v[28:31]
    v_mfma_f32_16x16x32_bf16 v[28:31], v[92:95], a[204:207], v[28:31]
    s_waitcnt lgkmcnt(0)
    v_mfma_f32_16x16x32_bf16 v[32:35], v[64:67], a[0:3], 0
    ds_read_b64_tr_b16 v[80:81], v121 offset:0
    v_mfma_f32_16x16x32_bf16 v[32:35], v[68:71], a[4:7], v[32:35]
    ds_read_b64_tr_b16 v[82:83], v121 offset:2048
    v_mfma_f32_16x16x32_bf16 v[32:35], v[72:75], a[8:11], v[32:35]
    ds_read_b64_tr_b16 v[84:85], v121 offset:4096
    v_mfma_f32_16x16x32_bf16 v[32:35], v[76:79], a[12:15], v[32:35]
    buffer_load_dwordx4 v112, s[20:23], s62 offen offset:0 lds
    v_mfma_f32_16x16x32_bf16 v[40:43], v[64:67], a[64:67], 0
    ds_read_b64_tr_b16 v[86:87], v121 offset:6144
    s_add_u32 s62, s62, 7168
    v_mfma_f32_16x16x32_bf16 v[40:43], v[68:71], a[68:71], v[40:43]
    ds_read_b64_tr_b16 v[88:89], v121 offset:8192
    v_mfma_f32_16x16x32_bf16 v[40:43], v[72:75], a[72:75], v[40:43]
    ds_read_b64_tr_b16 v[90:91], v121 offset:10240
    v_mfma_f32_16x16x32_bf16 v[40:43], v[76:79], a[76:79], v[40:43]
    buffer_load_dwordx4 v113, s[20:23], s62 offen offset:1024 lds
    v_mfma_f32_16x16x32_bf16 v[48:51], v[64:67], a[128:131], 0
    ds_read_b64_tr_b16 v[92:93], v121 offset:12288
    s_add_u32 s62, s62, 7168
    v_mfma_f32_16x16x32_bf16 v[48:51], v[68:71], a[132:135], v[48:51]
    ds_read_b64_tr_b16 v[94:95], v121 offset:14336
    v_mfma_f32_16x16x32_bf16 v[48:51], v[72:75], a[136:139], v[48:51]
    v_mfma_f32_16x16x32_bf16 v[48:51], v[76:79], a[140:143], v[48:51]
    buffer_load_dwordx4 v112, s[20:23], s62 offen offset:2048 lds
    v_mfma_f32_16x16x32_bf16 v[56:59], v[64:67], a[192:195], 0
    s_add_u32 s62, s62, 7168
    v_mfma_f32_16x16x32_bf16 v[56:59], v[68:71], a[196:199], v[56:59]
    v_mfma_f32_16x16x32_bf16 v[56:59], v[72:75], a[200:203], v[56:59]
    v_mfma_f32_16x16x32_bf16 v[56:59], v[76:79], a[204:207], v[56:59]
    s_waitcnt lgkmcnt(0)
    buffer_load_dwordx4 v113, s[20:23], s62 offen offset:3072 lds
    v_mfma_f32_16x16x32_bf16 v[36:39], v[80:83], a[0:3], 0
    ds_read_b64_tr_b16 v[64:65], v104 offset:16384
    s_add_u32 s62, s63, 640
    v_mfma_f32_16x16x32_bf16 v[36:39], v[84:87], a[4:7], v[36:39]
    ds_read_b64_tr_b16 v[66:67], v104 offset:18432
    s_add_u32 m0, s64, 0
    v_mfma_f32_16x16x32_bf16 v[36:39], v[88:91], a[8:11], v[36:39]
    ds_read_b64_tr_b16 v[68:69], v104 offset:20480
    s_waitcnt vmcnt(8)
    v_mfma_f32_16x16x32_bf16 v[36:39], v[92:95], a[12:15], v[36:39]
    ds_read_b128 a[24:27], v114 offset:32768
    ds_read_b128 a[88:91], v114 offset:34816
    v_mfma_f32_16x16x32_bf16 v[44:47], v[80:83], a[64:67], 0
    ds_read_b64_tr_b16 v[70:71], v104 offset:22528
    s_nop 0
    v_mfma_f32_16x16x32_bf16 v[44:47], v[84:87], a[68:71], v[44:47]
    ds_read_b64_tr_b16 v[72:73], v104 offset:24576
    v_mfma_f32_16x16x32_bf16 v[44:47], v[88:91], a[72:75], v[44:47]
    ds_read_b64_tr_b16 v[74:75], v104 offset:26624
    v_mfma_f32_16x16x32_bf16 v[44:47], v[92:95], a[76:79], v[44:47]
    ds_read_b128 a[152:155], v114 offset:36864
    ds_read_b128 a[216:219], v114 offset:38912
    v_mfma_f32_16x16x32_bf16 v[52:55], v[80:83], a[128:131], 0
    ds_read_b64_tr_b16 v[76:77], v104 offset:28672
    v_mfma_f32_16x16x32_bf16 v[52:55], v[84:87], a[132:135], v[52:55]
    ds_read_b64_tr_b16 v[78:79], v104 offset:30720
    v_mfma_f32_16x16x32_bf16 v[52:55], v[88:91], a[136:139], v[52:55]
    ds_read_b128 a[28:31], v115 offset:32768
    ds_read_b128 a[92:95], v115 offset:34816
    v_mfma_f32_16x16x32_bf16 v[52:55], v[92:95], a[140:143], v[52:55]
    ds_read_b128 a[156:159], v115 offset:36864
    ds_read_b128 a[220:223], v115 offset:38912
    v_mfma_f32_16x16x32_bf16 v[60:63], v[80:83], a[192:195], 0
    buffer_load_dwordx4 v112, s[20:23], s62 offen offset:0 lds
    v_mfma_f32_16x16x32_bf16 v[60:63], v[84:87], a[196:199], v[60:63]
    s_add_u32 s62, s62, 7168
    v_mfma_f32_16x16x32_bf16 v[60:63], v[88:91], a[200:203], v[60:63]
    v_mfma_f32_16x16x32_bf16 v[60:63], v[92:95], a[204:207], v[60:63]
    s_waitcnt lgkmcnt(0)
    v_mfma_f32_16x16x32_bf16 v[144:147], v[64:67], a[16:19], v[144:147]
    ds_read_b64_tr_b16 v[80:81], v105 offset:16384
    v_mfma_f32_16x16x32_bf16 v[144:147], v[68:71], a[20:23], v[144:147]
    ds_read_b64_tr_b16 v[82:83], v105 offset:18432
    v_mfma_f32_16x16x32_bf16 v[144:147], v[72:75], a[24:27], v[144:147]
    ds_read_b64_tr_b16 v[84:85], v105 offset:20480
    v_mfma_f32_16x16x32_bf16 v[144:147], v[76:79], a[28:31], v[144:147]
    buffer_load_dwordx4 v113, s[20:23], s62 offen offset:1024 lds
    v_mfma_f32_16x16x32_bf16 v[152:155], v[64:67], a[80:83], v[152:155]
    ds_read_b64_tr_b16 v[86:87], v105 offset:22528
    s_add_u32 s62, s62, 7168
    v_mfma_f32_16x16x32_bf16 v[152:155], v[68:71], a[84:87], v[152:155]
    ds_read_b64_tr_b16 v[88:89], v105 offset:24576
    v_mfma_f32_16x16x32_bf16 v[152:155], v[72:75], a[88:91], v[152:155]
    ds_read_b64_tr_b16 v[90:91], v105 offset:26624
    v_mfma_f32_16x16x32_bf16 v[152:155], v[76:79], a[92:95], v[152:155]
    buffer_load_dwordx4 v112, s[20:23], s62 offen offset:2048 lds
    v_mfma_f32_16x16x32_bf16 v[160:163], v[64:67], a[144:147], v[160:163]
    ds_read_b64_tr_b16 v[92:93], v105 offset:28672
    s_add_u32 s62, s62, 7168
    v_mfma_f32_16x16x32_bf16 v[160:163], v[68:71], a[148:151], v[160:163]
    ds_read_b64_tr_b16 v[94:95], v105 offset:30720
    v_mfma_f32_16x16x32_bf16 v[160:163], v[72:75], a[152:155], v[160:163]
    v_mfma_f32_16x16x32_bf16 v[160:163], v[76:79], a[156:159], v[160:163]
    buffer_load_dwordx4 v113, s[20:23], s62 offen offset:3072 lds
    v_mfma_f32_16x16x32_bf16 v[168:171], v[64:67], a[208:211], v[168:171]
    s_add_u32 m0, s64, 4096
    s_add_u32 s62, s62, 11264
    v_mfma_f32_16x16x32_bf16 v[168:171], v[68:71], a[212:215], v[168:171]
    v_mfma_f32_16x16x32_bf16 v[168:171], v[72:75], a[216:219], v[168:171]
    v_mfma_f32_16x16x32_bf16 v[168:171], v[76:79], a[220:223], v[168:171]
    s_waitcnt lgkmcnt(0)
    buffer_load_dwordx4 v112, s[20:23], s62 offen offset:0 lds
    v_mfma_f32_16x16x32_bf16 v[148:151], v[80:83], a[16:19], v[148:151]
    ds_read_b64_tr_b16 v[64:65], v106 offset:16384
    s_add_u32 s62, s62, 7168
    v_mfma_f32_16x16x32_bf16 v[148:151], v[84:87], a[20:23], v[148:151]
    ds_read_b64_tr_b16 v[66:67], v106 offset:18432
    v_mfma_f32_16x16x32_bf16 v[148:151], v[88:91], a[24:27], v[148:151]
    ds_read_b64_tr_b16 v[68:69], v106 offset:20480
    v_mfma_f32_16x16x32_bf16 v[148:151], v[92:95], a[28:31], v[148:151]
    buffer_load_dwordx4 v113, s[20:23], s62 offen offset:1024 lds
    v_mfma_f32_16x16x32_bf16 v[156:159], v[80:83], a[80:83], v[156:159]
    ds_read_b64_tr_b16 v[70:71], v106 offset:22528
    s_add_u32 s62, s62, 7168
    v_mfma_f32_16x16x32_bf16 v[156:159], v[84:87], a[84:87], v[156:159]
    ds_read_b64_tr_b16 v[72:73], v106 offset:24576
    v_mfma_f32_16x16x32_bf16 v[156:159], v[88:91], a[88:91], v[156:159]
    ds_read_b64_tr_b16 v[74:75], v106 offset:26624
    v_mfma_f32_16x16x32_bf16 v[156:159], v[92:95], a[92:95], v[156:159]
    buffer_load_dwordx4 v112, s[20:23], s62 offen offset:2048 lds
    v_mfma_f32_16x16x32_bf16 v[164:167], v[80:83], a[144:147], v[164:167]
    ds_read_b64_tr_b16 v[76:77], v106 offset:28672
    s_add_u32 s62, s62, 7168
    v_mfma_f32_16x16x32_bf16 v[164:167], v[84:87], a[148:151], v[164:167]
    ds_read_b64_tr_b16 v[78:79], v106 offset:30720
    v_mfma_f32_16x16x32_bf16 v[164:167], v[88:91], a[152:155], v[164:167]
    v_mfma_f32_16x16x32_bf16 v[164:167], v[92:95], a[156:159], v[164:167]
    buffer_load_dwordx4 v113, s[20:23], s62 offen offset:3072 lds
    v_mfma_f32_16x16x32_bf16 v[172:175], v[80:83], a[208:211], v[172:175]
    s_add_u32 m0, s64, 32768
    s_mul_i32 s35, s100, 0
    v_mfma_f32_16x16x32_bf16 v[172:175], v[84:87], a[212:215], v[172:175]
    s_add_u32 s35, s35, s38
    s_add_u32 s35, s35, s65
    v_mfma_f32_16x16x32_bf16 v[172:175], v[88:91], a[216:219], v[172:175]
    buffer_load_dwordx4 v108, s[24:27], s35 offen offset:0 lds
    v_mfma_f32_16x16x32_bf16 v[172:175], v[92:95], a[220:223], v[172:175]
    s_waitcnt lgkmcnt(0)
    s_add_u32 s35, s35, s36
    v_mfma_f32_16x16x32_bf16 v[176:179], v[64:67], a[16:19], v[176:179]
    ds_read_b64_tr_b16 v[80:81], v107 offset:16384
    v_mfma_f32_16x16x32_bf16 v[176:179], v[68:71], a[20:23], v[176:179]
    ds_read_b64_tr_b16 v[82:83], v107 offset:18432
    v_mfma_f32_16x16x32_bf16 v[176:179], v[72:75], a[24:27], v[176:179]
    ds_read_b64_tr_b16 v[84:85], v107 offset:20480
    s_waitcnt vmcnt(9)
    v_mfma_f32_16x16x32_bf16 v[176:179], v[76:79], a[28:31], v[176:179]
    ds_read_b128 a[32:35], v116 offset:0
    ds_read_b128 a[96:99], v116 offset:2048
    v_mfma_f32_16x16x32_bf16 v[184:187], v[64:67], a[80:83], v[184:187]
    ds_read_b64_tr_b16 v[86:87], v107 offset:22528
    v_mfma_f32_16x16x32_bf16 v[184:187], v[68:71], a[84:87], v[184:187]
    ds_read_b64_tr_b16 v[88:89], v107 offset:24576
    v_mfma_f32_16x16x32_bf16 v[184:187], v[72:75], a[88:91], v[184:187]
    ds_read_b64_tr_b16 v[90:91], v107 offset:26624
    v_mfma_f32_16x16x32_bf16 v[184:187], v[76:79], a[92:95], v[184:187]
    ds_read_b128 a[160:163], v116 offset:4096
    ds_read_b128 a[224:227], v116 offset:6144
    v_mfma_f32_16x16x32_bf16 v[192:195], v[64:67], a[144:147], v[192:195]
    ds_read_b64_tr_b16 v[92:93], v107 offset:28672
    v_mfma_f32_16x16x32_bf16 v[192:195], v[68:71], a[148:151], v[192:195]
    ds_read_b64_tr_b16 v[94:95], v107 offset:30720
    v_mfma_f32_16x16x32_bf16 v[192:195], v[72:75], a[152:155], v[192:195]
    ds_read_b128 a[36:39], v117 offset:0
    ds_read_b128 a[100:103], v117 offset:2048
    v_mfma_f32_16x16x32_bf16 v[192:195], v[76:79], a[156:159], v[192:195]
    ds_read_b128 a[164:167], v117 offset:4096
    ds_read_b128 a[228:231], v117 offset:6144
    v_mfma_f32_16x16x32_bf16 v[200:203], v[64:67], a[208:211], v[200:203]
    buffer_load_dwordx4 v109, s[24:27], s35 offen offset:1024 lds
    v_mfma_f32_16x16x32_bf16 v[200:203], v[68:71], a[212:215], v[200:203]
    s_sub_u32 s35, s35, s37
    v_mfma_f32_16x16x32_bf16 v[200:203], v[72:75], a[216:219], v[200:203]
    buffer_load_dwordx4 v108, s[24:27], s35 offen offset:2048 lds
    v_mfma_f32_16x16x32_bf16 v[200:203], v[76:79], a[220:223], v[200:203]
    s_waitcnt lgkmcnt(0)
    s_add_u32 s35, s35, s36
    v_mfma_f32_16x16x32_bf16 v[180:183], v[80:83], a[16:19], v[180:183]
    ds_read_b64_tr_b16 v[64:65], v118 offset:16384
    v_mfma_f32_16x16x32_bf16 v[180:183], v[84:87], a[20:23], v[180:183]
    ds_read_b64_tr_b16 v[66:67], v118 offset:18432
    v_mfma_f32_16x16x32_bf16 v[180:183], v[88:91], a[24:27], v[180:183]
    ds_read_b64_tr_b16 v[68:69], v118 offset:20480
    v_mfma_f32_16x16x32_bf16 v[180:183], v[92:95], a[28:31], v[180:183]
    buffer_load_dwordx4 v109, s[24:27], s35 offen offset:3072 lds
    v_mfma_f32_16x16x32_bf16 v[188:191], v[80:83], a[80:83], v[188:191]
    ds_read_b64_tr_b16 v[70:71], v118 offset:22528
    s_add_u32 m0, m0, 4096
    v_mfma_f32_16x16x32_bf16 v[188:191], v[84:87], a[84:87], v[188:191]
    ds_read_b64_tr_b16 v[72:73], v118 offset:24576
    s_add_u32 s35, s35, s47
    v_mfma_f32_16x16x32_bf16 v[188:191], v[88:91], a[88:91], v[188:191]
    ds_read_b64_tr_b16 v[74:75], v118 offset:26624
    v_mfma_f32_16x16x32_bf16 v[188:191], v[92:95], a[92:95], v[188:191]
    buffer_load_dwordx4 v108, s[24:27], s35 offen offset:0 lds
    v_mfma_f32_16x16x32_bf16 v[196:199], v[80:83], a[144:147], v[196:199]
    ds_read_b64_tr_b16 v[76:77], v118 offset:28672
    s_add_u32 s35, s35, s36
    v_mfma_f32_16x16x32_bf16 v[196:199], v[84:87], a[148:151], v[196:199]
    ds_read_b64_tr_b16 v[78:79], v118 offset:30720
    v_mfma_f32_16x16x32_bf16 v[196:199], v[88:91], a[152:155], v[196:199]
    buffer_load_dwordx4 v109, s[24:27], s35 offen offset:1024 lds
    v_mfma_f32_16x16x32_bf16 v[196:199], v[92:95], a[156:159], v[196:199]
    s_sub_u32 s35, s35, s37
    v_mfma_f32_16x16x32_bf16 v[204:207], v[80:83], a[208:211], v[204:207]
    buffer_load_dwordx4 v108, s[24:27], s35 offen offset:2048 lds
    v_mfma_f32_16x16x32_bf16 v[204:207], v[84:87], a[212:215], v[204:207]
    s_add_u32 s35, s35, s36
    v_mfma_f32_16x16x32_bf16 v[204:207], v[88:91], a[216:219], v[204:207]
    buffer_load_dwordx4 v109, s[24:27], s35 offen offset:3072 lds
    v_mfma_f32_16x16x32_bf16 v[204:207], v[92:95], a[220:223], v[204:207]
    s_waitcnt lgkmcnt(0)
    s_add_u32 m0, s64, 65536
    s_mul_i32 s35, s100, 1
    v_mfma_f32_16x16x32_bf16 v[0:3], v[64:67], a[16:19], v[0:3]
    ds_read_b64_tr_b16 v[80:81], v119 offset:16384
    s_add_u32 s35, s35, s38
    v_mfma_f32_16x16x32_bf16 v[0:3], v[68:71], a[20:23], v[0:3]
    ds_read_b64_tr_b16 v[82:83], v119 offset:18432
    s_add_u32 s35, s35, s65
    v_mfma_f32_16x16x32_bf16 v[0:3], v[72:75], a[24:27], v[0:3]
    ds_read_b64_tr_b16 v[84:85], v119 offset:20480
    s_waitcnt vmcnt(8)
    v_mfma_f32_16x16x32_bf16 v[0:3], v[76:79], a[28:31], v[0:3]
    ds_read_b128 a[40:43], v114 offset:0
    ds_read_b128 a[104:107], v114 offset:2048
    v_mfma_f32_16x16x32_bf16 v[8:11], v[64:67], a[80:83], v[8:11]
    ds_read_b64_tr_b16 v[86:87], v119 offset:22528
    v_mfma_f32_16x16x32_bf16 v[8:11], v[68:71], a[84:87], v[8:11]
    ds_read_b64_tr_b16 v[88:89], v119 offset:24576
    v_mfma_f32_16x16x32_bf16 v[8:11], v[72:75], a[88:91], v[8:11]
    ds_read_b64_tr_b16 v[90:91], v119 offset:26624
    v_mfma_f32_16x16x32_bf16 v[8:11], v[76:79], a[92:95], v[8:11]
    ds_read_b128 a[168:171], v114 offset:4096
    ds_read_b128 a[232:235], v114 offset:6144
    v_mfma_f32_16x16x32_bf16 v[16:19], v[64:67], a[144:147], v[16:19]
    ds_read_b64_tr_b16 v[92:93], v119 offset:28672
    v_mfma_f32_16x16x32_bf16 v[16:19], v[68:71], a[148:151], v[16:19]
    ds_read_b64_tr_b16 v[94:95], v119 offset:30720
    v_mfma_f32_16x16x32_bf16 v[16:19], v[72:75], a[152:155], v[16:19]
    ds_read_b128 a[44:47], v115 offset:0
    ds_read_b128 a[108:111], v115 offset:2048
    v_mfma_f32_16x16x32_bf16 v[16:19], v[76:79], a[156:159], v[16:19]
    ds_read_b128 a[172:175], v115 offset:4096
    ds_read_b128 a[236:239], v115 offset:6144
    v_mfma_f32_16x16x32_bf16 v[24:27], v[64:67], a[208:211], v[24:27]
    buffer_load_dwordx4 v108, s[24:27], s35 offen offset:0 lds
    v_mfma_f32_16x16x32_bf16 v[24:27], v[68:71], a[212:215], v[24:27]
    s_add_u32 s35, s35, s36
    v_mfma_f32_16x16x32_bf16 v[24:27], v[72:75], a[216:219], v[24:27]
    buffer_load_dwordx4 v109, s[24:27], s35 offen offset:1024 lds
    v_mfma_f32_16x16x32_bf16 v[24:27], v[76:79], a[220:223], v[24:27]
    s_waitcnt lgkmcnt(0)
    s_sub_u32 s35, s35, s37
    v_mfma_f32_16x16x32_bf16 v[4:7], v[80:83], a[16:19], v[4:7]
    ds_read_b64_tr_b16 v[64:65], v120 offset:16384
    v_mfma_f32_16x16x32_bf16 v[4:7], v[84:87], a[20:23], v[4:7]
    ds_read_b64_tr_b16 v[66:67], v120 offset:18432
    v_mfma_f32_16x16x32_bf16 v[4:7], v[88:91], a[24:27], v[4:7]
    ds_read_b64_tr_b16 v[68:69], v120 offset:20480
    v_mfma_f32_16x16x32_bf16 v[4:7], v[92:95], a[28:31], v[4:7]
    buffer_load_dwordx4 v108, s[24:27], s35 offen offset:2048 lds
    v_mfma_f32_16x16x32_bf16 v[12:15], v[80:83], a[80:83], v[12:15]
    ds_read_b64_tr_b16 v[70:71], v120 offset:22528
    s_add_u32 s35, s35, s36
    v_mfma_f32_16x16x32_bf16 v[12:15], v[84:87], a[84:87], v[12:15]
    ds_read_b64_tr_b16 v[72:73], v120 offset:24576
    v_mfma_f32_16x16x32_bf16 v[12:15], v[88:91], a[88:91], v[12:15]
    ds_read_b64_tr_b16 v[74:75], v120 offset:26624
    v_mfma_f32_16x16x32_bf16 v[12:15], v[92:95], a[92:95], v[12:15]
    buffer_load_dwordx4 v109, s[24:27], s35 offen offset:3072 lds
    v_mfma_f32_16x16x32_bf16 v[20:23], v[80:83], a[144:147], v[20:23]
    ds_read_b64_tr_b16 v[76:77], v120 offset:28672
    s_add_u32 m0, m0, 4096
    v_mfma_f32_16x16x32_bf16 v[20:23], v[84:87], a[148:151], v[20:23]
    ds_read_b64_tr_b16 v[78:79], v120 offset:30720
    s_add_u32 s35, s35, s47
    v_mfma_f32_16x16x32_bf16 v[20:23], v[88:91], a[152:155], v[20:23]
    buffer_load_dwordx4 v108, s[24:27], s35 offen offset:0 lds
    v_mfma_f32_16x16x32_bf16 v[20:23], v[92:95], a[156:159], v[20:23]
    s_add_u32 s35, s35, s36
    v_mfma_f32_16x16x32_bf16 v[28:31], v[80:83], a[208:211], v[28:31]
    buffer_load_dwordx4 v109, s[24:27], s35 offen offset:1024 lds
    v_mfma_f32_16x16x32_bf16 v[28:31], v[84:87], a[212:215], v[28:31]
    s_sub_u32 s35, s35, s37
    v_mfma_f32_16x16x32_bf16 v[28:31], v[88:91], a[216:219], v[28:31]
    buffer_load_dwordx4 v108, s[24:27], s35 offen offset:2048 lds
    v_mfma_f32_16x16x32_bf16 v[28:31], v[92:95], a[220:223], v[28:31]
    s_waitcnt lgkmcnt(0)
    s_add_u32 s35, s35, s36
    v_mfma_f32_16x16x32_bf16 v[32:35], v[64:67], a[16:19], v[32:35]
    ds_read_b64_tr_b16 v[80:81], v121 offset:16384
    v_mfma_f32_16x16x32_bf16 v[32:35], v[68:71], a[20:23], v[32:35]
    ds_read_b64_tr_b16 v[82:83], v121 offset:18432
    v_mfma_f32_16x16x32_bf16 v[32:35], v[72:75], a[24:27], v[32:35]
    ds_read_b64_tr_b16 v[84:85], v121 offset:20480
    v_mfma_f32_16x16x32_bf16 v[32:35], v[76:79], a[28:31], v[32:35]
    buffer_load_dwordx4 v109, s[24:27], s35 offen offset:3072 lds
    v_mfma_f32_16x16x32_bf16 v[40:43], v[64:67], a[80:83], v[40:43]
    ds_read_b64_tr_b16 v[86:87], v121 offset:22528
    s_add_u32 s62, s63, 768
    v_mfma_f32_16x16x32_bf16 v[40:43], v[68:71], a[84:87], v[40:43]
    ds_read_b64_tr_b16 v[88:89], v121 offset:24576
    s_add_u32 m0, s64, 0
    v_mfma_f32_16x16x32_bf16 v[40:43], v[72:75], a[88:91], v[40:43]
    ds_read_b64_tr_b16 v[90:91], v121 offset:26624
    s_nop 0
    v_mfma_f32_16x16x32_bf16 v[40:43], v[76:79], a[92:95], v[40:43]
    buffer_load_dwordx4 v112, s[20:23], s62 offen offset:0 lds
    v_mfma_f32_16x16x32_bf16 v[48:51], v[64:67], a[144:147], v[48:51]
    ds_read_b64_tr_b16 v[92:93], v121 offset:28672
    s_add_u32 s62, s62, 7168
    v_mfma_f32_16x16x32_bf16 v[48:51], v[68:71], a[148:151], v[48:51]
    ds_read_b64_tr_b16 v[94:95], v121 offset:30720
    v_mfma_f32_16x16x32_bf16 v[48:51], v[72:75], a[152:155], v[48:51]
    s_waitcnt vmcnt(9)
    s_barrier
    v_mfma_f32_16x16x32_bf16 v[48:51], v[76:79], a[156:159], v[48:51]
    buffer_load_dwordx4 v113, s[20:23], s62 offen offset:1024 lds
    v_mfma_f32_16x16x32_bf16 v[56:59], v[64:67], a[208:211], v[56:59]
    s_add_u32 s62, s62, 7168
    v_mfma_f32_16x16x32_bf16 v[56:59], v[68:71], a[212:215], v[56:59]
    buffer_load_dwordx4 v112, s[20:23], s62 offen offset:2048 lds
    v_mfma_f32_16x16x32_bf16 v[56:59], v[72:75], a[216:219], v[56:59]
    s_add_u32 s62, s62, 7168
    v_mfma_f32_16x16x32_bf16 v[56:59], v[76:79], a[220:223], v[56:59]
    s_waitcnt lgkmcnt(0)
    buffer_load_dwordx4 v113, s[20:23], s62 offen offset:3072 lds
    v_mfma_f32_16x16x32_bf16 v[36:39], v[80:83], a[16:19], v[36:39]
    ds_read_b64_tr_b16 v[64:65], v122 offset:0
    s_add_u32 m0, s64, 4096
    v_mfma_f32_16x16x32_bf16 v[36:39], v[84:87], a[20:23], v[36:39]
    ds_read_b64_tr_b16 v[66:67], v122 offset:2048
    s_add_u32 s62, s62, 11264
    v_mfma_f32_16x16x32_bf16 v[36:39], v[88:91], a[24:27], v[36:39]
    ds_read_b64_tr_b16 v[68:69], v122 offset:4096
    v_mfma_f32_16x16x32_bf16 v[36:39], v[92:95], a[28:31], v[36:39]
    buffer_load_dwordx4 v112, s[20:23], s62 offen offset:0 lds
    v_mfma_f32_16x16x32_bf16 v[44:47], v[80:83], a[80:83], v[44:47]
    ds_read_b64_tr_b16 v[70:71], v122 offset:6144
    s_add_u32 s62, s62, 7168
    v_mfma_f32_16x16x32_bf16 v[44:47], v[84:87], a[84:87], v[44:47]
    ds_read_b64_tr_b16 v[72:73], v122 offset:8192
    v_mfma_f32_16x16x32_bf16 v[44:47], v[88:91], a[88:91], v[44:47]
    ds_read_b64_tr_b16 v[74:75], v122 offset:10240
    v_mfma_f32_16x16x32_bf16 v[44:47], v[92:95], a[92:95], v[44:47]
    buffer_load_dwordx4 v113, s[20:23], s62 offen offset:1024 lds
    v_mfma_f32_16x16x32_bf16 v[52:55], v[80:83], a[144:147], v[52:55]
    ds_read_b64_tr_b16 v[76:77], v122 offset:12288
    s_add_u32 s62, s62, 7168
    v_mfma_f32_16x16x32_bf16 v[52:55], v[84:87], a[148:151], v[52:55]
    ds_read_b64_tr_b16 v[78:79], v122 offset:14336
    v_mfma_f32_16x16x32_bf16 v[52:55], v[88:91], a[152:155], v[52:55]
    buffer_load_dwordx4 v112, s[20:23], s62 offen offset:2048 lds
    v_mfma_f32_16x16x32_bf16 v[52:55], v[92:95], a[156:159], v[52:55]
    s_add_u32 s62, s62, 7168
    v_mfma_f32_16x16x32_bf16 v[60:63], v[80:83], a[208:211], v[60:63]
    buffer_load_dwordx4 v113, s[20:23], s62 offen offset:3072 lds
    v_mfma_f32_16x16x32_bf16 v[60:63], v[84:87], a[212:215], v[60:63]
    s_add_u32 m0, s64, 98304
    s_mul_i32 s35, s100, 2
    v_mfma_f32_16x16x32_bf16 v[60:63], v[88:91], a[216:219], v[60:63]
    s_add_u32 s35, s35, s38
    v_mfma_f32_16x16x32_bf16 v[60:63], v[92:95], a[220:223], v[60:63]
    s_waitcnt lgkmcnt(0)
    buffer_load_dwordx4 v108, s[24:27], s35 offen offset:0 lds
    v_mfma_f32_16x16x32_bf16 v[144:147], v[64:67], a[32:35], v[144:147]
    ds_read_b64_tr_b16 v[80:81], v123 offset:0
    s_add_u32 s35, s35, s36
    v_mfma_f32_16x16x32_bf16 v[144:147], v[68:71], a[36:39], v[144:147]
    ds_read_b64_tr_b16 v[82:83], v123 offset:2048
    v_mfma_f32_16x16x32_bf16 v[144:147], v[72:75], a[40:43], v[144:147]
    ds_read_b64_tr_b16 v[84:85], v123 offset:4096
    v_mfma_f32_16x16x32_bf16 v[144:147], v[76:79], a[44:47], v[144:147]
    buffer_load_dwordx4 v109, s[24:27], s35 offen offset:1024 lds
    v_mfma_f32_16x16x32_bf16 v[152:155], v[64:67], a[96:99], v[152:155]
    ds_read_b64_tr_b16 v[86:87], v123 offset:6144
    s_sub_u32 s35, s35, s37
    v_mfma_f32_16x16x32_bf16 v[152:155], v[68:71], a[100:103], v[152:155]
    ds_read_b64_tr_b16 v[88:89], v123 offset:8192
    v_mfma_f32_16x16x32_bf16 v[152:155], v[72:75], a[104:107], v[152:155]
    ds_read_b64_tr_b16 v[90:91], v123 offset:10240
    v_mfma_f32_16x16x32_bf16 v[152:155], v[76:79], a[108:111], v[152:155]
    buffer_load_dwordx4 v108, s[24:27], s35 offen offset:2048 lds
    v_mfma_f32_16x16x32_bf16 v[160:163], v[64:67], a[160:163], v[160:163]
    ds_read_b64_tr_b16 v[92:93], v123 offset:12288
    s_add_u32 s35, s35, s36
    v_mfma_f32_16x16x32_bf16 v[160:163], v[68:71], a[164:167], v[160:163]
    ds_read_b64_tr_b16 v[94:95], v123 offset:14336
    v_mfma_f32_16x16x32_bf16 v[160:163], v[72:75], a[168:171], v[160:163]
    buffer_load_dwordx4 v109, s[24:27], s35 offen offset:3072 lds
    v_mfma_f32_16x16x32_bf16 v[160:163], v[76:79], a[172:175], v[160:163]
    s_add_u32 m0, m0, 4096
    s_add_u32 s35, s35, s47
    v_mfma_f32_16x16x32_bf16 v[168:171], v[64:67], a[224:227], v[168:171]
    buffer_load_dwordx4 v108, s[24:27], s35 offen offset:0 lds
    v_mfma_f32_16x16x32_bf16 v[168:171], v[68:71], a[228:231], v[168:171]
    s_add_u32 s35, s35, s36
    v_mfma_f32_16x16x32_bf16 v[168:171], v[72:75], a[232:235], v[168:171]
    buffer_load_dwordx4 v109, s[24:27], s35 offen offset:1024 lds
    v_mfma_f32_16x16x32_bf16 v[168:171], v[76:79], a[236:239], v[168:171]
    s_waitcnt lgkmcnt(0)
    s_sub_u32 s35, s35, s37
    v_mfma_f32_16x16x32_bf16 v[148:151], v[80:83], a[32:35], v[148:151]
    ds_read_b64_tr_b16 v[64:65], v124 offset:0
    v_mfma_f32_16x16x32_bf16 v[148:151], v[84:87], a[36:39], v[148:151]
    ds_read_b64_tr_b16 v[66:67], v124 offset:2048
    v_mfma_f32_16x16x32_bf16 v[148:151], v[88:91], a[40:43], v[148:151]
    ds_read_b64_tr_b16 v[68:69], v124 offset:4096
    s_waitcnt vmcnt(6)
    v_mfma_f32_16x16x32_bf16 v[148:151], v[92:95], a[44:47], v[148:151]
    ds_read_b128 a[48:51], v114 offset:0
    ds_read_b128 a[112:115], v114 offset:2048
    v_mfma_f32_16x16x32_bf16 v[156:159], v[80:83], a[96:99], v[156:159]
    ds_read_b64_tr_b16 v[70:71], v124 offset:6144
    v_mfma_f32_16x16x32_bf16 v[156:159], v[84:87], a[100:103], v[156:159]
    ds_read_b64_tr_b16 v[72:73], v124 offset:8192
    v_mfma_f32_16x16x32_bf16 v[156:159], v[88:91], a[104:107], v[156:159]
    ds_read_b64_tr_b16 v[74:75], v124 offset:10240
    v_mfma_f32_16x16x32_bf16 v[156:159], v[92:95], a[108:111], v[156:159]
    ds_read_b128 a[176:179], v114 offset:4096
    ds_read_b128 a[240:243], v114 offset:6144
    v_mfma_f32_16x16x32_bf16 v[164:167], v[80:83], a[160:163], v[164:167]
    ds_read_b64_tr_b16 v[76:77], v124 offset:12288
    v_mfma_f32_16x16x32_bf16 v[164:167], v[84:87], a[164:167], v[164:167]
    ds_read_b64_tr_b16 v[78:79], v124 offset:14336
    v_mfma_f32_16x16x32_bf16 v[164:167], v[88:91], a[168:171], v[164:167]
    ds_read_b128 a[52:55], v115 offset:0
    ds_read_b128 a[116:119], v115 offset:2048
    v_mfma_f32_16x16x32_bf16 v[164:167], v[92:95], a[172:175], v[164:167]
    ds_read_b128 a[180:183], v115 offset:4096
    ds_read_b128 a[244:247], v115 offset:6144
    v_mfma_f32_16x16x32_bf16 v[172:175], v[80:83], a[224:227], v[172:175]
    buffer_load_dwordx4 v108, s[24:27], s35 offen offset:2048 lds
    v_mfma_f32_16x16x32_bf16 v[172:175], v[84:87], a[228:231], v[172:175]
    s_add_u32 s35, s35, s36
    v_mfma_f32_16x16x32_bf16 v[172:175], v[88:91], a[232:235], v[172:175]
    buffer_load_dwordx4 v109, s[24:27], s35 offen offset:3072 lds
    v_mfma_f32_16x16x32_bf16 v[172:175], v[92:95], a[236:239], v[172:175]
    s_waitcnt lgkmcnt(0)
    v_mfma_f32_16x16x32_bf16 v[176:179], v[64:67], a[32:35], v[176:179]
    ds_read_b64_tr_b16 v[80:81], v125 offset:0
    s_add_u32 s62, s63, 896
    v_mfma_f32_16x16x32_bf16 v[176:179], v[68:71], a[36:39], v[176:179]
    ds_read_b64_tr_b16 v[82:83], v125 offset:2048
    s_add_u32 m0, s64, 0
    v_mfma_f32_16x16x32_bf16 v[176:179], v[72:75], a[40:43], v[176:179]
    ds_read_b64_tr_b16 v[84:85], v125 offset:4096
    s_nop 0
    v_mfma_f32_16x16x32_bf16 v[176:179], v[76:79], a[44:47], v[176:179]
    buffer_load_dwordx4 v112, s[20:23], s62 offen offset:0 lds
    v_mfma_f32_16x16x32_bf16 v[184:187], v[64:67], a[96:99], v[184:187]
    ds_read_b64_tr_b16 v[86:87], v125 offset:6144
    s_add_u32 s62, s62, 7168
    v_mfma_f32_16x16x32_bf16 v[184:187], v[68:71], a[100:103], v[184:187]
    ds_read_b64_tr_b16 v[88:89], v125 offset:8192
    v_mfma_f32_16x16x32_bf16 v[184:187], v[72:75], a[104:107], v[184:187]
    ds_read_b64_tr_b16 v[90:91], v125 offset:10240
    v_mfma_f32_16x16x32_bf16 v[184:187], v[76:79], a[108:111], v[184:187]
    buffer_load_dwordx4 v113, s[20:23], s62 offen offset:1024 lds
    v_mfma_f32_16x16x32_bf16 v[192:195], v[64:67], a[160:163], v[192:195]
    ds_read_b64_tr_b16 v[92:93], v125 offset:12288
    s_add_u32 s62, s62, 7168
    v_mfma_f32_16x16x32_bf16 v[192:195], v[68:71], a[164:167], v[192:195]
    ds_read_b64_tr_b16 v[94:95], v125 offset:14336
    v_mfma_f32_16x16x32_bf16 v[192:195], v[72:75], a[168:171], v[192:195]
    buffer_load_dwordx4 v112, s[20:23], s62 offen offset:2048 lds
    v_mfma_f32_16x16x32_bf16 v[192:195], v[76:79], a[172:175], v[192:195]
    s_add_u32 s62, s62, 7168
    v_mfma_f32_16x16x32_bf16 v[200:203], v[64:67], a[224:227], v[200:203]
    buffer_load_dwordx4 v113, s[20:23], s62 offen offset:3072 lds
    v_mfma_f32_16x16x32_bf16 v[200:203], v[68:71], a[228:231], v[200:203]
    s_add_u32 m0, s64, 4096
    s_add_u32 s62, s62, 11264
    v_mfma_f32_16x16x32_bf16 v[200:203], v[72:75], a[232:235], v[200:203]
    s_waitcnt vmcnt(20)
    s_barrier
    v_mfma_f32_16x16x32_bf16 v[200:203], v[76:79], a[236:239], v[200:203]
    s_waitcnt lgkmcnt(0)
    buffer_load_dwordx4 v112, s[20:23], s62 offen offset:0 lds
    v_mfma_f32_16x16x32_bf16 v[180:183], v[80:83], a[32:35], v[180:183]
    ds_read_b64_tr_b16 v[64:65], v122 offset:32768
    s_add_u32 s62, s62, 7168
    v_mfma_f32_16x16x32_bf16 v[180:183], v[84:87], a[36:39], v[180:183]
    ds_read_b64_tr_b16 v[66:67], v122 offset:34816
    v_mfma_f32_16x16x32_bf16 v[180:183], v[88:91], a[40:43], v[180:183]
    ds_read_b64_tr_b16 v[68:69], v122 offset:36864
    v_mfma_f32_16x16x32_bf16 v[180:183], v[92:95], a[44:47], v[180:183]
    buffer_load_dwordx4 v113, s[20:23], s62 offen offset:1024 lds
    v_mfma_f32_16x16x32_bf16 v[188:191], v[80:83], a[96:99], v[188:191]
    ds_read_b64_tr_b16 v[70:71], v122 offset:38912
    s_add_u32 s62, s62, 7168
    v_mfma_f32_16x16x32_bf16 v[188:191], v[84:87], a[100:103], v[188:191]
    ds_read_b64_tr_b16 v[72:73], v122 offset:40960
    v_mfma_f32_16x16x32_bf16 v[188:191], v[88:91], a[104:107], v[188:191]
    ds_read_b64_tr_b16 v[74:75], v122 offset:43008
    v_mfma_f32_16x16x32_bf16 v[188:191], v[92:95], a[108:111], v[188:191]
    buffer_load_dwordx4 v112, s[20:23], s62 offen offset:2048 lds
    v_mfma_f32_16x16x32_bf16 v[196:199], v[80:83], a[160:163], v[196:199]
    ds_read_b64_tr_b16 v[76:77], v122 offset:45056
    s_add_u32 s62, s62, 7168
    v_mfma_f32_16x16x32_bf16 v[196:199], v[84:87], a[164:167], v[196:199]
    ds_read_b64_tr_b16 v[78:79], v122 offset:47104
    v_mfma_f32_16x16x32_bf16 v[196:199], v[88:91], a[168:171], v[196:199]
    buffer_load_dwordx4 v113, s[20:23], s62 offen offset:3072 lds
    v_mfma_f32_16x16x32_bf16 v[196:199], v[92:95], a[172:175], v[196:199]
    s_add_u32 m0, s64, 4294934528
    s_mul_i32 s35, s100, 2
    v_mfma_f32_16x16x32_bf16 v[204:207], v[80:83], a[224:227], v[204:207]
    s_add_u32 s35, s35, s38
    s_add_u32 s35, s35, s65
    v_mfma_f32_16x16x32_bf16 v[204:207], v[84:87], a[228:231], v[204:207]
    v_mfma_f32_16x16x32_bf16 v[204:207], v[88:91], a[232:235], v[204:207]
    buffer_load_dwordx4 v108, s[24:27], s35 offen offset:0 lds
    v_mfma_f32_16x16x32_bf16 v[204:207], v[92:95], a[236:239], v[204:207]
    s_waitcnt lgkmcnt(0)
    s_add_u32 s35, s35, s36
    v_mfma_f32_16x16x32_bf16 v[0:3], v[64:67], a[32:35], v[0:3]
    ds_read_b64_tr_b16 v[80:81], v123 offset:32768
    v_mfma_f32_16x16x32_bf16 v[0:3], v[68:71], a[36:39], v[0:3]
    ds_read_b64_tr_b16 v[82:83], v123 offset:34816
    v_mfma_f32_16x16x32_bf16 v[0:3], v[72:75], a[40:43], v[0:3]
    ds_read_b64_tr_b16 v[84:85], v123 offset:36864
    v_mfma_f32_16x16x32_bf16 v[0:3], v[76:79], a[44:47], v[0:3]
    buffer_load_dwordx4 v109, s[24:27], s35 offen offset:1024 lds
    v_mfma_f32_16x16x32_bf16 v[8:11], v[64:67], a[96:99], v[8:11]
    ds_read_b64_tr_b16 v[86:87], v123 offset:38912
    s_sub_u32 s35, s35, s37
    v_mfma_f32_16x16x32_bf16 v[8:11], v[68:71], a[100:103], v[8:11]
    ds_read_b64_tr_b16 v[88:89], v123 offset:40960
    v_mfma_f32_16x16x32_bf16 v[8:11], v[72:75], a[104:107], v[8:11]
    ds_read_b64_tr_b16 v[90:91], v123 offset:43008
    v_mfma_f32_16x16x32_bf16 v[8:11], v[76:79], a[108:111], v[8:11]
    buffer_load_dwordx4 v108, s[24:27], s35 offen offset:2048 lds
    v_mfma_f32_16x16x32_bf16 v[16:19], v[64:67], a[160:163], v[16:19]
    ds_read_b64_tr_b16 v[92:93], v123 offset:45056
    s_add_u32 s35, s35, s36
    v_mfma_f32_16x16x32_bf16 v[16:19], v[68:71], a[164:167], v[16:19]
    ds_read_b64_tr_b16 v[94:95], v123 offset:47104
    v_mfma_f32_16x16x32_bf16 v[16:19], v[72:75], a[168:171], v[16:19]
    v_mfma_f32_16x16x32_bf16 v[16:19], v[76:79], a[172:175], v[16:19]
    buffer_load_dwordx4 v109, s[24:27], s35 offen offset:3072 lds
    v_mfma_f32_16x16x32_bf16 v[24:27], v[64:67], a[224:227], v[24:27]
    s_add_u32 m0, m0, 4096
    s_add_u32 s35, s35, s47
    v_mfma_f32_16x16x32_bf16 v[24:27], v[68:71], a[228:231], v[24:27]
    v_mfma_f32_16x16x32_bf16 v[24:27], v[72:75], a[232:235], v[24:27]
    v_mfma_f32_16x16x32_bf16 v[24:27], v[76:79], a[236:239], v[24:27]
    s_waitcnt lgkmcnt(0)
    buffer_load_dwordx4 v108, s[24:27], s35 offen offset:0 lds
    v_mfma_f32_16x16x32_bf16 v[4:7], v[80:83], a[32:35], v[4:7]
    ds_read_b64_tr_b16 v[64:65], v124 offset:32768
    s_add_u32 s35, s35, s36
    v_mfma_f32_16x16x32_bf16 v[4:7], v[84:87], a[36:39], v[4:7]
    ds_read_b64_tr_b16 v[66:67], v124 offset:34816
    v_mfma_f32_16x16x32_bf16 v[4:7], v[88:91], a[40:43], v[4:7]
    ds_read_b64_tr_b16 v[68:69], v124 offset:36864
    v_mfma_f32_16x16x32_bf16 v[4:7], v[92:95], a[44:47], v[4:7]
    buffer_load_dwordx4 v109, s[24:27], s35 offen offset:1024 lds
    v_mfma_f32_16x16x32_bf16 v[12:15], v[80:83], a[96:99], v[12:15]
    ds_read_b64_tr_b16 v[70:71], v124 offset:38912
    s_sub_u32 s35, s35, s37
    v_mfma_f32_16x16x32_bf16 v[12:15], v[84:87], a[100:103], v[12:15]
    ds_read_b64_tr_b16 v[72:73], v124 offset:40960
    v_mfma_f32_16x16x32_bf16 v[12:15], v[88:91], a[104:107], v[12:15]
    ds_read_b64_tr_b16 v[74:75], v124 offset:43008
    v_mfma_f32_16x16x32_bf16 v[12:15], v[92:95], a[108:111], v[12:15]
    buffer_load_dwordx4 v108, s[24:27], s35 offen offset:2048 lds
    v_mfma_f32_16x16x32_bf16 v[20:23], v[80:83], a[160:163], v[20:23]
    ds_read_b64_tr_b16 v[76:77], v124 offset:45056
    s_add_u32 s35, s35, s36
    v_mfma_f32_16x16x32_bf16 v[20:23], v[84:87], a[164:167], v[20:23]
    ds_read_b64_tr_b16 v[78:79], v124 offset:47104
    v_mfma_f32_16x16x32_bf16 v[20:23], v[88:91], a[168:171], v[20:23]
    v_mfma_f32_16x16x32_bf16 v[20:23], v[92:95], a[172:175], v[20:23]
    buffer_load_dwordx4 v109, s[24:27], s35 offen offset:3072 lds
    v_mfma_f32_16x16x32_bf16 v[28:31], v[80:83], a[224:227], v[28:31]
    v_mfma_f32_16x16x32_bf16 v[28:31], v[84:87], a[228:231], v[28:31]
    v_mfma_f32_16x16x32_bf16 v[28:31], v[88:91], a[232:235], v[28:31]
    v_mfma_f32_16x16x32_bf16 v[28:31], v[92:95], a[236:239], v[28:31]
    s_waitcnt lgkmcnt(0)
    buffer_load_dword v136, v138, s[24:27], 0 offen
    v_mfma_f32_16x16x32_bf16 v[32:35], v[64:67], a[32:35], v[32:35]
    ds_read_b64_tr_b16 v[80:81], v125 offset:32768
    v_mfma_f32_16x16x32_bf16 v[32:35], v[68:71], a[36:39], v[32:35]
    ds_read_b64_tr_b16 v[82:83], v125 offset:34816
    v_mfma_f32_16x16x32_bf16 v[32:35], v[72:75], a[40:43], v[32:35]
    ds_read_b64_tr_b16 v[84:85], v125 offset:36864
    v_mfma_f32_16x16x32_bf16 v[32:35], v[76:79], a[44:47], v[32:35]
    v_mfma_f32_16x16x32_bf16 v[40:43], v[64:67], a[96:99], v[40:43]
    ds_read_b64_tr_b16 v[86:87], v125 offset:38912
    v_mfma_f32_16x16x32_bf16 v[40:43], v[68:71], a[100:103], v[40:43]
    ds_read_b64_tr_b16 v[88:89], v125 offset:40960
    v_mfma_f32_16x16x32_bf16 v[40:43], v[72:75], a[104:107], v[40:43]
    ds_read_b64_tr_b16 v[90:91], v125 offset:43008
    v_mfma_f32_16x16x32_bf16 v[40:43], v[76:79], a[108:111], v[40:43]
    v_mfma_f32_16x16x32_bf16 v[48:51], v[64:67], a[160:163], v[48:51]
    ds_read_b64_tr_b16 v[92:93], v125 offset:45056
    v_mfma_f32_16x16x32_bf16 v[48:51], v[68:71], a[164:167], v[48:51]
    ds_read_b64_tr_b16 v[94:95], v125 offset:47104
    v_mfma_f32_16x16x32_bf16 v[48:51], v[72:75], a[168:171], v[48:51]
    v_mfma_f32_16x16x32_bf16 v[48:51], v[76:79], a[172:175], v[48:51]
    v_mfma_f32_16x16x32_bf16 v[56:59], v[64:67], a[224:227], v[56:59]
    v_mfma_f32_16x16x32_bf16 v[56:59], v[68:71], a[228:231], v[56:59]
    v_mfma_f32_16x16x32_bf16 v[56:59], v[72:75], a[232:235], v[56:59]
    v_mfma_f32_16x16x32_bf16 v[56:59], v[76:79], a[236:239], v[56:59]
    s_waitcnt lgkmcnt(0)
    v_mfma_f32_16x16x32_bf16 v[36:39], v[80:83], a[32:35], v[36:39]
    ds_read_b64_tr_b16 v[64:65], v122 offset:16384
    v_mfma_f32_16x16x32_bf16 v[36:39], v[84:87], a[36:39], v[36:39]
    ds_read_b64_tr_b16 v[66:67], v122 offset:18432
    v_mfma_f32_16x16x32_bf16 v[36:39], v[88:91], a[40:43], v[36:39]
    ds_read_b64_tr_b16 v[68:69], v122 offset:20480
    s_waitcnt vmcnt(9)
    v_mfma_f32_16x16x32_bf16 v[36:39], v[92:95], a[44:47], v[36:39]
    ds_read_b128 a[56:59], v114 offset:0
    ds_read_b128 a[120:123], v114 offset:2048
    v_mfma_f32_16x16x32_bf16 v[44:47], v[80:83], a[96:99], v[44:47]
    ds_read_b64_tr_b16 v[70:71], v122 offset:22528
    v_mfma_f32_16x16x32_bf16 v[44:47], v[84:87], a[100:103], v[44:47]
    ds_read_b64_tr_b16 v[72:73], v122 offset:24576
    v_mfma_f32_16x16x32_bf16 v[44:47], v[88:91], a[104:107], v[44:47]
    ds_read_b64_tr_b16 v[74:75], v122 offset:26624
    v_mfma_f32_16x16x32_bf16 v[44:47], v[92:95], a[108:111], v[44:47]
    ds_read_b128 a[184:187], v114 offset:4096
    ds_read_b128 a[248:251], v114 offset:6144
    v_mfma_f32_16x16x32_bf16 v[52:55], v[80:83], a[160:163], v[52:55]
    ds_read_b64_tr_b16 v[76:77], v122 offset:28672
    v_mfma_f32_16x16x32_bf16 v[52:55], v[84:87], a[164:167], v[52:55]
    ds_read_b64_tr_b16 v[78:79], v122 offset:30720
    v_mfma_f32_16x16x32_bf16 v[52:55], v[88:91], a[168:171], v[52:55]
    ds_read_b128 a[60:63], v115 offset:0
    ds_read_b128 a[124:127], v115 offset:2048
    v_mfma_f32_16x16x32_bf16 v[52:55], v[92:95], a[172:175], v[52:55]
    ds_read_b128 a[188:191], v115 offset:4096
    ds_read_b128 a[252:255], v115 offset:6144
    v_mfma_f32_16x16x32_bf16 v[60:63], v[80:83], a[224:227], v[60:63]
    v_mfma_f32_16x16x32_bf16 v[60:63], v[84:87], a[228:231], v[60:63]
    v_mfma_f32_16x16x32_bf16 v[60:63], v[88:91], a[232:235], v[60:63]
    v_mfma_f32_16x16x32_bf16 v[60:63], v[92:95], a[236:239], v[60:63]
    s_waitcnt lgkmcnt(0)
    v_mfma_f32_16x16x32_bf16 v[144:147], v[64:67], a[48:51], v[144:147]
    ds_read_b64_tr_b16 v[80:81], v123 offset:16384
    s_add_u32 m0, s64, 0
    v_mfma_f32_16x16x32_bf16 v[144:147], v[68:71], a[52:55], v[144:147]
    ds_read_b64_tr_b16 v[82:83], v123 offset:18432
    s_mul_i32 s35, s100, 3
    v_mfma_f32_16x16x32_bf16 v[144:147], v[72:75], a[56:59], v[144:147]
    ds_read_b64_tr_b16 v[84:85], v123 offset:20480
    s_add_u32 s35, s35, s38
    v_mfma_f32_16x16x32_bf16 v[144:147], v[76:79], a[60:63], v[144:147]
    buffer_load_dwordx4 v108, s[24:27], s35 offen offset:0 lds
    v_mfma_f32_16x16x32_bf16 v[152:155], v[64:67], a[112:115], v[152:155]
    ds_read_b64_tr_b16 v[86:87], v123 offset:22528
    s_add_u32 s35, s35, s36
    v_mfma_f32_16x16x32_bf16 v[152:155], v[68:71], a[116:119], v[152:155]
    ds_read_b64_tr_b16 v[88:89], v123 offset:24576
    v_mfma_f32_16x16x32_bf16 v[152:155], v[72:75], a[120:123], v[152:155]
    ds_read_b64_tr_b16 v[90:91], v123 offset:26624
    v_mfma_f32_16x16x32_bf16 v[152:155], v[76:79], a[124:127], v[152:155]
    buffer_load_dwordx4 v109, s[24:27], s35 offen offset:1024 lds
    v_mfma_f32_16x16x32_bf16 v[160:163], v[64:67], a[176:179], v[160:163]
    ds_read_b64_tr_b16 v[92:93], v123 offset:28672
    s_sub_u32 s35, s35, s37
    v_mfma_f32_16x16x32_bf16 v[160:163], v[68:71], a[180:183], v[160:163]
    ds_read_b64_tr_b16 v[94:95], v123 offset:30720
    v_mfma_f32_16x16x32_bf16 v[160:163], v[72:75], a[184:187], v[160:163]
    v_mfma_f32_16x16x32_bf16 v[160:163], v[76:79], a[188:191], v[160:163]
    buffer_load_dwordx4 v108, s[24:27], s35 offen offset:2048 lds
    v_mfma_f32_16x16x32_bf16 v[168:171], v[64:67], a[240:243], v[168:171]
    s_add_u32 s35, s35, s36
    v_mfma_f32_16x16x32_bf16 v[168:171], v[68:71], a[244:247], v[168:171]
    v_mfma_f32_16x16x32_bf16 v[168:171], v[72:75], a[248:251], v[168:171]
    v_mfma_f32_16x16x32_bf16 v[168:171], v[76:79], a[252:255], v[168:171]
    s_waitcnt lgkmcnt(0)
    buffer_load_dwordx4 v109, s[24:27], s35 offen offset:3072 lds
    v_mfma_f32_16x16x32_bf16 v[148:151], v[80:83], a[48:51], v[148:151]
    ds_read_b64_tr_b16 v[64:65], v124 offset:16384
    s_add_u32 m0, m0, 4096
    v_mfma_f32_16x16x32_bf16 v[148:151], v[84:87], a[52:55], v[148:151]
    ds_read_b64_tr_b16 v[66:67], v124 offset:18432
    s_add_u32 s35, s35, s47
    v_mfma_f32_16x16x32_bf16 v[148:151], v[88:91], a[56:59], v[148:151]
    ds_read_b64_tr_b16 v[68:69], v124 offset:20480
    v_mfma_f32_16x16x32_bf16 v[148:151], v[92:95], a[60:63], v[148:151]
    buffer_load_dwordx4 v108, s[24:27], s35 offen offset:0 lds
    v_mfma_f32_16x16x32_bf16 v[156:159], v[80:83], a[112:115], v[156:159]
    ds_read_b64_tr_b16 v[70:71], v124 offset:22528
    s_add_u32 s35, s35, s36
    v_mfma_f32_16x16x32_bf16 v[156:159], v[84:87], a[116:119], v[156:159]
    ds_read_b64_tr_b16 v[72:73], v124 offset:24576
    v_mfma_f32_16x16x32_bf16 v[156:159], v[88:91], a[120:123], v[156:159]
    ds_read_b64_tr_b16 v[74:75], v124 offset:26624
    v_mfma_f32_16x16x32_bf16 v[156:159], v[92:95], a[124:127], v[156:159]
    buffer_load_dwordx4 v109, s[24:27], s35 offen offset:1024 lds
    v_mfma_f32_16x16x32_bf16 v[164:167], v[80:83], a[176:179], v[164:167]
    ds_read_b64_tr_b16 v[76:77], v124 offset:28672
    s_sub_u32 s35, s35, s37
    v_mfma_f32_16x16x32_bf16 v[164:167], v[84:87], a[180:183], v[164:167]
    ds_read_b64_tr_b16 v[78:79], v124 offset:30720
    v_mul_f32 v144, s44, v144
    v_mfma_f32_16x16x32_bf16 v[164:167], v[88:91], a[184:187], v[164:167]
    v_mul_f32 v145, s44, v145
    v_cvt_pk_bf16_f32 v96, v144, v145
    v_mfma_f32_16x16x32_bf16 v[164:167], v[92:95], a[188:191], v[164:167]
    buffer_load_dwordx4 v108, s[24:27], s35 offen offset:2048 lds
    v_mfma_f32_16x16x32_bf16 v[172:175], v[80:83], a[240:243], v[172:175]
    s_add_u32 s35, s35, s36
    v_mul_f32 v146, s44, v146
    v_mul_f32 v147, s44, v147
    v_mfma_f32_16x16x32_bf16 v[172:175], v[84:87], a[244:247], v[172:175]
    v_cvt_pk_bf16_f32 v97, v146, v147
    v_mul_f32 v148, s44, v148
    v_mfma_f32_16x16x32_bf16 v[172:175], v[88:91], a[248:251], v[172:175]
    v_mul_f32 v149, s44, v149
    v_cvt_pk_bf16_f32 v98, v148, v149
    v_mfma_f32_16x16x32_bf16 v[172:175], v[92:95], a[252:255], v[172:175]
    s_waitcnt lgkmcnt(0)
    buffer_load_dwordx4 v109, s[24:27], s35 offen offset:3072 lds
    v_mfma_f32_16x16x32_bf16 v[176:179], v[64:67], a[48:51], v[176:179]
    ds_read_b64_tr_b16 v[80:81], v125 offset:16384
    v_mul_f32 v150, s44, v150
    v_mfma_f32_16x16x32_bf16 v[176:179], v[68:71], a[52:55], v[176:179]
    ds_read_b64_tr_b16 v[82:83], v125 offset:18432
    v_mul_f32 v151, s44, v151
    v_mfma_f32_16x16x32_bf16 v[176:179], v[72:75], a[56:59], v[176:179]
    ds_read_b64_tr_b16 v[84:85], v125 offset:20480
    v_cvt_pk_bf16_f32 v99, v150, v151
    v_mfma_f32_16x16x32_bf16 v[176:179], v[76:79], a[60:63], v[176:179]
    buffer_store_dwordx4 v[96:99], v110, s[28:31], s40 offen sc1
    v_mfma_f32_16x16x32_bf16 v[184:187], v[64:67], a[112:115], v[184:187]
    ds_read_b64_tr_b16 v[86:87], v125 offset:22528
    v_mul_f32 v152, s44, v152
    v_mfma_f32_16x16x32_bf16 v[184:187], v[68:71], a[116:119], v[184:187]
    ds_read_b64_tr_b16 v[88:89], v125 offset:24576
    v_mul_f32 v153, s44, v153
    v_mfma_f32_16x16x32_bf16 v[184:187], v[72:75], a[120:123], v[184:187]
    ds_read_b64_tr_b16 v[90:91], v125 offset:26624
    v_cvt_pk_bf16_f32 v100, v152, v153
    v_mfma_f32_16x16x32_bf16 v[184:187], v[76:79], a[124:127], v[184:187]
    v_mul_f32 v154, s44, v154
    v_mul_f32 v155, s44, v155
    v_mfma_f32_16x16x32_bf16 v[192:195], v[64:67], a[176:179], v[192:195]
    ds_read_b64_tr_b16 v[92:93], v125 offset:28672
    v_cvt_pk_bf16_f32 v101, v154, v155
    v_mfma_f32_16x16x32_bf16 v[192:195], v[68:71], a[180:183], v[192:195]
    ds_read_b64_tr_b16 v[94:95], v125 offset:30720
    v_mul_f32 v156, s44, v156
    v_mfma_f32_16x16x32_bf16 v[192:195], v[72:75], a[184:187], v[192:195]
    v_mul_f32 v157, s44, v157
    v_cvt_pk_bf16_f32 v102, v156, v157
    v_mfma_f32_16x16x32_bf16 v[192:195], v[76:79], a[188:191], v[192:195]
    v_mul_f32 v158, s44, v158
    v_mul_f32 v159, s44, v159
    v_mfma_f32_16x16x32_bf16 v[200:203], v[64:67], a[240:243], v[200:203]
    v_cvt_pk_bf16_f32 v103, v158, v159
    v_mul_f32 v160, s44, v160
    v_mfma_f32_16x16x32_bf16 v[200:203], v[68:71], a[244:247], v[200:203]
    buffer_store_dwordx4 v[100:103], v111, s[28:31], s40 offen sc1
    v_mfma_f32_16x16x32_bf16 v[200:203], v[72:75], a[248:251], v[200:203]
    v_mul_f32 v161, s44, v161
    v_cvt_pk_bf16_f32 v96, v160, v161
    v_mfma_f32_16x16x32_bf16 v[200:203], v[76:79], a[252:255], v[200:203]
    s_waitcnt lgkmcnt(0)
    v_mul_f32 v162, s44, v162
    v_mul_f32 v163, s44, v163
    v_mfma_f32_16x16x32_bf16 v[180:183], v[80:83], a[48:51], v[180:183]
    ds_read_b64_tr_b16 v[64:65], v122 offset:49152
    v_cvt_pk_bf16_f32 v97, v162, v163
    v_mfma_f32_16x16x32_bf16 v[180:183], v[84:87], a[52:55], v[180:183]
    ds_read_b64_tr_b16 v[66:67], v122 offset:51200
    v_mul_f32 v164, s44, v164
    v_mfma_f32_16x16x32_bf16 v[180:183], v[88:91], a[56:59], v[180:183]
    ds_read_b64_tr_b16 v[68:69], v122 offset:53248
    v_mul_f32 v165, s44, v165
    v_mfma_f32_16x16x32_bf16 v[180:183], v[92:95], a[60:63], v[180:183]
    s_barrier
    v_cvt_pk_bf16_f32 v98, v164, v165
    v_mul_f32 v166, s44, v166
    v_mfma_f32_16x16x32_bf16 v[188:191], v[80:83], a[112:115], v[188:191]
    ds_read_b64_tr_b16 v[70:71], v122 offset:55296
    s_add_u32 m0, s64, 32768
    v_mfma_f32_16x16x32_bf16 v[188:191], v[84:87], a[116:119], v[188:191]
    ds_read_b64_tr_b16 v[72:73], v122 offset:57344
    s_mul_i32 s35, s100, 3
    v_mfma_f32_16x16x32_bf16 v[188:191], v[88:91], a[120:123], v[188:191]
    ds_read_b64_tr_b16 v[74:75], v122 offset:59392
    s_add_u32 s35, s35, s38
    v_mfma_f32_16x16x32_bf16 v[188:191], v[92:95], a[124:127], v[188:191]
    s_add_u32 s35, s35, s65
    v_mul_f32 v167, s44, v167
    v_cvt_pk_bf16_f32 v99, v166, v167
    v_mfma_f32_16x16x32_bf16 v[196:199], v[80:83], a[176:179], v[196:199]
    ds_read_b64_tr_b16 v[76:77], v122 offset:61440
    v_mul_f32 v168, s44, v168
    v_mfma_f32_16x16x32_bf16 v[196:199], v[84:87], a[180:183], v[196:199]
    ds_read_b64_tr_b16 v[78:79], v122 offset:63488
    v_mul_f32 v169, s44, v169
    v_mfma_f32_16x16x32_bf16 v[196:199], v[88:91], a[184:187], v[196:199]
    buffer_load_dwordx4 v108, s[24:27], s35 offen offset:0 lds
    v_mfma_f32_16x16x32_bf16 v[196:199], v[92:95], a[188:191], v[196:199]
    s_add_u32 s35, s35, s36
    v_cvt_pk_bf16_f32 v100, v168, v169
    v_mul_f32 v170, s44, v170
    v_mfma_f32_16x16x32_bf16 v[204:207], v[80:83], a[240:243], v[204:207]
    buffer_store_dwordx4 v[96:99], v110, s[28:31], s41 offen sc1
    v_mfma_f32_16x16x32_bf16 v[204:207], v[84:87], a[244:247], v[204:207]
    v_mul_f32 v171, s44, v171
    v_cvt_pk_bf16_f32 v101, v170, v171
    v_mfma_f32_16x16x32_bf16 v[204:207], v[88:91], a[248:251], v[204:207]
    buffer_load_dwordx4 v109, s[24:27], s35 offen offset:1024 lds
    v_mfma_f32_16x16x32_bf16 v[204:207], v[92:95], a[252:255], v[204:207]
    s_waitcnt lgkmcnt(0)
    s_sub_u32 s35, s35, s37
    v_mul_f32 v172, s44, v172
    v_mfma_f32_16x16x32_bf16 v[0:3], v[64:67], a[48:51], v[0:3]
    ds_read_b64_tr_b16 v[80:81], v123 offset:49152
    v_mul_f32 v173, s44, v173
    v_mfma_f32_16x16x32_bf16 v[0:3], v[68:71], a[52:55], v[0:3]
    ds_read_b64_tr_b16 v[82:83], v123 offset:51200
    v_cvt_pk_bf16_f32 v102, v172, v173
    v_mfma_f32_16x16x32_bf16 v[0:3], v[72:75], a[56:59], v[0:3]
    ds_read_b64_tr_b16 v[84:85], v123 offset:53248
    v_mul_f32 v174, s44, v174
    v_mfma_f32_16x16x32_bf16 v[0:3], v[76:79], a[60:63], v[0:3]
    buffer_load_dwordx4 v108, s[24:27], s35 offen offset:2048 lds
    v_mfma_f32_16x16x32_bf16 v[8:11], v[64:67], a[112:115], v[8:11]
    ds_read_b64_tr_b16 v[86:87], v123 offset:55296
    s_add_u32 s35, s35, s36
    v_mfma_f32_16x16x32_bf16 v[8:11], v[68:71], a[116:119], v[8:11]
    ds_read_b64_tr_b16 v[88:89], v123 offset:57344
    v_mul_f32 v175, s44, v175
    v_mfma_f32_16x16x32_bf16 v[8:11], v[72:75], a[120:123], v[8:11]
    ds_read_b64_tr_b16 v[90:91], v123 offset:59392
    v_cvt_pk_bf16_f32 v103, v174, v175
    v_mfma_f32_16x16x32_bf16 v[8:11], v[76:79], a[124:127], v[8:11]
    buffer_load_dwordx4 v109, s[24:27], s35 offen offset:3072 lds
    v_mfma_f32_16x16x32_bf16 v[16:19], v[64:67], a[176:179], v[16:19]
    ds_read_b64_tr_b16 v[92:93], v123 offset:61440
    s_add_u32 m0, m0, 4096
    v_mfma_f32_16x16x32_bf16 v[16:19], v[68:71], a[180:183], v[16:19]
    ds_read_b64_tr_b16 v[94:95], v123 offset:63488
    s_add_u32 s35, s35, s47
    v_mfma_f32_16x16x32_bf16 v[16:19], v[72:75], a[184:187], v[16:19]
    v_mul_f32 v176, s44, v176
    v_mul_f32 v177, s44, v177
    v_mfma_f32_16x16x32_bf16 v[16:19], v[76:79], a[188:191], v[16:19]
    buffer_load_dwordx4 v108, s[24:27], s35 offen offset:0 lds
    v_mfma_f32_16x16x32_bf16 v[24:27], v[64:67], a[240:243], v[24:27]
    s_add_u32 s35, s35, s36
    v_cvt_pk_bf16_f32 v96, v176, v177
    v_mul_f32 v178, s44, v178
    v_mfma_f32_16x16x32_bf16 v[24:27], v[68:71], a[244:247], v[24:27]
    buffer_store_dwordx4 v[100:103], v111, s[28:31], s41 offen sc1
    v_mfma_f32_16x16x32_bf16 v[24:27], v[72:75], a[248:251], v[24:27]
    v_mul_f32 v179, s44, v179
    v_cvt_pk_bf16_f32 v97, v178, v179
    v_mfma_f32_16x16x32_bf16 v[24:27], v[76:79], a[252:255], v[24:27]
    s_waitcnt lgkmcnt(0)
    buffer_load_dwordx4 v109, s[24:27], s35 offen offset:1024 lds
    v_mfma_f32_16x16x32_bf16 v[4:7], v[80:83], a[48:51], v[4:7]
    ds_read_b64_tr_b16 v[64:65], v124 offset:49152
    s_sub_u32 s35, s35, s37
    v_mfma_f32_16x16x32_bf16 v[4:7], v[84:87], a[52:55], v[4:7]
    ds_read_b64_tr_b16 v[66:67], v124 offset:51200
    s_add_u32 s52, s52, s53
    v_mfma_f32_16x16x32_bf16 v[4:7], v[88:91], a[56:59], v[4:7]
    ds_read_b64_tr_b16 v[68:69], v124 offset:53248
    s_xor_b32 s53, s53, s54
    v_mfma_f32_16x16x32_bf16 v[4:7], v[92:95], a[60:63], v[4:7]
    buffer_load_dwordx4 v108, s[24:27], s35 offen offset:2048 lds
    v_mfma_f32_16x16x32_bf16 v[12:15], v[80:83], a[112:115], v[12:15]
    ds_read_b64_tr_b16 v[70:71], v124 offset:55296
    s_add_u32 s35, s35, s36
    v_mfma_f32_16x16x32_bf16 v[12:15], v[84:87], a[116:119], v[12:15]
    ds_read_b64_tr_b16 v[72:73], v124 offset:57344
    s_mov_b32 s40, s52
    v_mfma_f32_16x16x32_bf16 v[12:15], v[88:91], a[120:123], v[12:15]
    ds_read_b64_tr_b16 v[74:75], v124 offset:59392
    s_add_u32 s41, s52, s42
    v_mfma_f32_16x16x32_bf16 v[12:15], v[92:95], a[124:127], v[12:15]
    buffer_load_dwordx4 v109, s[24:27], s35 offen offset:3072 lds
    v_mfma_f32_16x16x32_bf16 v[20:23], v[80:83], a[176:179], v[20:23]
    ds_read_b64_tr_b16 v[76:77], v124 offset:61440
    s_lshl_b32 s35, s100, 2
    v_mfma_f32_16x16x32_bf16 v[20:23], v[84:87], a[180:183], v[20:23]
    ds_read_b64_tr_b16 v[78:79], v124 offset:63488
    s_add_u32 s38, s38, s35
    v_mfma_f32_16x16x32_bf16 v[20:23], v[88:91], a[184:187], v[20:23]
    v_mul_f32 v180, s44, v180
    v_mul_f32 v181, s44, v181
    v_mfma_f32_16x16x32_bf16 v[20:23], v[92:95], a[188:191], v[20:23]
    v_cvt_pk_bf16_f32 v98, v180, v181
    v_mul_f32 v182, s44, v182
    v_mfma_f32_16x16x32_bf16 v[28:31], v[80:83], a[240:243], v[28:31]
    v_mul_f32 v183, s44, v183
    v_cvt_pk_bf16_f32 v99, v182, v183
    v_mfma_f32_16x16x32_bf16 v[28:31], v[84:87], a[244:247], v[28:31]
    buffer_store_dwordx4 v[96:99], v110, s[28:31], s45 offen sc1
    v_mfma_f32_16x16x32_bf16 v[28:31], v[88:91], a[248:251], v[28:31]
    v_mul_f32 v184, s44, v184
    v_mul_f32 v185, s44, v185
    v_mfma_f32_16x16x32_bf16 v[28:31], v[92:95], a[252:255], v[28:31]
    s_waitcnt lgkmcnt(0)
    v_cvt_pk_bf16_f32 v100, v184, v185
    v_mul_f32 v186, s44, v186
    v_mfma_f32_16x16x32_bf16 v[32:35], v[64:67], a[48:51], v[32:35]
    ds_read_b64_tr_b16 v[80:81], v125 offset:49152
    v_mul_f32 v187, s44, v187
    v_mfma_f32_16x16x32_bf16 v[32:35], v[68:71], a[52:55], v[32:35]
    ds_read_b64_tr_b16 v[82:83], v125 offset:51200
    v_cvt_pk_bf16_f32 v101, v186, v187
    v_mfma_f32_16x16x32_bf16 v[32:35], v[72:75], a[56:59], v[32:35]
    ds_read_b64_tr_b16 v[84:85], v125 offset:53248
    v_mul_f32 v188, s44, v188
    v_mfma_f32_16x16x32_bf16 v[32:35], v[76:79], a[60:63], v[32:35]
    v_mul_f32 v189, s44, v189
    v_cvt_pk_bf16_f32 v102, v188, v189
    v_mfma_f32_16x16x32_bf16 v[40:43], v[64:67], a[112:115], v[40:43]
    ds_read_b64_tr_b16 v[86:87], v125 offset:55296
    v_mul_f32 v190, s44, v190
    v_mfma_f32_16x16x32_bf16 v[40:43], v[68:71], a[116:119], v[40:43]
    ds_read_b64_tr_b16 v[88:89], v125 offset:57344
    v_mul_f32 v191, s44, v191
    v_mfma_f32_16x16x32_bf16 v[40:43], v[72:75], a[120:123], v[40:43]
    ds_read_b64_tr_b16 v[90:91], v125 offset:59392
    v_cvt_pk_bf16_f32 v103, v190, v191
    v_mfma_f32_16x16x32_bf16 v[40:43], v[76:79], a[124:127], v[40:43]
    buffer_store_dwordx4 v[100:103], v111, s[28:31], s45 offen sc1
    v_mfma_f32_16x16x32_bf16 v[48:51], v[64:67], a[176:179], v[48:51]
    ds_read_b64_tr_b16 v[92:93], v125 offset:61440
    v_mul_f32 v192, s44, v192
    v_mfma_f32_16x16x32_bf16 v[48:51], v[68:71], a[180:183], v[48:51]
    ds_read_b64_tr_b16 v[94:95], v125 offset:63488
    v_mul_f32 v193, s44, v193
    v_mfma_f32_16x16x32_bf16 v[48:51], v[72:75], a[184:187], v[48:51]
    s_waitcnt vmcnt(39)
    s_barrier
    v_cvt_pk_bf16_f32 v96, v192, v193
    v_mfma_f32_16x16x32_bf16 v[48:51], v[76:79], a[188:191], v[48:51]
    v_mul_f32 v194, s44, v194
    v_mul_f32 v195, s44, v195
    v_mfma_f32_16x16x32_bf16 v[56:59], v[64:67], a[240:243], v[56:59]
    v_cvt_pk_bf16_f32 v97, v194, v195
    v_mul_f32 v196, s44, v196
    v_mfma_f32_16x16x32_bf16 v[56:59], v[68:71], a[244:247], v[56:59]
    v_mul_f32 v197, s44, v197
    v_cvt_pk_bf16_f32 v98, v196, v197
    v_mfma_f32_16x16x32_bf16 v[56:59], v[72:75], a[248:251], v[56:59]
    v_mul_f32 v198, s44, v198
    v_mul_f32 v199, s44, v199
    v_mfma_f32_16x16x32_bf16 v[56:59], v[76:79], a[252:255], v[56:59]
    s_waitcnt lgkmcnt(0)
    v_cvt_pk_bf16_f32 v99, v198, v199
    v_mul_f32 v200, s44, v200
    v_mfma_f32_16x16x32_bf16 v[36:39], v[80:83], a[48:51], v[36:39]
    ds_read_b64_tr_b16 v[64:65], v104 offset:0
    v_mul_f32 v201, s44, v201
    v_mfma_f32_16x16x32_bf16 v[36:39], v[84:87], a[52:55], v[36:39]
    ds_read_b64_tr_b16 v[66:67], v104 offset:2048
    v_cvt_pk_bf16_f32 v100, v200, v201
    v_mfma_f32_16x16x32_bf16 v[36:39], v[88:91], a[56:59], v[36:39]
    ds_read_b64_tr_b16 v[68:69], v104 offset:4096
    v_mul_f32 v202, s44, v202
    v_mfma_f32_16x16x32_bf16 v[36:39], v[92:95], a[60:63], v[36:39]
    buffer_store_dwordx4 v[96:99], v110, s[28:31], s46 offen sc1
    v_mfma_f32_16x16x32_bf16 v[44:47], v[80:83], a[112:115], v[44:47]
    ds_read_b64_tr_b16 v[70:71], v104 offset:6144
    v_mul_f32 v203, s44, v203
    v_mfma_f32_16x16x32_bf16 v[44:47], v[84:87], a[116:119], v[44:47]
    ds_read_b64_tr_b16 v[72:73], v104 offset:8192
    v_cvt_pk_bf16_f32 v101, v202, v203
    v_mfma_f32_16x16x32_bf16 v[44:47], v[88:91], a[120:123], v[44:47]
    ds_read_b64_tr_b16 v[74:75], v104 offset:10240
    v_mul_f32 v204, s44, v204
    v_mfma_f32_16x16x32_bf16 v[44:47], v[92:95], a[124:127], v[44:47]
    v_mul_f32 v205, s44, v205
    v_cvt_pk_bf16_f32 v102, v204, v205
    v_mfma_f32_16x16x32_bf16 v[52:55], v[80:83], a[176:179], v[52:55]
    ds_read_b64_tr_b16 v[76:77], v104 offset:12288
    v_mul_f32 v206, s44, v206
    v_mfma_f32_16x16x32_bf16 v[52:55], v[84:87], a[180:183], v[52:55]
    ds_read_b64_tr_b16 v[78:79], v104 offset:14336
    v_mul_f32 v207, s44, v207
    v_mfma_f32_16x16x32_bf16 v[52:55], v[88:91], a[184:187], v[52:55]
    v_cvt_pk_bf16_f32 v103, v206, v207
    v_mul_f32 v0, s44, v0
    v_mfma_f32_16x16x32_bf16 v[52:55], v[92:95], a[188:191], v[52:55]
    buffer_store_dwordx4 v[100:103], v111, s[28:31], s46 offen sc1
    v_mfma_f32_16x16x32_bf16 v[60:63], v[80:83], a[240:243], v[60:63]
    v_mul_f32 v1, s44, v1
    v_cvt_pk_bf16_f32 v96, v0, v1
    v_mfma_f32_16x16x32_bf16 v[60:63], v[84:87], a[244:247], v[60:63]
    s_add_u32 s45, s52, s43
    s_add_u32 s46, s41, s43
    v_mul_f32 v2, s44, v2
    v_mfma_f32_16x16x32_bf16 v[60:63], v[88:91], a[248:251], v[60:63]
    v_mul_f32 v3, s44, v3
    v_cvt_pk_bf16_f32 v97, v2, v3
    v_mfma_f32_16x16x32_bf16 v[60:63], v[92:95], a[252:255], v[60:63]
    s_waitcnt lgkmcnt(0)
    v_mul_f32 v4, s44, v4
    v_mul_f32 v5, s44, v5
    v_cvt_pk_bf16_f32 v98, v4, v5
    v_mul_f32 v6, s44, v6
    v_mul_f32 v7, s44, v7
    v_cvt_pk_bf16_f32 v99, v6, v7
    buffer_store_dwordx4 v[96:99], v110, s[28:31], s40 offen sc1
    v_mul_f32 v8, s44, v8
    v_mul_f32 v9, s44, v9
    v_cvt_pk_bf16_f32 v100, v8, v9
    v_mul_f32 v10, s44, v10
    v_mul_f32 v11, s44, v11
    v_cvt_pk_bf16_f32 v101, v10, v11
    v_mul_f32 v12, s44, v12
    v_mul_f32 v13, s44, v13
    v_cvt_pk_bf16_f32 v102, v12, v13
    v_mul_f32 v14, s44, v14
    v_mul_f32 v15, s44, v15
    v_cvt_pk_bf16_f32 v103, v14, v15
    buffer_store_dwordx4 v[100:103], v111, s[28:31], s40 offen sc1
    v_mul_f32 v16, s44, v16
    v_mul_f32 v17, s44, v17
    v_cvt_pk_bf16_f32 v96, v16, v17
    v_mul_f32 v18, s44, v18
    v_mul_f32 v19, s44, v19
    v_cvt_pk_bf16_f32 v97, v18, v19
    v_mul_f32 v20, s44, v20
    v_mul_f32 v21, s44, v21
    v_cvt_pk_bf16_f32 v98, v20, v21
    v_mul_f32 v22, s44, v22
    v_mul_f32 v23, s44, v23
    v_cvt_pk_bf16_f32 v99, v22, v23
    buffer_store_dwordx4 v[96:99], v110, s[28:31], s41 offen sc1
    v_mul_f32 v24, s44, v24
    v_mul_f32 v25, s44, v25
    v_cvt_pk_bf16_f32 v100, v24, v25
    v_mul_f32 v26, s44, v26
    v_mul_f32 v27, s44, v27
    v_cvt_pk_bf16_f32 v101, v26, v27
    v_mul_f32 v28, s44, v28
    v_mul_f32 v29, s44, v29
    v_cvt_pk_bf16_f32 v102, v28, v29
    v_mul_f32 v30, s44, v30
    v_mul_f32 v31, s44, v31
    v_cvt_pk_bf16_f32 v103, v30, v31
    buffer_store_dwordx4 v[100:103], v111, s[28:31], s41 offen sc1
.p2align 3
K1_S:
    v_mfma_f32_16x16x32_bf16 v[0:3], v[64:67], a[0:3], 0
    ds_read_b64_tr_b16 v[80:81], v105 offset:0
    v_mfma_f32_16x16x32_bf16 v[0:3], v[68:71], a[4:7], v[0:3]
    ds_read_b64_tr_b16 v[82:83], v105 offset:2048
    v_mfma_f32_16x16x32_bf16 v[0:3], v[72:75], a[8:11], v[0:3]
    ds_read_b64_tr_b16 v[84:85], v105 offset:4096
    v_mfma_f32_16x16x32_bf16 v[0:3], v[76:79], a[12:15], v[0:3]
    v_mul_f32 v32, s44, v32
    v_mul_f32 v33, s44, v33
    v_mfma_f32_16x16x32_bf16 v[8:11], v[64:67], a[64:67], 0
    ds_read_b64_tr_b16 v[86:87], v105 offset:6144
    v_cvt_pk_bf16_f32 v96, v32, v33
    v_mfma_f32_16x16x32_bf16 v[8:11], v[68:71], a[68:71], v[8:11]
    ds_read_b64_tr_b16 v[88:89], v105 offset:8192
    v_mul_f32 v34, s44, v34
    v_mfma_f32_16x16x32_bf16 v[8:11], v[72:75], a[72:75], v[8:11]
    ds_read_b64_tr_b16 v[90:91], v105 offset:10240
    v_mul_f32 v35, s44, v35
    v_mfma_f32_16x16x32_bf16 v[8:11], v[76:79], a[76:79], v[8:11]
    v_cvt_pk_bf16_f32 v97, v34, v35
    v_mul_f32 v36, s44, v36
    v_mfma_f32_16x16x32_bf16 v[16:19], v[64:67], a[128:131], 0
    ds_read_b64_tr_b16 v[92:93], v105 offset:12288
    v_mul_f32 v37, s44, v37
    v_mfma_f32_16x16x32_bf16 v[16:19], v[68:71], a[132:135], v[16:19]
    ds_read_b64_tr_b16 v[94:95], v105 offset:14336
    v_cvt_pk_bf16_f32 v98, v36, v37
    v_mfma_f32_16x16x32_bf16 v[16:19], v[72:75], a[136:139], v[16:19]
    v_mul_f32 v38, s44, v38
    v_mul_f32 v39, s44, v39
    v_mfma_f32_16x16x32_bf16 v[16:19], v[76:79], a[140:143], v[16:19]
    v_cvt_pk_bf16_f32 v99, v38, v39
    v_mul_f32 v40, s44, v40
    v_mfma_f32_16x16x32_bf16 v[24:27], v[64:67], a[192:195], 0
    buffer_store_dwordx4 v[96:99], v110, s[28:31], s45 offen sc1
    v_mfma_f32_16x16x32_bf16 v[24:27], v[68:71], a[196:199], v[24:27]
    v_mul_f32 v41, s44, v41
    v_cvt_pk_bf16_f32 v100, v40, v41
    v_mfma_f32_16x16x32_bf16 v[24:27], v[72:75], a[200:203], v[24:27]
    v_mul_f32 v42, s44, v42
    v_mul_f32 v43, s44, v43
    v_mfma_f32_16x16x32_bf16 v[24:27], v[76:79], a[204:207], v[24:27]
    s_waitcnt lgkmcnt(0)
    v_cvt_pk_bf16_f32 v101, v42, v43
    v_mul_f32 v44, s44, v44
    v_mfma_f32_16x16x32_bf16 v[4:7], v[80:83], a[0:3], 0
    ds_read_b64_tr_b16 v[64:65], v106 offset:0
    v_mul_f32 v45, s44, v45
    v_mfma_f32_16x16x32_bf16 v[4:7], v[84:87], a[4:7], v[4:7]
    ds_read_b64_tr_b16 v[66:67], v106 offset:2048
    v_cvt_pk_bf16_f32 v102, v44, v45
    v_mfma_f32_16x16x32_bf16 v[4:7], v[88:91], a[8:11], v[4:7]
    ds_read_b64_tr_b16 v[68:69], v106 offset:4096
    v_mul_f32 v46, s44, v46
    v_mfma_f32_16x16x32_bf16 v[4:7], v[92:95], a[12:15], v[4:7]
    v_mul_f32 v47, s44, v47
    v_cvt_pk_bf16_f32 v103, v46, v47
    v_mfma_f32_16x16x32_bf16 v[12:15], v[80:83], a[64:67], 0
    ds_read_b64_tr_b16 v[70:71], v106 offset:6144
    v_mul_f32 v48, s44, v48
    v_mfma_f32_16x16x32_bf16 v[12:15], v[84:87], a[68:71], v[12:15]
    ds_read_b64_tr_b16 v[72:73], v106 offset:8192
    v_mul_f32 v49, s44, v49
    v_mfma_f32_16x16x32_bf16 v[12:15], v[88:91], a[72:75], v[12:15]
    ds_read_b64_tr_b16 v[74:75], v106 offset:10240
    v_cvt_pk_bf16_f32 v96, v48, v49
    v_mfma_f32_16x16x32_bf16 v[12:15], v[92:95], a[76:79], v[12:15]
    buffer_store_dwordx4 v[100:103], v111, s[28:31], s45 offen sc1
    v_mfma_f32_16x16x32_bf16 v[20:23], v[80:83], a[128:131], 0
    ds_read_b64_tr_b16 v[76:77], v106 offset:12288
    v_mul_f32 v50, s44, v50
    v_mfma_f32_16x16x32_bf16 v[20:23], v[84:87], a[132:135], v[20:23]
    ds_read_b64_tr_b16 v[78:79], v106 offset:14336
    v_mul_f32 v51, s44, v51
    v_mfma_f32_16x16x32_bf16 v[20:23], v[88:91], a[136:139], v[20:23]
    v_cvt_pk_bf16_f32 v97, v50, v51
    v_mul_f32 v52, s44, v52
    v_mfma_f32_16x16x32_bf16 v[20:23], v[92:95], a[140:143], v[20:23]
    v_mul_f32 v53, s44, v53
    v_cvt_pk_bf16_f32 v98, v52, v53
    v_mfma_f32_16x16x32_bf16 v[28:31], v[80:83], a[192:195], 0
    v_mul_f32 v54, s44, v54
    v_mul_f32 v55, s44, v55
    v_mfma_f32_16x16x32_bf16 v[28:31], v[84:87], a[196:199], v[28:31]
    v_cvt_pk_bf16_f32 v99, v54, v55
    v_mul_f32 v56, s44, v56
    v_mfma_f32_16x16x32_bf16 v[28:31], v[88:91], a[200:203], v[28:31]
    buffer_store_dwordx4 v[96:99], v110, s[28:31], s46 offen sc1
    v_mfma_f32_16x16x32_bf16 v[28:31], v[92:95], a[204:207], v[28:31]
    s_waitcnt lgkmcnt(0)
    v_mul_f32 v57, s44, v57
    v_cvt_pk_bf16_f32 v100, v56, v57
    v_mfma_f32_16x16x32_bf16 v[32:35], v[64:67], a[0:3], 0
    ds_read_b64_tr_b16 v[80:81], v107 offset:0
    v_mul_f32 v58, s44, v58
    v_mfma_f32_16x16x32_bf16 v[32:35], v[68:71], a[4:7], v[32:35]
    ds_read_b64_tr_b16 v[82:83], v107 offset:2048
    v_mul_f32 v59, s44, v59
    v_mfma_f32_16x16x32_bf16 v[32:35], v[72:75], a[8:11], v[32:35]
    ds_read_b64_tr_b16 v[84:85], v107 offset:4096
    v_cvt_pk_bf16_f32 v101, v58, v59
    v_mfma_f32_16x16x32_bf16 v[32:35], v[76:79], a[12:15], v[32:35]
    v_mul_f32 v60, s44, v60
    v_mul_f32 v61, s44, v61
    v_mfma_f32_16x16x32_bf16 v[40:43], v[64:67], a[64:67], 0
    ds_read_b64_tr_b16 v[86:87], v107 offset:6144
    v_cvt_pk_bf16_f32 v102, v60, v61
    v_mfma_f32_16x16x32_bf16 v[40:43], v[68:71], a[68:71], v[40:43]
    ds_read_b64_tr_b16 v[88:89], v107 offset:8192
    v_mul_f32 v62, s44, v62
    v_mfma_f32_16x16x32_bf16 v[40:43], v[72:75], a[72:75], v[40:43]
    ds_read_b64_tr_b16 v[90:91], v107 offset:10240
    v_mul_f32 v63, s44, v63
    v_mfma_f32_16x16x32_bf16 v[40:43], v[76:79], a[76:79], v[40:43]
    v_cvt_pk_bf16_f32 v103, v62, v63
    v_mfma_f32_16x16x32_bf16 v[48:51], v[64:67], a[128:131], 0
    ds_read_b64_tr_b16 v[92:93], v107 offset:12288
    v_mfma_f32_16x16x32_bf16 v[48:51], v[68:71], a[132:135], v[48:51]
    ds_read_b64_tr_b16 v[94:95], v107 offset:14336
    v_mfma_f32_16x16x32_bf16 v[48:51], v[72:75], a[136:139], v[48:51]
    buffer_store_dwordx4 v[100:103], v111, s[28:31], s46 offen sc1
    v_mfma_f32_16x16x32_bf16 v[48:51], v[76:79], a[140:143], v[48:51]
    v_mfma_f32_16x16x32_bf16 v[56:59], v[64:67], a[192:195], 0
    v_mfma_f32_16x16x32_bf16 v[56:59], v[68:71], a[196:199], v[56:59]
    v_mfma_f32_16x16x32_bf16 v[56:59], v[72:75], a[200:203], v[56:59]
    v_mfma_f32_16x16x32_bf16 v[56:59], v[76:79], a[204:207], v[56:59]
    s_waitcnt lgkmcnt(0)
    v_mfma_f32_16x16x32_bf16 v[36:39], v[80:83], a[0:3], 0
    ds_read_b64_tr_b16 v[64:65], v104 offset:16384
    s_add_u32 s66, s66, 1
    v_mfma_f32_16x16x32_bf16 v[36:39], v[84:87], a[4:7], v[36:39]
    ds_read_b64_tr_b16 v[66:67], v104 offset:18432
    s_cmp_eq_u32 s66, 5
    v_mfma_f32_16x16x32_bf16 v[36:39], v[88:91], a[8:11], v[36:39]
    ds_read_b64_tr_b16 v[68:69], v104 offset:20480
    s_cselect_b32 s32, 0xfffe0000, s67
    v_mfma_f32_16x16x32_bf16 v[36:39], v[92:95], a[12:15], v[36:39]
    v_mfma_f32_16x16x32_bf16 v[44:47], v[80:83], a[64:67], 0
    ds_read_b64_tr_b16 v[70:71], v104 offset:22528
    s_cselect_b32 s66, 0, s66
    v_mfma_f32_16x16x32_bf16 v[44:47], v[84:87], a[68:71], v[44:47]
    ds_read_b64_tr_b16 v[72:73], v104 offset:24576
    v_mfma_f32_16x16x32_bf16 v[44:47], v[88:91], a[72:75], v[44:47]
    ds_read_b64_tr_b16 v[74:75], v104 offset:26624
    v_mfma_f32_16x16x32_bf16 v[44:47], v[92:95], a[76:79], v[44:47]
    v_mfma_f32_16x16x32_bf16 v[52:55], v[80:83], a[128:131], 0
    ds_read_b64_tr_b16 v[76:77], v104 offset:28672
    v_mfma_f32_16x16x32_bf16 v[52:55], v[84:87], a[132:135], v[52:55]
    ds_read_b64_tr_b16 v[78:79], v104 offset:30720
    v_mfma_f32_16x16x32_bf16 v[52:55], v[88:91], a[136:139], v[52:55]
    s_waitcnt vmcnt(24)
    s_barrier
    v_mfma_f32_16x16x32_bf16 v[52:55], v[92:95], a[140:143], v[52:55]
    s_cmp_lt_u32 s55, s34
    s_cbranch_scc0 K1_VS0
    s_mov_b32 s35, s38
K1_RS0:
    v_mfma_f32_16x16x32_bf16 v[60:63], v[80:83], a[192:195], 0
    s_mov_b32 m0, s51
    s_add_u32 s51, s51, 32768
    v_mfma_f32_16x16x32_bf16 v[60:63], v[84:87], a[196:199], v[60:63]
    buffer_load_dwordx4 v108, s[24:27], s35 offen offset:0 lds
    v_mfma_f32_16x16x32_bf16 v[60:63], v[88:91], a[200:203], v[60:63]
    s_add_u32 s35, s35, s36
    v_mfma_f32_16x16x32_bf16 v[60:63], v[92:95], a[204:207], v[60:63]
    s_waitcnt lgkmcnt(0)
    v_mfma_f32_16x16x32_bf16 v[0:3], v[64:67], a[16:19], v[0:3]
    ds_read_b64_tr_b16 v[80:81], v105 offset:16384
    v_mfma_f32_16x16x32_bf16 v[0:3], v[68:71], a[20:23], v[0:3]
    ds_read_b64_tr_b16 v[82:83], v105 offset:18432
    v_mfma_f32_16x16x32_bf16 v[0:3], v[72:75], a[24:27], v[0:3]
    ds_read_b64_tr_b16 v[84:85], v105 offset:20480
    v_mfma_f32_16x16x32_bf16 v[0:3], v[76:79], a[28:31], v[0:3]
    buffer_load_dwordx4 v109, s[24:27], s35 offen offset:1024 lds
    v_mfma_f32_16x16x32_bf16 v[8:11], v[64:67], a[80:83], v[8:11]
    ds_read_b64_tr_b16 v[86:87], v105 offset:22528
    s_sub_u32 s35, s35, s37
    v_mfma_f32_16x16x32_bf16 v[8:11], v[68:71], a[84:87], v[8:11]
    ds_read_b64_tr_b16 v[88:89], v105 offset:24576
    v_mfma_f32_16x16x32_bf16 v[8:11], v[72:75], a[88:91], v[8:11]
    ds_read_b64_tr_b16 v[90:91], v105 offset:26624
    v_mfma_f32_16x16x32_bf16 v[8:11], v[76:79], a[92:95], v[8:11]
    buffer_load_dwordx4 v108, s[24:27], s35 offen offset:2048 lds
    v_mfma_f32_16x16x32_bf16 v[16:19], v[64:67], a[144:147], v[16:19]
    ds_read_b64_tr_b16 v[92:93], v105 offset:28672
    s_add_u32 s35, s35, s36
    v_mfma_f32_16x16x32_bf16 v[16:19], v[68:71], a[148:151], v[16:19]
    ds_read_b64_tr_b16 v[94:95], v105 offset:30720
    v_mfma_f32_16x16x32_bf16 v[16:19], v[72:75], a[152:155], v[16:19]
    v_add_u32 v104, s32, v104
    v_mfma_f32_16x16x32_bf16 v[16:19], v[76:79], a[156:159], v[16:19]
    buffer_load_dwordx4 v109, s[24:27], s35 offen offset:3072 lds
    v_mfma_f32_16x16x32_bf16 v[24:27], v[64:67], a[208:211], v[24:27]
    s_add_u32 m0, m0, 4096
    s_add_u32 s35, s35, s47
    v_mfma_f32_16x16x32_bf16 v[24:27], v[68:71], a[212:215], v[24:27]
    v_mfma_f32_16x16x32_bf16 v[24:27], v[72:75], a[216:219], v[24:27]
    v_mfma_f32_16x16x32_bf16 v[24:27], v[76:79], a[220:223], v[24:27]
    s_waitcnt lgkmcnt(0)
    buffer_load_dwordx4 v108, s[24:27], s35 offen offset:0 lds
    v_mfma_f32_16x16x32_bf16 v[4:7], v[80:83], a[16:19], v[4:7]
    ds_read_b64_tr_b16 v[64:65], v106 offset:16384
    s_add_u32 s35, s35, s36
    v_mfma_f32_16x16x32_bf16 v[4:7], v[84:87], a[20:23], v[4:7]
    ds_read_b64_tr_b16 v[66:67], v106 offset:18432
    v_mfma_f32_16x16x32_bf16 v[4:7], v[88:91], a[24:27], v[4:7]
    ds_read_b64_tr_b16 v[68:69], v106 offset:20480
    v_mfma_f32_16x16x32_bf16 v[4:7], v[92:95], a[28:31], v[4:7]
    buffer_load_dwordx4 v109, s[24:27], s35 offen offset:1024 lds
    v_mfma_f32_16x16x32_bf16 v[12:15], v[80:83], a[80:83], v[12:15]
    ds_read_b64_tr_b16 v[70:71], v106 offset:22528
    s_sub_u32 s35, s35, s37
    v_mfma_f32_16x16x32_bf16 v[12:15], v[84:87], a[84:87], v[12:15]
    ds_read_b64_tr_b16 v[72:73], v106 offset:24576
    v_mfma_f32_16x16x32_bf16 v[12:15], v[88:91], a[88:91], v[12:15]
    ds_read_b64_tr_b16 v[74:75], v106 offset:26624
    v_mfma_f32_16x16x32_bf16 v[12:15], v[92:95], a[92:95], v[12:15]
    buffer_load_dwordx4 v108, s[24:27], s35 offen offset:2048 lds
    v_mfma_f32_16x16x32_bf16 v[20:23], v[80:83], a[144:147], v[20:23]
    ds_read_b64_tr_b16 v[76:77], v106 offset:28672
    s_add_u32 s35, s35, s36
    v_mfma_f32_16x16x32_bf16 v[20:23], v[84:87], a[148:151], v[20:23]
    ds_read_b64_tr_b16 v[78:79], v106 offset:30720
    v_mfma_f32_16x16x32_bf16 v[20:23], v[88:91], a[152:155], v[20:23]
    v_add_u32 v105, s32, v105
    v_mfma_f32_16x16x32_bf16 v[20:23], v[92:95], a[156:159], v[20:23]
    buffer_load_dwordx4 v109, s[24:27], s35 offen offset:3072 lds
    v_mfma_f32_16x16x32_bf16 v[28:31], v[80:83], a[208:211], v[28:31]
    s_cmp_ge_u32 s51, 163840
    s_cselect_b32 s49, 163840, 0
    v_mfma_f32_16x16x32_bf16 v[28:31], v[84:87], a[212:215], v[28:31]
    s_sub_u32 s51, s51, s49
    s_add_u32 s55, s55, 1
    v_mfma_f32_16x16x32_bf16 v[28:31], v[88:91], a[216:219], v[28:31]
    s_add_u32 s52, s52, s53
    v_mfma_f32_16x16x32_bf16 v[28:31], v[92:95], a[220:223], v[28:31]
    s_waitcnt lgkmcnt(0)
    s_xor_b32 s53, s53, s54
    v_mfma_f32_16x16x32_bf16 v[32:35], v[64:67], a[16:19], v[32:35]
    ds_read_b64_tr_b16 v[80:81], v107 offset:16384
    s_mov_b32 s40, s52
    v_mfma_f32_16x16x32_bf16 v[32:35], v[68:71], a[20:23], v[32:35]
    ds_read_b64_tr_b16 v[82:83], v107 offset:18432
    s_add_u32 s41, s52, s42
    v_mfma_f32_16x16x32_bf16 v[32:35], v[72:75], a[24:27], v[32:35]
    ds_read_b64_tr_b16 v[84:85], v107 offset:20480
    s_add_u32 s45, s52, s43
    v_mfma_f32_16x16x32_bf16 v[32:35], v[76:79], a[28:31], v[32:35]
    s_add_u32 s46, s41, s43
    v_mfma_f32_16x16x32_bf16 v[40:43], v[64:67], a[80:83], v[40:43]
    ds_read_b64_tr_b16 v[86:87], v107 offset:22528
    s_add_u32 s33, s33, 2
    v_mfma_f32_16x16x32_bf16 v[40:43], v[68:71], a[84:87], v[40:43]
    ds_read_b64_tr_b16 v[88:89], v107 offset:24576
    v_mfma_f32_16x16x32_bf16 v[40:43], v[72:75], a[88:91], v[40:43]
    ds_read_b64_tr_b16 v[90:91], v107 offset:26624
    v_mfma_f32_16x16x32_bf16 v[40:43], v[76:79], a[92:95], v[40:43]
    v_mfma_f32_16x16x32_bf16 v[48:51], v[64:67], a[144:147], v[48:51]
    ds_read_b64_tr_b16 v[92:93], v107 offset:28672
    v_mfma_f32_16x16x32_bf16 v[48:51], v[68:71], a[148:151], v[48:51]
    ds_read_b64_tr_b16 v[94:95], v107 offset:30720
    v_mfma_f32_16x16x32_bf16 v[48:51], v[72:75], a[152:155], v[48:51]
    v_add_u32 v106, s32, v106
    v_mfma_f32_16x16x32_bf16 v[48:51], v[76:79], a[156:159], v[48:51]
    v_mfma_f32_16x16x32_bf16 v[56:59], v[64:67], a[208:211], v[56:59]
    v_mfma_f32_16x16x32_bf16 v[56:59], v[68:71], a[212:215], v[56:59]
    v_mfma_f32_16x16x32_bf16 v[56:59], v[72:75], a[216:219], v[56:59]
    v_mfma_f32_16x16x32_bf16 v[56:59], v[76:79], a[220:223], v[56:59]
    s_waitcnt lgkmcnt(0)
    v_mfma_f32_16x16x32_bf16 v[36:39], v[80:83], a[16:19], v[36:39]
    ds_read_b64_tr_b16 v[64:65], v104 offset:0
    v_mfma_f32_16x16x32_bf16 v[36:39], v[84:87], a[20:23], v[36:39]
    ds_read_b64_tr_b16 v[66:67], v104 offset:2048
    v_mfma_f32_16x16x32_bf16 v[36:39], v[88:91], a[24:27], v[36:39]
    ds_read_b64_tr_b16 v[68:69], v104 offset:4096
    v_mfma_f32_16x16x32_bf16 v[36:39], v[92:95], a[28:31], v[36:39]
    v_mfma_f32_16x16x32_bf16 v[44:47], v[80:83], a[80:83], v[44:47]
    ds_read_b64_tr_b16 v[70:71], v104 offset:6144
    v_mfma_f32_16x16x32_bf16 v[44:47], v[84:87], a[84:87], v[44:47]
    ds_read_b64_tr_b16 v[72:73], v104 offset:8192
    v_mfma_f32_16x16x32_bf16 v[44:47], v[88:91], a[88:91], v[44:47]
    ds_read_b64_tr_b16 v[74:75], v104 offset:10240
    v_mfma_f32_16x16x32_bf16 v[44:47], v[92:95], a[92:95], v[44:47]
    v_mfma_f32_16x16x32_bf16 v[52:55], v[80:83], a[144:147], v[52:55]
    ds_read_b64_tr_b16 v[76:77], v104 offset:12288
    v_mfma_f32_16x16x32_bf16 v[52:55], v[84:87], a[148:151], v[52:55]
    ds_read_b64_tr_b16 v[78:79], v104 offset:14336
    v_mfma_f32_16x16x32_bf16 v[52:55], v[88:91], a[152:155], v[52:55]
    v_add_u32 v107, s32, v107
    v_mfma_f32_16x16x32_bf16 v[52:55], v[92:95], a[156:159], v[52:55]
    v_mfma_f32_16x16x32_bf16 v[60:63], v[80:83], a[208:211], v[60:63]
    v_mfma_f32_16x16x32_bf16 v[60:63], v[84:87], a[212:215], v[60:63]
    v_mfma_f32_16x16x32_bf16 v[60:63], v[88:91], a[216:219], v[60:63]
    v_mfma_f32_16x16x32_bf16 v[60:63], v[92:95], a[220:223], v[60:63]
    s_waitcnt lgkmcnt(0)
    v_mfma_f32_16x16x32_bf16 v[0:3], v[64:67], a[32:35], v[0:3]
    ds_read_b64_tr_b16 v[80:81], v105 offset:0
    s_add_u32 s66, s66, 1
    v_mfma_f32_16x16x32_bf16 v[0:3], v[68:71], a[36:39], v[0:3]
    ds_read_b64_tr_b16 v[82:83], v105 offset:2048
    s_cmp_eq_u32 s66, 5
    v_mfma_f32_16x16x32_bf16 v[0:3], v[72:75], a[40:43], v[0:3]
    ds_read_b64_tr_b16 v[84:85], v105 offset:4096
    s_cselect_b32 s32, 0xfffe0000, s67
    v_mfma_f32_16x16x32_bf16 v[0:3], v[76:79], a[44:47], v[0:3]
    v_mfma_f32_16x16x32_bf16 v[8:11], v[64:67], a[96:99], v[8:11]
    ds_read_b64_tr_b16 v[86:87], v105 offset:6144
    s_cselect_b32 s66, 0, s66
    v_mfma_f32_16x16x32_bf16 v[8:11], v[68:71], a[100:103], v[8:11]
    ds_read_b64_tr_b16 v[88:89], v105 offset:8192
    v_mfma_f32_16x16x32_bf16 v[8:11], v[72:75], a[104:107], v[8:11]
    ds_read_b64_tr_b16 v[90:91], v105 offset:10240
    v_mfma_f32_16x16x32_bf16 v[8:11], v[76:79], a[108:111], v[8:11]
    v_mfma_f32_16x16x32_bf16 v[16:19], v[64:67], a[160:163], v[16:19]
    ds_read_b64_tr_b16 v[92:93], v105 offset:12288
    v_mfma_f32_16x16x32_bf16 v[16:19], v[68:71], a[164:167], v[16:19]
    ds_read_b64_tr_b16 v[94:95], v105 offset:14336
    v_mfma_f32_16x16x32_bf16 v[16:19], v[72:75], a[168:171], v[16:19]
    s_waitcnt vmcnt(24)
    s_barrier
    v_mfma_f32_16x16x32_bf16 v[16:19], v[76:79], a[172:175], v[16:19]
    s_cmp_lt_u32 s55, s34
    s_cbranch_scc0 K1_VS1
    s_add_u32 s35, s38, s65
K1_RS1:
    v_mfma_f32_16x16x32_bf16 v[24:27], v[64:67], a[224:227], v[24:27]
    s_mov_b32 m0, s51
    s_add_u32 s51, s51, 32768
    v_mfma_f32_16x16x32_bf16 v[24:27], v[68:71], a[228:231], v[24:27]
    buffer_load_dwordx4 v108, s[24:27], s35 offen offset:0 lds
    v_mfma_f32_16x16x32_bf16 v[24:27], v[72:75], a[232:235], v[24:27]
    s_add_u32 s35, s35, s36
    v_mfma_f32_16x16x32_bf16 v[24:27], v[76:79], a[236:239], v[24:27]
    s_waitcnt lgkmcnt(0)
    v_mfma_f32_16x16x32_bf16 v[4:7], v[80:83], a[32:35], v[4:7]
    ds_read_b64_tr_b16 v[64:65], v106 offset:0
    v_mfma_f32_16x16x32_bf16 v[4:7], v[84:87], a[36:39], v[4:7]
    ds_read_b64_tr_b16 v[66:67], v106 offset:2048
    v_mfma_f32_16x16x32_bf16 v[4:7], v[88:91], a[40:43], v[4:7]
    ds_read_b64_tr_b16 v[68:69], v106 offset:4096
    v_mfma_f32_16x16x32_bf16 v[4:7], v[92:95], a[44:47], v[4:7]
    buffer_load_dwordx4 v109, s[24:27], s35 offen offset:1024 lds
    v_mfma_f32_16x16x32_bf16 v[12:15], v[80:83], a[96:99], v[12:15]
    ds_read_b64_tr_b16 v[70:71], v106 offset:6144
    s_sub_u32 s35, s35, s37
    v_mfma_f32_16x16x32_bf16 v[12:15], v[84:87], a[100:103], v[12:15]
    ds_read_b64_tr_b16 v[72:73], v106 offset:8192
    v_mfma_f32_16x16x32_bf16 v[12:15], v[88:91], a[104:107], v[12:15]
    ds_read_b64_tr_b16 v[74:75], v106 offset:10240
    v_mfma_f32_16x16x32_bf16 v[12:15], v[92:95], a[108:111], v[12:15]
    buffer_load_dwordx4 v108, s[24:27], s35 offen offset:2048 lds
    v_mfma_f32_16x16x32_bf16 v[20:23], v[80:83], a[160:163], v[20:23]
    ds_read_b64_tr_b16 v[76:77], v106 offset:12288
    s_add_u32 s35, s35, s36
    v_mfma_f32_16x16x32_bf16 v[20:23], v[84:87], a[164:167], v[20:23]
    ds_read_b64_tr_b16 v[78:79], v106 offset:14336
    v_mfma_f32_16x16x32_bf16 v[20:23], v[88:91], a[168:171], v[20:23]
    v_mfma_f32_16x16x32_bf16 v[20:23], v[92:95], a[172:175], v[20:23]
    buffer_load_dwordx4 v109, s[24:27], s35 offen offset:3072 lds
    v_mfma_f32_16x16x32_bf16 v[28:31], v[80:83], a[224:227], v[28:31]
    s_add_u32 m0, m0, 4096
    s_add_u32 s35, s35, s47
    v_mfma_f32_16x16x32_bf16 v[28:31], v[84:87], a[228:231], v[28:31]
    v_mfma_f32_16x16x32_bf16 v[28:31], v[88:91], a[232:235], v[28:31]
    v_mfma_f32_16x16x32_bf16 v[28:31], v[92:95], a[236:239], v[28:31]
    s_waitcnt lgkmcnt(0)
    buffer_load_dwordx4 v108, s[24:27], s35 offen offset:0 lds
    v_mfma_f32_16x16x32_bf16 v[32:35], v[64:67], a[32:35], v[32:35]
    ds_read_b64_tr_b16 v[80:81], v107 offset:0
    s_add_u32 s35, s35, s36
    v_mfma_f32_16x16x32_bf16 v[32:35], v[68:71], a[36:39], v[32:35]
    ds_read_b64_tr_b16 v[82:83], v107 offset:2048
    v_mfma_f32_16x16x32_bf16 v[32:35], v[72:75], a[40:43], v[32:35]
    ds_read_b64_tr_b16 v[84:85], v107 offset:4096
    v_mfma_f32_16x16x32_bf16 v[32:35], v[76:79], a[44:47], v[32:35]
    buffer_load_dwordx4 v109, s[24:27], s35 offen offset:1024 lds
    v_mfma_f32_16x16x32_bf16 v[40:43], v[64:67], a[96:99], v[40:43]
    ds_read_b64_tr_b16 v[86:87], v107 offset:6144
    s_sub_u32 s35, s35, s37
    v_mfma_f32_16x16x32_bf16 v[40:43], v[68:71], a[100:103], v[40:43]
    ds_read_b64_tr_b16 v[88:89], v107 offset:8192
    v_mfma_f32_16x16x32_bf16 v[40:43], v[72:75], a[104:107], v[40:43]
    ds_read_b64_tr_b16 v[90:91], v107 offset:10240
    v_mfma_f32_16x16x32_bf16 v[40:43], v[76:79], a[108:111], v[40:43]
    buffer_load_dwordx4 v108, s[24:27], s35 offen offset:2048 lds
    v_mfma_f32_16x16x32_bf16 v[48:51], v[64:67], a[160:163], v[48:51]
    ds_read_b64_tr_b16 v[92:93], v107 offset:12288
    s_add_u32 s35, s35, s36
    v_mfma_f32_16x16x32_bf16 v[48:51], v[68:71], a[164:167], v[48:51]
    ds_read_b64_tr_b16 v[94:95], v107 offset:14336
    v_mfma_f32_16x16x32_bf16 v[48:51], v[72:75], a[168:171], v[48:51]
    v_mfma_f32_16x16x32_bf16 v[48:51], v[76:79], a[172:175], v[48:51]
    buffer_load_dwordx4 v109, s[24:27], s35 offen offset:3072 lds
    v_mfma_f32_16x16x32_bf16 v[56:59], v[64:67], a[224:227], v[56:59]
    s_cmp_ge_u32 s51, 163840
    s_cselect_b32 s49, 163840, 0
    v_mfma_f32_16x16x32_bf16 v[56:59], v[68:71], a[228:231], v[56:59]
    s_sub_u32 s51, s51, s49
    s_add_u32 s55, s55, 1
    v_mfma_f32_16x16x32_bf16 v[56:59], v[72:75], a[232:235], v[56:59]
    s_add_u32 s38, s38, s100
    v_mfma_f32_16x16x32_bf16 v[56:59], v[76:79], a[236:239], v[56:59]
    s_waitcnt lgkmcnt(0)
    v_mfma_f32_16x16x32_bf16 v[36:39], v[80:83], a[32:35], v[36:39]
    ds_read_b64_tr_b16 v[64:65], v104 offset:16384
    v_mfma_f32_16x16x32_bf16 v[36:39], v[84:87], a[36:39], v[36:39]
    ds_read_b64_tr_b16 v[66:67], v104 offset:18432
    v_mfma_f32_16x16x32_bf16 v[36:39], v[88:91], a[40:43], v[36:39]
    ds_read_b64_tr_b16 v[68:69], v104 offset:20480
    v_mfma_f32_16x16x32_bf16 v[36:39], v[92:95], a[44:47], v[36:39]
    v_mfma_f32_16x16x32_bf16 v[44:47], v[80:83], a[96:99], v[44:47]
    ds_read_b64_tr_b16 v[70:71], v104 offset:22528
    v_mfma_f32_16x16x32_bf16 v[44:47], v[84:87], a[100:103], v[44:47]
    ds_read_b64_tr_b16 v[72:73], v104 offset:24576
    v_mfma_f32_16x16x32_bf16 v[44:47], v[88:91], a[104:107], v[44:47]
    ds_read_b64_tr_b16 v[74:75], v104 offset:26624
    v_mfma_f32_16x16x32_bf16 v[44:47], v[92:95], a[108:111], v[44:47]
    v_mfma_f32_16x16x32_bf16 v[52:55], v[80:83], a[160:163], v[52:55]
    ds_read_b64_tr_b16 v[76:77], v104 offset:28672
    v_mfma_f32_16x16x32_bf16 v[52:55], v[84:87], a[164:167], v[52:55]
    ds_read_b64_tr_b16 v[78:79], v104 offset:30720
    v_mfma_f32_16x16x32_bf16 v[52:55], v[88:91], a[168:171], v[52:55]
    v_mfma_f32_16x16x32_bf16 v[52:55], v[92:95], a[172:175], v[52:55]
    v_mfma_f32_16x16x32_bf16 v[60:63], v[80:83], a[224:227], v[60:63]
    v_mfma_f32_16x16x32_bf16 v[60:63], v[84:87], a[228:231], v[60:63]
    v_mfma_f32_16x16x32_bf16 v[60:63], v[88:91], a[232:235], v[60:63]
    v_mfma_f32_16x16x32_bf16 v[60:63], v[92:95], a[236:239], v[60:63]
    s_waitcnt lgkmcnt(0)
    v_mfma_f32_16x16x32_bf16 v[0:3], v[64:67], a[48:51], v[0:3]
    ds_read_b64_tr_b16 v[80:81], v105 offset:16384
    v_mfma_f32_16x16x32_bf16 v[0:3], v[68:71], a[52:55], v[0:3]
    ds_read_b64_tr_b16 v[82:83], v105 offset:18432
    v_mfma_f32_16x16x32_bf16 v[0:3], v[72:75], a[56:59], v[0:3]
    ds_read_b64_tr_b16 v[84:85], v105 offset:20480
    v_mfma_f32_16x16x32_bf16 v[0:3], v[76:79], a[60:63], v[0:3]
    v_mfma_f32_16x16x32_bf16 v[8:11], v[64:67], a[112:115], v[8:11]
    ds_read_b64_tr_b16 v[86:87], v105 offset:22528
    v_mfma_f32_16x16x32_bf16 v[8:11], v[68:71], a[116:119], v[8:11]
    ds_read_b64_tr_b16 v[88:89], v105 offset:24576
    v_mfma_f32_16x16x32_bf16 v[8:11], v[72:75], a[120:123], v[8:11]
    ds_read_b64_tr_b16 v[90:91], v105 offset:26624
    v_mfma_f32_16x16x32_bf16 v[8:11], v[76:79], a[124:127], v[8:11]
    v_mfma_f32_16x16x32_bf16 v[16:19], v[64:67], a[176:179], v[16:19]
    ds_read_b64_tr_b16 v[92:93], v105 offset:28672
    v_mfma_f32_16x16x32_bf16 v[16:19], v[68:71], a[180:183], v[16:19]
    ds_read_b64_tr_b16 v[94:95], v105 offset:30720
    v_mfma_f32_16x16x32_bf16 v[16:19], v[72:75], a[184:187], v[16:19]
    v_add_u32 v104, s32, v104
    v_mfma_f32_16x16x32_bf16 v[16:19], v[76:79], a[188:191], v[16:19]
    v_mfma_f32_16x16x32_bf16 v[24:27], v[64:67], a[240:243], v[24:27]
    v_mfma_f32_16x16x32_bf16 v[24:27], v[68:71], a[244:247], v[24:27]
    v_mfma_f32_16x16x32_bf16 v[24:27], v[72:75], a[248:251], v[24:27]
    v_mfma_f32_16x16x32_bf16 v[24:27], v[76:79], a[252:255], v[24:27]
    s_waitcnt lgkmcnt(0)
    v_mfma_f32_16x16x32_bf16 v[4:7], v[80:83], a[48:51], v[4:7]
    ds_read_b64_tr_b16 v[64:65], v106 offset:16384
    v_mfma_f32_16x16x32_bf16 v[4:7], v[84:87], a[52:55], v[4:7]
    ds_read_b64_tr_b16 v[66:67], v106 offset:18432
    v_mfma_f32_16x16x32_bf16 v[4:7], v[88:91], a[56:59], v[4:7]
    ds_read_b64_tr_b16 v[68:69], v106 offset:20480
    v_mfma_f32_16x16x32_bf16 v[4:7], v[92:95], a[60:63], v[4:7]
    v_mfma_f32_16x16x32_bf16 v[12:15], v[80:83], a[112:115], v[12:15]
    ds_read_b64_tr_b16 v[70:71], v106 offset:22528
    v_mfma_f32_16x16x32_bf16 v[12:15], v[84:87], a[116:119], v[12:15]
    ds_read_b64_tr_b16 v[72:73], v106 offset:24576
    v_mfma_f32_16x16x32_bf16 v[12:15], v[88:91], a[120:123], v[12:15]
    ds_read_b64_tr_b16 v[74:75], v106 offset:26624
    v_mfma_f32_16x16x32_bf16 v[12:15], v[92:95], a[124:127], v[12:15]
    v_mfma_f32_16x16x32_bf16 v[20:23], v[80:83], a[176:179], v[20:23]
    ds_read_b64_tr_b16 v[76:77], v106 offset:28672
    v_mul_f32 v0, s44, v0
    v_mfma_f32_16x16x32_bf16 v[20:23], v[84:87], a[180:183], v[20:23]
    ds_read_b64_tr_b16 v[78:79], v106 offset:30720
    v_mul_f32 v1, s44, v1
    v_mfma_f32_16x16x32_bf16 v[20:23], v[88:91], a[184:187], v[20:23]
    v_add_u32 v105, s32, v105
    v_cvt_pk_bf16_f32 v96, v0, v1
    v_mfma_f32_16x16x32_bf16 v[20:23], v[92:95], a[188:191], v[20:23]
    v_mul_f32 v2, s44, v2
    v_mul_f32 v3, s44, v3
    v_mfma_f32_16x16x32_bf16 v[28:31], v[80:83], a[240:243], v[28:31]
    v_cvt_pk_bf16_f32 v97, v2, v3
    v_mul_f32 v4, s44, v4
    v_mfma_f32_16x16x32_bf16 v[28:31], v[84:87], a[244:247], v[28:31]
    v_mul_f32 v5, s44, v5
    v_cvt_pk_bf16_f32 v98, v4, v5
    v_mfma_f32_16x16x32_bf16 v[28:31], v[88:91], a[248:251], v[28:31]
    v_mul_f32 v6, s44, v6
    v_mul_f32 v7, s44, v7
    v_mfma_f32_16x16x32_bf16 v[28:31], v[92:95], a[252:255], v[28:31]
    s_waitcnt lgkmcnt(0)
    v_cvt_pk_bf16_f32 v99, v6, v7
    v_mul_f32 v8, s44, v8
    v_mfma_f32_16x16x32_bf16 v[32:35], v[64:67], a[48:51], v[32:35]
    ds_read_b64_tr_b16 v[80:81], v107 offset:16384
    v_mul_f32 v9, s44, v9
    v_mfma_f32_16x16x32_bf16 v[32:35], v[68:71], a[52:55], v[32:35]
    ds_read_b64_tr_b16 v[82:83], v107 offset:18432
    v_cvt_pk_bf16_f32 v100, v8, v9
    v_mfma_f32_16x16x32_bf16 v[32:35], v[72:75], a[56:59], v[32:35]
    ds_read_b64_tr_b16 v[84:85], v107 offset:20480
    v_mul_f32 v10, s44, v10
    v_mfma_f32_16x16x32_bf16 v[32:35], v[76:79], a[60:63], v[32:35]
    buffer_store_dwordx4 v[96:99], v110, s[28:31], s40 offen sc1
    v_mfma_f32_16x16x32_bf16 v[40:43], v[64:67], a[112:115], v[40:43]
    ds_read_b64_tr_b16 v[86:87], v107 offset:22528
    v_mul_f32 v11, s44, v11
    v_mfma_f32_16x16x32_bf16 v[40:43], v[68:71], a[116:119], v[40:43]
    ds_read_b64_tr_b16 v[88:89], v107 offset:24576
    v_cvt_pk_bf16_f32 v101, v10, v11
    v_mfma_f32_16x16x32_bf16 v[40:43], v[72:75], a[120:123], v[40:43]
    ds_read_b64_tr_b16 v[90:91], v107 offset:26624
    v_mul_f32 v12, s44, v12
    v_mfma_f32_16x16x32_bf16 v[40:43], v[76:79], a[124:127], v[40:43]
    v_mul_f32 v13, s44, v13
    v_cvt_pk_bf16_f32 v102, v12, v13
    v_mfma_f32_16x16x32_bf16 v[48:51], v[64:67], a[176:179], v[48:51]
    ds_read_b64_tr_b16 v[92:93], v107 offset:28672
    v_mul_f32 v14, s44, v14
    v_mfma_f32_16x16x32_bf16 v[48:51], v[68:71], a[180:183], v[48:51]
    ds_read_b64_tr_b16 v[94:95], v107 offset:30720
    v_mul_f32 v15, s44, v15
    v_mfma_f32_16x16x32_bf16 v[48:51], v[72:75], a[184:187], v[48:51]
    v_add_u32 v106, s32, v106
    v_cvt_pk_bf16_f32 v103, v14, v15
    v_mfma_f32_16x16x32_bf16 v[48:51], v[76:79], a[188:191], v[48:51]
    buffer_store_dwordx4 v[100:103], v111, s[28:31], s40 offen sc1
    v_mfma_f32_16x16x32_bf16 v[56:59], v[64:67], a[240:243], v[56:59]
    v_mul_f32 v16, s44, v16
    v_mul_f32 v17, s44, v17
    v_mfma_f32_16x16x32_bf16 v[56:59], v[68:71], a[244:247], v[56:59]
    v_cvt_pk_bf16_f32 v96, v16, v17
    v_mul_f32 v18, s44, v18
    v_mfma_f32_16x16x32_bf16 v[56:59], v[72:75], a[248:251], v[56:59]
    v_mul_f32 v19, s44, v19
    v_cvt_pk_bf16_f32 v97, v18, v19
    v_mfma_f32_16x16x32_bf16 v[56:59], v[76:79], a[252:255], v[56:59]
    s_waitcnt lgkmcnt(0)
    v_mul_f32 v20, s44, v20
    v_mul_f32 v21, s44, v21
    v_mfma_f32_16x16x32_bf16 v[36:39], v[80:83], a[48:51], v[36:39]
    ds_read_b64_tr_b16 v[64:65], v104 offset:0
    s_cmp_lt_u32 s33, s34
    v_mfma_f32_16x16x32_bf16 v[36:39], v[84:87], a[52:55], v[36:39]
    ds_read_b64_tr_b16 v[66:67], v104 offset:2048
    v_cvt_pk_bf16_f32 v98, v20, v21
    v_mfma_f32_16x16x32_bf16 v[36:39], v[88:91], a[56:59], v[36:39]
    ds_read_b64_tr_b16 v[68:69], v104 offset:4096
    v_mul_f32 v22, s44, v22
    v_mfma_f32_16x16x32_bf16 v[36:39], v[92:95], a[60:63], v[36:39]
    v_mul_f32 v23, s44, v23
    v_cvt_pk_bf16_f32 v99, v22, v23
    v_mfma_f32_16x16x32_bf16 v[44:47], v[80:83], a[112:115], v[44:47]
    ds_read_b64_tr_b16 v[70:71], v104 offset:6144
    v_mul_f32 v24, s44, v24
    v_mfma_f32_16x16x32_bf16 v[44:47], v[84:87], a[116:119], v[44:47]
    ds_read_b64_tr_b16 v[72:73], v104 offset:8192
    v_mul_f32 v25, s44, v25
    v_mfma_f32_16x16x32_bf16 v[44:47], v[88:91], a[120:123], v[44:47]
    ds_read_b64_tr_b16 v[74:75], v104 offset:10240
    v_cvt_pk_bf16_f32 v100, v24, v25
    v_mfma_f32_16x16x32_bf16 v[44:47], v[92:95], a[124:127], v[44:47]
    buffer_store_dwordx4 v[96:99], v110, s[28:31], s41 offen sc1
    v_mfma_f32_16x16x32_bf16 v[52:55], v[80:83], a[176:179], v[52:55]
    ds_read_b64_tr_b16 v[76:77], v104 offset:12288
    v_mul_f32 v26, s44, v26
    v_mfma_f32_16x16x32_bf16 v[52:55], v[84:87], a[180:183], v[52:55]
    ds_read_b64_tr_b16 v[78:79], v104 offset:14336
    v_mul_f32 v27, s44, v27
    v_mfma_f32_16x16x32_bf16 v[52:55], v[88:91], a[184:187], v[52:55]
    v_add_u32 v107, s32, v107
    v_cvt_pk_bf16_f32 v101, v26, v27
    v_mfma_f32_16x16x32_bf16 v[52:55], v[92:95], a[188:191], v[52:55]
    v_mul_f32 v28, s44, v28
    v_mul_f32 v29, s44, v29
    v_mfma_f32_16x16x32_bf16 v[60:63], v[80:83], a[240:243], v[60:63]
    v_cvt_pk_bf16_f32 v102, v28, v29
    v_mul_f32 v30, s44, v30
    v_mfma_f32_16x16x32_bf16 v[60:63], v[84:87], a[244:247], v[60:63]
    v_mul_f32 v31, s44, v31
    v_cvt_pk_bf16_f32 v103, v30, v31
    v_mfma_f32_16x16x32_bf16 v[60:63], v[88:91], a[248:251], v[60:63]
    buffer_store_dwordx4 v[100:103], v111, s[28:31], s41 offen sc1
    v_mfma_f32_16x16x32_bf16 v[60:63], v[92:95], a[252:255], v[60:63]
    s_waitcnt lgkmcnt(0)
    s_cbranch_scc1 K1_S
K1_FIN:
    s_nop 7
    v_mul_f32 v32, s44, v32
    v_mul_f32 v33, s44, v33
    v_cvt_pk_bf16_f32 v96, v32, v33
    v_mul_f32 v34, s44, v34
    v_mul_f32 v35, s44, v35
    v_cvt_pk_bf16_f32 v97, v34, v35
    v_mul_f32 v36, s44, v36
    v_mul_f32 v37, s44, v37
    v_cvt_pk_bf16_f32 v98, v36, v37
    v_mul_f32 v38, s44, v38
    v_mul_f32 v39, s44, v39
    v_cvt_pk_bf16_f32 v99, v38, v39
    buffer_store_dwordx4 v[96:99], v110, s[28:31], s45 offen sc1
    v_mul_f32 v40, s44, v40
    v_mul_f32 v41, s44, v41
    v_cvt_pk_bf16_f32 v100, v40, v41
    v_mul_f32 v42, s44, v42
    v_mul_f32 v43, s44, v43
    v_cvt_pk_bf16_f32 v101, v42, v43
    v_mul_f32 v44, s44, v44
    v_mul_f32 v45, s44, v45
    v_cvt_pk_bf16_f32 v102, v44, v45
    v_mul_f32 v46, s44, v46
    v_mul_f32 v47, s44, v47
    v_cvt_pk_bf16_f32 v103, v46, v47
    buffer_store_dwordx4 v[100:103], v111, s[28:31], s45 offen sc1
    v_mul_f32 v48, s44, v48
    v_mul_f32 v49, s44, v49
    v_cvt_pk_bf16_f32 v96, v48, v49
    v_mul_f32 v50, s44, v50
    v_mul_f32 v51, s44, v51
    v_cvt_pk_bf16_f32 v97, v50, v51
    v_mul_f32 v52, s44, v52
    v_mul_f32 v53, s44, v53
    v_cvt_pk_bf16_f32 v98, v52, v53
    v_mul_f32 v54, s44, v54
    v_mul_f32 v55, s44, v55
    v_cvt_pk_bf16_f32 v99, v54, v55
    buffer_store_dwordx4 v[96:99], v110, s[28:31], s46 offen sc1
    v_mul_f32 v56, s44, v56
    v_mul_f32 v57, s44, v57
    v_cvt_pk_bf16_f32 v100, v56, v57
    v_mul_f32 v58, s44, v58
    v_mul_f32 v59, s44, v59
    v_cvt_pk_bf16_f32 v101, v58, v59
    v_mul_f32 v60, s44, v60
    v_mul_f32 v61, s44, v61
    v_cvt_pk_bf16_f32 v102, v60, v61
    v_mul_f32 v62, s44, v62
    v_mul_f32 v63, s44, v63
    v_cvt_pk_bf16_f32 v103, v62, v63
    buffer_store_dwordx4 v[100:103], v111, s[28:31], s46 offen sc1
    s_cmp_lg_u32 s60, 4
    s_cbranch_scc1 K1_END
    s_mov_b64 s[24:25], s[16:17]
    s_mov_b32 s26, 1024
    v_lshrrev_b32 v128, 4, v140
    v_lshlrev_b32 v128, 4, v128
    buffer_load_dwordx4 v[144:147], v128, s[24:27], 0 offen offset:0
    buffer_load_dwordx4 v[148:151], v128, s[24:27], 0 offen offset:64
    buffer_load_dwordx4 v[152:155], v128, s[24:27], 0 offen offset:128
    buffer_load_dwordx4 v[156:159], v128, s[24:27], 0 offen offset:192
    buffer_load_dwordx4 v[160:163], v128, s[24:27], 0 offen offset:256
    buffer_load_dwordx4 v[164:167], v128, s[24:27], 0 offen offset:320
    buffer_load_dwordx4 v[168:171], v128, s[24:27], 0 offen offset:384
    buffer_load_dwordx4 v[172:175], v128, s[24:27], 0 offen offset:448
    buffer_load_dwordx4 v[176:179], v128, s[24:27], 0 offen offset:512
    buffer_load_dwordx4 v[180:183], v128, s[24:27], 0 offen offset:576
    buffer_load_dwordx4 v[184:187], v128, s[24:27], 0 offen offset:640
    buffer_load_dwordx4 v[188:191], v128, s[24:27], 0 offen offset:704
    buffer_load_dwordx4 v[192:195], v128, s[24:27], 0 offen offset:768
    buffer_load_dwordx4 v[196:199], v128, s[24:27], 0 offen offset:832
    buffer_load_dwordx4 v[200:203], v128, s[24:27], 0 offen offset:896
    buffer_load_dwordx4 v[204:207], v128, s[24:27], 0 offen offset:960
    v_and_b32 v129, 15, v140
    v_lshlrev_b32 v129, 2, v129
    s_lshl_b32 s49, s61, 8
    s_add_u32 s49, s49, 56623104
    s_waitcnt vmcnt(0)
    v_mfma_f32_16x16x32_bf16 v[0:3], v[144:147], a[0:3], 0
    v_mfma_f32_16x16x32_bf16 v[0:3], v[148:151], a[4:7], v[0:3]
    v_mfma_f32_16x16x32_bf16 v[0:3], v[152:155], a[8:11], v[0:3]
    v_mfma_f32_16x16x32_bf16 v[0:3], v[156:159], a[12:15], v[0:3]
    v_mfma_f32_16x16x32_bf16 v[0:3], v[160:163], a[16:19], v[0:3]
    v_mfma_f32_16x16x32_bf16 v[0:3], v[164:167], a[20:23], v[0:3]
    v_mfma_f32_16x16x32_bf16 v[0:3], v[168:171], a[24:27], v[0:3]
    v_mfma_f32_16x16x32_bf16 v[0:3], v[172:175], a[28:31], v[0:3]
    v_mfma_f32_16x16x32_bf16 v[0:3], v[176:179], a[32:35], v[0:3]
    v_mfma_f32_16x16x32_bf16 v[0:3], v[180:183], a[36:39], v[0:3]
    v_mfma_f32_16x16x32_bf16 v[0:3], v[184:187], a[40:43], v[0:3]
    v_mfma_f32_16x16x32_bf16 v[0:3], v[188:191], a[44:47], v[0:3]
    v_mfma_f32_16x16x32_bf16 v[0:3], v[192:195], a[48:51], v[0:3]
    v_mfma_f32_16x16x32_bf16 v[0:3], v[196:199], a[52:55], v[0:3]
    v_mfma_f32_16x16x32_bf16 v[0:3], v[200:203], a[56:59], v[0:3]
    v_mfma_f32_16x16x32_bf16 v[0:3], v[204:207], a[60:63], v[0:3]
    v_mfma_f32_16x16x32_bf16 v[4:7], v[144:147], a[64:67], 0
    v_mfma_f32_16x16x32_bf16 v[4:7], v[148:151], a[68:71], v[4:7]
    v_mfma_f32_16x16x32_bf16 v[4:7], v[152:155], a[72:75], v[4:7]
    v_mfma_f32_16x16x32_bf16 v[4:7], v[156:159], a[76:79], v[4:7]
    v_mfma_f32_16x16x32_bf16 v[4:7], v[160:163], a[80:83], v[4:7]
    v_mfma_f32_16x16x32_bf16 v[4:7], v[164:167], a[84:87], v[4:7]
    v_mfma_f32_16x16x32_bf16 v[4:7], v[168:171], a[88:91], v[4:7]
    v_mfma_f32_16x16x32_bf16 v[4:7], v[172:175], a[92:95], v[4:7]
    v_mfma_f32_16x16x32_bf16 v[4:7], v[176:179], a[96:99], v[4:7]
    v_mfma_f32_16x16x32_bf16 v[4:7], v[180:183], a[100:103], v[4:7]
    v_mfma_f32_16x16x32_bf16 v[4:7], v[184:187], a[104:107], v[4:7]
    v_mfma_f32_16x16x32_bf16 v[4:7], v[188:191], a[108:111], v[4:7]
    v_mfma_f32_16x16x32_bf16 v[4:7], v[192:195], a[112:115], v[4:7]
    v_mfma_f32_16x16x32_bf16 v[4:7], v[196:199], a[116:119], v[4:7]
    v_mfma_f32_16x16x32_bf16 v[4:7], v[200:203], a[120:123], v[4:7]
    v_mfma_f32_16x16x32_bf16 v[4:7], v[204:207], a[124:127], v[4:7]
    v_mfma_f32_16x16x32_bf16 v[8:11], v[144:147], a[128:131], 0
    v_mfma_f32_16x16x32_bf16 v[8:11], v[148:151], a[132:135], v[8:11]
    v_mfma_f32_16x16x32_bf16 v[8:11], v[152:155], a[136:139], v[8:11]
    v_mfma_f32_16x16x32_bf16 v[8:11], v[156:159], a[140:143], v[8:11]
    v_mfma_f32_16x16x32_bf16 v[8:11], v[160:163], a[144:147], v[8:11]
    v_mfma_f32_16x16x32_bf16 v[8:11], v[164:167], a[148:151], v[8:11]
    v_mfma_f32_16x16x32_bf16 v[8:11], v[168:171], a[152:155], v[8:11]
    v_mfma_f32_16x16x32_bf16 v[8:11], v[172:175], a[156:159], v[8:11]
    v_mfma_f32_16x16x32_bf16 v[8:11], v[176:179], a[160:163], v[8:11]
    v_mfma_f32_16x16x32_bf16 v[8:11], v[180:183], a[164:167], v[8:11]
    v_mfma_f32_16x16x32_bf16 v[8:11], v[184:187], a[168:171], v[8:11]
    v_mfma_f32_16x16x32_bf16 v[8:11], v[188:191], a[172:175], v[8:11]
    v_mfma_f32_16x16x32_bf16 v[8:11], v[192:195], a[176:179], v[8:11]
    v_mfma_f32_16x16x32_bf16 v[8:11], v[196:199], a[180:183], v[8:11]
    v_mfma_f32_16x16x32_bf16 v[8:11], v[200:203], a[184:187], v[8:11]
    v_mfma_f32_16x16x32_bf16 v[8:11], v[204:207], a[188:191], v[8:11]
    v_mfma_f32_16x16x32_bf16 v[12:15], v[144:147], a[192:195], 0
    v_mfma_f32_16x16x32_bf16 v[12:15], v[148:151], a[196:199], v[12:15]
    v_mfma_f32_16x16x32_bf16 v[12:15], v[152:155], a[200:203], v[12:15]
    v_mfma_f32_16x16x32_bf16 v[12:15], v[156:159], a[204:207], v[12:15]
    v_mfma_f32_16x16x32_bf16 v[12:15], v[160:163], a[208:211], v[12:15]
    v_mfma_f32_16x16x32_bf16 v[12:15], v[164:167], a[212:215], v[12:15]
    v_mfma_f32_16x16x32_bf16 v[12:15], v[168:171], a[216:219], v[12:15]
    v_mfma_f32_16x16x32_bf16 v[12:15], v[172:175], a[220:223], v[12:15]
    v_mfma_f32_16x16x32_bf16 v[12:15], v[176:179], a[224:227], v[12:15]
    v_mfma_f32_16x16x32_bf16 v[12:15], v[180:183], a[228:231], v[12:15]
    v_mfma_f32_16x16x32_bf16 v[12:15], v[184:187], a[232:235], v[12:15]
    v_mfma_f32_16x16x32_bf16 v[12:15], v[188:191], a[236:239], v[12:15]
    v_mfma_f32_16x16x32_bf16 v[12:15], v[192:195], a[240:243], v[12:15]
    v_mfma_f32_16x16x32_bf16 v[12:15], v[196:199], a[244:247], v[12:15]
    v_mfma_f32_16x16x32_bf16 v[12:15], v[200:203], a[248:251], v[12:15]
    v_mfma_f32_16x16x32_bf16 v[12:15], v[204:207], a[252:255], v[12:15]
    s_nop 7
    v_mul_f32 v0, 0xbfb8aa3b, v0
    v_mul_f32 v4, 0xbfb8aa3b, v4
    v_mul_f32 v8, 0xbfb8aa3b, v8
    v_mul_f32 v12, 0xbfb8aa3b, v12
    v_exp_f32 v0, v0
    v_exp_f32 v4, v4
    v_exp_f32 v8, v8
    v_exp_f32 v12, v12
    v_add_f32 v0, 1.0, v0
    v_add_f32 v4, 1.0, v4
    v_add_f32 v8, 1.0, v8
    v_add_f32 v12, 1.0, v12
    v_rcp_f32 v0, v0
    v_rcp_f32 v4, v4
    v_rcp_f32 v8, v8
    v_rcp_f32 v12, v12
    s_nop 0
    buffer_store_dword v0, v129, s[28:31], s49 offen offset:0 sc1
    buffer_store_dword v4, v129, s[28:31], s49 offen offset:64 sc1
    buffer_store_dword v8, v129, s[28:31], s49 offen offset:128 sc1
    buffer_store_dword v12, v129, s[28:31], s49 offen offset:192 sc1
K1_END:
    s_mov_b32 s37, s34
    v_mbcnt_lo_u32_b32 v235, -1, 0
    v_mbcnt_hi_u32_b32 v235, -1, v235
    v_lshlrev_b32 v232, 4, v235
    s_and_b32 s26, s2, 7
    s_lshl_b32 s26, s26, 2
    s_lshr_b32 s30, s2, 6
    s_add_u32 s26, s26, s30
    s_lshr_b32 s25, s2, 3
    s_and_b32 s25, s25, 7
    s_lshl_b32 s34, s25, 3
    s_sub_u32 s35, 120, s34
    s_add_u32 s34, s34, s3
    s_add_u32 s35, s35, s3
    s_lshl_b32 s52, s34, 14
    s_lshl_b32 s53, s35, 14
    s_lshl_b32 s43, s3, 1
    s_sub_u32 s43, 7, s43
    s_lshl_b32 s58, s43, 14
    s_sub_u32 s58, s58, 9216
    s_lshl_b32 s57, s3, 13
    s_lshl_b32 s55, s3, 18
    s_lshl_b32 s30, s26, 8
    s_add_u32 s55, s55, s30
    s_mov_b32 s46, 0x200000
    s_mov_b32 s47, 0x20000
    s_mov_b32 s50, 0x400000
    s_mov_b32 s51, 0x20000
    v_lshrrev_b32 v240, 4, v235
    v_and_b32 v238, 7, v235
    v_xor_b32 v238, v238, v240
    v_lshlrev_b32 v238, 4, v238
    v_lshrrev_b32 v239, 3, v235
    v_lshl_add_u32 v172, v239, 10, v238
    v_xor_b32 v173, 64, v172
    v_and_b32 v238, 15, v235
    v_lshlrev_b32 v239, 1, v240
    v_xor_b32 v238, v238, v239
    v_lshrrev_b32 v239, 1, v238
    v_xor_b32 v239, v239, v238
    v_and_b32 v239, 1, v239
    v_mul_u32_u24 v239, 3, v239
    v_xor_b32 v238, v238, v239
    v_lshlrev_b32 v238, 4, v238
    v_lshl_add_u32 v174, v240, 13, v238
    v_xor_b32 v175, 128, v174
    v_and_b32 v241, 15, v235
    v_lshrrev_b32 v238, 1, v241
    v_xor_b32 v238, v238, v240
    v_lshlrev_b32 v238, 4, v238
    v_lshl_add_u32 v238, v241, 7, v238
    s_add_u32 s30, s57, 32768
    v_add_u32 v168, s30, v238
    v_xor_b32 v169, 64, v168
    v_add_u32 v170, 0x10000, v168
    v_add_u32 v171, 0x10000, v169
    v_bfe_u32 v238, v235, 1, 1
    v_bfe_u32 v239, v235, 2, 3
    v_lshl_add_u32 v238, v239, 1, v238
    v_lshlrev_b32 v238, 4, v238
    v_and_b32 v239, 1, v235
    v_lshl_add_u32 v238, v239, 3, v238
    v_lshrrev_b32 v239, 2, v235
    v_lshl_add_u32 v160, v239, 8, v238
    v_xor_b32 v161, 32, v160
    s_waitcnt lgkmcnt(0)
    s_mov_b64 s[44:45], s[4:5]
    s_mov_b64 s[48:49], s[10:11]
    s_waitcnt vmcnt(8)
    s_barrier
    s_cmp_eq_u32 s37, 10
    s_cbranch_scc1 KB_GO
    s_add_u32 m0, s57, 32768
    s_add_u32 s54, s52, 0
    buffer_load_dwordx4 v172, s[44:47], s54 offen offset:0 lds
    s_add_u32 s54, s54, 7168
    buffer_load_dwordx4 v173, s[44:47], s54 offen offset:1024 lds
    s_add_u32 s54, s54, s58
    buffer_load_dwordx4 v172, s[44:47], s54 offen offset:2048 lds
    s_add_u32 s54, s54, 7168
    buffer_load_dwordx4 v173, s[44:47], s54 offen offset:3072 lds
    s_add_u32 m0, s57, 36864
    s_add_u32 s54, s53, 0
    buffer_load_dwordx4 v172, s[44:47], s54 offen offset:0 lds
    s_add_u32 s54, s54, 7168
    buffer_load_dwordx4 v173, s[44:47], s54 offen offset:1024 lds
    s_add_u32 s54, s54, s58
    buffer_load_dwordx4 v172, s[44:47], s54 offen offset:2048 lds
    s_add_u32 s54, s54, 7168
    buffer_load_dwordx4 v173, s[44:47], s54 offen offset:3072 lds
    s_add_u32 m0, s57, 65536
    s_add_u32 s54, s52, 128
    buffer_load_dwordx4 v172, s[44:47], s54 offen offset:0 lds
    s_add_u32 s54, s54, 7168
    buffer_load_dwordx4 v173, s[44:47], s54 offen offset:1024 lds
    s_add_u32 s54, s54, s58
    buffer_load_dwordx4 v172, s[44:47], s54 offen offset:2048 lds
    s_add_u32 s54, s54, 7168
    buffer_load_dwordx4 v173, s[44:47], s54 offen offset:3072 lds
    s_add_u32 m0, s57, 69632
    s_add_u32 s54, s53, 128
    buffer_load_dwordx4 v172, s[44:47], s54 offen offset:0 lds
    s_add_u32 s54, s54, 7168
    buffer_load_dwordx4 v173, s[44:47], s54 offen offset:1024 lds
    s_add_u32 s54, s54, s58
    buffer_load_dwordx4 v172, s[44:47], s54 offen offset:2048 lds
    s_add_u32 s54, s54, 7168
    buffer_load_dwordx4 v173, s[44:47], s54 offen offset:3072 lds
    s_add_u32 m0, s57, 0
    s_add_u32 s56, s55, 0
    buffer_load_dwordx4 v174, s[48:51], s56 offen offset:0 lds
    s_add_u32 s56, s56, 64512
    buffer_load_dwordx4 v175, s[48:51], s56 offen offset:1024 lds
    s_add_u32 s56, s56, 64512
    buffer_load_dwordx4 v174, s[48:51], s56 offen offset:2048 lds
    s_add_u32 s56, s56, 64512
    buffer_load_dwordx4 v175, s[48:51], s56 offen offset:3072 lds
    s_add_u32 m0, s57, 4096
    s_add_u32 s56, s55, 32768
    buffer_load_dwordx4 v174, s[48:51], s56 offen offset:0 lds
    s_add_u32 s56, s56, 64512
    buffer_load_dwordx4 v175, s[48:51], s56 offen offset:1024 lds
    s_add_u32 s56, s56, 64512
    buffer_load_dwordx4 v174, s[48:51], s56 offen offset:2048 lds
    s_add_u32 s56, s56, 64512
    buffer_load_dwordx4 v175, s[48:51], s56 offen offset:3072 lds
    s_add_u32 m0, s57, 98304
    s_add_u32 s54, s52, 256
    buffer_load_dwordx4 v172, s[44:47], s54 offen offset:0 lds
    s_add_u32 s54, s54, 7168
    buffer_load_dwordx4 v173, s[44:47], s54 offen offset:1024 lds
    s_add_u32 s54, s54, s58
    buffer_load_dwordx4 v172, s[44:47], s54 offen offset:2048 lds
    s_add_u32 s54, s54, 7168
    buffer_load_dwordx4 v173, s[44:47], s54 offen offset:3072 lds
    s_add_u32 m0, s57, 102400
    s_add_u32 s54, s53, 256
    buffer_load_dwordx4 v172, s[44:47], s54 offen offset:0 lds
    s_add_u32 s54, s54, 7168
    buffer_load_dwordx4 v173, s[44:47], s54 offen offset:1024 lds
    s_add_u32 s54, s54, s58
    buffer_load_dwordx4 v172, s[44:47], s54 offen offset:2048 lds
    s_add_u32 s54, s54, 7168
    buffer_load_dwordx4 v173, s[44:47], s54 offen offset:3072 lds
    s_waitcnt vmcnt(8)
    s_barrier
KB_GO:
    ds_read_b64_tr_b16 v[144:145], v160 offset:0
    ds_read_b64_tr_b16 v[146:147], v160 offset:4096
    ds_read_b64_tr_b16 v[148:149], v160 offset:8192
    ds_read_b64_tr_b16 v[150:151], v160 offset:12288
    ds_read_b64_tr_b16 v[152:153], v160 offset:16384
    ds_read_b64_tr_b16 v[154:155], v160 offset:20480
    ds_read_b64_tr_b16 v[156:157], v160 offset:24576
    ds_read_b64_tr_b16 v[158:159], v160 offset:28672
    ds_read_b128 a[128:131], v168 offset:0
    ds_read_b128 a[132:135], v169 offset:0
    ds_read_b128 a[136:139], v168 offset:32768
    ds_read_b128 a[140:143], v169 offset:32768
    ds_read_b128 a[144:147], v168 offset:2048
    ds_read_b128 a[148:151], v169 offset:2048
    ds_read_b128 a[152:155], v168 offset:34816
    s_add_u32 s20, s18, 58720256
    s_addc_u32 s21, s19, 0
    s_mov_b32 s22, 28311552
    s_mov_b32 s23, 0x20000
    s_lshr_b32 s30, s2, 3
    s_and_b32 s30, s30, 7
    s_lshl_b32 s30, s30, 2
    s_add_u32 s30, s30, s3
    s_lshl_b32 s30, s30, 6
    s_and_b32 s31, s2, 7
    s_lshl_b32 s31, s31, 2
    s_add_u32 s30, s30, s31
    s_lshr_b32 s31, s2, 6
    s_add_u32 s30, s30, s31
    s_lshl_b32 s30, s30, 10
    s_add_u32 s30, s30, 16777216
    s_add_u32 s31, s30, 32768
    v_mov_b32 v220, -1
    v_mov_b32 v221, -1
    v_mov_b32 v222, -1
    v_mov_b32 v223, -1
    buffer_store_dwordx4 v[220:223], v232, s[20:23], s30 offen sc1
    buffer_store_dwordx4 v[220:223], v232, s[20:23], s31 offen sc1
    s_lshl_b32 s30, s2, 4
    s_add_u32 s30, s30, 28049408
    s_mov_b64 exec, 1
    v_mov_b32 v224, -1
    buffer_store_dword v224, off, s[20:23], s30 sc1
    s_mov_b64 exec, -1
    s_waitcnt lgkmcnt(6)
    ds_read_b128 a[156:159], v169 offset:34816
    ds_read_b128 a[160:163], v168 offset:4096
    ds_read_b128 a[164:167], v169 offset:4096
    ds_read_b128 a[168:171], v168 offset:36864
    ds_read_b128 a[172:175], v169 offset:36864
    ds_read_b128 a[176:179], v168 offset:6144
    ds_read_b128 a[180:183], v169 offset:6144
    ds_read_b128 a[184:187], v168 offset:38912
    ds_read_b128 a[188:191], v169 offset:38912
    s_waitcnt lgkmcnt(0)
    v_mfma_f32_16x16x32_bf16 v[0:3], v[144:147], a[128:131], 0
    ds_read_b64_tr_b16 v[128:129], v161 offset:0
    v_xor_b32 v162, 96, v161
    v_mfma_f32_16x16x32_bf16 v[0:3], v[148:151], a[132:135], v[0:3]
    ds_read_b64_tr_b16 v[130:131], v161 offset:4096
    v_xor_b32 v163, 64, v161
    v_mfma_f32_16x16x32_bf16 v[0:3], v[152:155], a[136:139], v[0:3]
    ds_read_b64_tr_b16 v[132:133], v161 offset:8192
    v_xor_b32 v164, 160, v161
    v_mfma_f32_16x16x32_bf16 v[0:3], v[156:159], a[140:143], v[0:3]
    s_add_u32 m0, s57, 131072
    s_add_u32 s56, s55, 1048576
    v_xor_b32 v160, 0x20000, v160
    v_mfma_f32_16x16x32_bf16 v[32:35], v[144:147], a[144:147], 0
    ds_read_b64_tr_b16 v[134:135], v161 offset:12288
    v_xor_b32 v165, 128, v161
    v_mfma_f32_16x16x32_bf16 v[32:35], v[148:151], a[148:151], v[32:35]
    ds_read_b64_tr_b16 v[136:137], v161 offset:16384
    v_xor_b32 v166, 224, v161
    v_mfma_f32_16x16x32_bf16 v[32:35], v[152:155], a[152:155], v[32:35]
    ds_read_b64_tr_b16 v[138:139], v161 offset:20480
    v_xor_b32 v167, 192, v161
    v_mfma_f32_16x16x32_bf16 v[32:35], v[156:159], a[156:159], v[32:35]
    buffer_load_dwordx4 v174, s[48:51], s56 offen offset:0 lds
    v_mfma_f32_16x16x32_bf16 v[64:67], v[144:147], a[160:163], 0
    ds_read_b64_tr_b16 v[140:141], v161 offset:24576
    s_add_u32 s56, s56, 64512
    v_mfma_f32_16x16x32_bf16 v[64:67], v[148:151], a[164:167], v[64:67]
    ds_read_b64_tr_b16 v[142:143], v161 offset:28672
    v_and_b32 v238, 1, v240
    v_mfma_f32_16x16x32_bf16 v[64:67], v[152:155], a[168:171], v[64:67]
    v_xor_b32 v161, 0x20000, v161
    v_lshlrev_b32 v236, 4, v241
    v_mfma_f32_16x16x32_bf16 v[64:67], v[156:159], a[172:175], v[64:67]
    buffer_load_dwordx4 v175, s[48:51], s56 offen offset:1024 lds
    v_mfma_f32_16x16x32_bf16 v[96:99], v[144:147], a[176:179], 0
    s_add_u32 s56, s56, 64512
    v_lshl_add_u32 v236, v238, 9, v236
    v_mfma_f32_16x16x32_bf16 v[96:99], v[148:151], a[180:183], v[96:99]
    v_lshrrev_b32 v238, 1, v240
    v_mfma_f32_16x16x32_bf16 v[96:99], v[152:155], a[184:187], v[96:99]
    v_lshl_add_u32 v236, v238, 10, v236
    v_mfma_f32_16x16x32_bf16 v[96:99], v[156:159], a[188:191], v[96:99]
    s_waitcnt lgkmcnt(0)
    buffer_load_dwordx4 v174, s[48:51], s56 offen offset:2048 lds
    v_mfma_f32_16x16x32_bf16 v[4:7], v[128:131], a[128:131], 0
    ds_read_b64_tr_b16 v[144:145], v162 offset:0
    s_add_u32 s56, s56, 64512
    v_mfma_f32_16x16x32_bf16 v[4:7], v[132:135], a[132:135], v[4:7]
    ds_read_b64_tr_b16 v[146:147], v162 offset:4096
    v_lshlrev_b32 v237, 2, v241
    v_mfma_f32_16x16x32_bf16 v[4:7], v[136:139], a[136:139], v[4:7]
    ds_read_b64_tr_b16 v[148:149], v162 offset:8192
    v_lshlrev_b32 v238, 2, v240
    v_mfma_f32_16x16x32_bf16 v[4:7], v[140:143], a[140:143], v[4:7]
    buffer_load_dwordx4 v175, s[48:51], s56 offen offset:3072 lds
    v_mfma_f32_16x16x32_bf16 v[36:39], v[128:131], a[144:147], 0
    ds_read_b64_tr_b16 v[150:151], v162 offset:12288
    s_add_u32 m0, s57, 135168
    v_mfma_f32_16x16x32_bf16 v[36:39], v[132:135], a[148:151], v[36:39]
    ds_read_b64_tr_b16 v[152:153], v162 offset:16384
    s_add_u32 s56, s55, 1081344
    v_mfma_f32_16x16x32_bf16 v[36:39], v[136:139], a[152:155], v[36:39]
    ds_read_b64_tr_b16 v[154:155], v162 offset:20480
    v_sub_u32 v250, v241, v238
    v_mfma_f32_16x16x32_bf16 v[36:39], v[140:143], a[156:159], v[36:39]
    buffer_load_dwordx4 v174, s[48:51], s56 offen offset:0 lds
    v_mfma_f32_16x16x32_bf16 v[68:71], v[128:131], a[160:163], 0
    ds_read_b64_tr_b16 v[156:157], v162 offset:24576
    s_add_u32 s56, s56, 64512
    v_mfma_f32_16x16x32_bf16 v[68:71], v[132:135], a[164:167], v[68:71]
    ds_read_b64_tr_b16 v[158:159], v162 offset:28672
    v_mov_b32 v233, v232
    v_mfma_f32_16x16x32_bf16 v[68:71], v[136:139], a[168:171], v[68:71]
    v_xor_b32 v162, 0x20000, v162
    v_xor_b32 v234, 0x10000, v232
    v_mfma_f32_16x16x32_bf16 v[68:71], v[140:143], a[172:175], v[68:71]
    buffer_load_dwordx4 v175, s[48:51], s56 offen offset:1024 lds
    v_mfma_f32_16x16x32_bf16 v[100:103], v[128:131], a[176:179], 0
    s_add_u32 s56, s56, 64512
    v_mov_b32 v238, 0xff800000
    v_mfma_f32_16x16x32_bf16 v[100:103], v[132:135], a[180:183], v[100:103]
    v_cmp_le_i32 vcc, 0, v250
    v_mfma_f32_16x16x32_bf16 v[100:103], v[136:139], a[184:187], v[100:103]
    v_mov_b32 v192, 0
    v_mfma_f32_16x16x32_bf16 v[100:103], v[140:143], a[188:191], v[100:103]
    s_waitcnt lgkmcnt(0)
    buffer_load_dwordx4 v174, s[48:51], s56 offen offset:2048 lds
    v_mfma_f32_16x16x32_bf16 v[8:11], v[144:147], a[128:131], 0
    ds_read_b64_tr_b16 v[128:129], v163 offset:0
    s_add_u32 s56, s56, 64512
    v_mfma_f32_16x16x32_bf16 v[8:11], v[148:151], a[132:135], v[8:11]
    ds_read_b64_tr_b16 v[130:131], v163 offset:4096
    v_mov_b32 v193, 0
    v_mfma_f32_16x16x32_bf16 v[8:11], v[152:155], a[136:139], v[8:11]
    ds_read_b64_tr_b16 v[132:133], v163 offset:8192
    v_cndmask_b32 v188, v238, 0, vcc
    v_mfma_f32_16x16x32_bf16 v[8:11], v[156:159], a[140:143], v[8:11]
    buffer_load_dwordx4 v175, s[48:51], s56 offen offset:3072 lds
    v_mfma_f32_16x16x32_bf16 v[40:43], v[144:147], a[144:147], 0
    ds_read_b64_tr_b16 v[134:135], v163 offset:12288
    s_add_u32 m0, s57, 32768
    v_mfma_f32_16x16x32_bf16 v[40:43], v[148:151], a[148:151], v[40:43]
    ds_read_b64_tr_b16 v[136:137], v163 offset:16384
    s_add_u32 s54, s52, 384
    v_mfma_f32_16x16x32_bf16 v[40:43], v[152:155], a[152:155], v[40:43]
    ds_read_b64_tr_b16 v[138:139], v163 offset:20480
    v_cmp_le_i32 vcc, 1, v250
    v_mfma_f32_16x16x32_bf16 v[40:43], v[156:159], a[156:159], v[40:43]
    buffer_load_dwordx4 v172, s[44:47], s54 offen offset:0 lds
    v_mfma_f32_16x16x32_bf16 v[72:75], v[144:147], a[160:163], 0
    ds_read_b64_tr_b16 v[140:141], v163 offset:24576
    s_add_u32 s54, s54, 7168
    v_mfma_f32_16x16x32_bf16 v[72:75], v[148:151], a[164:167], v[72:75]
    ds_read_b64_tr_b16 v[142:143], v163 offset:28672
    v_mov_b32 v194, 0
    v_mfma_f32_16x16x32_bf16 v[72:75], v[152:155], a[168:171], v[72:75]
    v_xor_b32 v163, 0x20000, v163
    v_mov_b32 v195, 0
    v_mfma_f32_16x16x32_bf16 v[72:75], v[156:159], a[172:175], v[72:75]
    buffer_load_dwordx4 v173, s[44:47], s54 offen offset:1024 lds
    v_mfma_f32_16x16x32_bf16 v[104:107], v[144:147], a[176:179], 0
    s_add_u32 s54, s54, s58
    v_cndmask_b32 v189, v238, 0, vcc
    v_mfma_f32_16x16x32_bf16 v[104:107], v[148:151], a[180:183], v[104:107]
    s_waitcnt vmcnt(10)
    s_barrier
    v_cmp_le_i32 vcc, 2, v250
    v_mfma_f32_16x16x32_bf16 v[104:107], v[152:155], a[184:187], v[104:107]
    s_cmp_lg_u32 s3, 0
    s_cbranch_scc1 F1_S
    v_mov_b32 v176, 128
    v_mov_b32 v177, 1
    s_mov_b64 exec, 1
    global_atomic_add v177, v176, v177, s[74:75] sc0 sc1
    s_mov_b64 exec, -1
F1_S:
    v_mov_b32 v196, 0
    v_mfma_f32_16x16x32_bf16 v[104:107], v[156:159], a[188:191], v[104:107]
    s_waitcnt lgkmcnt(0)
    buffer_load_dwordx4 v172, s[44:47], s54 offen offset:2048 lds
    v_mfma_f32_16x16x32_bf16 v[12:15], v[128:131], a[128:131], 0
    ds_read_b64_tr_b16 v[144:145], v164 offset:0
    s_add_u32 s54, s54, 7168
    v_mfma_f32_16x16x32_bf16 v[12:15], v[132:135], a[132:135], v[12:15]
    ds_read_b64_tr_b16 v[146:147], v164 offset:4096
    v_mov_b32 v197, 0
    v_mfma_f32_16x16x32_bf16 v[12:15], v[136:139], a[136:139], v[12:15]
    ds_read_b64_tr_b16 v[148:149], v164 offset:8192
    v_cndmask_b32 v190, v238, 0, vcc
    v_mfma_f32_16x16x32_bf16 v[12:15], v[140:143], a[140:143], v[12:15]
    buffer_load_dwordx4 v173, s[44:47], s54 offen offset:3072 lds
    v_mfma_f32_16x16x32_bf16 v[44:47], v[128:131], a[144:147], 0
    ds_read_b64_tr_b16 v[150:151], v164 offset:12288
    s_add_u32 m0, s57, 36864
    v_mfma_f32_16x16x32_bf16 v[44:47], v[132:135], a[148:151], v[44:47]
    ds_read_b64_tr_b16 v[152:153], v164 offset:16384
    s_add_u32 s54, s53, 384
    v_mfma_f32_16x16x32_bf16 v[44:47], v[136:139], a[152:155], v[44:47]
    ds_read_b64_tr_b16 v[154:155], v164 offset:20480
    v_cmp_le_i32 vcc, 3, v250
    v_mfma_f32_16x16x32_bf16 v[44:47], v[140:143], a[156:159], v[44:47]
    buffer_load_dwordx4 v172, s[44:47], s54 offen offset:0 lds
    v_mfma_f32_16x16x32_bf16 v[76:79], v[128:131], a[160:163], 0
    ds_read_b64_tr_b16 v[156:157], v164 offset:24576
    s_add_u32 s54, s54, 7168
    v_mfma_f32_16x16x32_bf16 v[76:79], v[132:135], a[164:167], v[76:79]
    ds_read_b64_tr_b16 v[158:159], v164 offset:28672
    v_mov_b32 v198, 0
    v_mfma_f32_16x16x32_bf16 v[76:79], v[136:139], a[168:171], v[76:79]
    v_xor_b32 v164, 0x20000, v164
    v_mov_b32 v199, 0
    v_mfma_f32_16x16x32_bf16 v[76:79], v[140:143], a[172:175], v[76:79]
    buffer_load_dwordx4 v173, s[44:47], s54 offen offset:1024 lds
    v_mfma_f32_16x16x32_bf16 v[108:111], v[128:131], a[176:179], 0
    s_add_u32 s54, s54, s58
    v_cndmask_b32 v191, v238, 0, vcc
    v_mfma_f32_16x16x32_bf16 v[108:111], v[132:135], a[180:183], v[108:111]
    v_mov_b32 v200, 0
    v_mfma_f32_16x16x32_bf16 v[108:111], v[136:139], a[184:187], v[108:111]
    v_mov_b32 v201, 0
    v_mfma_f32_16x16x32_bf16 v[108:111], v[140:143], a[188:191], v[108:111]
    s_waitcnt lgkmcnt(0)
    buffer_load_dwordx4 v172, s[44:47], s54 offen offset:2048 lds
    v_mfma_f32_16x16x32_bf16 v[16:19], v[144:147], a[128:131], 0
    ds_read_b64_tr_b16 v[128:129], v165 offset:0
    s_add_u32 s54, s54, 7168
    v_mfma_f32_16x16x32_bf16 v[16:19], v[148:151], a[132:135], v[16:19]
    ds_read_b64_tr_b16 v[130:131], v165 offset:4096
    v_mov_b32 v202, 0
    v_mfma_f32_16x16x32_bf16 v[16:19], v[152:155], a[136:139], v[16:19]
    ds_read_b64_tr_b16 v[132:133], v165 offset:8192
    v_mov_b32 v203, 0
    v_mfma_f32_16x16x32_bf16 v[16:19], v[156:159], a[140:143], v[16:19]
    buffer_load_dwordx4 v173, s[44:47], s54 offen offset:3072 lds
    v_mfma_f32_16x16x32_bf16 v[48:51], v[144:147], a[144:147], 0
    ds_read_b64_tr_b16 v[134:135], v165 offset:12288
    s_add_u32 m0, s57, 65536
    v_mfma_f32_16x16x32_bf16 v[48:51], v[148:151], a[148:151], v[48:51]
    ds_read_b64_tr_b16 v[136:137], v165 offset:16384
    s_add_u32 s54, s52, 512
    v_mfma_f32_16x16x32_bf16 v[48:51], v[152:155], a[152:155], v[48:51]
    ds_read_b64_tr_b16 v[138:139], v165 offset:20480
    v_mov_b32 v204, 0
    v_mfma_f32_16x16x32_bf16 v[48:51], v[156:159], a[156:159], v[48:51]
    buffer_load_dwordx4 v172, s[44:47], s54 offen offset:0 lds
    v_mfma_f32_16x16x32_bf16 v[80:83], v[144:147], a[160:163], 0
    ds_read_b64_tr_b16 v[140:141], v165 offset:24576
    s_add_u32 s54, s54, 7168
    v_mfma_f32_16x16x32_bf16 v[80:83], v[148:151], a[164:167], v[80:83]
    ds_read_b64_tr_b16 v[142:143], v165 offset:28672
    v_mov_b32 v205, 0
    v_mfma_f32_16x16x32_bf16 v[80:83], v[152:155], a[168:171], v[80:83]
    v_xor_b32 v165, 0x20000, v165
    v_mov_b32 v206, 0
    v_mfma_f32_16x16x32_bf16 v[80:83], v[156:159], a[172:175], v[80:83]
    buffer_load_dwordx4 v173, s[44:47], s54 offen offset:1024 lds
    v_mfma_f32_16x16x32_bf16 v[112:115], v[144:147], a[176:179], 0
    s_add_u32 s54, s54, s58
    v_mov_b32 v207, 0
    v_mfma_f32_16x16x32_bf16 v[112:115], v[148:151], a[180:183], v[112:115]
    v_mov_b32 v212, 0
    v_mfma_f32_16x16x32_bf16 v[112:115], v[152:155], a[184:187], v[112:115]
    v_mov_b32 v213, 0
    v_mfma_f32_16x16x32_bf16 v[112:115], v[156:159], a[188:191], v[112:115]
    s_waitcnt lgkmcnt(0)
    buffer_load_dwordx4 v172, s[44:47], s54 offen offset:2048 lds
    v_mfma_f32_16x16x32_bf16 v[20:23], v[128:131], a[128:131], 0
    ds_read_b64_tr_b16 v[144:145], v166 offset:0
    s_add_u32 s54, s54, 7168
    v_mfma_f32_16x16x32_bf16 v[20:23], v[132:135], a[132:135], v[20:23]
    ds_read_b64_tr_b16 v[146:147], v166 offset:4096
    v_mov_b32 v214, 0
    v_mfma_f32_16x16x32_bf16 v[20:23], v[136:139], a[136:139], v[20:23]
    ds_read_b64_tr_b16 v[148:149], v166 offset:8192
    v_mov_b32 v215, 0
    v_mfma_f32_16x16x32_bf16 v[20:23], v[140:143], a[140:143], v[20:23]
    buffer_load_dwordx4 v173, s[44:47], s54 offen offset:3072 lds
    v_mfma_f32_16x16x32_bf16 v[52:55], v[128:131], a[144:147], 0
    ds_read_b64_tr_b16 v[150:151], v166 offset:12288
    s_add_u32 m0, s57, 69632
    v_mfma_f32_16x16x32_bf16 v[52:55], v[132:135], a[148:151], v[52:55]
    ds_read_b64_tr_b16 v[152:153], v166 offset:16384
    s_add_u32 s54, s53, 512
    v_mfma_f32_16x16x32_bf16 v[52:55], v[136:139], a[152:155], v[52:55]
    ds_read_b64_tr_b16 v[154:155], v166 offset:20480
    v_mov_b32 v208, 0x3f803f80
    v_mfma_f32_16x16x32_bf16 v[52:55], v[140:143], a[156:159], v[52:55]
    buffer_load_dwordx4 v172, s[44:47], s54 offen offset:0 lds
    v_mfma_f32_16x16x32_bf16 v[84:87], v[128:131], a[160:163], 0
    ds_read_b64_tr_b16 v[156:157], v166 offset:24576
    s_add_u32 s54, s54, 7168
    v_mfma_f32_16x16x32_bf16 v[84:87], v[132:135], a[164:167], v[84:87]
    ds_read_b64_tr_b16 v[158:159], v166 offset:28672
    v_mov_b32 v209, 0x3f803f80
    v_mfma_f32_16x16x32_bf16 v[84:87], v[136:139], a[168:171], v[84:87]
    v_xor_b32 v166, 0x20000, v166
    v_mov_b32 v210, 0x3f803f80
    v_mfma_f32_16x16x32_bf16 v[84:87], v[140:143], a[172:175], v[84:87]
    buffer_load_dwordx4 v173, s[44:47], s54 offen offset:1024 lds
    v_mfma_f32_16x16x32_bf16 v[116:119], v[128:131], a[176:179], 0
    s_add_u32 s54, s54, s58
    v_mov_b32 v211, 0x3f803f80
    v_mfma_f32_16x16x32_bf16 v[116:119], v[132:135], a[180:183], v[116:119]
    v_lshrrev_b32 v241, 4, v235
    v_mfma_f32_16x16x32_bf16 v[116:119], v[136:139], a[184:187], v[116:119]
    v_and_b32 v240, 15, v235
    v_mfma_f32_16x16x32_bf16 v[116:119], v[140:143], a[188:191], v[116:119]
    s_waitcnt lgkmcnt(0)
    buffer_load_dwordx4 v172, s[44:47], s54 offen offset:2048 lds
    v_mfma_f32_16x16x32_bf16 v[24:27], v[144:147], a[128:131], 0
    ds_read_b64_tr_b16 v[128:129], v167 offset:0
    s_add_u32 s54, s54, 7168
    v_mfma_f32_16x16x32_bf16 v[24:27], v[148:151], a[132:135], v[24:27]
    ds_read_b64_tr_b16 v[130:131], v167 offset:4096
    v_lshlrev_b32 v239, 2, v241
    v_mfma_f32_16x16x32_bf16 v[24:27], v[152:155], a[136:139], v[24:27]
    ds_read_b64_tr_b16 v[132:133], v167 offset:8192
    v_xor_b32 v240, v240, v239
    v_mfma_f32_16x16x32_bf16 v[24:27], v[156:159], a[140:143], v[24:27]
    buffer_load_dwordx4 v173, s[44:47], s54 offen offset:3072 lds
    v_mfma_f32_16x16x32_bf16 v[56:59], v[144:147], a[144:147], 0
    ds_read_b64_tr_b16 v[134:135], v167 offset:12288
    v_lshlrev_b32 v240, 4, v240
    v_mfma_f32_16x16x32_bf16 v[56:59], v[148:151], a[148:151], v[56:59]
    ds_read_b64_tr_b16 v[136:137], v167 offset:16384
    v_lshl_add_u32 v246, v241, 10, v240
    v_mfma_f32_16x16x32_bf16 v[56:59], v[152:155], a[152:155], v[56:59]
    ds_read_b64_tr_b16 v[138:139], v167 offset:20480
    v_bfe_u32 v242, v235, 2, 2
    v_mfma_f32_16x16x32_bf16 v[56:59], v[156:159], a[156:159], v[56:59]
    v_and_b32 v243, 3, v235
    v_mfma_f32_16x16x32_bf16 v[88:91], v[144:147], a[160:163], 0
    ds_read_b64_tr_b16 v[140:141], v167 offset:24576
    v_and_b32 v244, 1, v241
    v_mfma_f32_16x16x32_bf16 v[88:91], v[148:151], a[164:167], v[88:91]
    ds_read_b64_tr_b16 v[142:143], v167 offset:28672
    v_lshlrev_b32 v244, 1, v244
    v_mfma_f32_16x16x32_bf16 v[88:91], v[152:155], a[168:171], v[88:91]
    v_xor_b32 v167, 0x20000, v167
    v_lshrrev_b32 v239, 1, v243
    v_mfma_f32_16x16x32_bf16 v[88:91], v[156:159], a[172:175], v[88:91]
    v_add_u32 v244, v244, v239
    v_mfma_f32_16x16x32_bf16 v[120:123], v[144:147], a[176:179], 0
    v_lshlrev_b32 v239, 2, v242
    v_mfma_f32_16x16x32_bf16 v[120:123], v[148:151], a[180:183], v[120:123]
    v_xor_b32 v244, v244, v239
    v_mfma_f32_16x16x32_bf16 v[120:123], v[152:155], a[184:187], v[120:123]
    v_lshlrev_b32 v244, 4, v244
    v_mfma_f32_16x16x32_bf16 v[120:123], v[156:159], a[188:191], v[120:123]
    s_waitcnt lgkmcnt(0)
    s_waitcnt vmcnt(8)
    s_barrier
    v_mfma_f32_16x16x32_bf16 v[28:31], v[128:131], a[128:131], 0
    ds_read_b64_tr_b16 v[144:145], v160 offset:0
    ds_read_b128 a[128:131], v170 offset:0
    v_mfma_f32_16x16x32_bf16 v[28:31], v[132:135], a[132:135], v[28:31]
    ds_read_b64_tr_b16 v[146:147], v160 offset:4096
    ds_read_b128 a[132:135], v171 offset:0
    v_mfma_f32_16x16x32_bf16 v[28:31], v[136:139], a[136:139], v[28:31]
    ds_read_b64_tr_b16 v[148:149], v160 offset:8192
    ds_read_b128 a[136:139], v168 offset:0
    v_mfma_f32_16x16x32_bf16 v[28:31], v[140:143], a[140:143], v[28:31]
    ds_read_b64_tr_b16 v[150:151], v160 offset:12288
    ds_read_b128 a[140:143], v169 offset:0
    v_mfma_f32_16x16x32_bf16 v[60:63], v[128:131], a[144:147], 0
    ds_read_b64_tr_b16 v[152:153], v160 offset:16384
    ds_read_b128 a[144:147], v170 offset:2048
    v_mfma_f32_16x16x32_bf16 v[60:63], v[132:135], a[148:151], v[60:63]
    ds_read_b64_tr_b16 v[154:155], v160 offset:20480
    ds_read_b128 a[148:151], v171 offset:2048
    v_mfma_f32_16x16x32_bf16 v[60:63], v[136:139], a[152:155], v[60:63]
    ds_read_b64_tr_b16 v[156:157], v160 offset:24576
    ds_read_b128 a[152:155], v168 offset:2048
    v_mfma_f32_16x16x32_bf16 v[60:63], v[140:143], a[156:159], v[60:63]
    ds_read_b64_tr_b16 v[158:159], v160 offset:28672
    ds_read_b128 a[156:159], v169 offset:2048
    v_mfma_f32_16x16x32_bf16 v[92:95], v[128:131], a[160:163], 0
    ds_read_b128 a[160:163], v170 offset:4096
    v_and_b32 v243, 1, v243
    v_mfma_f32_16x16x32_bf16 v[92:95], v[132:135], a[164:167], v[92:95]
    ds_read_b128 a[164:167], v171 offset:4096
    v_lshl_add_u32 v244, v243, 3, v244
    v_mfma_f32_16x16x32_bf16 v[92:95], v[136:139], a[168:171], v[92:95]
    ds_read_b128 a[168:171], v168 offset:4096
    v_lshrrev_b32 v241, 1, v241
    v_mfma_f32_16x16x32_bf16 v[92:95], v[140:143], a[172:175], v[92:95]
    ds_read_b128 a[172:175], v169 offset:4096
    v_lshl_add_u32 v242, v241, 2, v242
    v_mfma_f32_16x16x32_bf16 v[124:127], v[128:131], a[176:179], 0
    ds_read_b128 a[176:179], v170 offset:6144
    v_lshl_add_u32 v244, v242, 8, v244
    s_cmp_lg_u32 s3, 0
    s_cbranch_scc1 F1_A
    s_waitcnt vmcnt(14)
    v_readfirstlane_b32 s38, v177
    v_mov_b32 v250, 0
    s_cmp_lg_u32 s38, 255
    s_cbranch_scc1 F1_A
    v_mov_b32 v251, 1
    global_store_dword v250, v251, s[74:75] sc1
F1_A:
    v_mfma_f32_16x16x32_bf16 v[124:127], v[132:135], a[180:183], v[124:127]
    ds_read_b128 a[180:183], v171 offset:6144
    v_add_u32 v244, 0x20000, v244
    v_mfma_f32_16x16x32_bf16 v[124:127], v[136:139], a[184:187], v[124:127]
    ds_read_b128 a[184:187], v168 offset:6144
    v_add_u32 v252, s57, v244
    v_mfma_f32_16x16x32_bf16 v[124:127], v[140:143], a[188:191], v[124:127]
    ds_read_b128 a[188:191], v169 offset:6144
    s_waitcnt lgkmcnt(8)
    v_mfma_f32_16x16x32_bf16 v[0:3], v[144:147], a[128:131], v[0:3]
    ds_read_b64_tr_b16 v[128:129], v161 offset:0
    v_xor_b32 v253, 64, v252
    v_mfma_f32_16x16x32_bf16 v[0:3], v[148:151], a[132:135], v[0:3]
    ds_read_b64_tr_b16 v[130:131], v161 offset:4096
    v_xor_b32 v254, 128, v252
    v_mfma_f32_16x16x32_bf16 v[0:3], v[152:155], a[136:139], v[0:3]
    ds_read_b64_tr_b16 v[132:133], v161 offset:8192
    v_xor_b32 v255, 192, v252
    v_mfma_f32_16x16x32_bf16 v[0:3], v[156:159], a[140:143], v[0:3]
    v_xor_b32 v160, 0x20000, v160
    v_mfma_f32_16x16x32_bf16 v[32:35], v[144:147], a[144:147], v[32:35]
    ds_read_b64_tr_b16 v[134:135], v161 offset:12288
    v_mfma_f32_16x16x32_bf16 v[32:35], v[148:151], a[148:151], v[32:35]
    ds_read_b64_tr_b16 v[136:137], v161 offset:16384
    v_mfma_f32_16x16x32_bf16 v[32:35], v[152:155], a[152:155], v[32:35]
    ds_read_b64_tr_b16 v[138:139], v161 offset:20480
    v_mfma_f32_16x16x32_bf16 v[32:35], v[156:159], a[156:159], v[32:35]
    s_waitcnt lgkmcnt(6)
    v_mfma_f32_16x16x32_bf16 v[64:67], v[144:147], a[160:163], v[64:67]
    ds_read_b64_tr_b16 v[140:141], v161 offset:24576
    s_add_u32 m0, s57, 0
    v_mfma_f32_16x16x32_bf16 v[64:67], v[148:151], a[164:167], v[64:67]
    ds_read_b64_tr_b16 v[142:143], v161 offset:28672
    s_add_u32 s56, s55, 2097152
    v_mfma_f32_16x16x32_bf16 v[64:67], v[152:155], a[168:171], v[64:67]
    v_xor_b32 v161, 0x20000, v161
    v_mfma_f32_16x16x32_bf16 v[64:67], v[156:159], a[172:175], v[64:67]
    buffer_load_dwordx4 v174, s[48:51], s56 offen offset:0 lds
    v_mfma_f32_16x16x32_bf16 v[96:99], v[144:147], a[176:179], v[96:99]
    s_add_u32 s56, s56, 64512
    v_mfma_f32_16x16x32_bf16 v[96:99], v[148:151], a[180:183], v[96:99]
    v_mfma_f32_16x16x32_bf16 v[96:99], v[152:155], a[184:187], v[96:99]
    v_mfma_f32_16x16x32_bf16 v[96:99], v[156:159], a[188:191], v[96:99]
    s_waitcnt lgkmcnt(0)
    buffer_load_dwordx4 v175, s[48:51], s56 offen offset:1024 lds
    v_mfma_f32_16x16x32_bf16 v[4:7], v[128:131], a[128:131], v[4:7]
    ds_read_b64_tr_b16 v[144:145], v162 offset:0
    s_add_u32 s56, s56, 64512
    v_mfma_f32_16x16x32_bf16 v[4:7], v[132:135], a[132:135], v[4:7]
    ds_read_b64_tr_b16 v[146:147], v162 offset:4096
    v_mfma_f32_16x16x32_bf16 v[4:7], v[136:139], a[136:139], v[4:7]
    ds_read_b64_tr_b16 v[148:149], v162 offset:8192
    v_mfma_f32_16x16x32_bf16 v[4:7], v[140:143], a[140:143], v[4:7]
    buffer_load_dwordx4 v174, s[48:51], s56 offen offset:2048 lds
    v_mfma_f32_16x16x32_bf16 v[36:39], v[128:131], a[144:147], v[36:39]
    ds_read_b64_tr_b16 v[150:151], v162 offset:12288
    s_add_u32 s56, s56, 64512
    v_mfma_f32_16x16x32_bf16 v[36:39], v[132:135], a[148:151], v[36:39]
    ds_read_b64_tr_b16 v[152:153], v162 offset:16384
    v_mfma_f32_16x16x32_bf16 v[36:39], v[136:139], a[152:155], v[36:39]
    ds_read_b64_tr_b16 v[154:155], v162 offset:20480
    v_mfma_f32_16x16x32_bf16 v[36:39], v[140:143], a[156:159], v[36:39]
    buffer_load_dwordx4 v175, s[48:51], s56 offen offset:3072 lds
    v_mfma_f32_16x16x32_bf16 v[68:71], v[128:131], a[160:163], v[68:71]
    ds_read_b64_tr_b16 v[156:157], v162 offset:24576
    s_add_u32 m0, s57, 4096
    v_mfma_f32_16x16x32_bf16 v[68:71], v[132:135], a[164:167], v[68:71]
    ds_read_b64_tr_b16 v[158:159], v162 offset:28672
    s_add_u32 s56, s55, 2129920
    v_mfma_f32_16x16x32_bf16 v[68:71], v[136:139], a[168:171], v[68:71]
    v_xor_b32 v162, 0x20000, v162
    v_mfma_f32_16x16x32_bf16 v[68:71], v[140:143], a[172:175], v[68:71]
    buffer_load_dwordx4 v174, s[48:51], s56 offen offset:0 lds
    v_mfma_f32_16x16x32_bf16 v[100:103], v[128:131], a[176:179], v[100:103]
    s_add_u32 s56, s56, 64512
    v_mfma_f32_16x16x32_bf16 v[100:103], v[132:135], a[180:183], v[100:103]
    v_mfma_f32_16x16x32_bf16 v[100:103], v[136:139], a[184:187], v[100:103]
    v_mfma_f32_16x16x32_bf16 v[100:103], v[140:143], a[188:191], v[100:103]
    s_waitcnt lgkmcnt(0)
    buffer_load_dwordx4 v175, s[48:51], s56 offen offset:1024 lds
    v_mfma_f32_16x16x32_bf16 v[8:11], v[144:147], a[128:131], v[8:11]
    ds_read_b64_tr_b16 v[128:129], v163 offset:0
    s_add_u32 s56, s56, 64512
    v_mfma_f32_16x16x32_bf16 v[8:11], v[148:151], a[132:135], v[8:11]
    ds_read_b64_tr_b16 v[130:131], v163 offset:4096
    v_mfma_f32_16x16x32_bf16 v[8:11], v[152:155], a[136:139], v[8:11]
    ds_read_b64_tr_b16 v[132:133], v163 offset:8192
    v_mfma_f32_16x16x32_bf16 v[8:11], v[156:159], a[140:143], v[8:11]
    buffer_load_dwordx4 v174, s[48:51], s56 offen offset:2048 lds
    v_mfma_f32_16x16x32_bf16 v[40:43], v[144:147], a[144:147], v[40:43]
    ds_read_b64_tr_b16 v[134:135], v163 offset:12288
    s_add_u32 s56, s56, 64512
    v_mfma_f32_16x16x32_bf16 v[40:43], v[148:151], a[148:151], v[40:43]
    ds_read_b64_tr_b16 v[136:137], v163 offset:16384
    v_mfma_f32_16x16x32_bf16 v[40:43], v[152:155], a[152:155], v[40:43]
    ds_read_b64_tr_b16 v[138:139], v163 offset:20480
    v_mfma_f32_16x16x32_bf16 v[40:43], v[156:159], a[156:159], v[40:43]
    buffer_load_dwordx4 v175, s[48:51], s56 offen offset:3072 lds
    v_mfma_f32_16x16x32_bf16 v[72:75], v[144:147], a[160:163], v[72:75]
    ds_read_b64_tr_b16 v[140:141], v163 offset:24576
    s_add_u32 m0, s57, 98304
    v_mfma_f32_16x16x32_bf16 v[72:75], v[148:151], a[164:167], v[72:75]
    ds_read_b64_tr_b16 v[142:143], v163 offset:28672
    s_add_u32 s54, s52, 640
    v_mfma_f32_16x16x32_bf16 v[72:75], v[152:155], a[168:171], v[72:75]
    v_xor_b32 v163, 0x20000, v163
    v_mfma_f32_16x16x32_bf16 v[72:75], v[156:159], a[172:175], v[72:75]
    buffer_load_dwordx4 v172, s[44:47], s54 offen offset:0 lds
    v_mfma_f32_16x16x32_bf16 v[104:107], v[144:147], a[176:179], v[104:107]
    s_add_u32 s54, s54, 7168
    v_mfma_f32_16x16x32_bf16 v[104:107], v[148:151], a[180:183], v[104:107]
    v_mfma_f32_16x16x32_bf16 v[104:107], v[152:155], a[184:187], v[104:107]
    v_mfma_f32_16x16x32_bf16 v[104:107], v[156:159], a[188:191], v[104:107]
    s_waitcnt lgkmcnt(0)
    buffer_load_dwordx4 v173, s[44:47], s54 offen offset:1024 lds
    v_mfma_f32_16x16x32_bf16 v[12:15], v[128:131], a[128:131], v[12:15]
    ds_read_b64_tr_b16 v[144:145], v164 offset:0
    s_add_u32 s54, s54, s58
    v_mfma_f32_16x16x32_bf16 v[12:15], v[132:135], a[132:135], v[12:15]
    ds_read_b64_tr_b16 v[146:147], v164 offset:4096
    v_mfma_f32_16x16x32_bf16 v[12:15], v[136:139], a[136:139], v[12:15]
    ds_read_b64_tr_b16 v[148:149], v164 offset:8192
    v_mfma_f32_16x16x32_bf16 v[12:15], v[140:143], a[140:143], v[12:15]
    buffer_load_dwordx4 v172, s[44:47], s54 offen offset:2048 lds
    v_mfma_f32_16x16x32_bf16 v[44:47], v[128:131], a[144:147], v[44:47]
    ds_read_b64_tr_b16 v[150:151], v164 offset:12288
    s_add_u32 s54, s54, 7168
    v_mfma_f32_16x16x32_bf16 v[44:47], v[132:135], a[148:151], v[44:47]
    ds_read_b64_tr_b16 v[152:153], v164 offset:16384
    v_mfma_f32_16x16x32_bf16 v[44:47], v[136:139], a[152:155], v[44:47]
    ds_read_b64_tr_b16 v[154:155], v164 offset:20480
    v_mfma_f32_16x16x32_bf16 v[44:47], v[140:143], a[156:159], v[44:47]
    buffer_load_dwordx4 v173, s[44:47], s54 offen offset:3072 lds
    v_mfma_f32_16x16x32_bf16 v[76:79], v[128:131], a[160:163], v[76:79]
    ds_read_b64_tr_b16 v[156:157], v164 offset:24576
    s_add_u32 m0, s57, 102400
    v_mfma_f32_16x16x32_bf16 v[76:79], v[132:135], a[164:167], v[76:79]
    ds_read_b64_tr_b16 v[158:159], v164 offset:28672
    s_add_u32 s54, s53, 640
    v_mfma_f32_16x16x32_bf16 v[76:79], v[136:139], a[168:171], v[76:79]
    v_xor_b32 v164, 0x20000, v164
    v_mfma_f32_16x16x32_bf16 v[76:79], v[140:143], a[172:175], v[76:79]
    buffer_load_dwordx4 v172, s[44:47], s54 offen offset:0 lds
    v_mfma_f32_16x16x32_bf16 v[108:111], v[128:131], a[176:179], v[108:111]
    s_add_u32 s54, s54, 7168
    v_mfma_f32_16x16x32_bf16 v[108:111], v[132:135], a[180:183], v[108:111]
    v_mfma_f32_16x16x32_bf16 v[108:111], v[136:139], a[184:187], v[108:111]
    v_mfma_f32_16x16x32_bf16 v[108:111], v[140:143], a[188:191], v[108:111]
    s_waitcnt lgkmcnt(0)
    buffer_load_dwordx4 v173, s[44:47], s54 offen offset:1024 lds
    v_mfma_f32_16x16x32_bf16 v[16:19], v[144:147], a[128:131], v[16:19]
    ds_read_b64_tr_b16 v[128:129], v165 offset:0
    s_add_u32 s54, s54, s58
    v_mfma_f32_16x16x32_bf16 v[16:19], v[148:151], a[132:135], v[16:19]
    ds_read_b64_tr_b16 v[130:131], v165 offset:4096
    v_mfma_f32_16x16x32_bf16 v[16:19], v[152:155], a[136:139], v[16:19]
    ds_read_b64_tr_b16 v[132:133], v165 offset:8192
    v_mfma_f32_16x16x32_bf16 v[16:19], v[156:159], a[140:143], v[16:19]
    buffer_load_dwordx4 v172, s[44:47], s54 offen offset:2048 lds
    v_mfma_f32_16x16x32_bf16 v[48:51], v[144:147], a[144:147], v[48:51]
    ds_read_b64_tr_b16 v[134:135], v165 offset:12288
    s_add_u32 s54, s54, 7168
    v_mfma_f32_16x16x32_bf16 v[48:51], v[148:151], a[148:151], v[48:51]
    ds_read_b64_tr_b16 v[136:137], v165 offset:16384
    v_mfma_f32_16x16x32_bf16 v[48:51], v[152:155], a[152:155], v[48:51]
    ds_read_b64_tr_b16 v[138:139], v165 offset:20480
    v_mfma_f32_16x16x32_bf16 v[48:51], v[156:159], a[156:159], v[48:51]
    buffer_load_dwordx4 v173, s[44:47], s54 offen offset:3072 lds
    v_mfma_f32_16x16x32_bf16 v[80:83], v[144:147], a[160:163], v[80:83]
    ds_read_b64_tr_b16 v[140:141], v165 offset:24576
    s_add_u32 m0, s57, 32768
    v_mfma_f32_16x16x32_bf16 v[80:83], v[148:151], a[164:167], v[80:83]
    ds_read_b64_tr_b16 v[142:143], v165 offset:28672
    s_add_u32 s54, s52, 768
    v_mfma_f32_16x16x32_bf16 v[80:83], v[152:155], a[168:171], v[80:83]
    v_xor_b32 v165, 0x20000, v165
    v_mfma_f32_16x16x32_bf16 v[80:83], v[156:159], a[172:175], v[80:83]
    buffer_load_dwordx4 v172, s[44:47], s54 offen offset:0 lds
    v_mfma_f32_16x16x32_bf16 v[112:115], v[144:147], a[176:179], v[112:115]
    s_add_u32 s54, s54, 7168
    v_mfma_f32_16x16x32_bf16 v[112:115], v[148:151], a[180:183], v[112:115]
    v_mfma_f32_16x16x32_bf16 v[112:115], v[152:155], a[184:187], v[112:115]
    v_mfma_f32_16x16x32_bf16 v[112:115], v[156:159], a[188:191], v[112:115]
    s_waitcnt lgkmcnt(0)
    buffer_load_dwordx4 v173, s[44:47], s54 offen offset:1024 lds
    v_mfma_f32_16x16x32_bf16 v[20:23], v[128:131], a[128:131], v[20:23]
    ds_read_b64_tr_b16 v[144:145], v166 offset:0
    s_add_u32 s54, s54, s58
    v_mfma_f32_16x16x32_bf16 v[20:23], v[132:135], a[132:135], v[20:23]
    ds_read_b64_tr_b16 v[146:147], v166 offset:4096
    v_mfma_f32_16x16x32_bf16 v[20:23], v[136:139], a[136:139], v[20:23]
    ds_read_b64_tr_b16 v[148:149], v166 offset:8192
    v_mfma_f32_16x16x32_bf16 v[20:23], v[140:143], a[140:143], v[20:23]
    buffer_load_dwordx4 v172, s[44:47], s54 offen offset:2048 lds
    v_mfma_f32_16x16x32_bf16 v[52:55], v[128:131], a[144:147], v[52:55]
    ds_read_b64_tr_b16 v[150:151], v166 offset:12288
    s_add_u32 s54, s54, 7168
    v_mfma_f32_16x16x32_bf16 v[52:55], v[132:135], a[148:151], v[52:55]
    ds_read_b64_tr_b16 v[152:153], v166 offset:16384
    v_mfma_f32_16x16x32_bf16 v[52:55], v[136:139], a[152:155], v[52:55]
    ds_read_b64_tr_b16 v[154:155], v166 offset:20480
    v_mfma_f32_16x16x32_bf16 v[52:55], v[140:143], a[156:159], v[52:55]
    buffer_load_dwordx4 v173, s[44:47], s54 offen offset:3072 lds
    v_mfma_f32_16x16x32_bf16 v[84:87], v[128:131], a[160:163], v[84:87]
    ds_read_b64_tr_b16 v[156:157], v166 offset:24576
    s_add_u32 m0, s57, 36864
    v_mfma_f32_16x16x32_bf16 v[84:87], v[132:135], a[164:167], v[84:87]
    ds_read_b64_tr_b16 v[158:159], v166 offset:28672
    s_add_u32 s54, s53, 768
    v_mfma_f32_16x16x32_bf16 v[84:87], v[136:139], a[168:171], v[84:87]
    v_xor_b32 v166, 0x20000, v166
    v_mfma_f32_16x16x32_bf16 v[84:87], v[140:143], a[172:175], v[84:87]
    buffer_load_dwordx4 v172, s[44:47], s54 offen offset:0 lds
    v_mfma_f32_16x16x32_bf16 v[116:119], v[128:131], a[176:179], v[116:119]
    s_add_u32 s54, s54, 7168
    v_mfma_f32_16x16x32_bf16 v[116:119], v[132:135], a[180:183], v[116:119]
    v_mfma_f32_16x16x32_bf16 v[116:119], v[136:139], a[184:187], v[116:119]
    v_mfma_f32_16x16x32_bf16 v[116:119], v[140:143], a[188:191], v[116:119]
    s_waitcnt lgkmcnt(0)
    buffer_load_dwordx4 v173, s[44:47], s54 offen offset:1024 lds
    v_mfma_f32_16x16x32_bf16 v[24:27], v[144:147], a[128:131], v[24:27]
    ds_read_b64_tr_b16 v[128:129], v167 offset:0
    s_add_u32 s54, s54, s58
    v_mfma_f32_16x16x32_bf16 v[24:27], v[148:151], a[132:135], v[24:27]
    ds_read_b64_tr_b16 v[130:131], v167 offset:4096
    v_mfma_f32_16x16x32_bf16 v[24:27], v[152:155], a[136:139], v[24:27]
    ds_read_b64_tr_b16 v[132:133], v167 offset:8192
    v_mfma_f32_16x16x32_bf16 v[24:27], v[156:159], a[140:143], v[24:27]
    buffer_load_dwordx4 v172, s[44:47], s54 offen offset:2048 lds
    v_mfma_f32_16x16x32_bf16 v[56:59], v[144:147], a[144:147], v[56:59]
    ds_read_b64_tr_b16 v[134:135], v167 offset:12288
    s_add_u32 s54, s54, 7168
    v_mfma_f32_16x16x32_bf16 v[56:59], v[148:151], a[148:151], v[56:59]
    ds_read_b64_tr_b16 v[136:137], v167 offset:16384
    v_mfma_f32_16x16x32_bf16 v[56:59], v[152:155], a[152:155], v[56:59]
    ds_read_b64_tr_b16 v[138:139], v167 offset:20480
    v_mfma_f32_16x16x32_bf16 v[56:59], v[156:159], a[156:159], v[56:59]
    buffer_load_dwordx4 v173, s[44:47], s54 offen offset:3072 lds
    v_mfma_f32_16x16x32_bf16 v[88:91], v[144:147], a[160:163], v[88:91]
    ds_read_b64_tr_b16 v[140:141], v167 offset:24576
    v_mfma_f32_16x16x32_bf16 v[88:91], v[148:151], a[164:167], v[88:91]
    ds_read_b64_tr_b16 v[142:143], v167 offset:28672
    v_mfma_f32_16x16x32_bf16 v[88:91], v[152:155], a[168:171], v[88:91]
    v_xor_b32 v167, 0x20000, v167
    v_mfma_f32_16x16x32_bf16 v[88:91], v[156:159], a[172:175], v[88:91]
    v_mfma_f32_16x16x32_bf16 v[120:123], v[144:147], a[176:179], v[120:123]
    v_mfma_f32_16x16x32_bf16 v[120:123], v[148:151], a[180:183], v[120:123]
    v_mfma_f32_16x16x32_bf16 v[120:123], v[152:155], a[184:187], v[120:123]
    v_mfma_f32_16x16x32_bf16 v[120:123], v[156:159], a[188:191], v[120:123]
    s_waitcnt lgkmcnt(0)
    s_waitcnt vmcnt(8)
    s_barrier
    v_mfma_f32_16x16x32_bf16 v[28:31], v[128:131], a[128:131], v[28:31]
    ds_read_b64_tr_b16 v[144:145], v160 offset:0
    ds_read_b128 a[128:131], v168 offset:32768
    v_mfma_f32_16x16x32_bf16 v[28:31], v[132:135], a[132:135], v[28:31]
    ds_read_b64_tr_b16 v[146:147], v160 offset:4096
    ds_read_b128 a[132:135], v169 offset:32768
    v_mfma_f32_16x16x32_bf16 v[28:31], v[136:139], a[136:139], v[28:31]
    ds_read_b64_tr_b16 v[148:149], v160 offset:8192
    ds_read_b128 a[136:139], v170 offset:0
    v_mfma_f32_16x16x32_bf16 v[28:31], v[140:143], a[140:143], v[28:31]
    ds_read_b64_tr_b16 v[150:151], v160 offset:12288
    ds_read_b128 a[140:143], v171 offset:0
    v_mfma_f32_16x16x32_bf16 v[60:63], v[128:131], a[144:147], v[60:63]
    ds_read_b64_tr_b16 v[152:153], v160 offset:16384
    ds_read_b128 a[144:147], v168 offset:34816
    v_mfma_f32_16x16x32_bf16 v[60:63], v[132:135], a[148:151], v[60:63]
    ds_read_b64_tr_b16 v[154:155], v160 offset:20480
    ds_read_b128 a[148:151], v169 offset:34816
    v_mfma_f32_16x16x32_bf16 v[60:63], v[136:139], a[152:155], v[60:63]
    ds_read_b64_tr_b16 v[156:157], v160 offset:24576
    ds_read_b128 a[152:155], v170 offset:2048
    v_mfma_f32_16x16x32_bf16 v[60:63], v[140:143], a[156:159], v[60:63]
    ds_read_b64_tr_b16 v[158:159], v160 offset:28672
    ds_read_b128 a[156:159], v171 offset:2048
    v_mfma_f32_16x16x32_bf16 v[92:95], v[128:131], a[160:163], v[92:95]
    ds_read_b128 a[160:163], v168 offset:36864
    v_mfma_f32_16x16x32_bf16 v[92:95], v[132:135], a[164:167], v[92:95]
    ds_read_b128 a[164:167], v169 offset:36864
    v_mfma_f32_16x16x32_bf16 v[92:95], v[136:139], a[168:171], v[92:95]
    ds_read_b128 a[168:171], v170 offset:4096
    v_mfma_f32_16x16x32_bf16 v[92:95], v[140:143], a[172:175], v[92:95]
    ds_read_b128 a[172:175], v171 offset:4096
    v_mfma_f32_16x16x32_bf16 v[124:127], v[128:131], a[176:179], v[124:127]
    ds_read_b128 a[176:179], v168 offset:38912
    v_mfma_f32_16x16x32_bf16 v[124:127], v[132:135], a[180:183], v[124:127]
    ds_read_b128 a[180:183], v169 offset:38912
    v_mfma_f32_16x16x32_bf16 v[124:127], v[136:139], a[184:187], v[124:127]
    ds_read_b128 a[184:187], v170 offset:6144
    v_mfma_f32_16x16x32_bf16 v[124:127], v[140:143], a[188:191], v[124:127]
    ds_read_b128 a[188:191], v171 offset:6144
    s_waitcnt lgkmcnt(8)
    v_mfma_f32_16x16x32_bf16 v[0:3], v[144:147], a[128:131], v[0:3]
    ds_read_b64_tr_b16 v[128:129], v161 offset:0
    v_mfma_f32_16x16x32_bf16 v[0:3], v[148:151], a[132:135], v[0:3]
    ds_read_b64_tr_b16 v[130:131], v161 offset:4096
    v_mfma_f32_16x16x32_bf16 v[0:3], v[152:155], a[136:139], v[0:3]
    ds_read_b64_tr_b16 v[132:133], v161 offset:8192
    v_mfma_f32_16x16x32_bf16 v[0:3], v[156:159], a[140:143], v[0:3]
    v_xor_b32 v160, 0x20000, v160
    v_mfma_f32_16x16x32_bf16 v[32:35], v[144:147], a[144:147], v[32:35]
    ds_read_b64_tr_b16 v[134:135], v161 offset:12288
    v_mfma_f32_16x16x32_bf16 v[32:35], v[148:151], a[148:151], v[32:35]
    ds_read_b64_tr_b16 v[136:137], v161 offset:16384
    v_mfma_f32_16x16x32_bf16 v[32:35], v[152:155], a[152:155], v[32:35]
    ds_read_b64_tr_b16 v[138:139], v161 offset:20480
    v_mfma_f32_16x16x32_bf16 v[32:35], v[156:159], a[156:159], v[32:35]
    s_waitcnt lgkmcnt(6)
    v_mfma_f32_16x16x32_bf16 v[64:67], v[144:147], a[160:163], v[64:67]
    ds_read_b64_tr_b16 v[140:141], v161 offset:24576
    s_add_u32 m0, s57, 131072
    v_mfma_f32_16x16x32_bf16 v[64:67], v[148:151], a[164:167], v[64:67]
    ds_read_b64_tr_b16 v[142:143], v161 offset:28672
    s_add_u32 s56, s55, 3145728
    v_mfma_f32_16x16x32_bf16 v[64:67], v[152:155], a[168:171], v[64:67]
    v_xor_b32 v161, 0x20000, v161
    v_mfma_f32_16x16x32_bf16 v[64:67], v[156:159], a[172:175], v[64:67]
    buffer_load_dwordx4 v174, s[48:51], s56 offen offset:0 lds
    v_mfma_f32_16x16x32_bf16 v[96:99], v[144:147], a[176:179], v[96:99]
    s_add_u32 s56, s56, 64512
    v_mfma_f32_16x16x32_bf16 v[96:99], v[148:151], a[180:183], v[96:99]
    v_mfma_f32_16x16x32_bf16 v[96:99], v[152:155], a[184:187], v[96:99]
    v_mfma_f32_16x16x32_bf16 v[96:99], v[156:159], a[188:191], v[96:99]
    s_waitcnt lgkmcnt(0)
    buffer_load_dwordx4 v175, s[48:51], s56 offen offset:1024 lds
    v_mfma_f32_16x16x32_bf16 v[4:7], v[128:131], a[128:131], v[4:7]
    ds_read_b64_tr_b16 v[144:145], v162 offset:0
    s_add_u32 s56, s56, 64512
    v_mfma_f32_16x16x32_bf16 v[4:7], v[132:135], a[132:135], v[4:7]
    ds_read_b64_tr_b16 v[146:147], v162 offset:4096
    v_mfma_f32_16x16x32_bf16 v[4:7], v[136:139], a[136:139], v[4:7]
    ds_read_b64_tr_b16 v[148:149], v162 offset:8192
    v_mfma_f32_16x16x32_bf16 v[4:7], v[140:143], a[140:143], v[4:7]
    buffer_load_dwordx4 v174, s[48:51], s56 offen offset:2048 lds
    v_mfma_f32_16x16x32_bf16 v[36:39], v[128:131], a[144:147], v[36:39]
    ds_read_b64_tr_b16 v[150:151], v162 offset:12288
    s_add_u32 s56, s56, 64512
    v_mfma_f32_16x16x32_bf16 v[36:39], v[132:135], a[148:151], v[36:39]
    ds_read_b64_tr_b16 v[152:153], v162 offset:16384
    v_mfma_f32_16x16x32_bf16 v[36:39], v[136:139], a[152:155], v[36:39]
    ds_read_b64_tr_b16 v[154:155], v162 offset:20480
    v_mfma_f32_16x16x32_bf16 v[36:39], v[140:143], a[156:159], v[36:39]
    buffer_load_dwordx4 v175, s[48:51], s56 offen offset:3072 lds
    v_mfma_f32_16x16x32_bf16 v[68:71], v[128:131], a[160:163], v[68:71]
    ds_read_b64_tr_b16 v[156:157], v162 offset:24576
    s_add_u32 m0, s57, 135168
    v_mfma_f32_16x16x32_bf16 v[68:71], v[132:135], a[164:167], v[68:71]
    ds_read_b64_tr_b16 v[158:159], v162 offset:28672
    s_add_u32 s56, s55, 3178496
    v_mfma_f32_16x16x32_bf16 v[68:71], v[136:139], a[168:171], v[68:71]
    v_xor_b32 v162, 0x20000, v162
    v_mfma_f32_16x16x32_bf16 v[68:71], v[140:143], a[172:175], v[68:71]
    buffer_load_dwordx4 v174, s[48:51], s56 offen offset:0 lds
    v_mfma_f32_16x16x32_bf16 v[100:103], v[128:131], a[176:179], v[100:103]
    s_add_u32 s56, s56, 64512
    v_mfma_f32_16x16x32_bf16 v[100:103], v[132:135], a[180:183], v[100:103]
    v_mfma_f32_16x16x32_bf16 v[100:103], v[136:139], a[184:187], v[100:103]
    v_mfma_f32_16x16x32_bf16 v[100:103], v[140:143], a[188:191], v[100:103]
    s_waitcnt lgkmcnt(0)
    buffer_load_dwordx4 v175, s[48:51], s56 offen offset:1024 lds
    v_mfma_f32_16x16x32_bf16 v[8:11], v[144:147], a[128:131], v[8:11]
    ds_read_b64_tr_b16 v[128:129], v163 offset:0
    s_add_u32 s56, s56, 64512
    v_mfma_f32_16x16x32_bf16 v[8:11], v[148:151], a[132:135], v[8:11]
    ds_read_b64_tr_b16 v[130:131], v163 offset:4096
    v_mfma_f32_16x16x32_bf16 v[8:11], v[152:155], a[136:139], v[8:11]
    ds_read_b64_tr_b16 v[132:133], v163 offset:8192
    s_cmp_lg_u32 s3, 0
    s_cbranch_scc1 F1_B
    global_load_dword v251, v250, s[74:75] sc1
F1_B:
    v_mfma_f32_16x16x32_bf16 v[8:11], v[156:159], a[140:143], v[8:11]
    buffer_load_dwordx4 v174, s[48:51], s56 offen offset:2048 lds
    v_mfma_f32_16x16x32_bf16 v[40:43], v[144:147], a[144:147], v[40:43]
    ds_read_b64_tr_b16 v[134:135], v163 offset:12288
    s_add_u32 s56, s56, 64512
    v_mfma_f32_16x16x32_bf16 v[40:43], v[148:151], a[148:151], v[40:43]
    ds_read_b64_tr_b16 v[136:137], v163 offset:16384
    v_mfma_f32_16x16x32_bf16 v[40:43], v[152:155], a[152:155], v[40:43]
    ds_read_b64_tr_b16 v[138:139], v163 offset:20480
    v_mfma_f32_16x16x32_bf16 v[40:43], v[156:159], a[156:159], v[40:43]
    buffer_load_dwordx4 v175, s[48:51], s56 offen offset:3072 lds
    v_mfma_f32_16x16x32_bf16 v[72:75], v[144:147], a[160:163], v[72:75]
    ds_read_b64_tr_b16 v[140:141], v163 offset:24576
    s_add_u32 m0, s57, 65536
    v_mfma_f32_16x16x32_bf16 v[72:75], v[148:151], a[164:167], v[72:75]
    ds_read_b64_tr_b16 v[142:143], v163 offset:28672
    s_add_u32 s54, s52, 896
    v_mfma_f32_16x16x32_bf16 v[72:75], v[152:155], a[168:171], v[72:75]
    v_xor_b32 v163, 0x20000, v163
    v_mfma_f32_16x16x32_bf16 v[72:75], v[156:159], a[172:175], v[72:75]
    buffer_load_dwordx4 v172, s[44:47], s54 offen offset:0 lds
    v_mfma_f32_16x16x32_bf16 v[104:107], v[144:147], a[176:179], v[104:107]
    s_add_u32 s54, s54, 7168
    v_mfma_f32_16x16x32_bf16 v[104:107], v[148:151], a[180:183], v[104:107]
    v_mfma_f32_16x16x32_bf16 v[104:107], v[152:155], a[184:187], v[104:107]
    v_mfma_f32_16x16x32_bf16 v[104:107], v[156:159], a[188:191], v[104:107]
    s_waitcnt lgkmcnt(0)
    buffer_load_dwordx4 v173, s[44:47], s54 offen offset:1024 lds
    v_mfma_f32_16x16x32_bf16 v[12:15], v[128:131], a[128:131], v[12:15]
    ds_read_b64_tr_b16 v[144:145], v164 offset:0
    s_add_u32 s54, s54, s58
    v_mfma_f32_16x16x32_bf16 v[12:15], v[132:135], a[132:135], v[12:15]
    ds_read_b64_tr_b16 v[146:147], v164 offset:4096
    v_mfma_f32_16x16x32_bf16 v[12:15], v[136:139], a[136:139], v[12:15]
    ds_read_b64_tr_b16 v[148:149], v164 offset:8192
    v_mfma_f32_16x16x32_bf16 v[12:15], v[140:143], a[140:143], v[12:15]
    buffer_load_dwordx4 v172, s[44:47], s54 offen offset:2048 lds
    v_mfma_f32_16x16x32_bf16 v[44:47], v[128:131], a[144:147], v[44:47]
    ds_read_b64_tr_b16 v[150:151], v164 offset:12288
    s_add_u32 s54, s54, 7168
    v_mfma_f32_16x16x32_bf16 v[44:47], v[132:135], a[148:151], v[44:47]
    ds_read_b64_tr_b16 v[152:153], v164 offset:16384
    v_mfma_f32_16x16x32_bf16 v[44:47], v[136:139], a[152:155], v[44:47]
    ds_read_b64_tr_b16 v[154:155], v164 offset:20480
    v_mfma_f32_16x16x32_bf16 v[44:47], v[140:143], a[156:159], v[44:47]
    buffer_load_dwordx4 v173, s[44:47], s54 offen offset:3072 lds
    v_mfma_f32_16x16x32_bf16 v[76:79], v[128:131], a[160:163], v[76:79]
    ds_read_b64_tr_b16 v[156:157], v164 offset:24576
    s_add_u32 m0, s57, 69632
    v_mfma_f32_16x16x32_bf16 v[76:79], v[132:135], a[164:167], v[76:79]
    ds_read_b64_tr_b16 v[158:159], v164 offset:28672
    s_add_u32 s54, s53, 896
    v_mfma_f32_16x16x32_bf16 v[76:79], v[136:139], a[168:171], v[76:79]
    v_xor_b32 v164, 0x20000, v164
    v_mfma_f32_16x16x32_bf16 v[76:79], v[140:143], a[172:175], v[76:79]
    buffer_load_dwordx4 v172, s[44:47], s54 offen offset:0 lds
    v_mfma_f32_16x16x32_bf16 v[108:111], v[128:131], a[176:179], v[108:111]
    s_add_u32 s54, s54, 7168
    v_mfma_f32_16x16x32_bf16 v[108:111], v[132:135], a[180:183], v[108:111]
    v_mfma_f32_16x16x32_bf16 v[108:111], v[136:139], a[184:187], v[108:111]
    v_mfma_f32_16x16x32_bf16 v[108:111], v[140:143], a[188:191], v[108:111]
    s_waitcnt lgkmcnt(0)
    buffer_load_dwordx4 v173, s[44:47], s54 offen offset:1024 lds
    v_mfma_f32_16x16x32_bf16 v[16:19], v[144:147], a[128:131], v[16:19]
    ds_read_b64_tr_b16 v[128:129], v165 offset:0
    s_add_u32 s54, s54, s58
    v_mfma_f32_16x16x32_bf16 v[16:19], v[148:151], a[132:135], v[16:19]
    ds_read_b64_tr_b16 v[130:131], v165 offset:4096
    v_mfma_f32_16x16x32_bf16 v[16:19], v[152:155], a[136:139], v[16:19]
    ds_read_b64_tr_b16 v[132:133], v165 offset:8192
    v_mfma_f32_16x16x32_bf16 v[16:19], v[156:159], a[140:143], v[16:19]
    buffer_load_dwordx4 v172, s[44:47], s54 offen offset:2048 lds
    v_mfma_f32_16x16x32_bf16 v[48:51], v[144:147], a[144:147], v[48:51]
    ds_read_b64_tr_b16 v[134:135], v165 offset:12288
    s_add_u32 s54, s54, 7168
    v_mfma_f32_16x16x32_bf16 v[48:51], v[148:151], a[148:151], v[48:51]
    ds_read_b64_tr_b16 v[136:137], v165 offset:16384
    v_mfma_f32_16x16x32_bf16 v[48:51], v[152:155], a[152:155], v[48:51]
    ds_read_b64_tr_b16 v[138:139], v165 offset:20480
    v_mfma_f32_16x16x32_bf16 v[48:51], v[156:159], a[156:159], v[48:51]
    buffer_load_dwordx4 v173, s[44:47], s54 offen offset:3072 lds
    v_mfma_f32_16x16x32_bf16 v[80:83], v[144:147], a[160:163], v[80:83]
    ds_read_b64_tr_b16 v[140:141], v165 offset:24576
    s_mov_b32 s29, s57
    v_mfma_f32_16x16x32_bf16 v[80:83], v[148:151], a[164:167], v[80:83]
    ds_read_b64_tr_b16 v[142:143], v165 offset:28672
    s_mov_b32 s28, s57
    v_mfma_f32_16x16x32_bf16 v[80:83], v[152:155], a[168:171], v[80:83]
    s_lshl_b32 s30, s26, 20
    s_add_u32 s30, s30, 16777216
    v_xor_b32 v165, 0x20000, v165
    v_mfma_f32_16x16x32_bf16 v[80:83], v[156:159], a[172:175], v[80:83]
    s_sub_u32 s66, 16, s25
    s_lshl_b32 s66, s66, 16
    v_mfma_f32_16x16x32_bf16 v[112:115], v[144:147], a[176:179], v[112:115]
    s_mov_b32 s67, 0x20000
    s_mov_b32 s62, 8192
    v_mfma_f32_16x16x32_bf16 v[112:115], v[148:151], a[180:183], v[112:115]
    s_mov_b32 s63, 0x20000
    s_add_u32 s64, s18, s30
    v_mfma_f32_16x16x32_bf16 v[112:115], v[152:155], a[184:187], v[112:115]
    s_addc_u32 s65, s19, 0
    s_add_u32 s60, s18, 56623104
    v_mfma_f32_16x16x32_bf16 v[112:115], v[156:159], a[188:191], v[112:115]
    s_waitcnt lgkmcnt(0)
    s_addc_u32 s61, s19, 0
    s_mov_b32 s36, 0
    v_mfma_f32_16x16x32_bf16 v[20:23], v[128:131], a[128:131], v[20:23]
    ds_read_b64_tr_b16 v[144:145], v166 offset:0
    s_getpc_b64 s[12:13]
CT_b:
    s_add_u32 s12, s12, KB_L1-CT_b
    s_addc_u32 s13, s13, 0
    v_mfma_f32_16x16x32_bf16 v[20:23], v[132:135], a[132:135], v[20:23]
    ds_read_b64_tr_b16 v[146:147], v166 offset:4096
    s_lshr_b32 s14, s2, 3
    v_mfma_f32_16x16x32_bf16 v[20:23], v[136:139], a[136:139], v[20:23]
    ds_read_b64_tr_b16 v[148:149], v166 offset:8192
    s_mul_i32 s14, s14, 640
    v_mfma_f32_16x16x32_bf16 v[20:23], v[140:143], a[140:143], v[20:23]
    v_min_u32 v178, 4, v235
    v_mfma_f32_16x16x32_bf16 v[52:55], v[128:131], a[144:147], v[52:55]
    ds_read_b64_tr_b16 v[150:151], v166 offset:12288
    v_lshl_add_u32 v178, v178, 7, s14
    v_mfma_f32_16x16x32_bf16 v[52:55], v[132:135], a[148:151], v[52:55]
    ds_read_b64_tr_b16 v[152:153], v166 offset:16384
    v_mfma_f32_16x16x32_bf16 v[52:55], v[136:139], a[152:155], v[52:55]
    ds_read_b64_tr_b16 v[154:155], v166 offset:20480
    v_mfma_f32_16x16x32_bf16 v[52:55], v[140:143], a[156:159], v[52:55]
    global_load_dword v179, v178, s[12:13]
    v_mfma_f32_16x16x32_bf16 v[84:87], v[128:131], a[160:163], v[84:87]
    ds_read_b64_tr_b16 v[156:157], v166 offset:24576
    v_mfma_f32_16x16x32_bf16 v[84:87], v[132:135], a[164:167], v[84:87]
    ds_read_b64_tr_b16 v[158:159], v166 offset:28672
    v_mfma_f32_16x16x32_bf16 v[84:87], v[136:139], a[168:171], v[84:87]
    v_xor_b32 v166, 0x20000, v166
    v_mfma_f32_16x16x32_bf16 v[84:87], v[140:143], a[172:175], v[84:87]
    v_mfma_f32_16x16x32_bf16 v[116:119], v[128:131], a[176:179], v[116:119]
    v_mfma_f32_16x16x32_bf16 v[116:119], v[132:135], a[180:183], v[116:119]
    v_mfma_f32_16x16x32_bf16 v[116:119], v[136:139], a[184:187], v[116:119]
    v_mfma_f32_16x16x32_bf16 v[116:119], v[140:143], a[188:191], v[116:119]
    s_waitcnt lgkmcnt(0)
    v_mfma_f32_16x16x32_bf16 v[24:27], v[144:147], a[128:131], v[24:27]
    ds_read_b64_tr_b16 v[128:129], v167 offset:0
    v_mfma_f32_16x16x32_bf16 v[24:27], v[148:151], a[132:135], v[24:27]
    ds_read_b64_tr_b16 v[130:131], v167 offset:4096
    v_mfma_f32_16x16x32_bf16 v[24:27], v[152:155], a[136:139], v[24:27]
    ds_read_b64_tr_b16 v[132:133], v167 offset:8192
    v_mfma_f32_16x16x32_bf16 v[24:27], v[156:159], a[140:143], v[24:27]
    v_mfma_f32_16x16x32_bf16 v[56:59], v[144:147], a[144:147], v[56:59]
    ds_read_b64_tr_b16 v[134:135], v167 offset:12288
    v_mfma_f32_16x16x32_bf16 v[56:59], v[148:151], a[148:151], v[56:59]
    ds_read_b64_tr_b16 v[136:137], v167 offset:16384
    v_mfma_f32_16x16x32_bf16 v[56:59], v[152:155], a[152:155], v[56:59]
    ds_read_b64_tr_b16 v[138:139], v167 offset:20480
    v_mfma_f32_16x16x32_bf16 v[56:59], v[156:159], a[156:159], v[56:59]
    v_mfma_f32_16x16x32_bf16 v[88:91], v[144:147], a[160:163], v[88:91]
    ds_read_b64_tr_b16 v[140:141], v167 offset:24576
    v_mfma_f32_16x16x32_bf16 v[88:91], v[148:151], a[164:167], v[88:91]
    ds_read_b64_tr_b16 v[142:143], v167 offset:28672
    v_mfma_f32_16x16x32_bf16 v[88:91], v[152:155], a[168:171], v[88:91]
    v_xor_b32 v167, 0x20000, v167
    s_cmp_lg_u32 s3, 0
    s_cbranch_scc1 F1_C
    s_mov_b32 s37, 1048576
    s_waitcnt vmcnt(10)
    s_branch F1_Q
F1_P:
    s_sleep 8
    global_load_dword v251, v250, s[74:75] sc1
    s_waitcnt vmcnt(0)
F1_Q:
    v_readfirstlane_b32 s38, v251
    s_sub_u32 s37, s37, 1
    s_cmp_eq_u32 s37, 0
    s_cselect_b32 s38, 1, s38
    s_cmp_eq_u32 s38, 0
    s_cbranch_scc1 F1_P
F1_C:
    v_mfma_f32_16x16x32_bf16 v[88:91], v[156:159], a[172:175], v[88:91]
    v_mfma_f32_16x16x32_bf16 v[120:123], v[144:147], a[176:179], v[120:123]
    v_mfma_f32_16x16x32_bf16 v[120:123], v[148:151], a[180:183], v[120:123]
    v_mfma_f32_16x16x32_bf16 v[120:123], v[152:155], a[184:187], v[120:123]
    v_mfma_f32_16x16x32_bf16 v[120:123], v[156:159], a[188:191], v[120:123]
    s_waitcnt lgkmcnt(0)
    s_waitcnt vmcnt(1)
    s_barrier
    v_mfma_f32_16x16x32_bf16 v[28:31], v[128:131], a[128:131], v[28:31]
    ds_read_b64_tr_b16 v[144:145], v160 offset:0
    ds_read_b128 a[128:131], v168 offset:0
    v_mfma_f32_16x16x32_bf16 v[28:31], v[132:135], a[132:135], v[28:31]
    ds_read_b64_tr_b16 v[146:147], v160 offset:4096
    ds_read_b128 a[132:135], v169 offset:0
    v_mfma_f32_16x16x32_bf16 v[28:31], v[136:139], a[136:139], v[28:31]
    ds_read_b64_tr_b16 v[148:149], v160 offset:8192
    ds_read_b128 a[136:139], v168 offset:32768
    v_mfma_f32_16x16x32_bf16 v[28:31], v[140:143], a[140:143], v[28:31]
    ds_read_b64_tr_b16 v[150:151], v160 offset:12288
    ds_read_b128 a[140:143], v169 offset:32768
    v_mfma_f32_16x16x32_bf16 v[60:63], v[128:131], a[144:147], v[60:63]
    ds_read_b64_tr_b16 v[152:153], v160 offset:16384
    ds_read_b128 a[144:147], v168 offset:2048
    v_mfma_f32_16x16x32_bf16 v[60:63], v[132:135], a[148:151], v[60:63]
    ds_read_b64_tr_b16 v[154:155], v160 offset:20480
    ds_read_b128 a[148:151], v169 offset:2048
    v_mfma_f32_16x16x32_bf16 v[60:63], v[136:139], a[152:155], v[60:63]
    ds_read_b64_tr_b16 v[156:157], v160 offset:24576
    ds_read_b128 a[152:155], v168 offset:34816
    v_mfma_f32_16x16x32_bf16 v[60:63], v[140:143], a[156:159], v[60:63]
    ds_read_b64_tr_b16 v[158:159], v160 offset:28672
    ds_read_b128 a[156:159], v169 offset:34816
    v_mfma_f32_16x16x32_bf16 v[92:95], v[128:131], a[160:163], v[92:95]
    ds_read_b128 a[160:163], v168 offset:4096
    v_mfma_f32_16x16x32_bf16 v[92:95], v[132:135], a[164:167], v[92:95]
    ds_read_b128 a[164:167], v169 offset:4096
    v_mfma_f32_16x16x32_bf16 v[92:95], v[136:139], a[168:171], v[92:95]
    ds_read_b128 a[168:171], v168 offset:36864
    v_mfma_f32_16x16x32_bf16 v[92:95], v[140:143], a[172:175], v[92:95]
    ds_read_b128 a[172:175], v169 offset:36864
    v_mfma_f32_16x16x32_bf16 v[124:127], v[128:131], a[176:179], v[124:127]
    ds_read_b128 a[176:179], v168 offset:6144
    v_mfma_f32_16x16x32_bf16 v[124:127], v[132:135], a[180:183], v[124:127]
    ds_read_b128 a[180:183], v169 offset:6144
    v_mfma_f32_16x16x32_bf16 v[124:127], v[136:139], a[184:187], v[124:127]
    ds_read_b128 a[184:187], v168 offset:38912
    v_mfma_f32_16x16x32_bf16 v[124:127], v[140:143], a[188:191], v[124:127]
    ds_read_b128 a[188:191], v169 offset:38912
    s_waitcnt lgkmcnt(8)
    v_mfma_f32_16x16x32_bf16 v[0:3], v[144:147], a[128:131], v[0:3]
    ds_read_b64_tr_b16 v[128:129], v161 offset:0
    v_mfma_f32_16x16x32_bf16 v[0:3], v[148:151], a[132:135], v[0:3]
    ds_read_b64_tr_b16 v[130:131], v161 offset:4096
    v_mfma_f32_16x16x32_bf16 v[0:3], v[152:155], a[136:139], v[0:3]
    ds_read_b64_tr_b16 v[132:133], v161 offset:8192
    v_mfma_f32_16x16x32_bf16 v[0:3], v[156:159], a[140:143], v[0:3]
    s_mov_b32 m0, s29
    s_add_u32 s29, s29, 32768
    v_mfma_f32_16x16x32_bf16 v[32:35], v[144:147], a[144:147], v[32:35]
    ds_read_b64_tr_b16 v[134:135], v161 offset:12288
    v_mfma_f32_16x16x32_bf16 v[32:35], v[148:151], a[148:151], v[32:35]
    ds_read_b64_tr_b16 v[136:137], v161 offset:16384
    v_mfma_f32_16x16x32_bf16 v[32:35], v[152:155], a[152:155], v[32:35]
    ds_read_b64_tr_b16 v[138:139], v161 offset:20480
    v_mfma_f32_16x16x32_bf16 v[32:35], v[156:159], a[156:159], v[32:35]
    s_waitcnt lgkmcnt(6)
    buffer_load_dwordx4 v232, s[64:67], s28 offen offset:0 sc1 lds
    v_mfma_f32_16x16x32_bf16 v[64:67], v[144:147], a[160:163], v[64:67]
    ds_read_b64_tr_b16 v[140:141], v161 offset:24576
    s_and_b32 s29, s29, 0x1ffff
    v_mfma_f32_16x16x32_bf16 v[64:67], v[148:151], a[164:167], v[64:67]
    ds_read_b64_tr_b16 v[142:143], v161 offset:28672
    v_mfma_f32_16x16x32_bf16 v[64:67], v[152:155], a[168:171], v[64:67]
    v_mfma_f32_16x16x32_bf16 v[64:67], v[156:159], a[172:175], v[64:67]
    buffer_load_dwordx4 v232, s[64:67], s28 offen offset:1024 sc1 lds
    v_mfma_f32_16x16x32_bf16 v[96:99], v[144:147], a[176:179], v[96:99]
    s_add_u32 s42, s28, 4096
    v_mov_b32 v168, 0
    v_mov_b32 v169, 0
    v_mfma_f32_16x16x32_bf16 v[96:99], v[148:151], a[180:183], v[96:99]
    v_mov_b32 v170, 0
    v_mov_b32 v171, 0
    v_mfma_f32_16x16x32_bf16 v[96:99], v[152:155], a[184:187], v[96:99]
    v_mov_b32 v172, 0
    v_mov_b32 v173, 0
    v_mfma_f32_16x16x32_bf16 v[96:99], v[156:159], a[188:191], v[96:99]
    s_waitcnt lgkmcnt(0)
    buffer_load_dwordx4 v232, s[64:67], s28 offen offset:2048 sc1 lds
    v_mfma_f32_16x16x32_bf16 v[4:7], v[128:131], a[128:131], v[4:7]
    ds_read_b64_tr_b16 v[144:145], v162 offset:0
    v_mov_b32 v174, 0
    v_mfma_f32_16x16x32_bf16 v[4:7], v[132:135], a[132:135], v[4:7]
    ds_read_b64_tr_b16 v[146:147], v162 offset:4096
    v_mov_b32 v175, 0
    v_mfma_f32_16x16x32_bf16 v[4:7], v[136:139], a[136:139], v[4:7]
    ds_read_b64_tr_b16 v[148:149], v162 offset:8192
    v_mfma_f32_16x16x32_bf16 v[4:7], v[140:143], a[140:143], v[4:7]
    buffer_load_dwordx4 v232, s[64:67], s28 offen offset:3072 sc1 lds
    v_mfma_f32_16x16x32_bf16 v[36:39], v[128:131], a[144:147], v[36:39]
    ds_read_b64_tr_b16 v[150:151], v162 offset:12288
    s_add_u32 m0, m0, 4096
    v_mfma_f32_16x16x32_bf16 v[36:39], v[132:135], a[148:151], v[36:39]
    ds_read_b64_tr_b16 v[152:153], v162 offset:16384
    v_mfma_f32_16x16x32_bf16 v[36:39], v[136:139], a[152:155], v[36:39]
    ds_read_b64_tr_b16 v[154:155], v162 offset:20480
    v_mfma_f32_16x16x32_bf16 v[36:39], v[140:143], a[156:159], v[36:39]
    buffer_load_dwordx4 v232, s[64:67], s42 offen offset:0 sc1 lds
    v_mfma_f32_16x16x32_bf16 v[68:71], v[128:131], a[160:163], v[68:71]
    ds_read_b64_tr_b16 v[156:157], v162 offset:24576
    s_add_u32 s28, s28, 32768
    v_mfma_f32_16x16x32_bf16 v[68:71], v[132:135], a[164:167], v[68:71]
    ds_read_b64_tr_b16 v[158:159], v162 offset:28672
    v_mfma_f32_16x16x32_bf16 v[68:71], v[136:139], a[168:171], v[68:71]
    v_mfma_f32_16x16x32_bf16 v[68:71], v[140:143], a[172:175], v[68:71]
    buffer_load_dwordx4 v232, s[64:67], s42 offen offset:1024 sc1 lds
    v_mfma_f32_16x16x32_bf16 v[100:103], v[128:131], a[176:179], v[100:103]
    v_mfma_f32_16x16x32_bf16 v[100:103], v[132:135], a[180:183], v[100:103]
    v_mfma_f32_16x16x32_bf16 v[100:103], v[136:139], a[184:187], v[100:103]
    v_mfma_f32_16x16x32_bf16 v[100:103], v[140:143], a[188:191], v[100:103]
    s_waitcnt lgkmcnt(0)
    buffer_load_dwordx4 v232, s[64:67], s42 offen offset:2048 sc1 lds
    v_mfma_f32_16x16x32_bf16 v[8:11], v[144:147], a[128:131], v[8:11]
    ds_read_b64_tr_b16 v[128:129], v163 offset:0
    v_mfma_f32_16x16x32_bf16 v[8:11], v[148:151], a[132:135], v[8:11]
    ds_read_b64_tr_b16 v[130:131], v163 offset:4096
    v_mfma_f32_16x16x32_bf16 v[8:11], v[152:155], a[136:139], v[8:11]
    ds_read_b64_tr_b16 v[132:133], v163 offset:8192
    v_mfma_f32_16x16x32_bf16 v[8:11], v[156:159], a[140:143], v[8:11]
    buffer_load_dwordx4 v232, s[64:67], s42 offen offset:3072 sc1 lds
    v_mfma_f32_16x16x32_bf16 v[40:43], v[144:147], a[144:147], v[40:43]
    ds_read_b64_tr_b16 v[134:135], v163 offset:12288
    s_lshl_b32 s30, s34, 6
    v_mfma_f32_16x16x32_bf16 v[40:43], v[148:151], a[148:151], v[40:43]
    ds_read_b64_tr_b16 v[136:137], v163 offset:16384
    s_add_u32 s31, s34, s43
    v_mfma_f32_16x16x32_bf16 v[40:43], v[152:155], a[152:155], v[40:43]
    ds_read_b64_tr_b16 v[138:139], v163 offset:20480
    s_lshl_b32 s31, s31, 6
    v_mfma_f32_16x16x32_bf16 v[40:43], v[156:159], a[156:159], v[40:43]
    buffer_load_dword v228, v237, s[60:63], s30 offen sc1
    v_mfma_f32_16x16x32_bf16 v[72:75], v[144:147], a[160:163], v[72:75]
    ds_read_b64_tr_b16 v[140:141], v163 offset:24576
    v_cvt_pk_bf16_f32 v0, v0, v1
    v_mfma_f32_16x16x32_bf16 v[72:75], v[148:151], a[164:167], v[72:75]
    ds_read_b64_tr_b16 v[142:143], v163 offset:28672
    v_cvt_pk_bf16_f32 v1, v2, v3
    v_mfma_f32_16x16x32_bf16 v[72:75], v[152:155], a[168:171], v[72:75]
    v_cvt_pk_bf16_f32 v2, v4, v5
    v_cvt_pk_bf16_f32 v3, v6, v7
    v_mfma_f32_16x16x32_bf16 v[72:75], v[156:159], a[172:175], v[72:75]
    buffer_load_dword v229, v237, s[60:63], s31 offen sc1
    v_mfma_f32_16x16x32_bf16 v[104:107], v[144:147], a[176:179], v[104:107]
    s_lshl_b32 s30, s35, 6
    s_add_u32 s31, s35, s43
    v_accvgpr_write_b32 a0, v0
    v_mfma_f32_16x16x32_bf16 v[104:107], v[148:151], a[180:183], v[104:107]
    s_lshl_b32 s31, s31, 6
    v_accvgpr_write_b32 a1, v1
    v_accvgpr_write_b32 a2, v2
    v_mfma_f32_16x16x32_bf16 v[104:107], v[152:155], a[184:187], v[104:107]
    v_accvgpr_write_b32 a3, v3
    v_cvt_pk_bf16_f32 v32, v32, v33
    v_mfma_f32_16x16x32_bf16 v[104:107], v[156:159], a[188:191], v[104:107]
    s_waitcnt lgkmcnt(0)
    buffer_load_dword v230, v237, s[60:63], s30 offen sc1
    v_mfma_f32_16x16x32_bf16 v[12:15], v[128:131], a[128:131], v[12:15]
    ds_read_b64_tr_b16 v[144:145], v164 offset:0
    v_cvt_pk_bf16_f32 v33, v34, v35
    v_mfma_f32_16x16x32_bf16 v[12:15], v[132:135], a[132:135], v[12:15]
    ds_read_b64_tr_b16 v[146:147], v164 offset:4096
    v_cvt_pk_bf16_f32 v34, v36, v37
    v_mfma_f32_16x16x32_bf16 v[12:15], v[136:139], a[136:139], v[12:15]
    ds_read_b64_tr_b16 v[148:149], v164 offset:8192
    v_cvt_pk_bf16_f32 v35, v38, v39
    v_mfma_f32_16x16x32_bf16 v[12:15], v[140:143], a[140:143], v[12:15]
    buffer_load_dword v231, v237, s[60:63], s31 offen sc1
    v_mfma_f32_16x16x32_bf16 v[44:47], v[128:131], a[144:147], v[44:47]
    ds_read_b64_tr_b16 v[150:151], v164 offset:12288
    s_mov_b32 m0, s29
    v_mfma_f32_16x16x32_bf16 v[44:47], v[132:135], a[148:151], v[44:47]
    ds_read_b64_tr_b16 v[152:153], v164 offset:16384
    s_add_u32 s29, s29, 32768
    v_mfma_f32_16x16x32_bf16 v[44:47], v[136:139], a[152:155], v[44:47]
    ds_read_b64_tr_b16 v[154:155], v164 offset:20480
    v_accvgpr_write_b32 a16, v32
    v_mfma_f32_16x16x32_bf16 v[44:47], v[140:143], a[156:159], v[44:47]
    buffer_load_dwordx4 v232, s[64:67], s28 offen offset:0 sc1 lds
    v_mfma_f32_16x16x32_bf16 v[76:79], v[128:131], a[160:163], v[76:79]
    ds_read_b64_tr_b16 v[156:157], v164 offset:24576
    s_and_b32 s29, s29, 0x1ffff
    v_mfma_f32_16x16x32_bf16 v[76:79], v[132:135], a[164:167], v[76:79]
    ds_read_b64_tr_b16 v[158:159], v164 offset:28672
    v_accvgpr_write_b32 a17, v33
    v_mfma_f32_16x16x32_bf16 v[76:79], v[136:139], a[168:171], v[76:79]
    v_accvgpr_write_b32 a18, v34
    v_accvgpr_write_b32 a19, v35
    v_mfma_f32_16x16x32_bf16 v[76:79], v[140:143], a[172:175], v[76:79]
    buffer_load_dwordx4 v232, s[64:67], s28 offen offset:1024 sc1 lds
    v_mfma_f32_16x16x32_bf16 v[108:111], v[128:131], a[176:179], v[108:111]
    s_add_u32 s42, s28, 4096
    v_cvt_pk_bf16_f32 v64, v64, v65
    v_cvt_pk_bf16_f32 v65, v66, v67
    v_mfma_f32_16x16x32_bf16 v[108:111], v[132:135], a[180:183], v[108:111]
    v_cvt_pk_bf16_f32 v66, v68, v69
    v_cvt_pk_bf16_f32 v67, v70, v71
    v_mfma_f32_16x16x32_bf16 v[108:111], v[136:139], a[184:187], v[108:111]
    v_accvgpr_write_b32 a32, v64
    v_accvgpr_write_b32 a33, v65
    v_mfma_f32_16x16x32_bf16 v[108:111], v[140:143], a[188:191], v[108:111]
    s_waitcnt lgkmcnt(0)
    buffer_load_dwordx4 v232, s[64:67], s28 offen offset:2048 sc1 lds
    v_mfma_f32_16x16x32_bf16 v[16:19], v[144:147], a[128:131], v[16:19]
    ds_read_b64_tr_b16 v[128:129], v165 offset:0
    v_accvgpr_write_b32 a34, v66
    v_mfma_f32_16x16x32_bf16 v[16:19], v[148:151], a[132:135], v[16:19]
    ds_read_b64_tr_b16 v[130:131], v165 offset:4096
    v_accvgpr_write_b32 a35, v67
    v_mfma_f32_16x16x32_bf16 v[16:19], v[152:155], a[136:139], v[16:19]
    ds_read_b64_tr_b16 v[132:133], v165 offset:8192
    v_cvt_pk_bf16_f32 v96, v96, v97
    v_mfma_f32_16x16x32_bf16 v[16:19], v[156:159], a[140:143], v[16:19]
    buffer_load_dwordx4 v232, s[64:67], s28 offen offset:3072 sc1 lds
    v_mfma_f32_16x16x32_bf16 v[48:51], v[144:147], a[144:147], v[48:51]
    ds_read_b64_tr_b16 v[134:135], v165 offset:12288
    s_add_u32 m0, m0, 4096
    v_mfma_f32_16x16x32_bf16 v[48:51], v[148:151], a[148:151], v[48:51]
    ds_read_b64_tr_b16 v[136:137], v165 offset:16384
    v_cvt_pk_bf16_f32 v97, v98, v99
    v_mfma_f32_16x16x32_bf16 v[48:51], v[152:155], a[152:155], v[48:51]
    ds_read_b64_tr_b16 v[138:139], v165 offset:20480
    v_cvt_pk_bf16_f32 v98, v100, v101
    v_mfma_f32_16x16x32_bf16 v[48:51], v[156:159], a[156:159], v[48:51]
    buffer_load_dwordx4 v232, s[64:67], s42 offen offset:0 sc1 lds
    v_mfma_f32_16x16x32_bf16 v[80:83], v[144:147], a[160:163], v[80:83]
    ds_read_b64_tr_b16 v[140:141], v165 offset:24576
    s_add_u32 s28, s28, 32768
    v_mfma_f32_16x16x32_bf16 v[80:83], v[148:151], a[164:167], v[80:83]
    ds_read_b64_tr_b16 v[142:143], v165 offset:28672
    v_cvt_pk_bf16_f32 v99, v102, v103
    v_mfma_f32_16x16x32_bf16 v[80:83], v[152:155], a[168:171], v[80:83]
    v_accvgpr_write_b32 a48, v96
    v_accvgpr_write_b32 a49, v97
    v_mfma_f32_16x16x32_bf16 v[80:83], v[156:159], a[172:175], v[80:83]
    buffer_load_dwordx4 v232, s[64:67], s42 offen offset:1024 sc1 lds
    v_mfma_f32_16x16x32_bf16 v[112:115], v[144:147], a[176:179], v[112:115]
    v_accvgpr_write_b32 a50, v98
    v_accvgpr_write_b32 a51, v99
    v_mfma_f32_16x16x32_bf16 v[112:115], v[148:151], a[180:183], v[112:115]
    v_cvt_pk_bf16_f32 v8, v8, v9
    v_cvt_pk_bf16_f32 v9, v10, v11
    v_mfma_f32_16x16x32_bf16 v[112:115], v[152:155], a[184:187], v[112:115]
    v_cvt_pk_bf16_f32 v10, v12, v13
    v_cvt_pk_bf16_f32 v11, v14, v15
    v_mfma_f32_16x16x32_bf16 v[112:115], v[156:159], a[188:191], v[112:115]
    s_waitcnt lgkmcnt(0)
    buffer_load_dwordx4 v232, s[64:67], s42 offen offset:2048 sc1 lds
    v_mfma_f32_16x16x32_bf16 v[20:23], v[128:131], a[128:131], v[20:23]
    ds_read_b64_tr_b16 v[144:145], v166 offset:0
    v_accvgpr_write_b32 a4, v8
    v_mfma_f32_16x16x32_bf16 v[20:23], v[132:135], a[132:135], v[20:23]
    ds_read_b64_tr_b16 v[146:147], v166 offset:4096
    v_accvgpr_write_b32 a5, v9
    v_mfma_f32_16x16x32_bf16 v[20:23], v[136:139], a[136:139], v[20:23]
    ds_read_b64_tr_b16 v[148:149], v166 offset:8192
    v_accvgpr_write_b32 a6, v10
    v_mfma_f32_16x16x32_bf16 v[20:23], v[140:143], a[140:143], v[20:23]
    buffer_load_dwordx4 v232, s[64:67], s42 offen offset:3072 sc1 lds
    v_mfma_f32_16x16x32_bf16 v[52:55], v[128:131], a[144:147], v[52:55]
    ds_read_b64_tr_b16 v[150:151], v166 offset:12288
    s_mov_b32 m0, s29
    v_mfma_f32_16x16x32_bf16 v[52:55], v[132:135], a[148:151], v[52:55]
    ds_read_b64_tr_b16 v[152:153], v166 offset:16384
    s_add_u32 s29, s29, 32768
    v_mfma_f32_16x16x32_bf16 v[52:55], v[136:139], a[152:155], v[52:55]
    ds_read_b64_tr_b16 v[154:155], v166 offset:20480
    v_accvgpr_write_b32 a7, v11
    v_mfma_f32_16x16x32_bf16 v[52:55], v[140:143], a[156:159], v[52:55]
    buffer_load_dwordx4 v232, s[64:67], s28 offen offset:0 sc1 lds
    v_mfma_f32_16x16x32_bf16 v[84:87], v[128:131], a[160:163], v[84:87]
    ds_read_b64_tr_b16 v[156:157], v166 offset:24576
    s_and_b32 s29, s29, 0x1ffff
    v_mfma_f32_16x16x32_bf16 v[84:87], v[132:135], a[164:167], v[84:87]
    ds_read_b64_tr_b16 v[158:159], v166 offset:28672
    v_cvt_pk_bf16_f32 v40, v40, v41
    v_mfma_f32_16x16x32_bf16 v[84:87], v[136:139], a[168:171], v[84:87]
    v_cvt_pk_bf16_f32 v41, v42, v43
    v_cvt_pk_bf16_f32 v42, v44, v45
    v_mfma_f32_16x16x32_bf16 v[84:87], v[140:143], a[172:175], v[84:87]
    buffer_load_dwordx4 v232, s[64:67], s28 offen offset:1024 sc1 lds
    v_mfma_f32_16x16x32_bf16 v[116:119], v[128:131], a[176:179], v[116:119]
    s_add_u32 s42, s28, 4096
    v_cvt_pk_bf16_f32 v43, v46, v47
    v_accvgpr_write_b32 a20, v40
    v_mfma_f32_16x16x32_bf16 v[116:119], v[132:135], a[180:183], v[116:119]
    v_accvgpr_write_b32 a21, v41
    v_accvgpr_write_b32 a22, v42
    v_mfma_f32_16x16x32_bf16 v[116:119], v[136:139], a[184:187], v[116:119]
    v_accvgpr_write_b32 a23, v43
    v_cvt_pk_bf16_f32 v72, v72, v73
    v_mfma_f32_16x16x32_bf16 v[116:119], v[140:143], a[188:191], v[116:119]
    s_waitcnt lgkmcnt(0)
    buffer_load_dwordx4 v232, s[64:67], s28 offen offset:2048 sc1 lds
    v_mfma_f32_16x16x32_bf16 v[24:27], v[144:147], a[128:131], v[24:27]
    ds_read_b64_tr_b16 v[128:129], v167 offset:0
    v_cvt_pk_bf16_f32 v73, v74, v75
    v_mfma_f32_16x16x32_bf16 v[24:27], v[148:151], a[132:135], v[24:27]
    ds_read_b64_tr_b16 v[130:131], v167 offset:4096
    v_cvt_pk_bf16_f32 v74, v76, v77
    v_mfma_f32_16x16x32_bf16 v[24:27], v[152:155], a[136:139], v[24:27]
    ds_read_b64_tr_b16 v[132:133], v167 offset:8192
    v_cvt_pk_bf16_f32 v75, v78, v79
    v_mfma_f32_16x16x32_bf16 v[24:27], v[156:159], a[140:143], v[24:27]
    buffer_load_dwordx4 v232, s[64:67], s28 offen offset:3072 sc1 lds
    v_mfma_f32_16x16x32_bf16 v[56:59], v[144:147], a[144:147], v[56:59]
    ds_read_b64_tr_b16 v[134:135], v167 offset:12288
    s_add_u32 m0, m0, 4096
    v_mfma_f32_16x16x32_bf16 v[56:59], v[148:151], a[148:151], v[56:59]
    ds_read_b64_tr_b16 v[136:137], v167 offset:16384
    v_accvgpr_write_b32 a36, v72
    v_mfma_f32_16x16x32_bf16 v[56:59], v[152:155], a[152:155], v[56:59]
    ds_read_b64_tr_b16 v[138:139], v167 offset:20480
    v_accvgpr_write_b32 a37, v73
    v_mfma_f32_16x16x32_bf16 v[56:59], v[156:159], a[156:159], v[56:59]
    buffer_load_dwordx4 v232, s[64:67], s42 offen offset:0 sc1 lds
    v_mfma_f32_16x16x32_bf16 v[88:91], v[144:147], a[160:163], v[88:91]
    ds_read_b64_tr_b16 v[140:141], v167 offset:24576
    s_add_u32 s28, s28, 32768
    v_mfma_f32_16x16x32_bf16 v[88:91], v[148:151], a[164:167], v[88:91]
    ds_read_b64_tr_b16 v[142:143], v167 offset:28672
    v_accvgpr_write_b32 a38, v74
    v_mfma_f32_16x16x32_bf16 v[88:91], v[152:155], a[168:171], v[88:91]
    v_accvgpr_write_b32 a39, v75
    v_cvt_pk_bf16_f32 v104, v104, v105
    v_mfma_f32_16x16x32_bf16 v[88:91], v[156:159], a[172:175], v[88:91]
    buffer_load_dwordx4 v232, s[64:67], s42 offen offset:1024 sc1 lds
    v_mfma_f32_16x16x32_bf16 v[120:123], v[144:147], a[176:179], v[120:123]
    v_cvt_pk_bf16_f32 v105, v106, v107
    v_cvt_pk_bf16_f32 v106, v108, v109
    v_mfma_f32_16x16x32_bf16 v[120:123], v[148:151], a[180:183], v[120:123]
    v_cvt_pk_bf16_f32 v107, v110, v111
    v_accvgpr_write_b32 a52, v104
    v_mfma_f32_16x16x32_bf16 v[120:123], v[152:155], a[184:187], v[120:123]
    v_accvgpr_write_b32 a53, v105
    v_accvgpr_write_b32 a54, v106
    v_mfma_f32_16x16x32_bf16 v[120:123], v[156:159], a[188:191], v[120:123]
    s_waitcnt lgkmcnt(0)
    s_waitcnt vmcnt(18)
    s_barrier
    v_mfma_f32_16x16x32_bf16 v[28:31], v[128:131], a[128:131], v[28:31]
    buffer_load_dwordx4 v232, s[64:67], s42 offen offset:2048 sc1 lds
    v_mfma_f32_16x16x32_bf16 v[28:31], v[132:135], a[132:135], v[28:31]
    ds_read_b128 a[64:67], v233 offset:0
    v_accvgpr_write_b32 a55, v107
    v_mfma_f32_16x16x32_bf16 v[28:31], v[136:139], a[136:139], v[28:31]
    ds_read_b128 a[68:71], v233 offset:1024
    v_cvt_pk_bf16_f32 v16, v16, v17
    v_mfma_f32_16x16x32_bf16 v[28:31], v[140:143], a[140:143], v[28:31]
    ds_read_b128 a[72:75], v233 offset:2048
    v_cvt_pk_bf16_f32 v17, v18, v19
    v_mfma_f32_16x16x32_bf16 v[60:63], v[128:131], a[144:147], v[60:63]
    ds_read_b128 a[76:79], v233 offset:3072
    v_cvt_pk_bf16_f32 v18, v20, v21
    v_mfma_f32_16x16x32_bf16 v[60:63], v[132:135], a[148:151], v[60:63]
    ds_read_b128 a[80:83], v233 offset:4096
    v_cvt_pk_bf16_f32 v19, v22, v23
    v_mfma_f32_16x16x32_bf16 v[60:63], v[136:139], a[152:155], v[60:63]
    ds_read_b128 a[84:87], v233 offset:5120
    v_accvgpr_write_b32 a8, v16
    v_mfma_f32_16x16x32_bf16 v[60:63], v[140:143], a[156:159], v[60:63]
    ds_read_b128 a[88:91], v233 offset:6144
    v_accvgpr_write_b32 a9, v17
    v_mfma_f32_16x16x32_bf16 v[92:95], v[128:131], a[160:163], v[92:95]
    ds_read_b128 a[92:95], v233 offset:7168
    v_accvgpr_write_b32 a10, v18
    v_mfma_f32_16x16x32_bf16 v[92:95], v[132:135], a[164:167], v[92:95]
    buffer_load_dwordx4 v232, s[64:67], s42 offen offset:3072 sc1 lds
    v_mfma_f32_16x16x32_bf16 v[92:95], v[136:139], a[168:171], v[92:95]
    v_accvgpr_write_b32 a11, v19
    v_cvt_pk_bf16_f32 v48, v48, v49
    v_mfma_f32_16x16x32_bf16 v[92:95], v[140:143], a[172:175], v[92:95]
    v_cvt_pk_bf16_f32 v49, v50, v51
    v_cvt_pk_bf16_f32 v50, v52, v53
    v_mfma_f32_16x16x32_bf16 v[124:127], v[128:131], a[176:179], v[124:127]
    v_cvt_pk_bf16_f32 v51, v54, v55
    v_accvgpr_write_b32 a24, v48
    v_mfma_f32_16x16x32_bf16 v[124:127], v[132:135], a[180:183], v[124:127]
    v_accvgpr_write_b32 a25, v49
    v_accvgpr_write_b32 a26, v50
    v_mfma_f32_16x16x32_bf16 v[124:127], v[136:139], a[184:187], v[124:127]
    v_accvgpr_write_b32 a27, v51
    v_cvt_pk_bf16_f32 v80, v80, v81
    v_mfma_f32_16x16x32_bf16 v[124:127], v[140:143], a[188:191], v[124:127]
    v_cvt_pk_bf16_f32 v81, v82, v83
    v_cvt_pk_bf16_f32 v82, v84, v85
    v_cvt_pk_bf16_f32 v83, v86, v87
    v_accvgpr_write_b32 a40, v80
    v_accvgpr_write_b32 a41, v81
    v_accvgpr_write_b32 a42, v82
    v_accvgpr_write_b32 a43, v83
    v_cvt_pk_bf16_f32 v112, v112, v113
    v_cvt_pk_bf16_f32 v113, v114, v115
    v_cvt_pk_bf16_f32 v114, v116, v117
    v_cvt_pk_bf16_f32 v115, v118, v119
    v_accvgpr_write_b32 a56, v112
    v_accvgpr_write_b32 a57, v113
    v_accvgpr_write_b32 a58, v114
    v_accvgpr_write_b32 a59, v115
    v_mov_b32 v144, 0
    v_mov_b32 v145, 0
    v_mov_b32 v146, 0
    v_mov_b32 v147, 0
    v_mov_b32 v148, 0
    v_mov_b32 v149, 0
    v_mov_b32 v150, 0
    v_mov_b32 v151, 0
    v_mov_b32 v152, 0
    v_mov_b32 v153, 0
    v_mov_b32 v154, 0
    v_mov_b32 v155, v238
    v_mov_b32 v156, v238
    v_mov_b32 v157, v238
    v_mov_b32 v158, v238
    v_mov_b32 v159, v238
    v_mfma_f32_32x32x16_bf16 v[0:15], v[212:215], v[212:215], 0
    v_cvt_pk_bf16_f32 v24, v24, v25
    v_cvt_pk_bf16_f32 v25, v26, v27
    v_cvt_pk_bf16_f32 v26, v28, v29
    v_cvt_pk_bf16_f32 v27, v30, v31
    v_mfma_f32_32x32x16_bf16 v[32:47], v[212:215], v[212:215], 0
    v_accvgpr_write_b32 a12, v24
    v_accvgpr_write_b32 a13, v25
    v_accvgpr_write_b32 a14, v26
    v_accvgpr_write_b32 a15, v27
    v_mfma_f32_32x32x16_bf16 v[64:79], v[212:215], v[212:215], 0
    v_cvt_pk_bf16_f32 v56, v56, v57
    v_cvt_pk_bf16_f32 v57, v58, v59
    v_cvt_pk_bf16_f32 v58, v60, v61
    v_cvt_pk_bf16_f32 v59, v62, v63
    v_mfma_f32_32x32x16_bf16 v[96:111], v[212:215], v[212:215], 0
    v_accvgpr_write_b32 a28, v56
    v_accvgpr_write_b32 a29, v57
    v_accvgpr_write_b32 a30, v58
    v_accvgpr_write_b32 a31, v59
    v_mfma_f32_32x32x16_bf16 v[16:31], v[212:215], v[212:215], 0
    v_cvt_pk_bf16_f32 v88, v88, v89
    v_cvt_pk_bf16_f32 v89, v90, v91
    v_cvt_pk_bf16_f32 v90, v92, v93
    v_cvt_pk_bf16_f32 v91, v94, v95
    v_mfma_f32_32x32x16_bf16 v[48:63], v[212:215], v[212:215], 0
    v_accvgpr_write_b32 a44, v88
    v_accvgpr_write_b32 a45, v89
    v_accvgpr_write_b32 a46, v90
    v_accvgpr_write_b32 a47, v91
    v_mfma_f32_32x32x16_bf16 a[160:175], v[212:215], v[212:215], 0
    v_cvt_pk_bf16_f32 v120, v120, v121
    v_cvt_pk_bf16_f32 v121, v122, v123
    v_cvt_pk_bf16_f32 v122, v124, v125
    v_cvt_pk_bf16_f32 v123, v126, v127
    v_mfma_f32_32x32x16_bf16 v[80:95], v[212:215], v[212:215], 0
    v_accvgpr_write_b32 a60, v120
    v_accvgpr_write_b32 a61, v121
    v_accvgpr_write_b32 a62, v122
    v_accvgpr_write_b32 a63, v123
    v_mfma_f32_32x32x16_bf16 v[112:127], v[212:215], v[212:215], 0
    v_mfma_f32_32x32x16_bf16 a[176:191], v[212:215], v[212:215], 0
    s_cmp_lt_u32 s25, 3
    s_cbranch_scc1 KB_W1
    s_sub_u32 s24, s25, 4
    s_lshl_b32 s24, s24, 5
    s_add_u32 s24, s24, s26
    s_lshl_b32 s24, s24, 1
    s_add_u32 s30, s26, 256
    s_cmp_eq_u32 s25, 3
    s_cselect_b32 s24, s30, s24
    s_sub_u32 s31, s24, 32
    s_cmp_lt_u32 s24, 32
    s_cselect_b64 s[48:49], s[68:69], s[70:71]
    s_cselect_b32 s31, s24, s31
    s_cselect_b32 s50, 1, 8
    s_lshl_b32 s50, s50, 19
    s_lshl_b32 s31, s31, 6
    s_add_u32 s31, s31, s3
    s_lshl_b32 s54, s31, 8
    s_add_u32 m0, s57, 131072
    s_add_u32 s54, s54, 0
    buffer_load_dwordx4 v246, s[48:51], s54 offen offset:0 lds
    s_add_u32 s54, s54, 3072
    buffer_load_dwordx4 v246, s[48:51], s54 offen offset:1024 lds
    s_add_u32 s54, s54, 3072
    buffer_load_dwordx4 v246, s[48:51], s54 offen offset:2048 lds
    s_add_u32 s54, s54, 3072
    buffer_load_dwordx4 v246, s[48:51], s54 offen offset:3072 lds
    s_cmp_eq_u32 s25, 3
    s_cbranch_scc1 KB_W1
    s_add_u32 s24, s24, 1
    s_nop 0
    s_sub_u32 s31, s24, 32
    s_cmp_lt_u32 s24, 32
    s_cselect_b64 s[48:49], s[68:69], s[70:71]
    s_cselect_b32 s31, s24, s31
    s_cselect_b32 s50, 1, 8
    s_lshl_b32 s50, s50, 19
    s_lshl_b32 s31, s31, 6
    s_add_u32 s31, s31, s3
    s_lshl_b32 s54, s31, 8
    s_add_u32 m0, s57, 135168
    s_add_u32 s54, s54, 0
    buffer_load_dwordx4 v246, s[48:51], s54 offen offset:0 lds
    s_add_u32 s54, s54, 3072
    buffer_load_dwordx4 v246, s[48:51], s54 offen offset:1024 lds
    s_add_u32 s54, s54, 3072
    buffer_load_dwordx4 v246, s[48:51], s54 offen offset:2048 lds
    s_add_u32 s54, s54, 3072
    buffer_load_dwordx4 v246, s[48:51], s54 offen offset:3072 lds
KB_W1:
    s_mov_b32 s27, s25
    s_cmp_eq_u32 s25, 0
    s_waitcnt lgkmcnt(0)
    s_cbranch_scc1 KB_D1
.p2align 3
KB_L1:
    v_mfma_f32_16x16x32_bf16 v[128:131], a[64:67], a[0:3], 0
    v_exp_f32 v155, v155
    v_mfma_f32_16x16x32_bf16 v[128:131], a[68:71], a[4:7], v[128:131]
    v_cvt_pk_bf16_f32 v173, v154, v155
    v_mfma_f32_16x16x32_bf16 v[128:131], a[72:75], a[8:11], v[128:131]
    v_exp_f32 v156, v156
    v_mfma_f32_16x16x32_bf16 v[128:131], a[76:79], a[12:15], v[128:131]
    v_mfma_f32_16x16x32_bf16 v[132:135], a[80:83], a[0:3], 0
    v_exp_f32 v157, v157
    v_mfma_f32_16x16x32_bf16 v[132:135], a[84:87], a[4:7], v[132:135]
    v_cvt_pk_bf16_f32 v174, v156, v157
    v_mfma_f32_16x16x32_bf16 v[132:135], a[88:91], a[8:11], v[132:135]
    v_exp_f32 v158, v158
    v_mfma_f32_16x16x32_bf16 v[132:135], a[92:95], a[12:15], v[132:135]
    v_mfma_f32_16x16x32_bf16 v[136:139], a[64:67], a[16:19], 0
    v_exp_f32 v159, v159
    v_mfma_f32_16x16x32_bf16 v[136:139], a[68:71], a[20:23], v[136:139]
    v_cvt_pk_bf16_f32 v175, v158, v159
    v_mfma_f32_16x16x32_bf16 v[136:139], a[72:75], a[24:27], v[136:139]
    v_xor_b32 v234, 0x10000, v234
    v_mfma_f32_16x16x32_bf16 v[136:139], a[76:79], a[28:31], v[136:139]
    v_mfma_f32_16x16x32_bf16 v[140:143], a[80:83], a[16:19], 0
    v_exp_f32 v128, v128
    v_mfma_f32_16x16x32_bf16 v[140:143], a[84:87], a[20:23], v[140:143]
    v_mfma_f32_16x16x32_bf16 v[140:143], a[88:91], a[24:27], v[140:143]
    v_exp_f32 v129, v129
    v_mfma_f32_16x16x32_bf16 v[140:143], a[92:95], a[28:31], v[140:143]
    v_cvt_pk_bf16_f32 v160, v128, v129
    v_mfma_f32_16x16x32_bf16 v[64:67], a[160:163], v[168:171], v[64:67]
    v_exp_f32 v130, v130
    v_mfma_f32_16x16x32_bf16 v[96:99], a[160:163], v[172:175], v[96:99]
    ds_read_b128 a[96:99], v234 offset:8192
    v_mfma_f32_16x16x32_bf16 v[68:71], a[164:167], v[168:171], v[68:71]
    v_exp_f32 v131, v131
    v_mfma_f32_16x16x32_bf16 v[100:103], a[164:167], v[172:175], v[100:103]
    ds_read_b128 a[100:103], v234 offset:9216
    v_cvt_pk_bf16_f32 v161, v130, v131
    v_mfma_f32_16x16x32_bf16 v[72:75], a[168:171], v[168:171], v[72:75]
    v_exp_f32 v132, v132
    v_mfma_f32_16x16x32_bf16 v[104:107], a[168:171], v[172:175], v[104:107]
    ds_read_b128 a[104:107], v234 offset:10240
    v_mfma_f32_16x16x32_bf16 v[76:79], a[172:175], v[168:171], v[76:79]
    v_exp_f32 v133, v133
    v_mfma_f32_16x16x32_bf16 v[108:111], a[172:175], v[172:175], v[108:111]
    ds_read_b128 a[108:111], v234 offset:11264
    v_cvt_pk_bf16_f32 v162, v132, v133
    v_mfma_f32_16x16x32_bf16 v[80:83], a[176:179], v[168:171], v[80:83]
    v_exp_f32 v134, v134
    v_mfma_f32_16x16x32_bf16 v[112:115], a[176:179], v[172:175], v[112:115]
    ds_read_b128 a[112:115], v234 offset:12288
    v_mfma_f32_16x16x32_bf16 v[84:87], a[180:183], v[168:171], v[84:87]
    v_exp_f32 v135, v135
    v_mfma_f32_16x16x32_bf16 v[116:119], a[180:183], v[172:175], v[116:119]
    ds_read_b128 a[116:119], v234 offset:13312
    v_cvt_pk_bf16_f32 v163, v134, v135
    v_mfma_f32_16x16x32_bf16 v[88:91], a[184:187], v[168:171], v[88:91]
    v_exp_f32 v136, v136
    v_mfma_f32_16x16x32_bf16 v[120:123], a[184:187], v[172:175], v[120:123]
    ds_read_b128 a[120:123], v234 offset:14336
    v_mfma_f32_16x16x32_bf16 v[92:95], a[188:191], v[168:171], v[92:95]
    v_exp_f32 v137, v137
    v_mfma_f32_16x16x32_bf16 v[124:127], a[188:191], v[172:175], v[124:127]
    ds_read_b128 a[124:127], v234 offset:15360
    v_cvt_pk_bf16_f32 v164, v136, v137
    v_mfma_f32_16x16x32_bf16 v[200:203], v[208:211], v[168:171], v[200:203]
    v_exp_f32 v138, v138
    v_mfma_f32_16x16x32_bf16 v[204:207], v[208:211], v[172:175], v[204:207]
    v_mfma_f32_16x16x32_bf16 v[144:147], a[64:67], a[32:35], 0
    v_exp_f32 v139, v139
    v_mfma_f32_16x16x32_bf16 v[144:147], a[68:71], a[36:39], v[144:147]
    ds_read_b128 a[128:131], v233 offset:16384
    v_cvt_pk_bf16_f32 v165, v138, v139
    v_mfma_f32_16x16x32_bf16 v[144:147], a[72:75], a[40:43], v[144:147]
    v_exp_f32 v140, v140
    v_mfma_f32_16x16x32_bf16 v[144:147], a[76:79], a[44:47], v[144:147]
    ds_read_b128 a[132:135], v233 offset:17408
    v_mfma_f32_16x16x32_bf16 v[148:151], a[80:83], a[32:35], 0
    v_exp_f32 v141, v141
    v_mfma_f32_16x16x32_bf16 v[148:151], a[84:87], a[36:39], v[148:151]
    ds_read_b128 a[136:139], v233 offset:18432
    v_cvt_pk_bf16_f32 v166, v140, v141
    v_mfma_f32_16x16x32_bf16 v[148:151], a[88:91], a[40:43], v[148:151]
    v_exp_f32 v142, v142
    v_mfma_f32_16x16x32_bf16 v[148:151], a[92:95], a[44:47], v[148:151]
    ds_read_b128 a[140:143], v233 offset:19456
    v_mfma_f32_16x16x32_bf16 v[152:155], a[64:67], a[48:51], 0
    v_exp_f32 v143, v143
    v_mfma_f32_16x16x32_bf16 v[152:155], a[68:71], a[52:55], v[152:155]
    ds_read_b128 a[144:147], v233 offset:20480
    v_cvt_pk_bf16_f32 v167, v142, v143
    v_mfma_f32_16x16x32_bf16 v[152:155], a[72:75], a[56:59], v[152:155]
    v_mfma_f32_16x16x32_bf16 v[152:155], a[76:79], a[60:63], v[152:155]
    ds_read_b128 a[148:151], v233 offset:21504
    v_mfma_f32_16x16x32_bf16 v[156:159], a[80:83], a[48:51], 0
    v_exp_f32 v144, v144
    v_mfma_f32_16x16x32_bf16 v[156:159], a[84:87], a[52:55], v[156:159]
    ds_read_b128 a[152:155], v233 offset:22528
    v_mfma_f32_16x16x32_bf16 v[156:159], a[88:91], a[56:59], v[156:159]
    s_waitcnt lgkmcnt(7)
    v_exp_f32 v145, v145
    v_mfma_f32_16x16x32_bf16 v[156:159], a[92:95], a[60:63], v[156:159]
    ds_read_b128 a[156:159], v233 offset:23552
    v_cvt_pk_bf16_f32 v168, v144, v145
    v_mfma_f32_16x16x32_bf16 v[0:3], a[96:99], v[160:163], v[0:3]
    v_exp_f32 v146, v146
    v_mfma_f32_16x16x32_bf16 v[32:35], a[96:99], v[164:167], v[32:35]
    v_mfma_f32_16x16x32_bf16 v[4:7], a[100:103], v[160:163], v[4:7]
    v_exp_f32 v147, v147
    v_mfma_f32_16x16x32_bf16 v[36:39], a[100:103], v[164:167], v[36:39]
    v_cvt_pk_bf16_f32 v169, v146, v147
    v_mfma_f32_16x16x32_bf16 v[8:11], a[104:107], v[160:163], v[8:11]
    v_exp_f32 v148, v148
    v_mfma_f32_16x16x32_bf16 v[40:43], a[104:107], v[164:167], v[40:43]
    v_mfma_f32_16x16x32_bf16 v[12:15], a[108:111], v[160:163], v[12:15]
    v_exp_f32 v149, v149
    v_mfma_f32_16x16x32_bf16 v[44:47], a[108:111], v[164:167], v[44:47]
    v_cvt_pk_bf16_f32 v170, v148, v149
    v_mfma_f32_16x16x32_bf16 v[16:19], a[112:115], v[160:163], v[16:19]
    v_exp_f32 v150, v150
    v_mfma_f32_16x16x32_bf16 v[48:51], a[112:115], v[164:167], v[48:51]
    v_mfma_f32_16x16x32_bf16 v[20:23], a[116:119], v[160:163], v[20:23]
    v_exp_f32 v151, v151
    v_mfma_f32_16x16x32_bf16 v[52:55], a[116:119], v[164:167], v[52:55]
    v_cvt_pk_bf16_f32 v171, v150, v151
    v_mfma_f32_16x16x32_bf16 v[24:27], a[120:123], v[160:163], v[24:27]
    v_exp_f32 v152, v152
    v_mfma_f32_16x16x32_bf16 v[56:59], a[120:123], v[164:167], v[56:59]
    v_mfma_f32_16x16x32_bf16 v[28:31], a[124:127], v[160:163], v[28:31]
    v_exp_f32 v153, v153
    v_mfma_f32_16x16x32_bf16 v[60:63], a[124:127], v[164:167], v[60:63]
    v_cvt_pk_bf16_f32 v172, v152, v153
    v_mfma_f32_16x16x32_bf16 v[192:195], v[208:211], v[160:163], v[192:195]
    s_waitcnt lgkmcnt(0)
    v_exp_f32 v154, v154
    v_mfma_f32_16x16x32_bf16 v[196:199], v[208:211], v[164:167], v[196:199]
    v_mfma_f32_16x16x32_bf16 v[128:131], a[128:131], a[0:3], 0
    v_exp_f32 v155, v155
    v_mfma_f32_16x16x32_bf16 v[128:131], a[132:135], a[4:7], v[128:131]
    v_cvt_pk_bf16_f32 v173, v154, v155
    v_mfma_f32_16x16x32_bf16 v[128:131], a[136:139], a[8:11], v[128:131]
    v_exp_f32 v156, v156
    v_mfma_f32_16x16x32_bf16 v[128:131], a[140:143], a[12:15], v[128:131]
    v_mfma_f32_16x16x32_bf16 v[132:135], a[144:147], a[0:3], 0
    v_exp_f32 v157, v157
    v_mfma_f32_16x16x32_bf16 v[132:135], a[148:151], a[4:7], v[132:135]
    v_cvt_pk_bf16_f32 v174, v156, v157
    v_mfma_f32_16x16x32_bf16 v[132:135], a[152:155], a[8:11], v[132:135]
    v_exp_f32 v158, v158
    v_mfma_f32_16x16x32_bf16 v[132:135], a[156:159], a[12:15], v[132:135]
    v_mfma_f32_16x16x32_bf16 v[136:139], a[128:131], a[16:19], 0
    v_exp_f32 v159, v159
    v_mfma_f32_16x16x32_bf16 v[136:139], a[132:135], a[20:23], v[136:139]
    v_cvt_pk_bf16_f32 v175, v158, v159
    v_mfma_f32_16x16x32_bf16 v[136:139], a[136:139], a[24:27], v[136:139]
    s_waitcnt vmcnt(8)
    s_barrier
    v_mfma_f32_16x16x32_bf16 v[136:139], a[140:143], a[28:31], v[136:139]
    s_mov_b32 m0, s29
    v_mfma_f32_16x16x32_bf16 v[140:143], a[144:147], a[16:19], 0
    s_add_u32 s29, s29, 32768
    v_exp_f32 v128, v128
    v_mfma_f32_16x16x32_bf16 v[140:143], a[148:151], a[20:23], v[140:143]
    buffer_load_dwordx4 v232, s[64:67], s28 offen offset:0 sc1 lds
    v_mfma_f32_16x16x32_bf16 v[140:143], a[152:155], a[24:27], v[140:143]
    s_and_b32 s29, s29, 0x1ffff
    v_exp_f32 v129, v129
    v_mfma_f32_16x16x32_bf16 v[140:143], a[156:159], a[28:31], v[140:143]
    v_cvt_pk_bf16_f32 v160, v128, v129
    v_mfma_f32_16x16x32_bf16 v[64:67], a[96:99], v[168:171], v[64:67]
    v_exp_f32 v130, v130
    v_mfma_f32_16x16x32_bf16 v[96:99], a[96:99], v[172:175], v[96:99]
    ds_read_b128 a[160:163], v234 offset:24576
    v_mfma_f32_16x16x32_bf16 v[68:71], a[100:103], v[168:171], v[68:71]
    v_exp_f32 v131, v131
    v_mfma_f32_16x16x32_bf16 v[100:103], a[100:103], v[172:175], v[100:103]
    ds_read_b128 a[164:167], v234 offset:25600
    v_cvt_pk_bf16_f32 v161, v130, v131
    v_mfma_f32_16x16x32_bf16 v[72:75], a[104:107], v[168:171], v[72:75]
    v_exp_f32 v132, v132
    v_mfma_f32_16x16x32_bf16 v[104:107], a[104:107], v[172:175], v[104:107]
    ds_read_b128 a[168:171], v234 offset:26624
    v_mfma_f32_16x16x32_bf16 v[76:79], a[108:111], v[168:171], v[76:79]
    v_exp_f32 v133, v133
    v_mfma_f32_16x16x32_bf16 v[108:111], a[108:111], v[172:175], v[108:111]
    ds_read_b128 a[172:175], v234 offset:27648
    v_cvt_pk_bf16_f32 v162, v132, v133
    v_mfma_f32_16x16x32_bf16 v[80:83], a[112:115], v[168:171], v[80:83]
    v_exp_f32 v134, v134
    v_mfma_f32_16x16x32_bf16 v[112:115], a[112:115], v[172:175], v[112:115]
    ds_read_b128 a[176:179], v234 offset:28672
    v_mfma_f32_16x16x32_bf16 v[84:87], a[116:119], v[168:171], v[84:87]
    v_exp_f32 v135, v135
    v_mfma_f32_16x16x32_bf16 v[116:119], a[116:119], v[172:175], v[116:119]
    ds_read_b128 a[180:183], v234 offset:29696
    v_cvt_pk_bf16_f32 v163, v134, v135
    v_mfma_f32_16x16x32_bf16 v[88:91], a[120:123], v[168:171], v[88:91]
    v_exp_f32 v136, v136
    v_mfma_f32_16x16x32_bf16 v[120:123], a[120:123], v[172:175], v[120:123]
    ds_read_b128 a[184:187], v234 offset:30720
    v_mfma_f32_16x16x32_bf16 v[92:95], a[124:127], v[168:171], v[92:95]
    v_exp_f32 v137, v137
    v_mfma_f32_16x16x32_bf16 v[124:127], a[124:127], v[172:175], v[124:127]
    ds_read_b128 a[188:191], v234 offset:31744
    v_cvt_pk_bf16_f32 v164, v136, v137
    v_mfma_f32_16x16x32_bf16 v[200:203], v[208:211], v[168:171], v[200:203]
    v_exp_f32 v138, v138
    v_mfma_f32_16x16x32_bf16 v[204:207], v[208:211], v[172:175], v[204:207]
    buffer_load_dwordx4 v232, s[64:67], s28 offen offset:1024 sc1 lds
    v_mfma_f32_16x16x32_bf16 v[144:147], a[128:131], a[32:35], 0
    s_add_u32 s42, s28, 4096
    v_exp_f32 v139, v139
    v_mfma_f32_16x16x32_bf16 v[144:147], a[132:135], a[36:39], v[144:147]
    ds_read_b128 a[64:67], v233 offset:32768
    v_cvt_pk_bf16_f32 v165, v138, v139
    v_mfma_f32_16x16x32_bf16 v[144:147], a[136:139], a[40:43], v[144:147]
    v_exp_f32 v140, v140
    v_mfma_f32_16x16x32_bf16 v[144:147], a[140:143], a[44:47], v[144:147]
    ds_read_b128 a[68:71], v233 offset:33792
    v_mfma_f32_16x16x32_bf16 v[148:151], a[144:147], a[32:35], 0
    v_exp_f32 v141, v141
    v_mfma_f32_16x16x32_bf16 v[148:151], a[148:151], a[36:39], v[148:151]
    ds_read_b128 a[72:75], v233 offset:34816
    v_cvt_pk_bf16_f32 v166, v140, v141
    v_mfma_f32_16x16x32_bf16 v[148:151], a[152:155], a[40:43], v[148:151]
    v_exp_f32 v142, v142
    v_mfma_f32_16x16x32_bf16 v[148:151], a[156:159], a[44:47], v[148:151]
    ds_read_b128 a[76:79], v233 offset:35840
    v_mfma_f32_16x16x32_bf16 v[152:155], a[128:131], a[48:51], 0
    v_exp_f32 v143, v143
    v_mfma_f32_16x16x32_bf16 v[152:155], a[132:135], a[52:55], v[152:155]
    ds_read_b128 a[80:83], v233 offset:36864
    v_cvt_pk_bf16_f32 v167, v142, v143
    v_mfma_f32_16x16x32_bf16 v[152:155], a[136:139], a[56:59], v[152:155]
    buffer_load_dwordx4 v232, s[64:67], s28 offen offset:2048 sc1 lds
    v_mfma_f32_16x16x32_bf16 v[152:155], a[140:143], a[60:63], v[152:155]
    ds_read_b128 a[84:87], v233 offset:37888
    v_mfma_f32_16x16x32_bf16 v[156:159], a[144:147], a[48:51], 0
    v_exp_f32 v144, v144
    v_mfma_f32_16x16x32_bf16 v[156:159], a[148:151], a[52:55], v[156:159]
    ds_read_b128 a[88:91], v233 offset:38912
    v_mfma_f32_16x16x32_bf16 v[156:159], a[152:155], a[56:59], v[156:159]
    s_waitcnt lgkmcnt(7)
    v_exp_f32 v145, v145
    v_mfma_f32_16x16x32_bf16 v[156:159], a[156:159], a[60:63], v[156:159]
    ds_read_b128 a[92:95], v233 offset:39936
    v_cvt_pk_bf16_f32 v168, v144, v145
    v_mfma_f32_16x16x32_bf16 v[0:3], a[160:163], v[160:163], v[0:3]
    v_exp_f32 v146, v146
    v_mfma_f32_16x16x32_bf16 v[32:35], a[160:163], v[164:167], v[32:35]
    buffer_load_dwordx4 v232, s[64:67], s28 offen offset:3072 sc1 lds
    v_mfma_f32_16x16x32_bf16 v[4:7], a[164:167], v[160:163], v[4:7]
    s_add_u32 m0, m0, 4096
    v_exp_f32 v147, v147
    v_mfma_f32_16x16x32_bf16 v[36:39], a[164:167], v[164:167], v[36:39]
    v_cvt_pk_bf16_f32 v169, v146, v147
    v_mfma_f32_16x16x32_bf16 v[8:11], a[168:171], v[160:163], v[8:11]
    v_exp_f32 v148, v148
    v_mfma_f32_16x16x32_bf16 v[40:43], a[168:171], v[164:167], v[40:43]
    buffer_load_dwordx4 v232, s[64:67], s42 offen offset:0 sc1 lds
    v_mfma_f32_16x16x32_bf16 v[12:15], a[172:175], v[160:163], v[12:15]
    s_add_u32 s28, s28, 32768
    v_exp_f32 v149, v149
    v_mfma_f32_16x16x32_bf16 v[44:47], a[172:175], v[164:167], v[44:47]
    v_cvt_pk_bf16_f32 v170, v148, v149
    v_mfma_f32_16x16x32_bf16 v[16:19], a[176:179], v[160:163], v[16:19]
    v_exp_f32 v150, v150
    v_mfma_f32_16x16x32_bf16 v[48:51], a[176:179], v[164:167], v[48:51]
    buffer_load_dwordx4 v232, s[64:67], s42 offen offset:1024 sc1 lds
    v_mfma_f32_16x16x32_bf16 v[20:23], a[180:183], v[160:163], v[20:23]
    v_exp_f32 v151, v151
    v_mfma_f32_16x16x32_bf16 v[52:55], a[180:183], v[164:167], v[52:55]
    v_cvt_pk_bf16_f32 v171, v150, v151
    v_mfma_f32_16x16x32_bf16 v[24:27], a[184:187], v[160:163], v[24:27]
    v_exp_f32 v152, v152
    v_mfma_f32_16x16x32_bf16 v[56:59], a[184:187], v[164:167], v[56:59]
    buffer_load_dwordx4 v232, s[64:67], s42 offen offset:2048 sc1 lds
    v_mfma_f32_16x16x32_bf16 v[28:31], a[188:191], v[160:163], v[28:31]
    v_exp_f32 v153, v153
    v_mfma_f32_16x16x32_bf16 v[60:63], a[188:191], v[164:167], v[60:63]
    v_cvt_pk_bf16_f32 v172, v152, v153
    v_mfma_f32_16x16x32_bf16 v[192:195], v[208:211], v[160:163], v[192:195]
    s_waitcnt lgkmcnt(0)
    v_exp_f32 v154, v154
    v_mfma_f32_16x16x32_bf16 v[196:199], v[208:211], v[164:167], v[196:199]
    buffer_load_dwordx4 v232, s[64:67], s42 offen offset:3072 sc1 lds
    v_mfma_f32_16x16x32_bf16 v[128:131], a[64:67], a[0:3], 0
    v_exp_f32 v155, v155
    v_mfma_f32_16x16x32_bf16 v[128:131], a[68:71], a[4:7], v[128:131]
    v_cvt_pk_bf16_f32 v173, v154, v155
    v_mfma_f32_16x16x32_bf16 v[128:131], a[72:75], a[8:11], v[128:131]
    v_exp_f32 v156, v156
    v_mfma_f32_16x16x32_bf16 v[128:131], a[76:79], a[12:15], v[128:131]
    v_mfma_f32_16x16x32_bf16 v[132:135], a[80:83], a[0:3], 0
    v_exp_f32 v157, v157
    v_mfma_f32_16x16x32_bf16 v[132:135], a[84:87], a[4:7], v[132:135]
    v_cvt_pk_bf16_f32 v174, v156, v157
    v_mfma_f32_16x16x32_bf16 v[132:135], a[88:91], a[8:11], v[132:135]
    v_exp_f32 v158, v158
    v_mfma_f32_16x16x32_bf16 v[132:135], a[92:95], a[12:15], v[132:135]
    v_mfma_f32_16x16x32_bf16 v[136:139], a[64:67], a[16:19], 0
    v_exp_f32 v159, v159
    v_mfma_f32_16x16x32_bf16 v[136:139], a[68:71], a[20:23], v[136:139]
    v_cvt_pk_bf16_f32 v175, v158, v159
    v_mfma_f32_16x16x32_bf16 v[136:139], a[72:75], a[24:27], v[136:139]
    v_mfma_f32_16x16x32_bf16 v[136:139], a[76:79], a[28:31], v[136:139]
    v_mfma_f32_16x16x32_bf16 v[140:143], a[80:83], a[16:19], 0
    v_exp_f32 v128, v128
    v_mfma_f32_16x16x32_bf16 v[140:143], a[84:87], a[20:23], v[140:143]
    v_mfma_f32_16x16x32_bf16 v[140:143], a[88:91], a[24:27], v[140:143]
    v_exp_f32 v129, v129
    v_mfma_f32_16x16x32_bf16 v[140:143], a[92:95], a[28:31], v[140:143]
    v_cvt_pk_bf16_f32 v160, v128, v129
    v_mfma_f32_16x16x32_bf16 v[64:67], a[160:163], v[168:171], v[64:67]
    v_exp_f32 v130, v130
    v_mfma_f32_16x16x32_bf16 v[96:99], a[160:163], v[172:175], v[96:99]
    ds_read_b128 a[96:99], v234 offset:40960
    v_mfma_f32_16x16x32_bf16 v[68:71], a[164:167], v[168:171], v[68:71]
    v_exp_f32 v131, v131
    v_mfma_f32_16x16x32_bf16 v[100:103], a[164:167], v[172:175], v[100:103]
    ds_read_b128 a[100:103], v234 offset:41984
    v_cvt_pk_bf16_f32 v161, v130, v131
    v_mfma_f32_16x16x32_bf16 v[72:75], a[168:171], v[168:171], v[72:75]
    v_exp_f32 v132, v132
    v_mfma_f32_16x16x32_bf16 v[104:107], a[168:171], v[172:175], v[104:107]
    ds_read_b128 a[104:107], v234 offset:43008
    v_mfma_f32_16x16x32_bf16 v[76:79], a[172:175], v[168:171], v[76:79]
    v_exp_f32 v133, v133
    v_mfma_f32_16x16x32_bf16 v[108:111], a[172:175], v[172:175], v[108:111]
    ds_read_b128 a[108:111], v234 offset:44032
    v_cvt_pk_bf16_f32 v162, v132, v133
    v_mfma_f32_16x16x32_bf16 v[80:83], a[176:179], v[168:171], v[80:83]
    v_exp_f32 v134, v134
    v_mfma_f32_16x16x32_bf16 v[112:115], a[176:179], v[172:175], v[112:115]
    ds_read_b128 a[112:115], v234 offset:45056
    v_mfma_f32_16x16x32_bf16 v[84:87], a[180:183], v[168:171], v[84:87]
    v_exp_f32 v135, v135
    v_mfma_f32_16x16x32_bf16 v[116:119], a[180:183], v[172:175], v[116:119]
    ds_read_b128 a[116:119], v234 offset:46080
    v_cvt_pk_bf16_f32 v163, v134, v135
    v_mfma_f32_16x16x32_bf16 v[88:91], a[184:187], v[168:171], v[88:91]
    v_exp_f32 v136, v136
    v_mfma_f32_16x16x32_bf16 v[120:123], a[184:187], v[172:175], v[120:123]
    ds_read_b128 a[120:123], v234 offset:47104
    v_mfma_f32_16x16x32_bf16 v[92:95], a[188:191], v[168:171], v[92:95]
    v_exp_f32 v137, v137
    v_mfma_f32_16x16x32_bf16 v[124:127], a[188:191], v[172:175], v[124:127]
    ds_read_b128 a[124:127], v234 offset:48128
    v_cvt_pk_bf16_f32 v164, v136, v137
    v_mfma_f32_16x16x32_bf16 v[200:203], v[208:211], v[168:171], v[200:203]
    v_exp_f32 v138, v138
    v_mfma_f32_16x16x32_bf16 v[204:207], v[208:211], v[172:175], v[204:207]
    v_mfma_f32_16x16x32_bf16 v[144:147], a[64:67], a[32:35], 0
    v_exp_f32 v139, v139
    v_mfma_f32_16x16x32_bf16 v[144:147], a[68:71], a[36:39], v[144:147]
    ds_read_b128 a[128:131], v233 offset:49152
    v_cvt_pk_bf16_f32 v165, v138, v139
    v_mfma_f32_16x16x32_bf16 v[144:147], a[72:75], a[40:43], v[144:147]
    v_exp_f32 v140, v140
    v_mfma_f32_16x16x32_bf16 v[144:147], a[76:79], a[44:47], v[144:147]
    ds_read_b128 a[132:135], v233 offset:50176
    v_mfma_f32_16x16x32_bf16 v[148:151], a[80:83], a[32:35], 0
    v_exp_f32 v141, v141
    v_mfma_f32_16x16x32_bf16 v[148:151], a[84:87], a[36:39], v[148:151]
    ds_read_b128 a[136:139], v233 offset:51200
    v_cvt_pk_bf16_f32 v166, v140, v141
    v_mfma_f32_16x16x32_bf16 v[148:151], a[88:91], a[40:43], v[148:151]
    v_exp_f32 v142, v142
    v_mfma_f32_16x16x32_bf16 v[148:151], a[92:95], a[44:47], v[148:151]
    ds_read_b128 a[140:143], v233 offset:52224
    v_mfma_f32_16x16x32_bf16 v[152:155], a[64:67], a[48:51], 0
    v_exp_f32 v143, v143
    v_mfma_f32_16x16x32_bf16 v[152:155], a[68:71], a[52:55], v[152:155]
    ds_read_b128 a[144:147], v233 offset:53248
    v_cvt_pk_bf16_f32 v167, v142, v143
    v_mfma_f32_16x16x32_bf16 v[152:155], a[72:75], a[56:59], v[152:155]
    v_mfma_f32_16x16x32_bf16 v[152:155], a[76:79], a[60:63], v[152:155]
    ds_read_b128 a[148:151], v233 offset:54272
    v_mfma_f32_16x16x32_bf16 v[156:159], a[80:83], a[48:51], 0
    v_exp_f32 v144, v144
    v_mfma_f32_16x16x32_bf16 v[156:159], a[84:87], a[52:55], v[156:159]
    ds_read_b128 a[152:155], v233 offset:55296
    v_mfma_f32_16x16x32_bf16 v[156:159], a[88:91], a[56:59], v[156:159]
    s_waitcnt lgkmcnt(7)
    v_exp_f32 v145, v145
    v_mfma_f32_16x16x32_bf16 v[156:159], a[92:95], a[60:63], v[156:159]
    ds_read_b128 a[156:159], v233 offset:56320
    v_cvt_pk_bf16_f32 v168, v144, v145
    v_mfma_f32_16x16x32_bf16 v[0:3], a[96:99], v[160:163], v[0:3]
    v_exp_f32 v146, v146
    v_mfma_f32_16x16x32_bf16 v[32:35], a[96:99], v[164:167], v[32:35]
    v_mfma_f32_16x16x32_bf16 v[4:7], a[100:103], v[160:163], v[4:7]
    v_exp_f32 v147, v147
    v_mfma_f32_16x16x32_bf16 v[36:39], a[100:103], v[164:167], v[36:39]
    v_cvt_pk_bf16_f32 v169, v146, v147
    v_mfma_f32_16x16x32_bf16 v[8:11], a[104:107], v[160:163], v[8:11]
    v_exp_f32 v148, v148
    v_mfma_f32_16x16x32_bf16 v[40:43], a[104:107], v[164:167], v[40:43]
    v_mfma_f32_16x16x32_bf16 v[12:15], a[108:111], v[160:163], v[12:15]
    v_exp_f32 v149, v149
    v_mfma_f32_16x16x32_bf16 v[44:47], a[108:111], v[164:167], v[44:47]
    v_cvt_pk_bf16_f32 v170, v148, v149
    v_mfma_f32_16x16x32_bf16 v[16:19], a[112:115], v[160:163], v[16:19]
    v_exp_f32 v150, v150
    v_mfma_f32_16x16x32_bf16 v[48:51], a[112:115], v[164:167], v[48:51]
    v_mfma_f32_16x16x32_bf16 v[20:23], a[116:119], v[160:163], v[20:23]
    v_exp_f32 v151, v151
    v_mfma_f32_16x16x32_bf16 v[52:55], a[116:119], v[164:167], v[52:55]
    v_cvt_pk_bf16_f32 v171, v150, v151
    v_mfma_f32_16x16x32_bf16 v[24:27], a[120:123], v[160:163], v[24:27]
    v_exp_f32 v152, v152
    v_mfma_f32_16x16x32_bf16 v[56:59], a[120:123], v[164:167], v[56:59]
    v_mfma_f32_16x16x32_bf16 v[28:31], a[124:127], v[160:163], v[28:31]
    v_exp_f32 v153, v153
    v_mfma_f32_16x16x32_bf16 v[60:63], a[124:127], v[164:167], v[60:63]
    v_cvt_pk_bf16_f32 v172, v152, v153
    v_mfma_f32_16x16x32_bf16 v[192:195], v[208:211], v[160:163], v[192:195]
    s_waitcnt lgkmcnt(0)
    v_exp_f32 v154, v154
    v_mfma_f32_16x16x32_bf16 v[196:199], v[208:211], v[164:167], v[196:199]
    v_mfma_f32_16x16x32_bf16 v[128:131], a[128:131], a[0:3], 0
    v_exp_f32 v155, v155
    v_mfma_f32_16x16x32_bf16 v[128:131], a[132:135], a[4:7], v[128:131]
    v_cvt_pk_bf16_f32 v173, v154, v155
    v_mfma_f32_16x16x32_bf16 v[128:131], a[136:139], a[8:11], v[128:131]
    v_exp_f32 v156, v156
    v_mfma_f32_16x16x32_bf16 v[128:131], a[140:143], a[12:15], v[128:131]
    v_mfma_f32_16x16x32_bf16 v[132:135], a[144:147], a[0:3], 0
    v_exp_f32 v157, v157
    v_mfma_f32_16x16x32_bf16 v[132:135], a[148:151], a[4:7], v[132:135]
    v_cvt_pk_bf16_f32 v174, v156, v157
    v_mfma_f32_16x16x32_bf16 v[132:135], a[152:155], a[8:11], v[132:135]
    v_exp_f32 v158, v158
    v_mfma_f32_16x16x32_bf16 v[132:135], a[156:159], a[12:15], v[132:135]
    v_mfma_f32_16x16x32_bf16 v[136:139], a[128:131], a[16:19], 0
    v_exp_f32 v159, v159
    v_mfma_f32_16x16x32_bf16 v[136:139], a[132:135], a[20:23], v[136:139]
    v_cvt_pk_bf16_f32 v175, v158, v159
    v_mfma_f32_16x16x32_bf16 v[136:139], a[136:139], a[24:27], v[136:139]
    s_waitcnt vmcnt(8)
    s_barrier
    v_mfma_f32_16x16x32_bf16 v[136:139], a[140:143], a[28:31], v[136:139]
    s_mov_b32 m0, s29
    v_mfma_f32_16x16x32_bf16 v[140:143], a[144:147], a[16:19], 0
    s_add_u32 s29, s29, 32768
    v_exp_f32 v128, v128
    v_mfma_f32_16x16x32_bf16 v[140:143], a[148:151], a[20:23], v[140:143]
    buffer_load_dwordx4 v232, s[64:67], s28 offen offset:0 sc1 lds
    v_mfma_f32_16x16x32_bf16 v[140:143], a[152:155], a[24:27], v[140:143]
    s_and_b32 s29, s29, 0x1ffff
    v_exp_f32 v129, v129
    v_mfma_f32_16x16x32_bf16 v[140:143], a[156:159], a[28:31], v[140:143]
    v_cvt_pk_bf16_f32 v160, v128, v129
    v_mfma_f32_16x16x32_bf16 v[64:67], a[96:99], v[168:171], v[64:67]
    v_exp_f32 v130, v130
    v_mfma_f32_16x16x32_bf16 v[96:99], a[96:99], v[172:175], v[96:99]
    ds_read_b128 a[160:163], v234 offset:57344
    v_mfma_f32_16x16x32_bf16 v[68:71], a[100:103], v[168:171], v[68:71]
    v_exp_f32 v131, v131
    v_mfma_f32_16x16x32_bf16 v[100:103], a[100:103], v[172:175], v[100:103]
    ds_read_b128 a[164:167], v234 offset:58368
    v_cvt_pk_bf16_f32 v161, v130, v131
    v_mfma_f32_16x16x32_bf16 v[72:75], a[104:107], v[168:171], v[72:75]
    v_exp_f32 v132, v132
    v_mfma_f32_16x16x32_bf16 v[104:107], a[104:107], v[172:175], v[104:107]
    ds_read_b128 a[168:171], v234 offset:59392
    v_mfma_f32_16x16x32_bf16 v[76:79], a[108:111], v[168:171], v[76:79]
    v_exp_f32 v133, v133
    v_mfma_f32_16x16x32_bf16 v[108:111], a[108:111], v[172:175], v[108:111]
    ds_read_b128 a[172:175], v234 offset:60416
    v_cvt_pk_bf16_f32 v162, v132, v133
    v_mfma_f32_16x16x32_bf16 v[80:83], a[112:115], v[168:171], v[80:83]
    v_exp_f32 v134, v134
    v_mfma_f32_16x16x32_bf16 v[112:115], a[112:115], v[172:175], v[112:115]
    ds_read_b128 a[176:179], v234 offset:61440
    v_mfma_f32_16x16x32_bf16 v[84:87], a[116:119], v[168:171], v[84:87]
    v_exp_f32 v135, v135
    v_mfma_f32_16x16x32_bf16 v[116:119], a[116:119], v[172:175], v[116:119]
    ds_read_b128 a[180:183], v234 offset:62464
    v_cvt_pk_bf16_f32 v163, v134, v135
    v_mfma_f32_16x16x32_bf16 v[88:91], a[120:123], v[168:171], v[88:91]
    v_exp_f32 v136, v136
    v_mfma_f32_16x16x32_bf16 v[120:123], a[120:123], v[172:175], v[120:123]
    ds_read_b128 a[184:187], v234 offset:63488
    v_mfma_f32_16x16x32_bf16 v[92:95], a[124:127], v[168:171], v[92:95]
    v_exp_f32 v137, v137
    v_mfma_f32_16x16x32_bf16 v[124:127], a[124:127], v[172:175], v[124:127]
    ds_read_b128 a[188:191], v234 offset:64512
    v_cvt_pk_bf16_f32 v164, v136, v137
    v_xor_b32 v233, 0x10000, v233
    v_mfma_f32_16x16x32_bf16 v[200:203], v[208:211], v[168:171], v[200:203]
    v_exp_f32 v138, v138
    v_mfma_f32_16x16x32_bf16 v[204:207], v[208:211], v[172:175], v[204:207]
    buffer_load_dwordx4 v232, s[64:67], s28 offen offset:1024 sc1 lds
    v_mfma_f32_16x16x32_bf16 v[144:147], a[128:131], a[32:35], 0
    s_add_u32 s42, s28, 4096
    v_exp_f32 v139, v139
    v_mfma_f32_16x16x32_bf16 v[144:147], a[132:135], a[36:39], v[144:147]
    ds_read_b128 a[64:67], v233 offset:0
    v_cvt_pk_bf16_f32 v165, v138, v139
    v_mfma_f32_16x16x32_bf16 v[144:147], a[136:139], a[40:43], v[144:147]
    v_exp_f32 v140, v140
    v_mfma_f32_16x16x32_bf16 v[144:147], a[140:143], a[44:47], v[144:147]
    ds_read_b128 a[68:71], v233 offset:1024
    v_mfma_f32_16x16x32_bf16 v[148:151], a[144:147], a[32:35], 0
    v_exp_f32 v141, v141
    v_mfma_f32_16x16x32_bf16 v[148:151], a[148:151], a[36:39], v[148:151]
    ds_read_b128 a[72:75], v233 offset:2048
    v_cvt_pk_bf16_f32 v166, v140, v141
    v_mfma_f32_16x16x32_bf16 v[148:151], a[152:155], a[40:43], v[148:151]
    v_exp_f32 v142, v142
    v_mfma_f32_16x16x32_bf16 v[148:151], a[156:159], a[44:47], v[148:151]
    ds_read_b128 a[76:79], v233 offset:3072
    v_mfma_f32_16x16x32_bf16 v[152:155], a[128:131], a[48:51], 0
    v_exp_f32 v143, v143
    v_mfma_f32_16x16x32_bf16 v[152:155], a[132:135], a[52:55], v[152:155]
    ds_read_b128 a[80:83], v233 offset:4096
    v_cvt_pk_bf16_f32 v167, v142, v143
    v_mfma_f32_16x16x32_bf16 v[152:155], a[136:139], a[56:59], v[152:155]
    buffer_load_dwordx4 v232, s[64:67], s28 offen offset:2048 sc1 lds
    v_mfma_f32_16x16x32_bf16 v[152:155], a[140:143], a[60:63], v[152:155]
    ds_read_b128 a[84:87], v233 offset:5120
    v_mfma_f32_16x16x32_bf16 v[156:159], a[144:147], a[48:51], 0
    v_exp_f32 v144, v144
    v_mfma_f32_16x16x32_bf16 v[156:159], a[148:151], a[52:55], v[156:159]
    ds_read_b128 a[88:91], v233 offset:6144
    v_mfma_f32_16x16x32_bf16 v[156:159], a[152:155], a[56:59], v[156:159]
    s_waitcnt lgkmcnt(7)
    v_exp_f32 v145, v145
    v_mfma_f32_16x16x32_bf16 v[156:159], a[156:159], a[60:63], v[156:159]
    ds_read_b128 a[92:95], v233 offset:7168
    v_cvt_pk_bf16_f32 v168, v144, v145
    v_mfma_f32_16x16x32_bf16 v[0:3], a[160:163], v[160:163], v[0:3]
    v_exp_f32 v146, v146
    v_mfma_f32_16x16x32_bf16 v[32:35], a[160:163], v[164:167], v[32:35]
    buffer_load_dwordx4 v232, s[64:67], s28 offen offset:3072 sc1 lds
    v_mfma_f32_16x16x32_bf16 v[4:7], a[164:167], v[160:163], v[4:7]
    s_add_u32 m0, m0, 4096
    v_exp_f32 v147, v147
    v_mfma_f32_16x16x32_bf16 v[36:39], a[164:167], v[164:167], v[36:39]
    v_cvt_pk_bf16_f32 v169, v146, v147
    v_mfma_f32_16x16x32_bf16 v[8:11], a[168:171], v[160:163], v[8:11]
    v_exp_f32 v148, v148
    v_mfma_f32_16x16x32_bf16 v[40:43], a[168:171], v[164:167], v[40:43]
    buffer_load_dwordx4 v232, s[64:67], s42 offen offset:0 sc1 lds
    v_mfma_f32_16x16x32_bf16 v[12:15], a[172:175], v[160:163], v[12:15]
    s_add_u32 s28, s28, 32768
    v_exp_f32 v149, v149
    v_mfma_f32_16x16x32_bf16 v[44:47], a[172:175], v[164:167], v[44:47]
    v_cvt_pk_bf16_f32 v170, v148, v149
    v_mfma_f32_16x16x32_bf16 v[16:19], a[176:179], v[160:163], v[16:19]
    v_exp_f32 v150, v150
    v_mfma_f32_16x16x32_bf16 v[48:51], a[176:179], v[164:167], v[48:51]
    buffer_load_dwordx4 v232, s[64:67], s42 offen offset:1024 sc1 lds
    v_mfma_f32_16x16x32_bf16 v[20:23], a[180:183], v[160:163], v[20:23]
    v_exp_f32 v151, v151
    v_mfma_f32_16x16x32_bf16 v[52:55], a[180:183], v[164:167], v[52:55]
    v_cvt_pk_bf16_f32 v171, v150, v151
    v_mfma_f32_16x16x32_bf16 v[24:27], a[184:187], v[160:163], v[24:27]
    s_sub_u32 s27, s27, 1
    v_exp_f32 v152, v152
    v_mfma_f32_16x16x32_bf16 v[56:59], a[184:187], v[164:167], v[56:59]
    buffer_load_dwordx4 v232, s[64:67], s42 offen offset:2048 sc1 lds
    v_mfma_f32_16x16x32_bf16 v[28:31], a[188:191], v[160:163], v[28:31]
    s_cmp_lg_u32 s27, 0
    v_exp_f32 v153, v153
    v_mfma_f32_16x16x32_bf16 v[60:63], a[188:191], v[164:167], v[60:63]
    v_cvt_pk_bf16_f32 v172, v152, v153
    v_mfma_f32_16x16x32_bf16 v[192:195], v[208:211], v[160:163], v[192:195]
    s_waitcnt lgkmcnt(0)
    v_exp_f32 v154, v154
    v_mfma_f32_16x16x32_bf16 v[196:199], v[208:211], v[164:167], v[196:199]
    buffer_load_dwordx4 v232, s[64:67], s42 offen offset:3072 sc1 lds
    s_cbranch_scc1 KB_L1
KB_D1:
    s_cmp_gt_u32 s3, 0
    s_cselect_b32 s30, 0, 0xff800000
    s_cmp_eq_u32 s3, 0
    s_cselect_b64 vcc, -1, 0
    v_mov_b32 v179, s30
    v_cndmask_b32 v176, v179, v188, vcc
    v_cndmask_b32 v177, v179, v189, vcc
    v_cndmask_b32 v178, v179, v190, vcc
    v_cndmask_b32 v179, v179, v191, vcc
    s_cmp_gt_u32 s3, 1
    s_cselect_b32 s30, 0, 0xff800000
    s_cmp_eq_u32 s3, 1
    s_cselect_b64 vcc, -1, 0
    v_mov_b32 v183, s30
    v_cndmask_b32 v180, v183, v188, vcc
    v_cndmask_b32 v181, v183, v189, vcc
    v_cndmask_b32 v182, v183, v190, vcc
    v_cndmask_b32 v183, v183, v191, vcc
    s_nop 1
    v_mfma_f32_16x16x32_bf16 v[128:131], a[64:67], a[0:3], v[176:179]
    v_exp_f32 v155, v155
    v_mfma_f32_16x16x32_bf16 v[128:131], a[68:71], a[4:7], v[128:131]
    v_cvt_pk_bf16_f32 v173, v154, v155
    v_mfma_f32_16x16x32_bf16 v[128:131], a[72:75], a[8:11], v[128:131]
    v_exp_f32 v156, v156
    v_mfma_f32_16x16x32_bf16 v[128:131], a[76:79], a[12:15], v[128:131]
    v_mfma_f32_16x16x32_bf16 v[132:135], a[80:83], a[0:3], v[180:183]
    s_cmp_gt_u32 s3, 2
    s_cselect_b32 s30, 0, 0xff800000
    v_exp_f32 v157, v157
    v_mfma_f32_16x16x32_bf16 v[132:135], a[84:87], a[4:7], v[132:135]
    v_cvt_pk_bf16_f32 v174, v156, v157
    v_mfma_f32_16x16x32_bf16 v[132:135], a[88:91], a[8:11], v[132:135]
    s_cmp_eq_u32 s3, 2
    s_cselect_b64 vcc, -1, 0
    v_exp_f32 v158, v158
    v_mfma_f32_16x16x32_bf16 v[132:135], a[92:95], a[12:15], v[132:135]
    v_mov_b32 v179, s30
    v_cndmask_b32 v176, v179, v188, vcc
    v_mfma_f32_16x16x32_bf16 v[136:139], a[64:67], a[16:19], 0
    v_exp_f32 v159, v159
    v_mfma_f32_16x16x32_bf16 v[136:139], a[68:71], a[20:23], v[136:139]
    v_cvt_pk_bf16_f32 v175, v158, v159
    v_cndmask_b32 v177, v179, v189, vcc
    v_mfma_f32_16x16x32_bf16 v[136:139], a[72:75], a[24:27], v[136:139]
    v_xor_b32 v234, 0x10000, v234
    v_cndmask_b32 v178, v179, v190, vcc
    v_mfma_f32_16x16x32_bf16 v[136:139], a[76:79], a[28:31], v[136:139]
    v_cndmask_b32 v179, v179, v191, vcc
    v_mfma_f32_16x16x32_bf16 v[140:143], a[80:83], a[16:19], 0
    s_cmp_gt_u32 s3, 3
    s_cselect_b32 s30, 0, 0xff800000
    v_exp_f32 v128, v128
    v_mfma_f32_16x16x32_bf16 v[140:143], a[84:87], a[20:23], v[140:143]
    v_mfma_f32_16x16x32_bf16 v[140:143], a[88:91], a[24:27], v[140:143]
    s_cmp_eq_u32 s3, 3
    s_cselect_b64 vcc, -1, 0
    v_exp_f32 v129, v129
    v_mfma_f32_16x16x32_bf16 v[140:143], a[92:95], a[28:31], v[140:143]
    v_cvt_pk_bf16_f32 v160, v128, v129
    v_mov_b32 v183, s30
    v_mfma_f32_16x16x32_bf16 v[64:67], a[160:163], v[168:171], v[64:67]
    v_exp_f32 v130, v130
    v_mfma_f32_16x16x32_bf16 v[96:99], a[160:163], v[172:175], v[96:99]
    ds_read_b128 a[96:99], v234 offset:8192
    v_cndmask_b32 v180, v183, v188, vcc
    v_mfma_f32_16x16x32_bf16 v[68:71], a[164:167], v[168:171], v[68:71]
    v_exp_f32 v131, v131
    v_mfma_f32_16x16x32_bf16 v[100:103], a[164:167], v[172:175], v[100:103]
    ds_read_b128 a[100:103], v234 offset:9216
    v_cvt_pk_bf16_f32 v161, v130, v131
    v_mfma_f32_16x16x32_bf16 v[72:75], a[168:171], v[168:171], v[72:75]
    v_exp_f32 v132, v132
    v_mfma_f32_16x16x32_bf16 v[104:107], a[168:171], v[172:175], v[104:107]
    ds_read_b128 a[104:107], v234 offset:10240
    v_cndmask_b32 v181, v183, v189, vcc
    v_mfma_f32_16x16x32_bf16 v[76:79], a[172:175], v[168:171], v[76:79]
    v_exp_f32 v133, v133
    v_mfma_f32_16x16x32_bf16 v[108:111], a[172:175], v[172:175], v[108:111]
    ds_read_b128 a[108:111], v234 offset:11264
    v_cvt_pk_bf16_f32 v162, v132, v133
    v_mfma_f32_16x16x32_bf16 v[80:83], a[176:179], v[168:171], v[80:83]
    v_exp_f32 v134, v134
    v_mfma_f32_16x16x32_bf16 v[112:115], a[176:179], v[172:175], v[112:115]
    ds_read_b128 a[112:115], v234 offset:12288
    v_cndmask_b32 v182, v183, v190, vcc
    v_mfma_f32_16x16x32_bf16 v[84:87], a[180:183], v[168:171], v[84:87]
    v_exp_f32 v135, v135
    v_mfma_f32_16x16x32_bf16 v[116:119], a[180:183], v[172:175], v[116:119]
    ds_read_b128 a[116:119], v234 offset:13312
    v_cvt_pk_bf16_f32 v163, v134, v135
    v_mfma_f32_16x16x32_bf16 v[88:91], a[184:187], v[168:171], v[88:91]
    v_exp_f32 v136, v136
    v_mfma_f32_16x16x32_bf16 v[120:123], a[184:187], v[172:175], v[120:123]
    ds_read_b128 a[120:123], v234 offset:14336
    v_cndmask_b32 v183, v183, v191, vcc
    v_mfma_f32_16x16x32_bf16 v[92:95], a[188:191], v[168:171], v[92:95]
    s_cmp_lt_u32 s3, 3
    s_cselect_b32 s30, 0, 0xff800000
    v_exp_f32 v137, v137
    v_mfma_f32_16x16x32_bf16 v[124:127], a[188:191], v[172:175], v[124:127]
    ds_read_b128 a[124:127], v234 offset:15360
    v_cvt_pk_bf16_f32 v164, v136, v137
    v_mfma_f32_16x16x32_bf16 v[200:203], v[208:211], v[168:171], v[200:203]
    s_cmp_eq_u32 s3, 3
    s_cselect_b64 vcc, -1, 0
    v_exp_f32 v138, v138
    v_mfma_f32_16x16x32_bf16 v[204:207], v[208:211], v[172:175], v[204:207]
    v_mov_b32 v187, s30
    v_cndmask_b32 v184, v187, v188, vcc
    v_mfma_f32_16x16x32_bf16 v[144:147], a[64:67], a[32:35], 0
    v_exp_f32 v139, v139
    v_mfma_f32_16x16x32_bf16 v[144:147], a[68:71], a[36:39], v[144:147]
    ds_read_b128 a[128:131], v233 offset:16384
    v_cvt_pk_bf16_f32 v165, v138, v139
    v_mfma_f32_16x16x32_bf16 v[144:147], a[72:75], a[40:43], v[144:147]
    v_exp_f32 v140, v140
    v_mfma_f32_16x16x32_bf16 v[144:147], a[76:79], a[44:47], v[144:147]
    ds_read_b128 a[132:135], v233 offset:17408
    v_cndmask_b32 v185, v187, v189, vcc
    v_mfma_f32_16x16x32_bf16 v[148:151], a[80:83], a[32:35], 0
    v_exp_f32 v141, v141
    v_mfma_f32_16x16x32_bf16 v[148:151], a[84:87], a[36:39], v[148:151]
    ds_read_b128 a[136:139], v233 offset:18432
    v_cvt_pk_bf16_f32 v166, v140, v141
    v_mfma_f32_16x16x32_bf16 v[148:151], a[88:91], a[40:43], v[148:151]
    v_exp_f32 v142, v142
    v_mfma_f32_16x16x32_bf16 v[148:151], a[92:95], a[44:47], v[148:151]
    ds_read_b128 a[140:143], v233 offset:19456
    v_cndmask_b32 v186, v187, v190, vcc
    v_mfma_f32_16x16x32_bf16 v[152:155], a[64:67], a[48:51], 0
    v_exp_f32 v143, v143
    v_mfma_f32_16x16x32_bf16 v[152:155], a[68:71], a[52:55], v[152:155]
    ds_read_b128 a[144:147], v233 offset:20480
    v_cvt_pk_bf16_f32 v167, v142, v143
    v_mfma_f32_16x16x32_bf16 v[152:155], a[72:75], a[56:59], v[152:155]
    v_cndmask_b32 v187, v187, v191, vcc
    v_mfma_f32_16x16x32_bf16 v[152:155], a[76:79], a[60:63], v[152:155]
    ds_read_b128 a[148:151], v233 offset:21504
    v_mfma_f32_16x16x32_bf16 v[156:159], a[80:83], a[48:51], 0
    s_cmp_lt_u32 s3, 2
    s_cselect_b32 s30, 0, 0xff800000
    v_exp_f32 v144, v144
    v_mfma_f32_16x16x32_bf16 v[156:159], a[84:87], a[52:55], v[156:159]
    ds_read_b128 a[152:155], v233 offset:22528
    v_mfma_f32_16x16x32_bf16 v[156:159], a[88:91], a[56:59], v[156:159]
    s_waitcnt lgkmcnt(7)
    s_cmp_eq_u32 s3, 2
    s_cselect_b64 vcc, -1, 0
    v_exp_f32 v145, v145
    v_mfma_f32_16x16x32_bf16 v[156:159], a[92:95], a[60:63], v[156:159]
    ds_read_b128 a[156:159], v233 offset:23552
    v_cvt_pk_bf16_f32 v168, v144, v145
    v_mfma_f32_16x16x32_bf16 v[0:3], a[96:99], v[160:163], v[0:3]
    v_exp_f32 v146, v146
    v_mfma_f32_16x16x32_bf16 v[32:35], a[96:99], v[164:167], v[32:35]
    v_mov_b32 v223, s30
    v_cndmask_b32 v220, v223, v188, vcc
    v_mfma_f32_16x16x32_bf16 v[4:7], a[100:103], v[160:163], v[4:7]
    v_exp_f32 v147, v147
    v_mfma_f32_16x16x32_bf16 v[36:39], a[100:103], v[164:167], v[36:39]
    v_cvt_pk_bf16_f32 v169, v146, v147
    v_cndmask_b32 v221, v223, v189, vcc
    v_mfma_f32_16x16x32_bf16 v[8:11], a[104:107], v[160:163], v[8:11]
    v_exp_f32 v148, v148
    v_mfma_f32_16x16x32_bf16 v[40:43], a[104:107], v[164:167], v[40:43]
    v_cndmask_b32 v222, v223, v190, vcc
    v_cndmask_b32 v223, v223, v191, vcc
    v_mfma_f32_16x16x32_bf16 v[12:15], a[108:111], v[160:163], v[12:15]
    v_exp_f32 v149, v149
    v_mfma_f32_16x16x32_bf16 v[44:47], a[108:111], v[164:167], v[44:47]
    v_cvt_pk_bf16_f32 v170, v148, v149
    v_mfma_f32_16x16x32_bf16 v[16:19], a[112:115], v[160:163], v[16:19]
    v_exp_f32 v150, v150
    v_mfma_f32_16x16x32_bf16 v[48:51], a[112:115], v[164:167], v[48:51]
    v_mfma_f32_16x16x32_bf16 v[20:23], a[116:119], v[160:163], v[20:23]
    v_exp_f32 v151, v151
    v_mfma_f32_16x16x32_bf16 v[52:55], a[116:119], v[164:167], v[52:55]
    v_cvt_pk_bf16_f32 v171, v150, v151
    v_mfma_f32_16x16x32_bf16 v[24:27], a[120:123], v[160:163], v[24:27]
    v_exp_f32 v152, v152
    v_mfma_f32_16x16x32_bf16 v[56:59], a[120:123], v[164:167], v[56:59]
    v_mfma_f32_16x16x32_bf16 v[28:31], a[124:127], v[160:163], v[28:31]
    v_exp_f32 v153, v153
    v_mfma_f32_16x16x32_bf16 v[60:63], a[124:127], v[164:167], v[60:63]
    v_cvt_pk_bf16_f32 v172, v152, v153
    v_mfma_f32_16x16x32_bf16 v[192:195], v[208:211], v[160:163], v[192:195]
    s_waitcnt lgkmcnt(0)
    v_exp_f32 v154, v154
    v_mfma_f32_16x16x32_bf16 v[196:199], v[208:211], v[164:167], v[196:199]
    v_mfma_f32_16x16x32_bf16 v[128:131], a[128:131], a[0:3], v[176:179]
    v_exp_f32 v155, v155
    v_mfma_f32_16x16x32_bf16 v[128:131], a[132:135], a[4:7], v[128:131]
    v_cvt_pk_bf16_f32 v173, v154, v155
    v_mfma_f32_16x16x32_bf16 v[128:131], a[136:139], a[8:11], v[128:131]
    v_exp_f32 v156, v156
    v_mfma_f32_16x16x32_bf16 v[128:131], a[140:143], a[12:15], v[128:131]
    v_mfma_f32_16x16x32_bf16 v[132:135], a[144:147], a[0:3], v[180:183]
    v_exp_f32 v157, v157
    v_mfma_f32_16x16x32_bf16 v[132:135], a[148:151], a[4:7], v[132:135]
    v_cvt_pk_bf16_f32 v174, v156, v157
    v_mfma_f32_16x16x32_bf16 v[132:135], a[152:155], a[8:11], v[132:135]
    v_exp_f32 v158, v158
    v_mfma_f32_16x16x32_bf16 v[132:135], a[156:159], a[12:15], v[132:135]
    v_mfma_f32_16x16x32_bf16 v[136:139], a[128:131], a[16:19], 0
    v_exp_f32 v159, v159
    v_mfma_f32_16x16x32_bf16 v[136:139], a[132:135], a[20:23], v[136:139]
    v_cvt_pk_bf16_f32 v175, v158, v159
    v_mfma_f32_16x16x32_bf16 v[136:139], a[136:139], a[24:27], v[136:139]
    s_waitcnt vmcnt(8)
    s_barrier
    v_mfma_f32_16x16x32_bf16 v[136:139], a[140:143], a[28:31], v[136:139]
    s_mov_b32 m0, s29
    v_mfma_f32_16x16x32_bf16 v[140:143], a[144:147], a[16:19], 0
    s_add_u32 s29, s29, 32768
    v_exp_f32 v128, v128
    v_mfma_f32_16x16x32_bf16 v[140:143], a[148:151], a[20:23], v[140:143]
    buffer_load_dwordx4 v232, s[64:67], s28 offen offset:0 sc1 lds
    v_mfma_f32_16x16x32_bf16 v[140:143], a[152:155], a[24:27], v[140:143]
    s_and_b32 s29, s29, 0x1ffff
    v_exp_f32 v129, v129
    v_mfma_f32_16x16x32_bf16 v[140:143], a[156:159], a[28:31], v[140:143]
    v_cvt_pk_bf16_f32 v160, v128, v129
    v_mfma_f32_16x16x32_bf16 v[64:67], a[96:99], v[168:171], v[64:67]
    v_exp_f32 v130, v130
    v_mfma_f32_16x16x32_bf16 v[96:99], a[96:99], v[172:175], v[96:99]
    ds_read_b128 a[160:163], v234 offset:24576
    v_mfma_f32_16x16x32_bf16 v[68:71], a[100:103], v[168:171], v[68:71]
    v_exp_f32 v131, v131
    v_mfma_f32_16x16x32_bf16 v[100:103], a[100:103], v[172:175], v[100:103]
    ds_read_b128 a[164:167], v234 offset:25600
    v_cvt_pk_bf16_f32 v161, v130, v131
    v_mfma_f32_16x16x32_bf16 v[72:75], a[104:107], v[168:171], v[72:75]
    v_exp_f32 v132, v132
    v_mfma_f32_16x16x32_bf16 v[104:107], a[104:107], v[172:175], v[104:107]
    ds_read_b128 a[168:171], v234 offset:26624
    v_mfma_f32_16x16x32_bf16 v[76:79], a[108:111], v[168:171], v[76:79]
    v_exp_f32 v133, v133
    v_mfma_f32_16x16x32_bf16 v[108:111], a[108:111], v[172:175], v[108:111]
    ds_read_b128 a[172:175], v234 offset:27648
    v_cvt_pk_bf16_f32 v162, v132, v133
    v_mfma_f32_16x16x32_bf16 v[80:83], a[112:115], v[168:171], v[80:83]
    v_exp_f32 v134, v134
    v_mfma_f32_16x16x32_bf16 v[112:115], a[112:115], v[172:175], v[112:115]
    ds_read_b128 a[176:179], v234 offset:28672
    v_mfma_f32_16x16x32_bf16 v[84:87], a[116:119], v[168:171], v[84:87]
    v_exp_f32 v135, v135
    v_mfma_f32_16x16x32_bf16 v[116:119], a[116:119], v[172:175], v[116:119]
    ds_read_b128 a[180:183], v234 offset:29696
    v_cvt_pk_bf16_f32 v163, v134, v135
    v_mfma_f32_16x16x32_bf16 v[88:91], a[120:123], v[168:171], v[88:91]
    v_exp_f32 v136, v136
    v_mfma_f32_16x16x32_bf16 v[120:123], a[120:123], v[172:175], v[120:123]
    ds_read_b128 a[184:187], v234 offset:30720
    v_mfma_f32_16x16x32_bf16 v[92:95], a[124:127], v[168:171], v[92:95]
    v_exp_f32 v137, v137
    v_mfma_f32_16x16x32_bf16 v[124:127], a[124:127], v[172:175], v[124:127]
    ds_read_b128 a[188:191], v234 offset:31744
    v_cvt_pk_bf16_f32 v164, v136, v137
    v_mfma_f32_16x16x32_bf16 v[200:203], v[208:211], v[168:171], v[200:203]
    v_exp_f32 v138, v138
    v_mfma_f32_16x16x32_bf16 v[204:207], v[208:211], v[172:175], v[204:207]
    buffer_load_dwordx4 v232, s[64:67], s28 offen offset:1024 sc1 lds
    v_mfma_f32_16x16x32_bf16 v[144:147], a[128:131], a[32:35], 0
    s_add_u32 s42, s28, 4096
    v_exp_f32 v139, v139
    v_mfma_f32_16x16x32_bf16 v[144:147], a[132:135], a[36:39], v[144:147]
    ds_read_b128 a[64:67], v233 offset:32768
    v_cvt_pk_bf16_f32 v165, v138, v139
    v_mfma_f32_16x16x32_bf16 v[144:147], a[136:139], a[40:43], v[144:147]
    v_exp_f32 v140, v140
    v_mfma_f32_16x16x32_bf16 v[144:147], a[140:143], a[44:47], v[144:147]
    ds_read_b128 a[68:71], v233 offset:33792
    v_mfma_f32_16x16x32_bf16 v[148:151], a[144:147], a[32:35], 0
    v_exp_f32 v141, v141
    v_mfma_f32_16x16x32_bf16 v[148:151], a[148:151], a[36:39], v[148:151]
    ds_read_b128 a[72:75], v233 offset:34816
    v_cvt_pk_bf16_f32 v166, v140, v141
    v_mfma_f32_16x16x32_bf16 v[148:151], a[152:155], a[40:43], v[148:151]
    v_exp_f32 v142, v142
    v_mfma_f32_16x16x32_bf16 v[148:151], a[156:159], a[44:47], v[148:151]
    ds_read_b128 a[76:79], v233 offset:35840
    v_mfma_f32_16x16x32_bf16 v[152:155], a[128:131], a[48:51], 0
    v_exp_f32 v143, v143
    v_mfma_f32_16x16x32_bf16 v[152:155], a[132:135], a[52:55], v[152:155]
    ds_read_b128 a[80:83], v233 offset:36864
    v_cvt_pk_bf16_f32 v167, v142, v143
    v_mfma_f32_16x16x32_bf16 v[152:155], a[136:139], a[56:59], v[152:155]
    buffer_load_dwordx4 v232, s[64:67], s28 offen offset:2048 sc1 lds
    v_mfma_f32_16x16x32_bf16 v[152:155], a[140:143], a[60:63], v[152:155]
    ds_read_b128 a[84:87], v233 offset:37888
    v_mfma_f32_16x16x32_bf16 v[156:159], a[144:147], a[48:51], 0
    v_exp_f32 v144, v144
    v_mfma_f32_16x16x32_bf16 v[156:159], a[148:151], a[52:55], v[156:159]
    ds_read_b128 a[88:91], v233 offset:38912
    v_mfma_f32_16x16x32_bf16 v[156:159], a[152:155], a[56:59], v[156:159]
    s_waitcnt lgkmcnt(7)
    v_exp_f32 v145, v145
    v_mfma_f32_16x16x32_bf16 v[156:159], a[156:159], a[60:63], v[156:159]
    ds_read_b128 a[92:95], v233 offset:39936
    v_cvt_pk_bf16_f32 v168, v144, v145
    v_mfma_f32_16x16x32_bf16 v[0:3], a[160:163], v[160:163], v[0:3]
    s_cmp_lt_u32 s3, 1
    s_cselect_b32 s30, 0, 0xff800000
    v_exp_f32 v146, v146
    v_mfma_f32_16x16x32_bf16 v[32:35], a[160:163], v[164:167], v[32:35]
    buffer_load_dwordx4 v232, s[64:67], s28 offen offset:3072 sc1 lds
    v_mfma_f32_16x16x32_bf16 v[4:7], a[164:167], v[160:163], v[4:7]
    s_cmp_eq_u32 s3, 1
    s_cselect_b64 vcc, -1, 0
    v_exp_f32 v147, v147
    v_mfma_f32_16x16x32_bf16 v[36:39], a[164:167], v[164:167], v[36:39]
    s_add_u32 m0, m0, 4096
    v_cvt_pk_bf16_f32 v169, v146, v147
    v_mov_b32 v179, s30
    v_mfma_f32_16x16x32_bf16 v[8:11], a[168:171], v[160:163], v[8:11]
    v_exp_f32 v148, v148
    v_mfma_f32_16x16x32_bf16 v[40:43], a[168:171], v[164:167], v[40:43]
    v_cndmask_b32 v176, v179, v188, vcc
    v_cndmask_b32 v177, v179, v189, vcc
    v_mfma_f32_16x16x32_bf16 v[12:15], a[172:175], v[160:163], v[12:15]
    v_exp_f32 v149, v149
    v_mfma_f32_16x16x32_bf16 v[44:47], a[172:175], v[164:167], v[44:47]
    v_cvt_pk_bf16_f32 v170, v148, v149
    v_cndmask_b32 v178, v179, v190, vcc
    v_mfma_f32_16x16x32_bf16 v[16:19], a[176:179], v[160:163], v[16:19]
    v_exp_f32 v150, v150
    v_mfma_f32_16x16x32_bf16 v[48:51], a[176:179], v[164:167], v[48:51]
    v_cndmask_b32 v179, v179, v191, vcc
    v_mfma_f32_16x16x32_bf16 v[20:23], a[180:183], v[160:163], v[20:23]
    s_cmp_lt_u32 s3, 0
    s_cselect_b32 s30, 0, 0xff800000
    v_exp_f32 v151, v151
    v_mfma_f32_16x16x32_bf16 v[52:55], a[180:183], v[164:167], v[52:55]
    v_cvt_pk_bf16_f32 v171, v150, v151
    v_mfma_f32_16x16x32_bf16 v[24:27], a[184:187], v[160:163], v[24:27]
    s_cmp_eq_u32 s3, 0
    s_cselect_b64 vcc, -1, 0
    v_exp_f32 v152, v152
    v_mfma_f32_16x16x32_bf16 v[56:59], a[184:187], v[164:167], v[56:59]
    v_mov_b32 v183, s30
    v_cndmask_b32 v180, v183, v188, vcc
    v_mfma_f32_16x16x32_bf16 v[28:31], a[188:191], v[160:163], v[28:31]
    v_exp_f32 v153, v153
    v_mfma_f32_16x16x32_bf16 v[60:63], a[188:191], v[164:167], v[60:63]
    v_cvt_pk_bf16_f32 v172, v152, v153
    v_cndmask_b32 v181, v183, v189, vcc
    v_mfma_f32_16x16x32_bf16 v[192:195], v[208:211], v[160:163], v[192:195]
    s_waitcnt lgkmcnt(0)
    v_exp_f32 v154, v154
    v_mfma_f32_16x16x32_bf16 v[196:199], v[208:211], v[164:167], v[196:199]
    v_cndmask_b32 v182, v183, v190, vcc
    v_cndmask_b32 v183, v183, v191, vcc
    v_mfma_f32_16x16x32_bf16 v[128:131], a[64:67], a[32:35], 0
    v_exp_f32 v155, v155
    v_mfma_f32_16x16x32_bf16 v[128:131], a[68:71], a[36:39], v[128:131]
    ds_read_b128 a[128:131], v233 offset:49152
    v_cvt_pk_bf16_f32 v173, v154, v155
    v_mfma_f32_16x16x32_bf16 v[128:131], a[72:75], a[40:43], v[128:131]
    v_exp_f32 v156, v156
    v_mfma_f32_16x16x32_bf16 v[128:131], a[76:79], a[44:47], v[128:131]
    ds_read_b128 a[132:135], v233 offset:50176
    ds_read_b128 a[136:139], v233 offset:51200
    v_mfma_f32_16x16x32_bf16 v[132:135], a[80:83], a[32:35], 0
    v_exp_f32 v157, v157
    v_mfma_f32_16x16x32_bf16 v[132:135], a[84:87], a[36:39], v[132:135]
    ds_read_b128 a[140:143], v233 offset:52224
    v_cvt_pk_bf16_f32 v174, v156, v157
    v_mfma_f32_16x16x32_bf16 v[132:135], a[88:91], a[40:43], v[132:135]
    v_exp_f32 v158, v158
    v_mfma_f32_16x16x32_bf16 v[132:135], a[92:95], a[44:47], v[132:135]
    buffer_load_dwordx4 v232, s[64:67], s42 offen offset:0 sc1 lds
    v_mfma_f32_16x16x32_bf16 v[136:139], a[64:67], a[48:51], 0
    s_add_u32 s28, s28, 32768
    v_exp_f32 v159, v159
    v_mfma_f32_16x16x32_bf16 v[136:139], a[68:71], a[52:55], v[136:139]
    ds_read_b128 a[144:147], v233 offset:53248
    v_cvt_pk_bf16_f32 v175, v158, v159
    v_mfma_f32_16x16x32_bf16 v[136:139], a[72:75], a[56:59], v[136:139]
    buffer_load_dwordx4 v232, s[64:67], s42 offen offset:1024 sc1 lds
    v_mfma_f32_16x16x32_bf16 v[136:139], a[76:79], a[60:63], v[136:139]
    ds_read_b128 a[148:151], v233 offset:54272
    ds_read_b128 a[152:155], v233 offset:55296
    v_mfma_f32_16x16x32_bf16 v[140:143], a[80:83], a[48:51], 0
    v_exp_f32 v128, v128
    v_mfma_f32_16x16x32_bf16 v[140:143], a[84:87], a[52:55], v[140:143]
    buffer_load_dwordx4 v232, s[64:67], s42 offen offset:2048 sc1 lds
    v_mfma_f32_16x16x32_bf16 v[140:143], a[88:91], a[56:59], v[140:143]
    v_exp_f32 v129, v129
    v_mfma_f32_16x16x32_bf16 v[140:143], a[92:95], a[60:63], v[140:143]
    ds_read_b128 a[156:159], v233 offset:56320
    v_cvt_pk_bf16_f32 v160, v128, v129
    v_mfma_f32_16x16x32_bf16 v[64:67], a[160:163], v[168:171], v[64:67]
    v_exp_f32 v130, v130
    v_mfma_f32_16x16x32_bf16 v[96:99], a[160:163], v[172:175], v[96:99]
    buffer_load_dwordx4 v232, s[64:67], s42 offen offset:3072 sc1 lds
    v_mfma_f32_16x16x32_bf16 v[68:71], a[164:167], v[168:171], v[68:71]
    v_exp_f32 v131, v131
    v_mfma_f32_16x16x32_bf16 v[100:103], a[164:167], v[172:175], v[100:103]
    ds_read_b128 a[96:99], v234 offset:40960
    v_cvt_pk_bf16_f32 v161, v130, v131
    v_mfma_f32_16x16x32_bf16 v[72:75], a[168:171], v[168:171], v[72:75]
    v_exp_f32 v132, v132
    v_mfma_f32_16x16x32_bf16 v[104:107], a[168:171], v[172:175], v[104:107]
    ds_read_b128 a[100:103], v234 offset:41984
    ds_read_b128 a[104:107], v234 offset:43008
    v_mfma_f32_16x16x32_bf16 v[76:79], a[172:175], v[168:171], v[76:79]
    v_exp_f32 v133, v133
    v_mfma_f32_16x16x32_bf16 v[108:111], a[172:175], v[172:175], v[108:111]
    ds_read_b128 a[108:111], v234 offset:44032
    v_cvt_pk_bf16_f32 v162, v132, v133
    v_mfma_f32_16x16x32_bf16 v[80:83], a[176:179], v[168:171], v[80:83]
    v_exp_f32 v134, v134
    v_mfma_f32_16x16x32_bf16 v[112:115], a[176:179], v[172:175], v[112:115]
    v_mfma_f32_16x16x32_bf16 v[84:87], a[180:183], v[168:171], v[84:87]
    v_exp_f32 v135, v135
    v_mfma_f32_16x16x32_bf16 v[116:119], a[180:183], v[172:175], v[116:119]
    ds_read_b128 a[112:115], v234 offset:45056
    v_cvt_pk_bf16_f32 v163, v134, v135
    v_mfma_f32_16x16x32_bf16 v[88:91], a[184:187], v[168:171], v[88:91]
    v_exp_f32 v136, v136
    v_mfma_f32_16x16x32_bf16 v[120:123], a[184:187], v[172:175], v[120:123]
    ds_read_b128 a[116:119], v234 offset:46080
    ds_read_b128 a[120:123], v234 offset:47104
    v_mfma_f32_16x16x32_bf16 v[92:95], a[188:191], v[168:171], v[92:95]
    v_exp_f32 v137, v137
    v_mfma_f32_16x16x32_bf16 v[124:127], a[188:191], v[172:175], v[124:127]
    ds_read_b128 a[124:127], v234 offset:48128
    v_cvt_pk_bf16_f32 v164, v136, v137
    v_mfma_f32_16x16x32_bf16 v[200:203], v[208:211], v[168:171], v[200:203]
    s_waitcnt lgkmcnt(8)
    v_exp_f32 v138, v138
    v_mfma_f32_16x16x32_bf16 v[204:207], v[208:211], v[172:175], v[204:207]
    v_mfma_f32_16x16x32_bf16 v[144:147], a[64:67], a[16:19], v[184:187]
    s_and_b32 s52, s2, 7
    v_exp_f32 v139, v139
    v_mfma_f32_16x16x32_bf16 v[144:147], a[68:71], a[20:23], v[144:147]
    s_lshl_b32 s52, s52, 2
    v_cvt_pk_bf16_f32 v165, v138, v139
    v_mfma_f32_16x16x32_bf16 v[144:147], a[72:75], a[24:27], v[144:147]
    s_lshr_b32 s58, s2, 6
    v_exp_f32 v140, v140
    v_mfma_f32_16x16x32_bf16 v[144:147], a[76:79], a[28:31], v[144:147]
    s_waitcnt vmcnt(8)
    s_barrier
    s_add_u32 s52, s52, s58
    v_mfma_f32_16x16x32_bf16 v[148:151], a[80:83], a[16:19], v[220:223]
    s_mov_b32 m0, s29
    v_exp_f32 v141, v141
    v_mfma_f32_16x16x32_bf16 v[148:151], a[84:87], a[20:23], v[148:151]
    s_add_u32 s29, s29, 32768
    s_lshr_b32 s53, s2, 3
    v_cvt_pk_bf16_f32 v166, v140, v141
    v_mfma_f32_16x16x32_bf16 v[148:151], a[88:91], a[24:27], v[148:151]
    s_and_b32 s53, s53, 7
    v_exp_f32 v142, v142
    v_mfma_f32_16x16x32_bf16 v[148:151], a[92:95], a[28:31], v[148:151]
    buffer_load_dwordx4 v232, s[64:67], s28 offen offset:0 sc1 lds
    v_mfma_f32_16x16x32_bf16 v[152:155], a[128:131], a[16:19], v[176:179]
    s_and_b32 s29, s29, 0x1ffff
    v_exp_f32 v143, v143
    v_mfma_f32_16x16x32_bf16 v[152:155], a[132:135], a[20:23], v[152:155]
    s_mov_b64 s[44:45], s[18:19]
    v_cvt_pk_bf16_f32 v167, v142, v143
    v_mfma_f32_16x16x32_bf16 v[152:155], a[136:139], a[24:27], v[152:155]
    buffer_load_dwordx4 v232, s[64:67], s28 offen offset:1024 sc1 lds
    v_mfma_f32_16x16x32_bf16 v[152:155], a[140:143], a[28:31], v[152:155]
    s_add_u32 s42, s28, 4096
    s_mov_b32 s46, 87031808
    v_mfma_f32_16x16x32_bf16 v[156:159], a[144:147], a[16:19], v[180:183]
    s_mov_b32 s47, 0x20000
    v_exp_f32 v144, v144
    v_mfma_f32_16x16x32_bf16 v[156:159], a[148:151], a[20:23], v[156:159]
    buffer_load_dwordx4 v232, s[64:67], s28 offen offset:2048 sc1 lds
    v_mfma_f32_16x16x32_bf16 v[156:159], a[152:155], a[24:27], v[156:159]
    s_waitcnt lgkmcnt(0)
    v_exp_f32 v145, v145
    v_mfma_f32_16x16x32_bf16 v[156:159], a[156:159], a[28:31], v[156:159]
    s_mov_b64 s[48:49], s[18:19]
    v_cvt_pk_bf16_f32 v168, v144, v145
    v_mfma_f32_16x16x32_bf16 v[64:67], a[96:99], v[160:163], v[64:67]
    s_mov_b32 s51, 0x20000
    v_exp_f32 v146, v146
    v_mfma_f32_16x16x32_bf16 v[96:99], a[96:99], v[164:167], v[96:99]
    ds_read_b128 a[160:163], v234 offset:57344
    s_lshl_b32 s58, s52, 2
    v_mfma_f32_16x16x32_bf16 v[68:71], a[100:103], v[160:163], v[68:71]
    s_add_u32 s58, s58, s3
    v_exp_f32 v147, v147
    v_mfma_f32_16x16x32_bf16 v[100:103], a[100:103], v[164:167], v[100:103]
    ds_read_b128 a[164:167], v234 offset:58368
    v_cvt_pk_bf16_f32 v169, v146, v147
    v_mfma_f32_16x16x32_bf16 v[72:75], a[104:107], v[160:163], v[72:75]
    s_lshl_b32 s58, s58, 15
    v_exp_f32 v148, v148
    v_mfma_f32_16x16x32_bf16 v[104:107], a[104:107], v[164:167], v[104:107]
    ds_read_b128 a[168:171], v234 offset:59392
    s_add_u32 s54, s58, 52428800
    v_mfma_f32_16x16x32_bf16 v[76:79], a[108:111], v[160:163], v[76:79]
    s_add_u32 s50, s54, 32768
    v_exp_f32 v149, v149
    v_mfma_f32_16x16x32_bf16 v[108:111], a[108:111], v[164:167], v[108:111]
    ds_read_b128 a[172:175], v234 offset:60416
    v_cvt_pk_bf16_f32 v170, v148, v149
    v_mfma_f32_16x16x32_bf16 v[80:83], a[112:115], v[160:163], v[80:83]
    s_mov_b32 s55, 0
    v_exp_f32 v150, v150
    v_mfma_f32_16x16x32_bf16 v[112:115], a[112:115], v[164:167], v[112:115]
    ds_read_b128 a[176:179], v234 offset:61440
    s_lshl_b32 s56, s3, 13
    v_mfma_f32_16x16x32_bf16 v[84:87], a[116:119], v[160:163], v[84:87]
    s_add_u32 s56, s56, 131072
    v_exp_f32 v151, v151
    v_mfma_f32_16x16x32_bf16 v[116:119], a[116:119], v[164:167], v[116:119]
    ds_read_b128 a[180:183], v234 offset:62464
    v_cvt_pk_bf16_f32 v171, v150, v151
    v_mfma_f32_16x16x32_bf16 v[88:91], a[120:123], v[160:163], v[88:91]
    s_lshl_b32 s58, s53, 10
    v_exp_f32 v152, v152
    v_mfma_f32_16x16x32_bf16 v[120:123], a[120:123], v[164:167], v[120:123]
    ds_read_b128 a[184:187], v234 offset:63488
    s_lshl_b32 s59, s3, 8
    v_mfma_f32_16x16x32_bf16 v[92:95], a[124:127], v[160:163], v[92:95]
    s_add_u32 s58, s58, s59
    v_exp_f32 v153, v153
    v_mfma_f32_16x16x32_bf16 v[124:127], a[124:127], v[164:167], v[124:127]
    ds_read_b128 a[188:191], v234 offset:64512
    v_cvt_pk_bf16_f32 v172, v152, v153
    v_xor_b32 v233, 0x10000, v233
    v_mfma_f32_16x16x32_bf16 v[200:203], v[208:211], v[160:163], v[200:203]
    s_add_u32 s62, s58, 56623104
    v_exp_f32 v154, v154
    v_mfma_f32_16x16x32_bf16 v[204:207], v[208:211], v[164:167], v[204:207]
    buffer_load_dwordx4 v232, s[64:67], s28 offen offset:3072 sc1 lds
    v_mfma_f32_16x16x32_bf16 v[128:131], a[128:131], a[32:35], 0
    s_add_u32 m0, m0, 4096
    v_exp_f32 v155, v155
    v_mfma_f32_16x16x32_bf16 v[128:131], a[132:135], a[36:39], v[128:131]
    ds_read_b128 a[64:67], v233 offset:0
    v_cvt_pk_bf16_f32 v173, v154, v155
    v_mfma_f32_16x16x32_bf16 v[128:131], a[136:139], a[40:43], v[128:131]
    s_lshl_b32 s58, s52, 16
    v_exp_f32 v156, v156
    v_mfma_f32_16x16x32_bf16 v[128:131], a[140:143], a[44:47], v[128:131]
    ds_read_b128 a[68:71], v233 offset:1024
    ds_read_b128 a[72:75], v233 offset:2048
    v_mfma_f32_16x16x32_bf16 v[132:135], a[144:147], a[32:35], 0
    s_lshl_b32 s59, s53, 13
    v_exp_f32 v157, v157
    v_mfma_f32_16x16x32_bf16 v[132:135], a[148:151], a[36:39], v[132:135]
    ds_read_b128 a[76:79], v233 offset:3072
    v_cvt_pk_bf16_f32 v174, v156, v157
    v_mfma_f32_16x16x32_bf16 v[132:135], a[152:155], a[40:43], v[132:135]
    s_add_u32 s58, s58, s59
    v_exp_f32 v158, v158
    v_mfma_f32_16x16x32_bf16 v[132:135], a[156:159], a[44:47], v[132:135]
    buffer_load_dwordx4 v232, s[64:67], s42 offen offset:0 sc1 lds
    v_mfma_f32_16x16x32_bf16 v[136:139], a[128:131], a[48:51], 0
    s_add_u32 s28, s28, 32768
    v_exp_f32 v159, v159
    v_mfma_f32_16x16x32_bf16 v[136:139], a[132:135], a[52:55], v[136:139]
    ds_read_b128 a[80:83], v233 offset:4096
    v_cvt_pk_bf16_f32 v175, v158, v159
    v_mfma_f32_16x16x32_bf16 v[136:139], a[136:139], a[56:59], v[136:139]
    buffer_load_dwordx4 v232, s[64:67], s42 offen offset:1024 sc1 lds
    v_mfma_f32_16x16x32_bf16 v[136:139], a[140:143], a[60:63], v[136:139]
    ds_read_b128 a[84:87], v233 offset:5120
    ds_read_b128 a[88:91], v233 offset:6144
    v_mfma_f32_16x16x32_bf16 v[140:143], a[144:147], a[48:51], 0
    s_add_u32 s58, s58, 50331648
    v_exp_f32 v128, v128
    v_mfma_f32_16x16x32_bf16 v[140:143], a[148:151], a[52:55], v[140:143]
    buffer_load_dwordx4 v232, s[64:67], s42 offen offset:2048 sc1 lds
    v_mfma_f32_16x16x32_bf16 v[140:143], a[152:155], a[56:59], v[140:143]
    s_waitcnt lgkmcnt(7)
    v_exp_f32 v129, v129
    v_mfma_f32_16x16x32_bf16 v[140:143], a[156:159], a[60:63], v[140:143]
    ds_read_b128 a[92:95], v233 offset:7168
    v_cvt_pk_bf16_f32 v160, v128, v129
    v_mfma_f32_16x16x32_bf16 v[32:35], a[96:99], v[168:171], v[32:35]
    s_add_u32 s59, s58, 4096
    v_exp_f32 v130, v130
    v_mfma_f32_16x16x32_bf16 v[32:35], a[160:163], v[172:175], v[32:35]
    buffer_load_dwordx4 v232, s[64:67], s42 offen offset:3072 sc1 lds
    v_mfma_f32_16x16x32_bf16 v[36:39], a[100:103], v[168:171], v[36:39]
    v_exp_f32 v131, v131
    v_mfma_f32_16x16x32_bf16 v[36:39], a[164:167], v[172:175], v[36:39]
    v_cvt_pk_bf16_f32 v161, v130, v131
    v_mfma_f32_16x16x32_bf16 v[40:43], a[104:107], v[168:171], v[40:43]
    v_exp_f32 v132, v132
    v_mfma_f32_16x16x32_bf16 v[40:43], a[168:171], v[172:175], v[40:43]
    v_mfma_f32_16x16x32_bf16 v[44:47], a[108:111], v[168:171], v[44:47]
    v_exp_f32 v133, v133
    v_mfma_f32_16x16x32_bf16 v[44:47], a[172:175], v[172:175], v[44:47]
    v_cvt_pk_bf16_f32 v162, v132, v133
    v_mfma_f32_16x16x32_bf16 v[48:51], a[112:115], v[168:171], v[48:51]
    v_exp_f32 v134, v134
    v_mfma_f32_16x16x32_bf16 v[48:51], a[176:179], v[172:175], v[48:51]
    v_mfma_f32_16x16x32_bf16 v[52:55], a[116:119], v[168:171], v[52:55]
    v_exp_f32 v135, v135
    v_mfma_f32_16x16x32_bf16 v[52:55], a[180:183], v[172:175], v[52:55]
    v_cvt_pk_bf16_f32 v163, v134, v135
    v_mfma_f32_16x16x32_bf16 v[56:59], a[120:123], v[168:171], v[56:59]
    s_lshl_b32 s27, s25, 1
    v_exp_f32 v136, v136
    v_mfma_f32_16x16x32_bf16 v[56:59], a[184:187], v[172:175], v[56:59]
    v_mfma_f32_16x16x32_bf16 v[60:63], a[124:127], v[168:171], v[60:63]
    s_sub_u32 s27, 14, s27
    v_exp_f32 v137, v137
    v_mfma_f32_16x16x32_bf16 v[60:63], a[188:191], v[172:175], v[60:63]
    v_cvt_pk_bf16_f32 v164, v136, v137
    v_mfma_f32_16x16x32_bf16 v[196:199], v[208:211], v[168:171], v[196:199]
    s_waitcnt lgkmcnt(0)
    v_exp_f32 v138, v138
    v_mfma_f32_16x16x32_bf16 v[196:199], v[208:211], v[172:175], v[196:199]
    s_cmp_lt_u32 s25, 3
    s_cbranch_scc1 KB_W2
    s_sub_u32 s24, s25, 4
    s_lshl_b32 s24, s24, 5
    s_add_u32 s24, s24, s26
    s_lshl_b32 s24, s24, 1
    s_add_u32 s30, s26, 256
    s_cmp_eq_u32 s25, 3
    s_cselect_b32 s24, s30, s24
    ds_read_b64_tr_b16 v[220:221], v252 offset:0
    ds_read_b64_tr_b16 v[222:223], v252 offset:2048
    ds_read_b64_tr_b16 v[224:225], v253 offset:0
    ds_read_b64_tr_b16 v[226:227], v253 offset:2048
    ds_read_b64_tr_b16 v[238:239], v254 offset:0
    ds_read_b64_tr_b16 v[240:241], v254 offset:2048
    ds_read_b64_tr_b16 v[242:243], v255 offset:0
    ds_read_b64_tr_b16 v[244:245], v255 offset:2048
    s_mul_i32 s31, s3, 1152
    s_add_u32 s31, s31, s24
    s_lshl_b32 s31, s31, 10
    s_add_u32 s31, s31, 23068672
    s_waitcnt lgkmcnt(0)
    buffer_store_dwordx4 v[220:223], v232, s[20:23], s31 offen sc1
    s_add_u32 s31, s31, 294912
    buffer_store_dwordx4 v[224:227], v232, s[20:23], s31 offen sc1
    s_add_u32 s31, s31, 294912
    buffer_store_dwordx4 v[238:241], v232, s[20:23], s31 offen sc1
    s_add_u32 s31, s31, 294912
    buffer_store_dwordx4 v[242:245], v232, s[20:23], s31 offen sc1
    s_cmp_eq_u32 s25, 3
    s_cbranch_scc1 KB_W2
    s_add_u32 s24, s24, 1
    s_nop 0
    ds_read_b64_tr_b16 v[220:221], v252 offset:4096
    ds_read_b64_tr_b16 v[222:223], v252 offset:6144
    ds_read_b64_tr_b16 v[224:225], v253 offset:4096
    ds_read_b64_tr_b16 v[226:227], v253 offset:6144
    ds_read_b64_tr_b16 v[238:239], v254 offset:4096
    ds_read_b64_tr_b16 v[240:241], v254 offset:6144
    ds_read_b64_tr_b16 v[242:243], v255 offset:4096
    ds_read_b64_tr_b16 v[244:245], v255 offset:6144
    s_mul_i32 s31, s3, 1152
    s_add_u32 s31, s31, s24
    s_lshl_b32 s31, s31, 10
    s_add_u32 s31, s31, 23068672
    s_waitcnt lgkmcnt(0)
    buffer_store_dwordx4 v[220:223], v232, s[20:23], s31 offen sc1
    s_add_u32 s31, s31, 294912
    buffer_store_dwordx4 v[224:227], v232, s[20:23], s31 offen sc1
    s_add_u32 s31, s31, 294912
    buffer_store_dwordx4 v[238:241], v232, s[20:23], s31 offen sc1
    s_add_u32 s31, s31, 294912
    buffer_store_dwordx4 v[242:245], v232, s[20:23], s31 offen sc1
KB_W2:
    s_mov_b64 s[40:41], 0
    s_nop 0
    v_mov_b32 v242, 0x2b800000
    v_mov_b32 v243, 0x71800000
    s_lshl_b32 s39, s26, 13
    s_add_u32 s31, s34, 0
    s_lshr_b32 s30, s31, 1
    s_lshl_b32 s30, s30, 10
    s_and_b32 s31, s31, 1
    s_add_u32 s30, s30, s31
    s_lshl_b32 s30, s30, 8
    s_add_u32 s30, s30, s39
    s_add_u32 s31, s30, 4096
    v_cmp_ngt_f32 vcc, v192, v242
    v_rcp_f32 v239, v192
    s_or_b64 s[40:41], s[40:41], vcc
    v_cmp_nlt_f32 vcc, v192, v243
    v_sub_f32 v238, 1.0, v228
    s_or_b64 s[40:41], s[40:41], vcc
    v_mul_f32 v238, v238, v239
    v_mul_f32 v0, v0, v238
    v_mul_f32 v1, v1, v238
    v_mul_f32 v2, v2, v238
    v_mul_f32 v3, v3, v238
    v_mul_f32 v4, v4, v238
    v_mul_f32 v5, v5, v238
    v_mul_f32 v6, v6, v238
    v_mul_f32 v7, v7, v238
    v_cvt_pk_bf16_f32 v220, v0, v1
    v_cvt_pk_bf16_f32 v221, v2, v3
    v_cvt_pk_bf16_f32 v222, v4, v5
    v_cvt_pk_bf16_f32 v223, v6, v7
    buffer_store_dwordx4 v[220:223], v236, s[20:23], s30 offen offset:0 sc1
    v_mul_f32 v8, v8, v238
    v_mul_f32 v9, v9, v238
    v_mul_f32 v10, v10, v238
    v_mul_f32 v11, v11, v238
    v_mul_f32 v12, v12, v238
    v_mul_f32 v13, v13, v238
    v_mul_f32 v14, v14, v238
    v_mul_f32 v15, v15, v238
    v_mfma_f32_16x16x32_bf16 v[216:219], v[212:215], v[220:223], 0
    v_cvt_pk_bf16_f32 v224, v8, v9
    v_cvt_pk_bf16_f32 v225, v10, v11
    v_cvt_pk_bf16_f32 v226, v12, v13
    v_cvt_pk_bf16_f32 v227, v14, v15
    buffer_store_dwordx4 v[224:227], v236, s[20:23], s30 offen offset:2048 sc1
    v_mul_f32 v16, v16, v238
    v_mul_f32 v17, v17, v238
    v_mul_f32 v18, v18, v238
    v_mul_f32 v19, v19, v238
    v_mul_f32 v20, v20, v238
    v_mul_f32 v21, v21, v238
    v_mul_f32 v22, v22, v238
    v_mul_f32 v23, v23, v238
    v_mfma_f32_16x16x32_bf16 v[216:219], v[212:215], v[224:227], v[216:219]
    v_cvt_pk_bf16_f32 v220, v16, v17
    v_cvt_pk_bf16_f32 v221, v18, v19
    v_cvt_pk_bf16_f32 v222, v20, v21
    v_cvt_pk_bf16_f32 v223, v22, v23
    buffer_store_dwordx4 v[220:223], v236, s[20:23], s31 offen offset:0 sc1
    v_mul_f32 v24, v24, v238
    v_mul_f32 v25, v25, v238
    v_mul_f32 v26, v26, v238
    v_mul_f32 v27, v27, v238
    v_mul_f32 v28, v28, v238
    v_mul_f32 v29, v29, v238
    v_mul_f32 v30, v30, v238
    v_mul_f32 v31, v31, v238
    v_mfma_f32_16x16x32_bf16 v[216:219], v[212:215], v[220:223], v[216:219]
    v_cvt_pk_bf16_f32 v224, v24, v25
    v_cvt_pk_bf16_f32 v225, v26, v27
    v_cvt_pk_bf16_f32 v226, v28, v29
    v_cvt_pk_bf16_f32 v227, v30, v31
    buffer_store_dwordx4 v[224:227], v236, s[20:23], s31 offen offset:2048 sc1
    s_add_u32 s31, s34, s43
    s_lshr_b32 s30, s31, 1
    s_lshl_b32 s30, s30, 10
    s_and_b32 s31, s31, 1
    s_add_u32 s30, s30, s31
    s_lshl_b32 s30, s30, 8
    s_add_u32 s30, s30, s39
    s_add_u32 s31, s30, 4096
    v_cmp_ngt_f32 vcc, v196, v242
    v_rcp_f32 v239, v196
    s_or_b64 s[40:41], s[40:41], vcc
    v_cmp_nlt_f32 vcc, v196, v243
    v_sub_f32 v238, 1.0, v229
    s_or_b64 s[40:41], s[40:41], vcc
    v_mul_f32 v238, v238, v239
    v_mul_f32 v32, v32, v238
    v_mul_f32 v33, v33, v238
    v_mul_f32 v34, v34, v238
    v_mul_f32 v35, v35, v238
    v_mul_f32 v36, v36, v238
    v_mul_f32 v37, v37, v238
    v_mul_f32 v38, v38, v238
    v_mul_f32 v39, v39, v238
    v_mfma_f32_16x16x32_bf16 v[216:219], v[212:215], v[224:227], v[216:219]
    v_cvt_pk_bf16_f32 v220, v32, v33
    v_cvt_pk_bf16_f32 v221, v34, v35
    v_cvt_pk_bf16_f32 v222, v36, v37
    v_cvt_pk_bf16_f32 v223, v38, v39
    buffer_store_dwordx4 v[220:223], v236, s[20:23], s30 offen offset:0 sc1
    v_mul_f32 v40, v40, v238
    v_mul_f32 v41, v41, v238
    v_mul_f32 v42, v42, v238
    v_mul_f32 v43, v43, v238
    v_mul_f32 v44, v44, v238
    v_mul_f32 v45, v45, v238
    v_mul_f32 v46, v46, v238
    v_mul_f32 v47, v47, v238
    v_mfma_f32_16x16x32_bf16 v[216:219], v[212:215], v[220:223], v[216:219]
    v_cvt_pk_bf16_f32 v224, v40, v41
    v_cvt_pk_bf16_f32 v225, v42, v43
    v_cvt_pk_bf16_f32 v226, v44, v45
    v_cvt_pk_bf16_f32 v227, v46, v47
    buffer_store_dwordx4 v[224:227], v236, s[20:23], s30 offen offset:2048 sc1
    v_mul_f32 v48, v48, v238
    v_mul_f32 v49, v49, v238
    v_mul_f32 v50, v50, v238
    v_mul_f32 v51, v51, v238
    v_mul_f32 v52, v52, v238
    v_mul_f32 v53, v53, v238
    v_mul_f32 v54, v54, v238
    v_mul_f32 v55, v55, v238
    v_mfma_f32_16x16x32_bf16 v[216:219], v[212:215], v[224:227], v[216:219]
    v_cvt_pk_bf16_f32 v220, v48, v49
    v_cvt_pk_bf16_f32 v221, v50, v51
    v_cvt_pk_bf16_f32 v222, v52, v53
    v_cvt_pk_bf16_f32 v223, v54, v55
    buffer_store_dwordx4 v[220:223], v236, s[20:23], s31 offen offset:0 sc1
    v_mul_f32 v56, v56, v238
    v_mul_f32 v57, v57, v238
    v_mul_f32 v58, v58, v238
    v_mul_f32 v59, v59, v238
    v_mul_f32 v60, v60, v238
    v_mul_f32 v61, v61, v238
    v_mul_f32 v62, v62, v238
    v_mul_f32 v63, v63, v238
    v_mfma_f32_16x16x32_bf16 v[216:219], v[212:215], v[220:223], v[216:219]
    v_cvt_pk_bf16_f32 v224, v56, v57
    v_cvt_pk_bf16_f32 v225, v58, v59
    v_cvt_pk_bf16_f32 v226, v60, v61
    v_cvt_pk_bf16_f32 v227, v62, v63
    buffer_store_dwordx4 v[224:227], v236, s[20:23], s31 offen offset:2048 sc1
    s_nop 0
    v_mfma_f32_16x16x32_bf16 v[216:219], v[212:215], v[224:227], v[216:219]
    s_nop 7
    v_cmp_u_f32 vcc, v216, v216
    s_nop 0
    s_or_b64 s[40:41], s[40:41], vcc
    s_cmp_eq_u32 s27, 0
    s_cbranch_scc1 KB_D2
.p2align 3
KB_L2:
    v_mfma_f32_16x16x32_bf16 v[144:147], a[64:67], a[32:35], 0
    v_exp_f32 v139, v139
    v_mfma_f32_16x16x32_bf16 v[144:147], a[68:71], a[36:39], v[144:147]
    ds_read_b128 a[128:131], v233 offset:16384
    v_cvt_pk_bf16_f32 v165, v138, v139
    v_mfma_f32_16x16x32_bf16 v[144:147], a[72:75], a[40:43], v[144:147]
    v_exp_f32 v140, v140
    v_mfma_f32_16x16x32_bf16 v[144:147], a[76:79], a[44:47], v[144:147]
    ds_read_b128 a[132:135], v233 offset:17408
    ds_read_b128 a[136:139], v233 offset:18432
    v_mfma_f32_16x16x32_bf16 v[148:151], a[80:83], a[32:35], 0
    v_exp_f32 v141, v141
    v_mfma_f32_16x16x32_bf16 v[148:151], a[84:87], a[36:39], v[148:151]
    ds_read_b128 a[140:143], v233 offset:19456
    v_cvt_pk_bf16_f32 v166, v140, v141
    v_mfma_f32_16x16x32_bf16 v[148:151], a[88:91], a[40:43], v[148:151]
    v_exp_f32 v142, v142
    v_mfma_f32_16x16x32_bf16 v[148:151], a[92:95], a[44:47], v[148:151]
    v_mfma_f32_16x16x32_bf16 v[152:155], a[64:67], a[48:51], 0
    v_exp_f32 v143, v143
    v_mfma_f32_16x16x32_bf16 v[152:155], a[68:71], a[52:55], v[152:155]
    ds_read_b128 a[144:147], v233 offset:20480
    v_cvt_pk_bf16_f32 v167, v142, v143
    v_mfma_f32_16x16x32_bf16 v[152:155], a[72:75], a[56:59], v[152:155]
    v_xor_b32 v234, 0x10000, v234
    v_mfma_f32_16x16x32_bf16 v[152:155], a[76:79], a[60:63], v[152:155]
    ds_read_b128 a[148:151], v233 offset:21504
    ds_read_b128 a[152:155], v233 offset:22528
    v_mfma_f32_16x16x32_bf16 v[156:159], a[80:83], a[48:51], 0
    v_exp_f32 v144, v144
    v_mfma_f32_16x16x32_bf16 v[156:159], a[84:87], a[52:55], v[156:159]
    v_mfma_f32_16x16x32_bf16 v[156:159], a[88:91], a[56:59], v[156:159]
    s_waitcnt lgkmcnt(7)
    v_exp_f32 v145, v145
    v_mfma_f32_16x16x32_bf16 v[156:159], a[92:95], a[60:63], v[156:159]
    ds_read_b128 a[156:159], v233 offset:23552
    v_cvt_pk_bf16_f32 v168, v144, v145
    v_mfma_f32_16x16x32_bf16 v[64:67], a[160:163], v[160:163], v[64:67]
    v_exp_f32 v146, v146
    v_mfma_f32_16x16x32_bf16 v[96:99], a[160:163], v[164:167], v[96:99]
    s_waitcnt vmcnt(8)
    s_barrier
    v_mfma_f32_16x16x32_bf16 v[68:71], a[164:167], v[160:163], v[68:71]
    s_mov_b32 m0, s29
    v_exp_f32 v147, v147
    v_mfma_f32_16x16x32_bf16 v[100:103], a[164:167], v[164:167], v[100:103]
    ds_read_b128 a[96:99], v234 offset:8192
    v_cvt_pk_bf16_f32 v169, v146, v147
    v_mfma_f32_16x16x32_bf16 v[72:75], a[168:171], v[160:163], v[72:75]
    s_add_u32 s29, s29, 32768
    v_exp_f32 v148, v148
    v_mfma_f32_16x16x32_bf16 v[104:107], a[168:171], v[164:167], v[104:107]
    ds_read_b128 a[100:103], v234 offset:9216
    ds_read_b128 a[104:107], v234 offset:10240
    v_mfma_f32_16x16x32_bf16 v[76:79], a[172:175], v[160:163], v[76:79]
    v_exp_f32 v149, v149
    v_mfma_f32_16x16x32_bf16 v[108:111], a[172:175], v[164:167], v[108:111]
    ds_read_b128 a[108:111], v234 offset:11264
    v_cvt_pk_bf16_f32 v170, v148, v149
    v_mfma_f32_16x16x32_bf16 v[80:83], a[176:179], v[160:163], v[80:83]
    v_exp_f32 v150, v150
    v_mfma_f32_16x16x32_bf16 v[112:115], a[176:179], v[164:167], v[112:115]
    buffer_load_dwordx4 v232, s[64:67], s28 offen offset:0 sc1 lds
    v_mfma_f32_16x16x32_bf16 v[84:87], a[180:183], v[160:163], v[84:87]
    s_and_b32 s29, s29, 0x1ffff
    v_exp_f32 v151, v151
    v_mfma_f32_16x16x32_bf16 v[116:119], a[180:183], v[164:167], v[116:119]
    ds_read_b128 a[112:115], v234 offset:12288
    v_cvt_pk_bf16_f32 v171, v150, v151
    v_mfma_f32_16x16x32_bf16 v[88:91], a[184:187], v[160:163], v[88:91]
    v_exp_f32 v152, v152
    v_mfma_f32_16x16x32_bf16 v[120:123], a[184:187], v[164:167], v[120:123]
    ds_read_b128 a[116:119], v234 offset:13312
    ds_read_b128 a[120:123], v234 offset:14336
    v_mfma_f32_16x16x32_bf16 v[92:95], a[188:191], v[160:163], v[92:95]
    v_exp_f32 v153, v153
    v_mfma_f32_16x16x32_bf16 v[124:127], a[188:191], v[164:167], v[124:127]
    ds_read_b128 a[124:127], v234 offset:15360
    v_cvt_pk_bf16_f32 v172, v152, v153
    v_mfma_f32_16x16x32_bf16 v[200:203], v[208:211], v[160:163], v[200:203]
    s_waitcnt lgkmcnt(8)
    v_exp_f32 v154, v154
    v_mfma_f32_16x16x32_bf16 v[204:207], v[208:211], v[164:167], v[204:207]
    buffer_load_dwordx4 v232, s[64:67], s28 offen offset:1024 sc1 lds
    v_mfma_f32_16x16x32_bf16 v[128:131], a[128:131], a[32:35], 0
    s_add_u32 s42, s28, 4096
    v_exp_f32 v155, v155
    v_mfma_f32_16x16x32_bf16 v[128:131], a[132:135], a[36:39], v[128:131]
    ds_read_b128 a[64:67], v233 offset:32768
    v_cvt_pk_bf16_f32 v173, v154, v155
    v_mfma_f32_16x16x32_bf16 v[128:131], a[136:139], a[40:43], v[128:131]
    v_exp_f32 v156, v156
    v_mfma_f32_16x16x32_bf16 v[128:131], a[140:143], a[44:47], v[128:131]
    ds_read_b128 a[68:71], v233 offset:33792
    ds_read_b128 a[72:75], v233 offset:34816
    v_mfma_f32_16x16x32_bf16 v[132:135], a[144:147], a[32:35], 0
    v_exp_f32 v157, v157
    v_mfma_f32_16x16x32_bf16 v[132:135], a[148:151], a[36:39], v[132:135]
    ds_read_b128 a[76:79], v233 offset:35840
    v_cvt_pk_bf16_f32 v174, v156, v157
    v_mfma_f32_16x16x32_bf16 v[132:135], a[152:155], a[40:43], v[132:135]
    v_exp_f32 v158, v158
    v_mfma_f32_16x16x32_bf16 v[132:135], a[156:159], a[44:47], v[132:135]
    buffer_load_dwordx4 v232, s[64:67], s28 offen offset:2048 sc1 lds
    v_mfma_f32_16x16x32_bf16 v[136:139], a[128:131], a[48:51], 0
    v_exp_f32 v159, v159
    v_mfma_f32_16x16x32_bf16 v[136:139], a[132:135], a[52:55], v[136:139]
    ds_read_b128 a[80:83], v233 offset:36864
    v_cvt_pk_bf16_f32 v175, v158, v159
    v_mfma_f32_16x16x32_bf16 v[136:139], a[136:139], a[56:59], v[136:139]
    buffer_load_dwordx4 v232, s[64:67], s28 offen offset:3072 sc1 lds
    v_mfma_f32_16x16x32_bf16 v[136:139], a[140:143], a[60:63], v[136:139]
    ds_read_b128 a[84:87], v233 offset:37888
    ds_read_b128 a[88:91], v233 offset:38912
    v_mfma_f32_16x16x32_bf16 v[140:143], a[144:147], a[48:51], 0
    s_add_u32 m0, m0, 4096
    v_exp_f32 v128, v128
    v_mfma_f32_16x16x32_bf16 v[140:143], a[148:151], a[52:55], v[140:143]
    buffer_load_dwordx4 v232, s[64:67], s42 offen offset:0 sc1 lds
    v_mfma_f32_16x16x32_bf16 v[140:143], a[152:155], a[56:59], v[140:143]
    s_waitcnt lgkmcnt(7)
    v_exp_f32 v129, v129
    v_mfma_f32_16x16x32_bf16 v[140:143], a[156:159], a[60:63], v[140:143]
    ds_read_b128 a[92:95], v233 offset:39936
    v_cvt_pk_bf16_f32 v160, v128, v129
    v_mfma_f32_16x16x32_bf16 v[64:67], a[96:99], v[168:171], v[64:67]
    s_add_u32 s28, s28, 32768
    v_exp_f32 v130, v130
    v_mfma_f32_16x16x32_bf16 v[96:99], a[96:99], v[172:175], v[96:99]
    buffer_load_dwordx4 v232, s[64:67], s42 offen offset:1024 sc1 lds
    v_mfma_f32_16x16x32_bf16 v[68:71], a[100:103], v[168:171], v[68:71]
    v_exp_f32 v131, v131
    v_mfma_f32_16x16x32_bf16 v[100:103], a[100:103], v[172:175], v[100:103]
    ds_read_b128 a[160:163], v234 offset:24576
    v_cvt_pk_bf16_f32 v161, v130, v131
    v_mfma_f32_16x16x32_bf16 v[72:75], a[104:107], v[168:171], v[72:75]
    v_exp_f32 v132, v132
    v_mfma_f32_16x16x32_bf16 v[104:107], a[104:107], v[172:175], v[104:107]
    ds_read_b128 a[164:167], v234 offset:25600
    ds_read_b128 a[168:171], v234 offset:26624
    v_mfma_f32_16x16x32_bf16 v[76:79], a[108:111], v[168:171], v[76:79]
    v_exp_f32 v133, v133
    v_mfma_f32_16x16x32_bf16 v[108:111], a[108:111], v[172:175], v[108:111]
    ds_read_b128 a[172:175], v234 offset:27648
    v_cvt_pk_bf16_f32 v162, v132, v133
    v_mfma_f32_16x16x32_bf16 v[80:83], a[112:115], v[168:171], v[80:83]
    v_exp_f32 v134, v134
    v_mfma_f32_16x16x32_bf16 v[112:115], a[112:115], v[172:175], v[112:115]
    buffer_load_dwordx4 v232, s[64:67], s42 offen offset:2048 sc1 lds
    v_mfma_f32_16x16x32_bf16 v[84:87], a[116:119], v[168:171], v[84:87]
    v_exp_f32 v135, v135
    v_mfma_f32_16x16x32_bf16 v[116:119], a[116:119], v[172:175], v[116:119]
    ds_read_b128 a[176:179], v234 offset:28672
    v_cvt_pk_bf16_f32 v163, v134, v135
    v_mfma_f32_16x16x32_bf16 v[88:91], a[120:123], v[168:171], v[88:91]
    v_exp_f32 v136, v136
    v_mfma_f32_16x16x32_bf16 v[120:123], a[120:123], v[172:175], v[120:123]
    ds_read_b128 a[180:183], v234 offset:29696
    ds_read_b128 a[184:187], v234 offset:30720
    v_mfma_f32_16x16x32_bf16 v[92:95], a[124:127], v[168:171], v[92:95]
    v_exp_f32 v137, v137
    v_mfma_f32_16x16x32_bf16 v[124:127], a[124:127], v[172:175], v[124:127]
    ds_read_b128 a[188:191], v234 offset:31744
    v_cvt_pk_bf16_f32 v164, v136, v137
    v_mfma_f32_16x16x32_bf16 v[200:203], v[208:211], v[168:171], v[200:203]
    s_waitcnt lgkmcnt(8)
    v_exp_f32 v138, v138
    v_mfma_f32_16x16x32_bf16 v[204:207], v[208:211], v[172:175], v[204:207]
    buffer_load_dwordx4 v232, s[64:67], s42 offen offset:3072 sc1 lds
    v_mfma_f32_16x16x32_bf16 v[144:147], a[64:67], a[32:35], 0
    v_exp_f32 v139, v139
    v_mfma_f32_16x16x32_bf16 v[144:147], a[68:71], a[36:39], v[144:147]
    ds_read_b128 a[128:131], v233 offset:49152
    v_cvt_pk_bf16_f32 v165, v138, v139
    v_mfma_f32_16x16x32_bf16 v[144:147], a[72:75], a[40:43], v[144:147]
    v_exp_f32 v140, v140
    v_mfma_f32_16x16x32_bf16 v[144:147], a[76:79], a[44:47], v[144:147]
    ds_read_b128 a[132:135], v233 offset:50176
    ds_read_b128 a[136:139], v233 offset:51200
    v_mfma_f32_16x16x32_bf16 v[148:151], a[80:83], a[32:35], 0
    v_exp_f32 v141, v141
    v_mfma_f32_16x16x32_bf16 v[148:151], a[84:87], a[36:39], v[148:151]
    ds_read_b128 a[140:143], v233 offset:52224
    v_cvt_pk_bf16_f32 v166, v140, v141
    v_mfma_f32_16x16x32_bf16 v[148:151], a[88:91], a[40:43], v[148:151]
    v_exp_f32 v142, v142
    v_mfma_f32_16x16x32_bf16 v[148:151], a[92:95], a[44:47], v[148:151]
    v_mfma_f32_16x16x32_bf16 v[152:155], a[64:67], a[48:51], 0
    v_exp_f32 v143, v143
    v_mfma_f32_16x16x32_bf16 v[152:155], a[68:71], a[52:55], v[152:155]
    ds_read_b128 a[144:147], v233 offset:53248
    v_cvt_pk_bf16_f32 v167, v142, v143
    v_mfma_f32_16x16x32_bf16 v[152:155], a[72:75], a[56:59], v[152:155]
    v_mfma_f32_16x16x32_bf16 v[152:155], a[76:79], a[60:63], v[152:155]
    ds_read_b128 a[148:151], v233 offset:54272
    ds_read_b128 a[152:155], v233 offset:55296
    v_mfma_f32_16x16x32_bf16 v[156:159], a[80:83], a[48:51], 0
    v_exp_f32 v144, v144
    v_mfma_f32_16x16x32_bf16 v[156:159], a[84:87], a[52:55], v[156:159]
    v_mfma_f32_16x16x32_bf16 v[156:159], a[88:91], a[56:59], v[156:159]
    s_waitcnt lgkmcnt(7)
    v_exp_f32 v145, v145
    v_mfma_f32_16x16x32_bf16 v[156:159], a[92:95], a[60:63], v[156:159]
    ds_read_b128 a[156:159], v233 offset:56320
    v_cvt_pk_bf16_f32 v168, v144, v145
    v_mfma_f32_16x16x32_bf16 v[64:67], a[160:163], v[160:163], v[64:67]
    v_exp_f32 v146, v146
    v_mfma_f32_16x16x32_bf16 v[96:99], a[160:163], v[164:167], v[96:99]
    s_waitcnt vmcnt(8)
    s_barrier
    v_mfma_f32_16x16x32_bf16 v[68:71], a[164:167], v[160:163], v[68:71]
    s_mov_b32 m0, s29
    v_exp_f32 v147, v147
    v_mfma_f32_16x16x32_bf16 v[100:103], a[164:167], v[164:167], v[100:103]
    ds_read_b128 a[96:99], v234 offset:40960
    v_cvt_pk_bf16_f32 v169, v146, v147
    v_mfma_f32_16x16x32_bf16 v[72:75], a[168:171], v[160:163], v[72:75]
    s_add_u32 s29, s29, 32768
    v_exp_f32 v148, v148
    v_mfma_f32_16x16x32_bf16 v[104:107], a[168:171], v[164:167], v[104:107]
    ds_read_b128 a[100:103], v234 offset:41984
    ds_read_b128 a[104:107], v234 offset:43008
    v_mfma_f32_16x16x32_bf16 v[76:79], a[172:175], v[160:163], v[76:79]
    v_exp_f32 v149, v149
    v_mfma_f32_16x16x32_bf16 v[108:111], a[172:175], v[164:167], v[108:111]
    ds_read_b128 a[108:111], v234 offset:44032
    v_cvt_pk_bf16_f32 v170, v148, v149
    v_mfma_f32_16x16x32_bf16 v[80:83], a[176:179], v[160:163], v[80:83]
    v_exp_f32 v150, v150
    v_mfma_f32_16x16x32_bf16 v[112:115], a[176:179], v[164:167], v[112:115]
    buffer_load_dwordx4 v232, s[64:67], s28 offen offset:0 sc1 lds
    v_mfma_f32_16x16x32_bf16 v[84:87], a[180:183], v[160:163], v[84:87]
    s_and_b32 s29, s29, 0x1ffff
    v_exp_f32 v151, v151
    v_mfma_f32_16x16x32_bf16 v[116:119], a[180:183], v[164:167], v[116:119]
    ds_read_b128 a[112:115], v234 offset:45056
    v_cvt_pk_bf16_f32 v171, v150, v151
    v_mfma_f32_16x16x32_bf16 v[88:91], a[184:187], v[160:163], v[88:91]
    v_exp_f32 v152, v152
    v_mfma_f32_16x16x32_bf16 v[120:123], a[184:187], v[164:167], v[120:123]
    ds_read_b128 a[116:119], v234 offset:46080
    ds_read_b128 a[120:123], v234 offset:47104
    v_mfma_f32_16x16x32_bf16 v[92:95], a[188:191], v[160:163], v[92:95]
    v_exp_f32 v153, v153
    v_mfma_f32_16x16x32_bf16 v[124:127], a[188:191], v[164:167], v[124:127]
    ds_read_b128 a[124:127], v234 offset:48128
    v_cvt_pk_bf16_f32 v172, v152, v153
    v_xor_b32 v233, 0x10000, v233
    v_mfma_f32_16x16x32_bf16 v[200:203], v[208:211], v[160:163], v[200:203]
    s_waitcnt lgkmcnt(8)
    v_exp_f32 v154, v154
    v_mfma_f32_16x16x32_bf16 v[204:207], v[208:211], v[164:167], v[204:207]
    buffer_load_dwordx4 v232, s[64:67], s28 offen offset:1024 sc1 lds
    v_mfma_f32_16x16x32_bf16 v[128:131], a[128:131], a[32:35], 0
    s_add_u32 s42, s28, 4096
    v_exp_f32 v155, v155
    v_mfma_f32_16x16x32_bf16 v[128:131], a[132:135], a[36:39], v[128:131]
    ds_read_b128 a[64:67], v233 offset:0
    v_cvt_pk_bf16_f32 v173, v154, v155
    v_mfma_f32_16x16x32_bf16 v[128:131], a[136:139], a[40:43], v[128:131]
    v_exp_f32 v156, v156
    v_mfma_f32_16x16x32_bf16 v[128:131], a[140:143], a[44:47], v[128:131]
    ds_read_b128 a[68:71], v233 offset:1024
    ds_read_b128 a[72:75], v233 offset:2048
    v_mfma_f32_16x16x32_bf16 v[132:135], a[144:147], a[32:35], 0
    v_exp_f32 v157, v157
    v_mfma_f32_16x16x32_bf16 v[132:135], a[148:151], a[36:39], v[132:135]
    ds_read_b128 a[76:79], v233 offset:3072
    v_cvt_pk_bf16_f32 v174, v156, v157
    v_mfma_f32_16x16x32_bf16 v[132:135], a[152:155], a[40:43], v[132:135]
    v_exp_f32 v158, v158
    v_mfma_f32_16x16x32_bf16 v[132:135], a[156:159], a[44:47], v[132:135]
    buffer_load_dwordx4 v232, s[64:67], s28 offen offset:2048 sc1 lds
    v_mfma_f32_16x16x32_bf16 v[136:139], a[128:131], a[48:51], 0
    v_exp_f32 v159, v159
    v_mfma_f32_16x16x32_bf16 v[136:139], a[132:135], a[52:55], v[136:139]
    ds_read_b128 a[80:83], v233 offset:4096
    v_cvt_pk_bf16_f32 v175, v158, v159
    v_mfma_f32_16x16x32_bf16 v[136:139], a[136:139], a[56:59], v[136:139]
    buffer_load_dwordx4 v232, s[64:67], s28 offen offset:3072 sc1 lds
    v_mfma_f32_16x16x32_bf16 v[136:139], a[140:143], a[60:63], v[136:139]
    ds_read_b128 a[84:87], v233 offset:5120
    ds_read_b128 a[88:91], v233 offset:6144
    v_mfma_f32_16x16x32_bf16 v[140:143], a[144:147], a[48:51], 0
    s_add_u32 m0, m0, 4096
    v_exp_f32 v128, v128
    v_mfma_f32_16x16x32_bf16 v[140:143], a[148:151], a[52:55], v[140:143]
    buffer_load_dwordx4 v232, s[64:67], s42 offen offset:0 sc1 lds
    v_mfma_f32_16x16x32_bf16 v[140:143], a[152:155], a[56:59], v[140:143]
    s_waitcnt lgkmcnt(7)
    v_exp_f32 v129, v129
    v_mfma_f32_16x16x32_bf16 v[140:143], a[156:159], a[60:63], v[140:143]
    ds_read_b128 a[92:95], v233 offset:7168
    v_cvt_pk_bf16_f32 v160, v128, v129
    v_mfma_f32_16x16x32_bf16 v[64:67], a[96:99], v[168:171], v[64:67]
    s_add_u32 s28, s28, 32768
    v_exp_f32 v130, v130
    v_mfma_f32_16x16x32_bf16 v[96:99], a[96:99], v[172:175], v[96:99]
    buffer_load_dwordx4 v232, s[64:67], s42 offen offset:1024 sc1 lds
    v_mfma_f32_16x16x32_bf16 v[68:71], a[100:103], v[168:171], v[68:71]
    v_exp_f32 v131, v131
    v_mfma_f32_16x16x32_bf16 v[100:103], a[100:103], v[172:175], v[100:103]
    ds_read_b128 a[160:163], v234 offset:57344
    v_cvt_pk_bf16_f32 v161, v130, v131
    v_mfma_f32_16x16x32_bf16 v[72:75], a[104:107], v[168:171], v[72:75]
    v_exp_f32 v132, v132
    v_mfma_f32_16x16x32_bf16 v[104:107], a[104:107], v[172:175], v[104:107]
    ds_read_b128 a[164:167], v234 offset:58368
    ds_read_b128 a[168:171], v234 offset:59392
    v_mfma_f32_16x16x32_bf16 v[76:79], a[108:111], v[168:171], v[76:79]
    v_exp_f32 v133, v133
    v_mfma_f32_16x16x32_bf16 v[108:111], a[108:111], v[172:175], v[108:111]
    ds_read_b128 a[172:175], v234 offset:60416
    v_cvt_pk_bf16_f32 v162, v132, v133
    v_mfma_f32_16x16x32_bf16 v[80:83], a[112:115], v[168:171], v[80:83]
    v_exp_f32 v134, v134
    v_mfma_f32_16x16x32_bf16 v[112:115], a[112:115], v[172:175], v[112:115]
    buffer_load_dwordx4 v232, s[64:67], s42 offen offset:2048 sc1 lds
    v_mfma_f32_16x16x32_bf16 v[84:87], a[116:119], v[168:171], v[84:87]
    v_exp_f32 v135, v135
    v_mfma_f32_16x16x32_bf16 v[116:119], a[116:119], v[172:175], v[116:119]
    ds_read_b128 a[176:179], v234 offset:61440
    v_cvt_pk_bf16_f32 v163, v134, v135
    v_mfma_f32_16x16x32_bf16 v[88:91], a[120:123], v[168:171], v[88:91]
    s_sub_u32 s27, s27, 1
    v_exp_f32 v136, v136
    v_mfma_f32_16x16x32_bf16 v[120:123], a[120:123], v[172:175], v[120:123]
    ds_read_b128 a[180:183], v234 offset:62464
    ds_read_b128 a[184:187], v234 offset:63488
    v_mfma_f32_16x16x32_bf16 v[92:95], a[124:127], v[168:171], v[92:95]
    s_cmp_lg_u32 s27, 0
    v_exp_f32 v137, v137
    v_mfma_f32_16x16x32_bf16 v[124:127], a[124:127], v[172:175], v[124:127]
    ds_read_b128 a[188:191], v234 offset:64512
    v_cvt_pk_bf16_f32 v164, v136, v137
    v_mfma_f32_16x16x32_bf16 v[200:203], v[208:211], v[168:171], v[200:203]
    s_waitcnt lgkmcnt(8)
    v_exp_f32 v138, v138
    v_mfma_f32_16x16x32_bf16 v[204:207], v[208:211], v[172:175], v[204:207]
    buffer_load_dwordx4 v232, s[64:67], s42 offen offset:3072 sc1 lds
    s_cbranch_scc1 KB_L2
KB_D2:
    s_cmp_gt_u32 s3, 0
    s_cselect_b32 s30, 0, 0xff800000
    s_cmp_eq_u32 s3, 0
    s_cselect_b64 vcc, -1, 0
    v_mov_b32 v179, s30
    v_cndmask_b32 v176, v179, v188, vcc
    v_cndmask_b32 v177, v179, v189, vcc
    v_cndmask_b32 v178, v179, v190, vcc
    v_cndmask_b32 v179, v179, v191, vcc
    s_cmp_gt_u32 s3, 1
    s_cselect_b32 s30, 0, 0xff800000
    s_cmp_eq_u32 s3, 1
    s_cselect_b64 vcc, -1, 0
    v_mov_b32 v183, s30
    v_cndmask_b32 v180, v183, v188, vcc
    v_cndmask_b32 v181, v183, v189, vcc
    v_cndmask_b32 v182, v183, v190, vcc
    v_cndmask_b32 v183, v183, v191, vcc
    s_nop 1
    v_mfma_f32_16x16x32_bf16 v[144:147], a[64:67], a[32:35], v[176:179]
    v_exp_f32 v139, v139
    v_mfma_f32_16x16x32_bf16 v[144:147], a[68:71], a[36:39], v[144:147]
    ds_read_b128 a[128:131], v233 offset:16384
    v_cvt_pk_bf16_f32 v165, v138, v139
    v_mfma_f32_16x16x32_bf16 v[144:147], a[72:75], a[40:43], v[144:147]
    s_cmp_gt_u32 s3, 2
    v_exp_f32 v140, v140
    v_mfma_f32_16x16x32_bf16 v[144:147], a[76:79], a[44:47], v[144:147]
    ds_read_b128 a[132:135], v233 offset:17408
    ds_read_b128 a[136:139], v233 offset:18432
    v_mfma_f32_16x16x32_bf16 v[148:151], a[80:83], a[32:35], v[180:183]
    s_cselect_b32 s30, 0, 0xff800000
    s_cmp_eq_u32 s3, 2
    v_exp_f32 v141, v141
    v_mfma_f32_16x16x32_bf16 v[148:151], a[84:87], a[36:39], v[148:151]
    ds_read_b128 a[140:143], v233 offset:19456
    v_cvt_pk_bf16_f32 v166, v140, v141
    v_mfma_f32_16x16x32_bf16 v[148:151], a[88:91], a[40:43], v[148:151]
    s_cselect_b64 vcc, -1, 0
    v_exp_f32 v142, v142
    v_mfma_f32_16x16x32_bf16 v[148:151], a[92:95], a[44:47], v[148:151]
    v_mov_b32 v179, s30
    v_cndmask_b32 v176, v179, v188, vcc
    v_mfma_f32_16x16x32_bf16 v[152:155], a[64:67], a[48:51], 0
    v_exp_f32 v143, v143
    v_mfma_f32_16x16x32_bf16 v[152:155], a[68:71], a[52:55], v[152:155]
    ds_read_b128 a[144:147], v233 offset:20480
    v_cvt_pk_bf16_f32 v167, v142, v143
    v_cndmask_b32 v177, v179, v189, vcc
    v_mfma_f32_16x16x32_bf16 v[152:155], a[72:75], a[56:59], v[152:155]
    v_xor_b32 v234, 0x10000, v234
    v_cndmask_b32 v178, v179, v190, vcc
    v_mfma_f32_16x16x32_bf16 v[152:155], a[76:79], a[60:63], v[152:155]
    ds_read_b128 a[148:151], v233 offset:21504
    ds_read_b128 a[152:155], v233 offset:22528
    v_mfma_f32_16x16x32_bf16 v[156:159], a[80:83], a[48:51], 0
    v_exp_f32 v144, v144
    v_mfma_f32_16x16x32_bf16 v[156:159], a[84:87], a[52:55], v[156:159]
    v_cndmask_b32 v179, v179, v191, vcc
    v_and_b32 v246, 31, v235
    v_mfma_f32_16x16x32_bf16 v[156:159], a[88:91], a[56:59], v[156:159]
    s_waitcnt lgkmcnt(7)
    s_cmp_gt_u32 s3, 3
    v_exp_f32 v145, v145
    v_mfma_f32_16x16x32_bf16 v[156:159], a[92:95], a[60:63], v[156:159]
    ds_read_b128 a[156:159], v233 offset:23552
    v_cvt_pk_bf16_f32 v168, v144, v145
    v_mfma_f32_16x16x32_bf16 v[64:67], a[160:163], v[160:163], v[64:67]
    s_cselect_b32 s30, 0, 0xff800000
    s_cmp_eq_u32 s3, 3
    v_exp_f32 v146, v146
    v_mfma_f32_16x16x32_bf16 v[96:99], a[160:163], v[164:167], v[96:99]
    s_waitcnt vmcnt(8)
    s_barrier
    v_mfma_f32_16x16x32_bf16 v[68:71], a[164:167], v[160:163], v[68:71]
    s_cselect_b64 vcc, -1, 0
    v_exp_f32 v147, v147
    v_mfma_f32_16x16x32_bf16 v[100:103], a[164:167], v[164:167], v[100:103]
    ds_read_b128 a[96:99], v234 offset:8192
    v_cvt_pk_bf16_f32 v169, v146, v147
    v_mov_b32 v183, s30
    v_mfma_f32_16x16x32_bf16 v[72:75], a[168:171], v[160:163], v[72:75]
    s_mov_b32 m0, s56
    v_exp_f32 v148, v148
    v_mfma_f32_16x16x32_bf16 v[104:107], a[168:171], v[164:167], v[104:107]
    buffer_load_dwordx4 v232, s[48:51], s54 offen offset:0 sc1 lds
    ds_read_b128 a[100:103], v234 offset:9216
    ds_read_b128 a[104:107], v234 offset:10240
    v_lshlrev_b32 v246, 2, v246
    v_mfma_f32_16x16x32_bf16 v[76:79], a[172:175], v[160:163], v[76:79]
    v_exp_f32 v149, v149
    v_mfma_f32_16x16x32_bf16 v[108:111], a[172:175], v[164:167], v[108:111]
    ds_read_b128 a[108:111], v234 offset:11264
    v_cvt_pk_bf16_f32 v170, v148, v149
    v_cndmask_b32 v180, v183, v188, vcc
    v_mfma_f32_16x16x32_bf16 v[80:83], a[176:179], v[160:163], v[80:83]
    v_exp_f32 v150, v150
    v_mfma_f32_16x16x32_bf16 v[112:115], a[176:179], v[164:167], v[112:115]
    buffer_load_dwordx4 v232, s[48:51], s54 offen offset:1024 sc1 lds
    v_cndmask_b32 v181, v183, v189, vcc
    v_cndmask_b32 v182, v183, v190, vcc
    v_mfma_f32_16x16x32_bf16 v[84:87], a[180:183], v[160:163], v[84:87]
    v_exp_f32 v151, v151
    v_mfma_f32_16x16x32_bf16 v[116:119], a[180:183], v[164:167], v[116:119]
    ds_read_b128 a[112:115], v234 offset:12288
    v_cvt_pk_bf16_f32 v171, v150, v151
    v_cndmask_b32 v183, v183, v191, vcc
    v_mfma_f32_16x16x32_bf16 v[88:91], a[184:187], v[160:163], v[88:91]
    s_cmp_lt_u32 s3, 3
    s_cselect_b32 s30, 0, 0xff800000
    v_exp_f32 v152, v152
    v_mfma_f32_16x16x32_bf16 v[120:123], a[184:187], v[164:167], v[120:123]
    buffer_load_dwordx4 v232, s[48:51], s54 offen offset:2048 sc1 lds
    ds_read_b128 a[116:119], v234 offset:13312
    ds_read_b128 a[120:123], v234 offset:14336
    v_mfma_f32_16x16x32_bf16 v[92:95], a[188:191], v[160:163], v[92:95]
    s_cmp_eq_u32 s3, 3
    s_cselect_b64 vcc, -1, 0
    v_exp_f32 v153, v153
    v_mfma_f32_16x16x32_bf16 v[124:127], a[188:191], v[164:167], v[124:127]
    ds_read_b128 a[124:127], v234 offset:15360
    v_cvt_pk_bf16_f32 v172, v152, v153
    v_mov_b32 v187, s30
    v_mfma_f32_16x16x32_bf16 v[200:203], v[208:211], v[160:163], v[200:203]
    s_waitcnt lgkmcnt(8)
    v_exp_f32 v154, v154
    v_mfma_f32_16x16x32_bf16 v[204:207], v[208:211], v[164:167], v[204:207]
    buffer_load_dwordx4 v232, s[48:51], s54 offen offset:3072 sc1 lds
    v_cndmask_b32 v184, v187, v188, vcc
    v_cndmask_b32 v185, v187, v189, vcc
    v_mfma_f32_16x16x32_bf16 v[128:131], a[128:131], a[32:35], v[176:179]
    v_exp_f32 v155, v155
    v_mfma_f32_16x16x32_bf16 v[128:131], a[132:135], a[36:39], v[128:131]
    ds_read_b128 a[64:67], v233 offset:32768
    v_cvt_pk_bf16_f32 v173, v154, v155
    v_cndmask_b32 v186, v187, v190, vcc
    v_mfma_f32_16x16x32_bf16 v[128:131], a[136:139], a[40:43], v[128:131]
    s_add_u32 m0, m0, 4096
    s_add_u32 s54, s54, 4096
    v_exp_f32 v156, v156
    v_mfma_f32_16x16x32_bf16 v[128:131], a[140:143], a[44:47], v[128:131]
    buffer_load_dwordx4 v232, s[48:51], s54 offen offset:0 sc1 lds
    ds_read_b128 a[68:71], v233 offset:33792
    ds_read_b128 a[72:75], v233 offset:34816
    v_mfma_f32_16x16x32_bf16 v[132:135], a[144:147], a[32:35], v[180:183]
    v_exp_f32 v157, v157
    v_mfma_f32_16x16x32_bf16 v[132:135], a[148:151], a[36:39], v[132:135]
    ds_read_b128 a[76:79], v233 offset:35840
    v_cvt_pk_bf16_f32 v174, v156, v157
    v_cndmask_b32 v187, v187, v191, vcc
    v_mfma_f32_16x16x32_bf16 v[132:135], a[152:155], a[40:43], v[132:135]
    s_cmp_lt_u32 s3, 2
    v_exp_f32 v158, v158
    v_mfma_f32_16x16x32_bf16 v[132:135], a[156:159], a[44:47], v[132:135]
    buffer_load_dwordx4 v232, s[48:51], s54 offen offset:1024 sc1 lds
    ds_read_b128 a[80:83], v233 offset:36864
    ds_read_b128 a[84:87], v233 offset:37888
    v_mfma_f32_16x16x32_bf16 v[136:139], a[128:131], a[48:51], 0
    s_cselect_b32 s30, 0, 0xff800000
    s_cmp_eq_u32 s3, 2
    v_exp_f32 v159, v159
    v_mfma_f32_16x16x32_bf16 v[136:139], a[132:135], a[52:55], v[136:139]
    ds_read_b128 a[88:91], v233 offset:38912
    v_cvt_pk_bf16_f32 v175, v158, v159
    v_mfma_f32_16x16x32_bf16 v[136:139], a[136:139], a[56:59], v[136:139]
    ds_read_b128 a[92:95], v233 offset:39936
    v_mfma_f32_16x16x32_bf16 v[136:139], a[140:143], a[60:63], v[136:139]
    buffer_load_dwordx4 v232, s[48:51], s54 offen offset:2048 sc1 lds
    ds_read_b128 a[128:131], v233 offset:49152
    ds_read_b128 a[132:135], v233 offset:50176
    v_mfma_f32_16x16x32_bf16 v[140:143], a[144:147], a[48:51], 0
    s_cselect_b64 vcc, -1, 0
    v_exp_f32 v128, v128
    v_mfma_f32_16x16x32_bf16 v[140:143], a[148:151], a[52:55], v[140:143]
    ds_read_b128 a[136:139], v233 offset:51200
    ds_read_b128 a[140:143], v233 offset:52224
    v_mfma_f32_16x16x32_bf16 v[140:143], a[152:155], a[56:59], v[140:143]
    s_waitcnt lgkmcnt(12)
    v_exp_f32 v129, v129
    v_mfma_f32_16x16x32_bf16 v[140:143], a[156:159], a[60:63], v[140:143]
    buffer_load_dwordx4 v232, s[48:51], s54 offen offset:3072 sc1 lds
    ds_read_b128 a[144:147], v233 offset:53248
    v_cvt_pk_bf16_f32 v160, v128, v129
    v_mov_b32 v223, s30
    v_mfma_f32_16x16x32_bf16 v[64:67], a[96:99], v[168:171], v[64:67]
    v_exp_f32 v130, v130
    v_mfma_f32_16x16x32_bf16 v[96:99], a[96:99], v[172:175], v[96:99]
    ds_read_b128 a[148:151], v233 offset:54272
    ds_read_b128 a[152:155], v233 offset:55296
    v_mfma_f32_16x16x32_bf16 v[68:71], a[100:103], v[168:171], v[68:71]
    s_add_u32 s54, s54, 4096
    v_exp_f32 v131, v131
    v_mfma_f32_16x16x32_bf16 v[100:103], a[100:103], v[172:175], v[100:103]
    buffer_load_dwordx4 v[0:3], v232, s[44:47], s58 offen offset:0 sc1
    ds_read_b128 a[156:159], v233 offset:56320
    v_cvt_pk_bf16_f32 v161, v130, v131
    v_cndmask_b32 v220, v223, v188, vcc
    v_mfma_f32_16x16x32_bf16 v[72:75], a[104:107], v[168:171], v[72:75]
    v_exp_f32 v132, v132
    v_mfma_f32_16x16x32_bf16 v[104:107], a[104:107], v[172:175], v[104:107]
    ds_read_b128 a[160:163], v234 offset:24576
    ds_read_b128 a[164:167], v234 offset:25600
    v_mfma_f32_16x16x32_bf16 v[76:79], a[108:111], v[168:171], v[76:79]
    v_exp_f32 v133, v133
    v_mfma_f32_16x16x32_bf16 v[108:111], a[108:111], v[172:175], v[108:111]
    buffer_load_dwordx4 v[4:7], v232, s[44:47], s58 offen offset:1024 sc1
    ds_read_b128 a[168:171], v234 offset:26624
    v_cvt_pk_bf16_f32 v162, v132, v133
    v_cndmask_b32 v221, v223, v189, vcc
    v_cndmask_b32 v222, v223, v190, vcc
    v_mfma_f32_16x16x32_bf16 v[80:83], a[112:115], v[168:171], v[80:83]
    v_exp_f32 v134, v134
    v_mfma_f32_16x16x32_bf16 v[112:115], a[112:115], v[172:175], v[112:115]
    ds_read_b128 a[172:175], v234 offset:27648
    ds_read_b128 a[176:179], v234 offset:28672
    v_mfma_f32_16x16x32_bf16 v[84:87], a[116:119], v[168:171], v[84:87]
    v_exp_f32 v135, v135
    v_mfma_f32_16x16x32_bf16 v[116:119], a[116:119], v[172:175], v[116:119]
    buffer_load_dwordx4 v[8:11], v232, s[44:47], s58 offen offset:2048 sc1
    ds_read_b128 a[180:183], v234 offset:29696
    v_cvt_pk_bf16_f32 v163, v134, v135
    v_cndmask_b32 v223, v223, v191, vcc
    v_mfma_f32_16x16x32_bf16 v[88:91], a[120:123], v[168:171], v[88:91]
    s_cmp_lt_u32 s3, 1
    s_cselect_b32 s30, 0, 0xff800000
    v_exp_f32 v136, v136
    v_mfma_f32_16x16x32_bf16 v[120:123], a[120:123], v[172:175], v[120:123]
    ds_read_b128 a[184:187], v234 offset:30720
    ds_read_b128 a[188:191], v234 offset:31744
    v_mfma_f32_16x16x32_bf16 v[92:95], a[124:127], v[168:171], v[92:95]
    s_cmp_eq_u32 s3, 1
    s_cselect_b64 vcc, -1, 0
    v_exp_f32 v137, v137
    v_mfma_f32_16x16x32_bf16 v[124:127], a[124:127], v[172:175], v[124:127]
    buffer_load_dwordx4 v[12:15], v232, s[44:47], s58 offen offset:3072 sc1
    v_cvt_pk_bf16_f32 v164, v136, v137
    v_mov_b32 v179, s30
    v_mfma_f32_16x16x32_bf16 v[200:203], v[208:211], v[168:171], v[200:203]
    s_waitcnt lgkmcnt(8)
    v_exp_f32 v138, v138
    v_mfma_f32_16x16x32_bf16 v[204:207], v[208:211], v[172:175], v[204:207]
    v_cndmask_b32 v176, v179, v188, vcc
    v_cndmask_b32 v177, v179, v189, vcc
    v_mfma_f32_16x16x32_bf16 v[144:147], a[64:67], a[48:51], v[184:187]
    v_exp_f32 v139, v139
    v_mfma_f32_16x16x32_bf16 v[144:147], a[68:71], a[52:55], v[144:147]
    buffer_load_dwordx4 v[16:19], v232, s[44:47], s59 offen offset:0 sc1
    ds_read_b128 a[96:99], v234 offset:40960
    v_cvt_pk_bf16_f32 v165, v138, v139
    v_cndmask_b32 v178, v179, v190, vcc
    v_mfma_f32_16x16x32_bf16 v[144:147], a[72:75], a[56:59], v[144:147]
    v_exp_f32 v140, v140
    v_mfma_f32_16x16x32_bf16 v[144:147], a[76:79], a[60:63], v[144:147]
    ds_read_b128 a[100:103], v234 offset:41984
    ds_read_b128 a[104:107], v234 offset:43008
    v_cndmask_b32 v179, v179, v191, vcc
    v_mfma_f32_16x16x32_bf16 v[148:151], a[80:83], a[48:51], v[220:223]
    s_cmp_lt_u32 s3, 0
    s_cselect_b32 s30, 0, 0xff800000
    s_cmp_eq_u32 s3, 0
    s_cselect_b64 vcc, -1, 0
    v_exp_f32 v141, v141
    v_mfma_f32_16x16x32_bf16 v[148:151], a[84:87], a[52:55], v[148:151]
    buffer_load_dwordx4 v[20:23], v232, s[44:47], s59 offen offset:1024 sc1
    ds_read_b128 a[108:111], v234 offset:44032
    v_cvt_pk_bf16_f32 v166, v140, v141
    v_mov_b32 v183, s30
    v_mfma_f32_16x16x32_bf16 v[148:151], a[88:91], a[56:59], v[148:151]
    v_exp_f32 v142, v142
    v_mfma_f32_16x16x32_bf16 v[148:151], a[92:95], a[60:63], v[148:151]
    v_cndmask_b32 v180, v183, v188, vcc
    v_cndmask_b32 v181, v183, v189, vcc
    v_mfma_f32_16x16x32_bf16 v[152:155], a[128:131], a[48:51], v[176:179]
    v_exp_f32 v143, v143
    v_mfma_f32_16x16x32_bf16 v[152:155], a[132:135], a[52:55], v[152:155]
    buffer_load_dwordx4 v[24:27], v232, s[44:47], s59 offen offset:2048 sc1
    ds_read_b128 a[112:115], v234 offset:45056
    v_cvt_pk_bf16_f32 v167, v142, v143
    v_cndmask_b32 v182, v183, v190, vcc
    v_mfma_f32_16x16x32_bf16 v[152:155], a[136:139], a[56:59], v[152:155]
    v_cndmask_b32 v183, v183, v191, vcc
    v_mfma_f32_16x16x32_bf16 v[152:155], a[140:143], a[60:63], v[152:155]
    ds_read_b128 a[116:119], v234 offset:46080
    ds_read_b128 a[120:123], v234 offset:47104
    v_mfma_f32_16x16x32_bf16 v[156:159], a[144:147], a[48:51], v[180:183]
    v_exp_f32 v144, v144
    v_mfma_f32_16x16x32_bf16 v[156:159], a[148:151], a[52:55], v[156:159]
    buffer_load_dwordx4 v[28:31], v232, s[44:47], s59 offen offset:3072 sc1
    v_mfma_f32_16x16x32_bf16 v[156:159], a[152:155], a[56:59], v[156:159]
    s_waitcnt lgkmcnt(7)
    v_exp_f32 v145, v145
    v_mfma_f32_16x16x32_bf16 v[156:159], a[156:159], a[60:63], v[156:159]
    ds_read_b128 a[124:127], v234 offset:48128
    v_cvt_pk_bf16_f32 v168, v144, v145
    v_mfma_f32_16x16x32_bf16 v[64:67], a[160:163], v[160:163], v[64:67]
    v_exp_f32 v146, v146
    v_mfma_f32_16x16x32_bf16 v[96:99], a[160:163], v[164:167], v[96:99]
    buffer_load_dword v244, v246, s[44:47], s62 offen offset:0 sc1
    ds_read_b128 a[160:163], v234 offset:57344
    v_mfma_f32_16x16x32_bf16 v[68:71], a[164:167], v[160:163], v[68:71]
    v_exp_f32 v147, v147
    v_mfma_f32_16x16x32_bf16 v[100:103], a[164:167], v[164:167], v[100:103]
    ds_read_b128 a[164:167], v234 offset:58368
    v_cvt_pk_bf16_f32 v169, v146, v147
    v_mfma_f32_16x16x32_bf16 v[72:75], a[168:171], v[160:163], v[72:75]
    v_exp_f32 v148, v148
    v_mfma_f32_16x16x32_bf16 v[104:107], a[168:171], v[164:167], v[104:107]
    buffer_load_dword v245, v246, s[44:47], s62 offen offset:128 sc1
    ds_read_b128 a[168:171], v234 offset:59392
    v_mfma_f32_16x16x32_bf16 v[76:79], a[172:175], v[160:163], v[76:79]
    v_exp_f32 v149, v149
    v_mfma_f32_16x16x32_bf16 v[108:111], a[172:175], v[164:167], v[108:111]
    ds_read_b128 a[172:175], v234 offset:60416
    v_cvt_pk_bf16_f32 v170, v148, v149
    v_mfma_f32_16x16x32_bf16 v[80:83], a[176:179], v[160:163], v[80:83]
    v_exp_f32 v150, v150
    v_mfma_f32_16x16x32_bf16 v[112:115], a[176:179], v[164:167], v[112:115]
    ds_read_b128 a[176:179], v234 offset:61440
    v_mfma_f32_16x16x32_bf16 v[84:87], a[180:183], v[160:163], v[84:87]
    v_exp_f32 v151, v151
    v_mfma_f32_16x16x32_bf16 v[116:119], a[180:183], v[164:167], v[116:119]
    ds_read_b128 a[180:183], v234 offset:62464
    v_cvt_pk_bf16_f32 v171, v150, v151
    v_mfma_f32_16x16x32_bf16 v[88:91], a[184:187], v[160:163], v[88:91]
    v_exp_f32 v152, v152
    v_mfma_f32_16x16x32_bf16 v[120:123], a[184:187], v[164:167], v[120:123]
    ds_read_b128 a[184:187], v234 offset:63488
    v_mfma_f32_16x16x32_bf16 v[92:95], a[188:191], v[160:163], v[92:95]
    v_exp_f32 v153, v153
    v_mfma_f32_16x16x32_bf16 v[124:127], a[188:191], v[164:167], v[124:127]
    ds_read_b128 a[188:191], v234 offset:64512
    v_cvt_pk_bf16_f32 v172, v152, v153
    v_mfma_f32_16x16x32_bf16 v[200:203], v[208:211], v[160:163], v[200:203]
    v_exp_f32 v154, v154
    v_mfma_f32_16x16x32_bf16 v[204:207], v[208:211], v[164:167], v[204:207]
    s_waitcnt lgkmcnt(8)
    v_mfma_f32_16x16x32_bf16 v[96:99], a[96:99], v[168:171], v[96:99]
    v_exp_f32 v155, v155
    v_mfma_f32_16x16x32_bf16 v[100:103], a[100:103], v[168:171], v[100:103]
    v_cvt_pk_bf16_f32 v173, v154, v155
    v_mfma_f32_16x16x32_bf16 v[104:107], a[104:107], v[168:171], v[104:107]
    v_exp_f32 v156, v156
    v_mfma_f32_16x16x32_bf16 v[108:111], a[108:111], v[168:171], v[108:111]
    v_exp_f32 v157, v157
    v_mfma_f32_16x16x32_bf16 v[112:115], a[112:115], v[168:171], v[112:115]
    v_cvt_pk_bf16_f32 v174, v156, v157
    v_mfma_f32_16x16x32_bf16 v[116:119], a[116:119], v[168:171], v[116:119]
    v_exp_f32 v158, v158
    v_mfma_f32_16x16x32_bf16 v[120:123], a[120:123], v[168:171], v[120:123]
    v_exp_f32 v159, v159
    v_mfma_f32_16x16x32_bf16 v[124:127], a[124:127], v[168:171], v[124:127]
    v_cvt_pk_bf16_f32 v175, v158, v159
    v_mfma_f32_16x16x32_bf16 v[204:207], v[208:211], v[168:171], v[204:207]
    s_waitcnt lgkmcnt(0)
    v_mfma_f32_16x16x32_bf16 v[96:99], a[160:163], v[172:175], v[96:99]
    v_mfma_f32_16x16x32_bf16 v[100:103], a[164:167], v[172:175], v[100:103]
    v_mfma_f32_16x16x32_bf16 v[104:107], a[168:171], v[172:175], v[104:107]
    v_mfma_f32_16x16x32_bf16 v[108:111], a[172:175], v[172:175], v[108:111]
    v_mfma_f32_16x16x32_bf16 v[112:115], a[176:179], v[172:175], v[112:115]
    v_mfma_f32_16x16x32_bf16 v[116:119], a[180:183], v[172:175], v[116:119]
    v_mfma_f32_16x16x32_bf16 v[120:123], a[184:187], v[172:175], v[120:123]
    v_mfma_f32_16x16x32_bf16 v[124:127], a[188:191], v[172:175], v[124:127]
    v_mfma_f32_16x16x32_bf16 v[204:207], v[208:211], v[172:175], v[204:207]
    s_nop 7
    v_mov_b32 v242, 0x2b800000
    v_mov_b32 v243, 0x71800000
    s_lshl_b32 s39, s26, 13
    s_add_u32 s31, s35, 0
    s_lshr_b32 s30, s31, 1
    s_lshl_b32 s30, s30, 10
    s_and_b32 s31, s31, 1
    s_add_u32 s30, s30, s31
    s_lshl_b32 s30, s30, 8
    s_add_u32 s30, s30, s39
    s_add_u32 s31, s30, 4096
    v_cmp_ngt_f32 vcc, v200, v242
    v_rcp_f32 v239, v200
    s_or_b64 s[40:41], s[40:41], vcc
    v_cmp_nlt_f32 vcc, v200, v243
    v_sub_f32 v238, 1.0, v230
    s_or_b64 s[40:41], s[40:41], vcc
    v_mul_f32 v238, v238, v239
    v_mul_f32 v64, v64, v238
    v_mul_f32 v65, v65, v238
    v_mul_f32 v66, v66, v238
    v_mul_f32 v67, v67, v238
    v_mul_f32 v68, v68, v238
    v_mul_f32 v69, v69, v238
    v_mul_f32 v70, v70, v238
    v_mul_f32 v71, v71, v238
    v_cvt_pk_bf16_f32 v220, v64, v65
    v_cvt_pk_bf16_f32 v221, v66, v67
    v_cvt_pk_bf16_f32 v222, v68, v69
    v_cvt_pk_bf16_f32 v223, v70, v71
    buffer_store_dwordx4 v[220:223], v236, s[20:23], s30 offen offset:0 sc1
    v_mul_f32 v72, v72, v238
    v_mul_f32 v73, v73, v238
    v_mul_f32 v74, v74, v238
    v_mul_f32 v75, v75, v238
    v_mul_f32 v76, v76, v238
    v_mul_f32 v77, v77, v238
    v_mul_f32 v78, v78, v238
    v_mul_f32 v79, v79, v238
    v_mfma_f32_16x16x32_bf16 v[216:219], v[212:215], v[220:223], 0
    v_cvt_pk_bf16_f32 v224, v72, v73
    v_cvt_pk_bf16_f32 v225, v74, v75
    v_cvt_pk_bf16_f32 v226, v76, v77
    v_cvt_pk_bf16_f32 v227, v78, v79
    buffer_store_dwordx4 v[224:227], v236, s[20:23], s30 offen offset:2048 sc1
    v_mul_f32 v80, v80, v238
    v_mul_f32 v81, v81, v238
    v_mul_f32 v82, v82, v238
    v_mul_f32 v83, v83, v238
    v_mul_f32 v84, v84, v238
    v_mul_f32 v85, v85, v238
    v_mul_f32 v86, v86, v238
    v_mul_f32 v87, v87, v238
    v_mfma_f32_16x16x32_bf16 v[216:219], v[212:215], v[224:227], v[216:219]
    v_cvt_pk_bf16_f32 v220, v80, v81
    v_cvt_pk_bf16_f32 v221, v82, v83
    v_cvt_pk_bf16_f32 v222, v84, v85
    v_cvt_pk_bf16_f32 v223, v86, v87
    buffer_store_dwordx4 v[220:223], v236, s[20:23], s31 offen offset:0 sc1
    v_mul_f32 v88, v88, v238
    v_mul_f32 v89, v89, v238
    v_mul_f32 v90, v90, v238
    v_mul_f32 v91, v91, v238
    v_mul_f32 v92, v92, v238
    v_mul_f32 v93, v93, v238
    v_mul_f32 v94, v94, v238
    v_mul_f32 v95, v95, v238
    v_mfma_f32_16x16x32_bf16 v[216:219], v[212:215], v[220:223], v[216:219]
    v_cvt_pk_bf16_f32 v224, v88, v89
    v_cvt_pk_bf16_f32 v225, v90, v91
    v_cvt_pk_bf16_f32 v226, v92, v93
    v_cvt_pk_bf16_f32 v227, v94, v95
    buffer_store_dwordx4 v[224:227], v236, s[20:23], s31 offen offset:2048 sc1
    s_add_u32 s31, s35, s43
    s_lshr_b32 s30, s31, 1
    s_lshl_b32 s30, s30, 10
    s_and_b32 s31, s31, 1
    s_add_u32 s30, s30, s31
    s_lshl_b32 s30, s30, 8
    s_add_u32 s30, s30, s39
    s_add_u32 s31, s30, 4096
    v_cmp_ngt_f32 vcc, v204, v242
    v_rcp_f32 v239, v204
    s_or_b64 s[40:41], s[40:41], vcc
    v_cmp_nlt_f32 vcc, v204, v243
    v_sub_f32 v238, 1.0, v231
    s_or_b64 s[40:41], s[40:41], vcc
    v_mul_f32 v238, v238, v239
    v_mul_f32 v96, v96, v238
    v_mul_f32 v97, v97, v238
    v_mul_f32 v98, v98, v238
    v_mul_f32 v99, v99, v238
    v_mul_f32 v100, v100, v238
    v_mul_f32 v101, v101, v238
    v_mul_f32 v102, v102, v238
    v_mul_f32 v103, v103, v238
    v_mfma_f32_16x16x32_bf16 v[216:219], v[212:215], v[224:227], v[216:219]
    v_cvt_pk_bf16_f32 v220, v96, v97
    v_cvt_pk_bf16_f32 v221, v98, v99
    v_cvt_pk_bf16_f32 v222, v100, v101
    v_cvt_pk_bf16_f32 v223, v102, v103
    buffer_store_dwordx4 v[220:223], v236, s[20:23], s30 offen offset:0 sc1
    v_mul_f32 v104, v104, v238
    v_mul_f32 v105, v105, v238
    v_mul_f32 v106, v106, v238
    v_mul_f32 v107, v107, v238
    v_mul_f32 v108, v108, v238
    v_mul_f32 v109, v109, v238
    v_mul_f32 v110, v110, v238
    v_mul_f32 v111, v111, v238
    v_mfma_f32_16x16x32_bf16 v[216:219], v[212:215], v[220:223], v[216:219]
    v_cvt_pk_bf16_f32 v224, v104, v105
    v_cvt_pk_bf16_f32 v225, v106, v107
    v_cvt_pk_bf16_f32 v226, v108, v109
    v_cvt_pk_bf16_f32 v227, v110, v111
    buffer_store_dwordx4 v[224:227], v236, s[20:23], s30 offen offset:2048 sc1
    v_mul_f32 v112, v112, v238
    v_mul_f32 v113, v113, v238
    v_mul_f32 v114, v114, v238
    v_mul_f32 v115, v115, v238
    v_mul_f32 v116, v116, v238
    v_mul_f32 v117, v117, v238
    v_mul_f32 v118, v118, v238
    v_mul_f32 v119, v119, v238
    v_mfma_f32_16x16x32_bf16 v[216:219], v[212:215], v[224:227], v[216:219]
    v_cvt_pk_bf16_f32 v220, v112, v113
    v_cvt_pk_bf16_f32 v221, v114, v115
    v_cvt_pk_bf16_f32 v222, v116, v117
    v_cvt_pk_bf16_f32 v223, v118, v119
    buffer_store_dwordx4 v[220:223], v236, s[20:23], s31 offen offset:0 sc1
    v_mul_f32 v120, v120, v238
    v_mul_f32 v121, v121, v238
    v_mul_f32 v122, v122, v238
    v_mul_f32 v123, v123, v238
    v_mul_f32 v124, v124, v238
    v_mul_f32 v125, v125, v238
    v_mul_f32 v126, v126, v238
    v_mul_f32 v127, v127, v238
    v_mfma_f32_16x16x32_bf16 v[216:219], v[212:215], v[220:223], v[216:219]
    v_cvt_pk_bf16_f32 v224, v120, v121
    v_cvt_pk_bf16_f32 v225, v122, v123
    v_cvt_pk_bf16_f32 v226, v124, v125
    v_cvt_pk_bf16_f32 v227, v126, v127
    buffer_store_dwordx4 v[224:227], v236, s[20:23], s31 offen offset:2048 sc1
    s_nop 0
    v_mfma_f32_16x16x32_bf16 v[216:219], v[212:215], v[224:227], v[216:219]
    s_nop 7
    v_cmp_u_f32 vcc, v216, v216
    s_nop 0
    s_or_b64 s[40:41], s[40:41], vcc
    s_cmp_lg_u64 s[40:41], 0
    s_cbranch_scc1 KB_FB
KB_END:
    s_mov_b32 s60, 0xffff
    s_mov_b32 s61, 0xffff
    v_and_b32 v246, 27, v235
    v_cmp_eq_u32 vcc, 16, v246
    v_mov_b32 v247, 0x3f803f80
    v_lshrrev_b32 v249, 5, v235
    v_and_b32 v246, 15, v235
    v_lshlrev_b32 v246, 4, v246
    v_lshl_add_u32 v246, v249, 8, v246
    s_add_u32 s30, s56, 1024
    v_add_u32 v241, s30, v246
    v_add_u32 v240, s56, v232
    v_cndmask_b32 v80, 0, v247, vcc
    v_cndmask_b32 v81, 0, v247, vcc
    v_cndmask_b32 v82, 0, v247, vcc
    v_cndmask_b32 v83, 0, v247, vcc
    v_cndmask_b32 v84, 0, v247, vcc
    v_cndmask_b32 v85, 0, v247, vcc
    v_cndmask_b32 v86, 0, v247, vcc
    v_cndmask_b32 v87, 0, v247, vcc
    v_cndmask_b32 v88, 0, v247, vcc
    v_cndmask_b32 v89, 0, v247, vcc
    v_cndmask_b32 v90, 0, v247, vcc
    v_cndmask_b32 v91, 0, v247, vcc
    v_cndmask_b32 v92, 0, v247, vcc
    v_cndmask_b32 v93, 0, v247, vcc
    v_cndmask_b32 v94, 0, v247, vcc
    v_cndmask_b32 v95, 0, v247, vcc
    v_mov_b32 v224, 0
    v_mov_b32 v225, 0
    v_mov_b32 v226, 0
    v_mov_b32 v227, 0
    s_waitcnt vmcnt(8)
    ds_read_b128 v[72:75], v240 offset:0
    s_mov_b64 exec, s[60:61]
    ds_read_b128 v[80:83], v241 offset:0
    ds_read_b128 v[84:87], v241 offset:512
    s_mov_b64 exec, -1
    v_mfma_f32_32x32x16_bf16 a[128:143], v[224:227], v[224:227], 0
    v_mfma_f32_32x32x16_bf16 a[144:159], v[224:227], v[224:227], 0
    v_mfma_f32_32x32x16_bf16 a[160:175], v[224:227], v[224:227], 0
    v_mfma_f32_32x32x16_bf16 a[176:191], v[224:227], v[224:227], 0
    s_waitcnt lgkmcnt(0)
    v_mfma_f32_32x32x16_bf16 v[32:47], v[72:75], v[0:3], 0
    s_add_u32 m0, s56, s55
    s_add_u32 s55, s55, 2048
    buffer_load_dwordx4 v232, s[48:51], s54 offen offset:0 sc1 lds
    buffer_load_dwordx4 v232, s[48:51], s54 offen offset:1024 sc1 lds
    s_and_b32 s55, s55, 0x1fff
    s_add_u32 s54, s54, 2048
    s_nop 5
    v_mfma_f32_32x32x16_bf16 v[48:63], v[72:75], v[4:7], 0
    s_and_b32 s30, s2, 7
    v_exp_f32 v32, v32
    v_exp_f32 v33, v33
    v_exp_f32 v34, v34
    v_exp_f32 v35, v35
    v_exp_f32 v36, v36
    v_exp_f32 v37, v37
    s_nop 0
    s_lshr_b32 s31, s2, 3
    v_cvt_pk_bf16_f32 v64, v32, v33
    v_cvt_pk_bf16_f32 v65, v34, v35
    v_exp_f32 v38, v38
    v_exp_f32 v39, v39
    v_cvt_pk_bf16_f32 v66, v36, v37
    v_cvt_pk_bf16_f32 v67, v38, v39
    v_exp_f32 v40, v40
    v_exp_f32 v41, v41
    v_mfma_f32_32x32x16_bf16 a[0:15], v[80:83], v[64:67], 0
    s_lshr_b32 s24, s30, 1
    v_exp_f32 v42, v42
    v_exp_f32 v43, v43
    v_cvt_pk_bf16_f32 v68, v40, v41
    v_cvt_pk_bf16_f32 v69, v42, v43
    v_exp_f32 v44, v44
    v_exp_f32 v45, v45
    v_exp_f32 v46, v46
    v_exp_f32 v47, v47
    v_cvt_pk_bf16_f32 v70, v44, v45
    v_cvt_pk_bf16_f32 v71, v46, v47
    v_mfma_f32_32x32x16_bf16 v[32:47], v[72:75], v[8:11], 0
    s_lshl_b32 s24, s24, 3
    v_exp_f32 v48, v48
    v_exp_f32 v49, v49
    v_exp_f32 v50, v50
    v_exp_f32 v51, v51
    v_exp_f32 v52, v52
    v_exp_f32 v53, v53
    v_mfma_f32_32x32x16_bf16 a[0:15], v[84:87], v[68:71], a[0:15]
    s_and_b32 s25, s31, 7
    v_cvt_pk_bf16_f32 v64, v48, v49
    v_cvt_pk_bf16_f32 v65, v50, v51
    v_exp_f32 v54, v54
    v_exp_f32 v55, v55
    v_cvt_pk_bf16_f32 v66, v52, v53
    v_cvt_pk_bf16_f32 v67, v54, v55
    v_exp_f32 v56, v56
    v_exp_f32 v57, v57
    v_mfma_f32_32x32x16_bf16 a[16:31], v[80:83], v[64:67], 0
    s_add_u32 s24, s24, s25
    v_exp_f32 v58, v58
    v_exp_f32 v59, v59
    v_cvt_pk_bf16_f32 v68, v56, v57
    v_cvt_pk_bf16_f32 v69, v58, v59
    v_exp_f32 v60, v60
    v_exp_f32 v61, v61
    v_exp_f32 v62, v62
    v_exp_f32 v63, v63
    v_cvt_pk_bf16_f32 v70, v60, v61
    v_cvt_pk_bf16_f32 v71, v62, v63
    v_mfma_f32_32x32x16_bf16 v[48:63], v[72:75], v[12:15], 0
    s_and_b32 s25, s30, 1
    v_exp_f32 v32, v32
    v_exp_f32 v33, v33
    v_exp_f32 v34, v34
    v_exp_f32 v35, v35
    v_exp_f32 v36, v36
    v_exp_f32 v37, v37
    v_mfma_f32_32x32x16_bf16 a[16:31], v[84:87], v[68:71], a[16:31]
    ds_read_b128 v[76:79], v240 offset:2048
    v_cvt_pk_bf16_f32 v64, v32, v33
    v_cvt_pk_bf16_f32 v65, v34, v35
    v_exp_f32 v38, v38
    v_exp_f32 v39, v39
    v_cvt_pk_bf16_f32 v66, v36, v37
    v_cvt_pk_bf16_f32 v67, v38, v39
    v_exp_f32 v40, v40
    v_exp_f32 v41, v41
    v_mfma_f32_32x32x16_bf16 a[32:47], v[80:83], v[64:67], 0
    s_lshl_b32 s25, s25, 2
    v_exp_f32 v42, v42
    v_exp_f32 v43, v43
    v_cvt_pk_bf16_f32 v68, v40, v41
    v_cvt_pk_bf16_f32 v69, v42, v43
    v_exp_f32 v44, v44
    v_exp_f32 v45, v45
    v_exp_f32 v46, v46
    v_exp_f32 v47, v47
    v_cvt_pk_bf16_f32 v70, v44, v45
    v_cvt_pk_bf16_f32 v71, v46, v47
    v_mfma_f32_32x32x16_bf16 v[32:47], v[72:75], v[16:19], 0
    s_mov_b64 exec, s[60:61]
    ds_read_b128 v[88:91], v241 offset:2048
    ds_read_b128 v[92:95], v241 offset:2560
    s_mov_b64 exec, -1
    v_exp_f32 v48, v48
    v_exp_f32 v49, v49
    v_exp_f32 v50, v50
    v_exp_f32 v51, v51
    v_exp_f32 v52, v52
    v_exp_f32 v53, v53
    v_mfma_f32_32x32x16_bf16 a[32:47], v[84:87], v[68:71], a[32:47]
    s_lshr_b32 s31, s31, 3
    v_cvt_pk_bf16_f32 v64, v48, v49
    v_cvt_pk_bf16_f32 v65, v50, v51
    v_exp_f32 v54, v54
    v_exp_f32 v55, v55
    v_cvt_pk_bf16_f32 v66, v52, v53
    v_cvt_pk_bf16_f32 v67, v54, v55
    v_exp_f32 v56, v56
    v_exp_f32 v57, v57
    v_mfma_f32_32x32x16_bf16 a[48:63], v[80:83], v[64:67], 0
    s_add_u32 s25, s25, s31
    v_exp_f32 v58, v58
    v_exp_f32 v59, v59
    v_cvt_pk_bf16_f32 v68, v56, v57
    v_cvt_pk_bf16_f32 v69, v58, v59
    v_exp_f32 v60, v60
    v_exp_f32 v61, v61
    v_exp_f32 v62, v62
    v_exp_f32 v63, v63
    v_cvt_pk_bf16_f32 v70, v60, v61
    v_cvt_pk_bf16_f32 v71, v62, v63
    v_mfma_f32_32x32x16_bf16 v[48:63], v[72:75], v[20:23], 0
    s_mov_b64 s[20:21], s[72:73]
    v_exp_f32 v32, v32
    v_exp_f32 v33, v33
    v_exp_f32 v34, v34
    v_exp_f32 v35, v35
    v_exp_f32 v36, v36
    v_exp_f32 v37, v37
    v_mfma_f32_32x32x16_bf16 a[48:63], v[84:87], v[68:71], a[48:63]
    s_mov_b32 s22, 0x200000
    v_cvt_pk_bf16_f32 v64, v32, v33
    v_cvt_pk_bf16_f32 v65, v34, v35
    v_exp_f32 v38, v38
    v_exp_f32 v39, v39
    v_cvt_pk_bf16_f32 v66, v36, v37
    v_cvt_pk_bf16_f32 v67, v38, v39
    v_exp_f32 v40, v40
    v_exp_f32 v41, v41
    v_mfma_f32_32x32x16_bf16 a[64:79], v[80:83], v[64:67], 0
    s_mov_b32 s23, 0x20000
    v_exp_f32 v42, v42
    v_exp_f32 v43, v43
    v_cvt_pk_bf16_f32 v68, v40, v41
    v_cvt_pk_bf16_f32 v69, v42, v43
    v_exp_f32 v44, v44
    v_exp_f32 v45, v45
    v_exp_f32 v46, v46
    v_exp_f32 v47, v47
    v_cvt_pk_bf16_f32 v70, v44, v45
    v_cvt_pk_bf16_f32 v71, v46, v47
    v_mfma_f32_32x32x16_bf16 v[32:47], v[72:75], v[24:27], 0
    s_lshl_b32 s38, s3, 15
    v_exp_f32 v48, v48
    v_exp_f32 v49, v49
    v_exp_f32 v50, v50
    v_exp_f32 v51, v51
    v_exp_f32 v52, v52
    v_exp_f32 v53, v53
    v_mfma_f32_32x32x16_bf16 a[64:79], v[84:87], v[68:71], a[64:79]
    s_waitcnt lgkmcnt(0)
    v_cvt_pk_bf16_f32 v64, v48, v49
    v_cvt_pk_bf16_f32 v65, v50, v51
    v_exp_f32 v54, v54
    v_exp_f32 v55, v55
    v_cvt_pk_bf16_f32 v66, v52, v53
    v_cvt_pk_bf16_f32 v67, v54, v55
    v_exp_f32 v56, v56
    v_exp_f32 v57, v57
    v_mfma_f32_32x32x16_bf16 a[80:95], v[80:83], v[64:67], 0
    s_add_u32 m0, s56, s55
    v_exp_f32 v58, v58
    v_exp_f32 v59, v59
    v_cvt_pk_bf16_f32 v68, v56, v57
    v_cvt_pk_bf16_f32 v69, v58, v59
    v_exp_f32 v60, v60
    v_exp_f32 v61, v61
    v_exp_f32 v62, v62
    v_exp_f32 v63, v63
    v_cvt_pk_bf16_f32 v70, v60, v61
    v_cvt_pk_bf16_f32 v71, v62, v63
    v_mfma_f32_32x32x16_bf16 v[48:63], v[72:75], v[28:31], 0
    buffer_load_dwordx4 v232, s[48:51], s54 offen offset:0 sc1 lds
    v_exp_f32 v32, v32
    v_exp_f32 v33, v33
    v_exp_f32 v34, v34
    v_exp_f32 v35, v35
    v_exp_f32 v36, v36
    v_exp_f32 v37, v37
    v_mfma_f32_32x32x16_bf16 a[80:95], v[84:87], v[68:71], a[80:95]
    s_add_u32 s55, s55, 2048
    v_cvt_pk_bf16_f32 v64, v32, v33
    v_cvt_pk_bf16_f32 v65, v34, v35
    v_exp_f32 v38, v38
    v_exp_f32 v39, v39
    v_cvt_pk_bf16_f32 v66, v36, v37
    v_cvt_pk_bf16_f32 v67, v38, v39
    v_exp_f32 v40, v40
    v_exp_f32 v41, v41
    v_mfma_f32_32x32x16_bf16 a[96:111], v[80:83], v[64:67], 0
    buffer_load_dwordx4 v232, s[48:51], s54 offen offset:1024 sc1 lds
    v_exp_f32 v42, v42
    v_exp_f32 v43, v43
    v_cvt_pk_bf16_f32 v68, v40, v41
    v_cvt_pk_bf16_f32 v69, v42, v43
    v_exp_f32 v44, v44
    v_exp_f32 v45, v45
    v_exp_f32 v46, v46
    v_exp_f32 v47, v47
    v_cvt_pk_bf16_f32 v70, v44, v45
    v_cvt_pk_bf16_f32 v71, v46, v47
    v_mfma_f32_32x32x16_bf16 v[32:47], v[76:79], v[0:3], 0
    s_and_b32 s55, s55, 0x1fff
    v_exp_f32 v48, v48
    v_exp_f32 v49, v49
    v_exp_f32 v50, v50
    v_exp_f32 v51, v51
    v_exp_f32 v52, v52
    v_exp_f32 v53, v53
    v_mfma_f32_32x32x16_bf16 a[96:111], v[84:87], v[68:71], a[96:111]
    s_add_u32 s54, s54, 2048
    v_cvt_pk_bf16_f32 v64, v48, v49
    v_cvt_pk_bf16_f32 v65, v50, v51
    v_exp_f32 v54, v54
    v_exp_f32 v55, v55
    v_cvt_pk_bf16_f32 v66, v52, v53
    v_cvt_pk_bf16_f32 v67, v54, v55
    v_exp_f32 v56, v56
    v_exp_f32 v57, v57
    v_mfma_f32_32x32x16_bf16 a[112:127], v[80:83], v[64:67], 0
    s_mul_i32 s30, s25, 589824
    v_exp_f32 v58, v58
    v_exp_f32 v59, v59
    v_cvt_pk_bf16_f32 v68, v56, v57
    v_cvt_pk_bf16_f32 v69, v58, v59
    v_exp_f32 v60, v60
    v_exp_f32 v61, v61
    v_exp_f32 v62, v62
    v_exp_f32 v63, v63
    v_cvt_pk_bf16_f32 v70, v60, v61
    v_cvt_pk_bf16_f32 v71, v62, v63
    s_waitcnt vmcnt(2)
    s_barrier
    s_cmp_lg_u32 s3, 0
    s_cbranch_scc1 F3_S
    s_lshl_b32 s58, s2, 4
    s_add_u32 s58, s58, 86769664
    s_mov_b64 exec, 1
    v_mov_b32 v250, 1
    buffer_store_dword v250, off, s[44:47], s58 sc1
    s_mov_b64 exec, -1
F3_S:
    s_mov_b32 s29, 86769664
    v_mfma_f32_32x32x16_bf16 v[48:63], v[76:79], v[4:7], 0
    s_add_u32 s30, s30, 81821696
    v_exp_f32 v32, v32
    v_exp_f32 v33, v33
    v_exp_f32 v34, v34
    v_exp_f32 v35, v35
    v_exp_f32 v36, v36
    v_exp_f32 v37, v37
    v_mfma_f32_32x32x16_bf16 a[112:127], v[84:87], v[68:71], a[112:127]
    v_add_u32 v238, s30, v232
    v_cvt_pk_bf16_f32 v64, v32, v33
    v_cvt_pk_bf16_f32 v65, v34, v35
    v_exp_f32 v38, v38
    v_exp_f32 v39, v39
    v_cvt_pk_bf16_f32 v66, v36, v37
    v_cvt_pk_bf16_f32 v67, v38, v39
    v_exp_f32 v40, v40
    v_exp_f32 v41, v41
    v_mfma_f32_32x32x16_bf16 a[0:15], v[88:91], v[64:67], a[0:15]
    v_add_u32 v239, 294912, v238
    v_exp_f32 v42, v42
    v_exp_f32 v43, v43
    v_cvt_pk_bf16_f32 v68, v40, v41
    v_cvt_pk_bf16_f32 v69, v42, v43
    v_exp_f32 v44, v44
    v_exp_f32 v45, v45
    v_exp_f32 v46, v46
    v_exp_f32 v47, v47
    v_cvt_pk_bf16_f32 v70, v44, v45
    v_cvt_pk_bf16_f32 v71, v46, v47
    v_mfma_f32_32x32x16_bf16 v[32:47], v[76:79], v[8:11], 0
    s_lshl_b32 s36, s3, 13
    v_exp_f32 v48, v48
    v_exp_f32 v49, v49
    v_exp_f32 v50, v50
    v_exp_f32 v51, v51
    v_exp_f32 v52, v52
    v_exp_f32 v53, v53
    v_mfma_f32_32x32x16_bf16 a[0:15], v[92:95], v[68:71], a[0:15]
    s_add_u32 s37, s36, 4096
    v_cvt_pk_bf16_f32 v64, v48, v49
    v_cvt_pk_bf16_f32 v65, v50, v51
    v_exp_f32 v54, v54
    v_exp_f32 v55, v55
    v_cvt_pk_bf16_f32 v66, v52, v53
    v_cvt_pk_bf16_f32 v67, v54, v55
    v_exp_f32 v56, v56
    v_exp_f32 v57, v57
    v_mfma_f32_32x32x16_bf16 a[16:31], v[88:91], v[64:67], a[16:31]
    s_lshl_b32 s27, s3, 16
    v_exp_f32 v58, v58
    v_exp_f32 v59, v59
    v_cvt_pk_bf16_f32 v68, v56, v57
    v_cvt_pk_bf16_f32 v69, v58, v59
    v_exp_f32 v60, v60
    v_exp_f32 v61, v61
    v_exp_f32 v62, v62
    v_exp_f32 v63, v63
    v_cvt_pk_bf16_f32 v70, v60, v61
    v_cvt_pk_bf16_f32 v71, v62, v63
    v_mfma_f32_32x32x16_bf16 v[48:63], v[76:79], v[12:15], 0
    s_lshl_b32 s30, s24, 19
    v_exp_f32 v32, v32
    v_exp_f32 v33, v33
    v_exp_f32 v34, v34
    v_exp_f32 v35, v35
    v_exp_f32 v36, v36
    v_exp_f32 v37, v37
    v_xor_b32 v240, 4096, v240
    v_xor_b32 v241, 4096, v241
    v_mfma_f32_32x32x16_bf16 a[16:31], v[92:95], v[68:71], a[16:31]
    ds_read_b128 v[72:75], v240 offset:0
    v_cvt_pk_bf16_f32 v64, v32, v33
    v_cvt_pk_bf16_f32 v65, v34, v35
    v_exp_f32 v38, v38
    v_exp_f32 v39, v39
    v_cvt_pk_bf16_f32 v66, v36, v37
    v_cvt_pk_bf16_f32 v67, v38, v39
    v_exp_f32 v40, v40
    v_exp_f32 v41, v41
    v_mfma_f32_32x32x16_bf16 a[32:47], v[88:91], v[64:67], a[32:47]
    s_add_u32 s30, s30, 58720256
    v_exp_f32 v42, v42
    v_exp_f32 v43, v43
    v_cvt_pk_bf16_f32 v68, v40, v41
    v_cvt_pk_bf16_f32 v69, v42, v43
    v_exp_f32 v44, v44
    v_exp_f32 v45, v45
    v_exp_f32 v46, v46
    v_exp_f32 v47, v47
    v_cvt_pk_bf16_f32 v70, v44, v45
    v_cvt_pk_bf16_f32 v71, v46, v47
    v_mfma_f32_32x32x16_bf16 v[32:47], v[76:79], v[16:19], 0
    s_mov_b64 exec, s[60:61]
    ds_read_b128 v[80:83], v241 offset:0
    ds_read_b128 v[84:87], v241 offset:512
    s_mov_b64 exec, -1
    v_exp_f32 v48, v48
    v_exp_f32 v49, v49
    v_exp_f32 v50, v50
    v_exp_f32 v51, v51
    v_exp_f32 v52, v52
    v_exp_f32 v53, v53
    v_mfma_f32_32x32x16_bf16 a[32:47], v[92:95], v[68:71], a[32:47]
    v_add_u32 v236, s30, v232
    v_cvt_pk_bf16_f32 v64, v48, v49
    v_cvt_pk_bf16_f32 v65, v50, v51
    v_exp_f32 v54, v54
    v_exp_f32 v55, v55
    v_cvt_pk_bf16_f32 v66, v52, v53
    v_cvt_pk_bf16_f32 v67, v54, v55
    v_exp_f32 v56, v56
    v_exp_f32 v57, v57
    v_mfma_f32_32x32x16_bf16 a[48:63], v[88:91], v[64:67], a[48:63]
    v_add_u32 v237, 0x40000, v236
    v_exp_f32 v58, v58
    v_exp_f32 v59, v59
    v_cvt_pk_bf16_f32 v68, v56, v57
    v_cvt_pk_bf16_f32 v69, v58, v59
    v_exp_f32 v60, v60
    v_exp_f32 v61, v61
    v_exp_f32 v62, v62
    v_exp_f32 v63, v63
    v_cvt_pk_bf16_f32 v70, v60, v61
    v_cvt_pk_bf16_f32 v71, v62, v63
    v_mfma_f32_32x32x16_bf16 v[48:63], v[76:79], v[20:23], 0
    s_mov_b32 s32, 0
    v_exp_f32 v32, v32
    v_exp_f32 v33, v33
    v_exp_f32 v34, v34
    v_exp_f32 v35, v35
    v_exp_f32 v36, v36
    v_exp_f32 v37, v37
    v_mfma_f32_32x32x16_bf16 a[48:63], v[92:95], v[68:71], a[48:63]
    s_mov_b32 s26, 6
    v_cvt_pk_bf16_f32 v64, v32, v33
    v_cvt_pk_bf16_f32 v65, v34, v35
    v_exp_f32 v38, v38
    v_exp_f32 v39, v39
    v_cvt_pk_bf16_f32 v66, v36, v37
    v_cvt_pk_bf16_f32 v67, v38, v39
    v_exp_f32 v40, v40
    v_exp_f32 v41, v41
    v_mfma_f32_32x32x16_bf16 a[64:79], v[88:91], v[64:67], a[64:79]
    v_exp_f32 v42, v42
    v_exp_f32 v43, v43
    v_cvt_pk_bf16_f32 v68, v40, v41
    v_cvt_pk_bf16_f32 v69, v42, v43
    v_exp_f32 v44, v44
    v_exp_f32 v45, v45
    v_exp_f32 v46, v46
    v_exp_f32 v47, v47
    v_cvt_pk_bf16_f32 v70, v44, v45
    v_cvt_pk_bf16_f32 v71, v46, v47
    v_mfma_f32_32x32x16_bf16 v[32:47], v[76:79], v[24:27], 0
    s_cmp_lg_u32 s3, 0
    s_cbranch_scc1 F3_A
    buffer_load_dword v246, v232, s[44:47], s29 offen offset:0 sc1
    buffer_load_dword v247, v232, s[44:47], s29 offen offset:1024 sc1
    buffer_load_dword v248, v232, s[44:47], s29 offen offset:2048 sc1
    buffer_load_dword v249, v232, s[44:47], s29 offen offset:3072 sc1
F3_A:
    v_exp_f32 v48, v48
    v_exp_f32 v49, v49
    v_exp_f32 v50, v50
    v_exp_f32 v51, v51
    v_exp_f32 v52, v52
    v_exp_f32 v53, v53
    v_mfma_f32_32x32x16_bf16 a[64:79], v[92:95], v[68:71], a[64:79]
    s_waitcnt lgkmcnt(0)
    v_cvt_pk_bf16_f32 v64, v48, v49
    v_cvt_pk_bf16_f32 v65, v50, v51
    v_exp_f32 v54, v54
    v_exp_f32 v55, v55
    v_cvt_pk_bf16_f32 v66, v52, v53
    v_cvt_pk_bf16_f32 v67, v54, v55
    v_exp_f32 v56, v56
    v_exp_f32 v57, v57
    v_mfma_f32_32x32x16_bf16 a[80:95], v[88:91], v[64:67], a[80:95]
    s_add_u32 m0, s56, s55
    v_exp_f32 v58, v58
    v_exp_f32 v59, v59
    v_cvt_pk_bf16_f32 v68, v56, v57
    v_cvt_pk_bf16_f32 v69, v58, v59
    v_exp_f32 v60, v60
    v_exp_f32 v61, v61
    v_exp_f32 v62, v62
    v_exp_f32 v63, v63
    v_cvt_pk_bf16_f32 v70, v60, v61
    v_cvt_pk_bf16_f32 v71, v62, v63
    v_mfma_f32_32x32x16_bf16 v[48:63], v[76:79], v[28:31], 0
    buffer_load_dwordx4 v232, s[48:51], s54 offen offset:0 sc1 lds
    v_exp_f32 v32, v32
    v_exp_f32 v33, v33
    v_exp_f32 v34, v34
    v_exp_f32 v35, v35
    v_exp_f32 v36, v36
    v_exp_f32 v37, v37
    v_mfma_f32_32x32x16_bf16 a[80:95], v[92:95], v[68:71], a[80:95]
    s_add_u32 s55, s55, 2048
    v_cvt_pk_bf16_f32 v64, v32, v33
    v_cvt_pk_bf16_f32 v65, v34, v35
    v_exp_f32 v38, v38
    v_exp_f32 v39, v39
    v_cvt_pk_bf16_f32 v66, v36, v37
    v_cvt_pk_bf16_f32 v67, v38, v39
    v_exp_f32 v40, v40
    v_exp_f32 v41, v41
    v_mfma_f32_32x32x16_bf16 a[96:111], v[88:91], v[64:67], a[96:111]
    buffer_load_dwordx4 v232, s[48:51], s54 offen offset:1024 sc1 lds
    v_exp_f32 v42, v42
    v_exp_f32 v43, v43
    v_cvt_pk_bf16_f32 v68, v40, v41
    v_cvt_pk_bf16_f32 v69, v42, v43
    v_exp_f32 v44, v44
    v_exp_f32 v45, v45
    v_exp_f32 v46, v46
    v_exp_f32 v47, v47
    v_cvt_pk_bf16_f32 v70, v44, v45
    v_cvt_pk_bf16_f32 v71, v46, v47
    v_mfma_f32_32x32x16_bf16 v[32:47], v[72:75], v[0:3], 0
    s_and_b32 s55, s55, 0x1fff
    v_exp_f32 v48, v48
    v_exp_f32 v49, v49
    v_exp_f32 v50, v50
    v_exp_f32 v51, v51
    v_exp_f32 v52, v52
    v_exp_f32 v53, v53
    v_mfma_f32_32x32x16_bf16 a[96:111], v[92:95], v[68:71], a[96:111]
    s_add_u32 s54, s54, 2048
    v_cvt_pk_bf16_f32 v64, v48, v49
    v_cvt_pk_bf16_f32 v65, v50, v51
    v_exp_f32 v54, v54
    v_exp_f32 v55, v55
    v_cvt_pk_bf16_f32 v66, v52, v53
    v_cvt_pk_bf16_f32 v67, v54, v55
    v_exp_f32 v56, v56
    v_exp_f32 v57, v57
    v_mfma_f32_32x32x16_bf16 a[112:127], v[88:91], v[64:67], a[112:127]
    v_exp_f32 v58, v58
    v_exp_f32 v59, v59
    v_cvt_pk_bf16_f32 v68, v56, v57
    v_cvt_pk_bf16_f32 v69, v58, v59
    v_exp_f32 v60, v60
    v_exp_f32 v61, v61
    v_exp_f32 v62, v62
    v_exp_f32 v63, v63
    v_cvt_pk_bf16_f32 v70, v60, v61
    v_cvt_pk_bf16_f32 v71, v62, v63
    s_cmp_lg_u32 s3, 0
    s_cbranch_scc1 F3_C
    s_mov_b32 s28, 1048576
    s_branch CHK_F3
POLL_F3:
    s_sleep 8
    buffer_load_dword v246, v232, s[44:47], s29 offen offset:0 sc1
    buffer_load_dword v247, v232, s[44:47], s29 offen offset:1024 sc1
    buffer_load_dword v248, v232, s[44:47], s29 offen offset:2048 sc1
    buffer_load_dword v249, v232, s[44:47], s29 offen offset:3072 sc1
CHK_F3:
    s_sub_u32 s28, s28, 1
    s_waitcnt vmcnt(0)
    v_or3_b32 v246, v246, v247, v248
    v_or_b32 v246, v246, v249
    v_cmp_ne_u32 vcc, 1, v246
    s_cmp_eq_u32 s28, 0
    s_cselect_b64 vcc, 0, vcc
    s_cmp_lg_u64 vcc, 0
    s_cbranch_scc1 POLL_F3
F3_C:
    s_waitcnt vmcnt(0)
    s_barrier
    v_mfma_f32_32x32x16_bf16 v[48:63], v[72:75], v[4:7], 0
    buffer_load_dwordx4 v[128:131], v238, s[44:47], s27 offen offset:0 sc1
    buffer_load_dwordx4 v[132:135], v239, s[44:47], s27 offen offset:0 sc1
    v_exp_f32 v32, v32
    v_exp_f32 v33, v33
    v_exp_f32 v34, v34
    v_exp_f32 v35, v35
    v_exp_f32 v36, v36
    v_exp_f32 v37, v37
    v_mfma_f32_32x32x16_bf16 a[112:127], v[92:95], v[68:71], a[112:127]
    buffer_load_dwordx4 a[192:195], v236, s[44:47], s27 offen offset:0 sc1
    v_cvt_pk_bf16_f32 v64, v32, v33
    v_cvt_pk_bf16_f32 v65, v34, v35
    v_exp_f32 v38, v38
    v_exp_f32 v39, v39
    v_cvt_pk_bf16_f32 v66, v36, v37
    v_cvt_pk_bf16_f32 v67, v38, v39
    v_exp_f32 v40, v40
    v_exp_f32 v41, v41
    v_mfma_f32_32x32x16_bf16 a[0:15], v[80:83], v[64:67], a[0:15]
    buffer_load_dwordx4 a[196:199], v237, s[44:47], s27 offen offset:0 sc1
    v_exp_f32 v42, v42
    v_exp_f32 v43, v43
    v_cvt_pk_bf16_f32 v68, v40, v41
    v_cvt_pk_bf16_f32 v69, v42, v43
    v_exp_f32 v44, v44
    v_exp_f32 v45, v45
    v_exp_f32 v46, v46
    v_exp_f32 v47, v47
    v_cvt_pk_bf16_f32 v70, v44, v45
    v_cvt_pk_bf16_f32 v71, v46, v47
    v_mfma_f32_32x32x16_bf16 v[32:47], v[72:75], v[8:11], 0
    buffer_load_dwordx4 v[136:139], v238, s[44:47], s27 offen offset:1024 sc1
    v_exp_f32 v48, v48
    v_exp_f32 v49, v49
    v_exp_f32 v50, v50
    v_exp_f32 v51, v51
    v_exp_f32 v52, v52
    v_exp_f32 v53, v53
    v_mfma_f32_32x32x16_bf16 a[0:15], v[84:87], v[68:71], a[0:15]
    buffer_load_dwordx4 v[140:143], v239, s[44:47], s27 offen offset:1024 sc1
    buffer_load_dwordx4 a[200:203], v236, s[44:47], s27 offen offset:1024 sc1
    v_cvt_pk_bf16_f32 v64, v48, v49
    v_cvt_pk_bf16_f32 v65, v50, v51
    v_exp_f32 v54, v54
    v_exp_f32 v55, v55
    v_cvt_pk_bf16_f32 v66, v52, v53
    v_cvt_pk_bf16_f32 v67, v54, v55
    v_exp_f32 v56, v56
    v_exp_f32 v57, v57
    v_mfma_f32_32x32x16_bf16 a[16:31], v[80:83], v[64:67], a[16:31]
    buffer_load_dwordx4 a[204:207], v237, s[44:47], s27 offen offset:1024 sc1
    v_exp_f32 v58, v58
    v_exp_f32 v59, v59
    v_cvt_pk_bf16_f32 v68, v56, v57
    v_cvt_pk_bf16_f32 v69, v58, v59
    v_exp_f32 v60, v60
    v_exp_f32 v61, v61
    v_exp_f32 v62, v62
    v_exp_f32 v63, v63
    v_cvt_pk_bf16_f32 v70, v60, v61
    v_cvt_pk_bf16_f32 v71, v62, v63
    v_mfma_f32_32x32x16_bf16 v[48:63], v[72:75], v[12:15], 0
    buffer_load_dwordx4 v[144:147], v238, s[44:47], s27 offen offset:2048 sc1
    v_exp_f32 v32, v32
    v_exp_f32 v33, v33
    v_exp_f32 v34, v34
    v_exp_f32 v35, v35
    v_exp_f32 v36, v36
    v_exp_f32 v37, v37
    v_mfma_f32_32x32x16_bf16 a[16:31], v[84:87], v[68:71], a[16:31]
    buffer_load_dwordx4 v[148:151], v239, s[44:47], s27 offen offset:2048 sc1
    ds_read_b128 v[76:79], v240 offset:2048
    v_cvt_pk_bf16_f32 v64, v32, v33
    v_cvt_pk_bf16_f32 v65, v34, v35
    v_exp_f32 v38, v38
    v_exp_f32 v39, v39
    v_cvt_pk_bf16_f32 v66, v36, v37
    v_cvt_pk_bf16_f32 v67, v38, v39
    v_exp_f32 v40, v40
    v_exp_f32 v41, v41
    v_mfma_f32_32x32x16_bf16 a[32:47], v[80:83], v[64:67], a[32:47]
    buffer_load_dwordx4 a[208:211], v236, s[44:47], s27 offen offset:2048 sc1
    v_exp_f32 v42, v42
    v_exp_f32 v43, v43
    v_cvt_pk_bf16_f32 v68, v40, v41
    v_cvt_pk_bf16_f32 v69, v42, v43
    v_exp_f32 v44, v44
    v_exp_f32 v45, v45
    v_exp_f32 v46, v46
    v_exp_f32 v47, v47
    v_cvt_pk_bf16_f32 v70, v44, v45
    v_cvt_pk_bf16_f32 v71, v46, v47
    v_mfma_f32_32x32x16_bf16 v[32:47], v[72:75], v[16:19], 0
    buffer_load_dwordx4 a[212:215], v237, s[44:47], s27 offen offset:2048 sc1
    buffer_load_dwordx4 v[152:155], v238, s[44:47], s27 offen offset:3072 sc1
    s_mov_b64 exec, s[60:61]
    ds_read_b128 v[88:91], v241 offset:2048
    ds_read_b128 v[92:95], v241 offset:2560
    s_mov_b64 exec, -1
    v_exp_f32 v48, v48
    v_exp_f32 v49, v49
    v_exp_f32 v50, v50
    v_exp_f32 v51, v51
    v_exp_f32 v52, v52
    v_exp_f32 v53, v53
    v_mfma_f32_32x32x16_bf16 a[32:47], v[84:87], v[68:71], a[32:47]
    buffer_load_dwordx4 v[156:159], v239, s[44:47], s27 offen offset:3072 sc1
    v_cvt_pk_bf16_f32 v64, v48, v49
    v_cvt_pk_bf16_f32 v65, v50, v51
    v_exp_f32 v54, v54
    v_exp_f32 v55, v55
    v_cvt_pk_bf16_f32 v66, v52, v53
    v_cvt_pk_bf16_f32 v67, v54, v55
    v_exp_f32 v56, v56
    v_exp_f32 v57, v57
    v_mfma_f32_32x32x16_bf16 a[48:63], v[80:83], v[64:67], a[48:63]
    buffer_load_dwordx4 a[216:219], v236, s[44:47], s27 offen offset:3072 sc1
    v_exp_f32 v58, v58
    v_exp_f32 v59, v59
    v_cvt_pk_bf16_f32 v68, v56, v57
    v_cvt_pk_bf16_f32 v69, v58, v59
    v_exp_f32 v60, v60
    v_exp_f32 v61, v61
    v_exp_f32 v62, v62
    v_exp_f32 v63, v63
    v_cvt_pk_bf16_f32 v70, v60, v61
    v_cvt_pk_bf16_f32 v71, v62, v63
    v_mfma_f32_32x32x16_bf16 v[48:63], v[72:75], v[20:23], 0
    buffer_load_dwordx4 a[220:223], v237, s[44:47], s27 offen offset:3072 sc1
    v_exp_f32 v32, v32
    v_exp_f32 v33, v33
    v_exp_f32 v34, v34
    v_exp_f32 v35, v35
    v_exp_f32 v36, v36
    v_exp_f32 v37, v37
    v_mfma_f32_32x32x16_bf16 a[48:63], v[84:87], v[68:71], a[48:63]
    s_add_u32 s27, s27, 4096
    v_cvt_pk_bf16_f32 v64, v32, v33
    v_cvt_pk_bf16_f32 v65, v34, v35
    v_exp_f32 v38, v38
    v_exp_f32 v39, v39
    v_cvt_pk_bf16_f32 v66, v36, v37
    v_cvt_pk_bf16_f32 v67, v38, v39
    v_exp_f32 v40, v40
    v_exp_f32 v41, v41
    v_mfma_f32_32x32x16_bf16 a[64:79], v[80:83], v[64:67], a[64:79]
    buffer_load_dwordx4 v[160:163], v238, s[44:47], s27 offen offset:0 sc1
    buffer_load_dwordx4 v[164:167], v239, s[44:47], s27 offen offset:0 sc1
    v_exp_f32 v42, v42
    v_exp_f32 v43, v43
    v_cvt_pk_bf16_f32 v68, v40, v41
    v_cvt_pk_bf16_f32 v69, v42, v43
    v_exp_f32 v44, v44
    v_exp_f32 v45, v45
    v_exp_f32 v46, v46
    v_exp_f32 v47, v47
    v_cvt_pk_bf16_f32 v70, v44, v45
    v_cvt_pk_bf16_f32 v71, v46, v47
    v_mfma_f32_32x32x16_bf16 v[32:47], v[72:75], v[24:27], 0
    buffer_load_dwordx4 a[224:227], v236, s[44:47], s27 offen offset:0 sc1
    v_exp_f32 v48, v48
    v_exp_f32 v49, v49
    v_exp_f32 v50, v50
    v_exp_f32 v51, v51
    v_exp_f32 v52, v52
    v_exp_f32 v53, v53
    v_mfma_f32_32x32x16_bf16 a[64:79], v[84:87], v[68:71], a[64:79]
    buffer_load_dwordx4 a[228:231], v237, s[44:47], s27 offen offset:0 sc1
    s_waitcnt lgkmcnt(0)
    v_cvt_pk_bf16_f32 v64, v48, v49
    v_cvt_pk_bf16_f32 v65, v50, v51
    v_exp_f32 v54, v54
    v_exp_f32 v55, v55
    v_cvt_pk_bf16_f32 v66, v52, v53
    v_cvt_pk_bf16_f32 v67, v54, v55
    v_exp_f32 v56, v56
    v_exp_f32 v57, v57
    v_mfma_f32_32x32x16_bf16 a[80:95], v[80:83], v[64:67], a[80:95]
    buffer_load_dwordx4 v[168:171], v238, s[44:47], s27 offen offset:1024 sc1
    s_add_u32 m0, s56, s55
    v_exp_f32 v58, v58
    v_exp_f32 v59, v59
    v_cvt_pk_bf16_f32 v68, v56, v57
    v_cvt_pk_bf16_f32 v69, v58, v59
    v_exp_f32 v60, v60
    v_exp_f32 v61, v61
    v_exp_f32 v62, v62
    v_exp_f32 v63, v63
    v_cvt_pk_bf16_f32 v70, v60, v61
    v_cvt_pk_bf16_f32 v71, v62, v63
    v_mfma_f32_32x32x16_bf16 v[48:63], v[72:75], v[28:31], 0
    buffer_load_dwordx4 v[172:175], v239, s[44:47], s27 offen offset:1024 sc1
    buffer_load_dwordx4 v232, s[48:51], s54 offen offset:0 sc1 lds
    v_exp_f32 v32, v32
    v_exp_f32 v33, v33
    v_exp_f32 v34, v34
    v_exp_f32 v35, v35
    v_exp_f32 v36, v36
    v_exp_f32 v37, v37
    v_mfma_f32_32x32x16_bf16 a[80:95], v[84:87], v[68:71], a[80:95]
    buffer_load_dwordx4 a[232:235], v236, s[44:47], s27 offen offset:1024 sc1
    buffer_load_dwordx4 a[236:239], v237, s[44:47], s27 offen offset:1024 sc1
    s_add_u32 s55, s55, 2048
    v_cvt_pk_bf16_f32 v64, v32, v33
    v_cvt_pk_bf16_f32 v65, v34, v35
    v_exp_f32 v38, v38
    v_exp_f32 v39, v39
    v_cvt_pk_bf16_f32 v66, v36, v37
    v_cvt_pk_bf16_f32 v67, v38, v39
    v_exp_f32 v40, v40
    v_exp_f32 v41, v41
    v_mfma_f32_32x32x16_bf16 a[96:111], v[80:83], v[64:67], a[96:111]
    buffer_load_dwordx4 v[176:179], v238, s[44:47], s27 offen offset:2048 sc1
    buffer_load_dwordx4 v232, s[48:51], s54 offen offset:1024 sc1 lds
    v_exp_f32 v42, v42
    v_exp_f32 v43, v43
    v_cvt_pk_bf16_f32 v68, v40, v41
    v_cvt_pk_bf16_f32 v69, v42, v43
    v_exp_f32 v44, v44
    v_exp_f32 v45, v45
    v_exp_f32 v46, v46
    v_exp_f32 v47, v47
    v_cvt_pk_bf16_f32 v70, v44, v45
    v_cvt_pk_bf16_f32 v71, v46, v47
    v_mfma_f32_32x32x16_bf16 v[32:47], v[76:79], v[0:3], 0
    buffer_load_dwordx4 v[180:183], v239, s[44:47], s27 offen offset:2048 sc1
    s_and_b32 s55, s55, 0x1fff
    v_exp_f32 v48, v48
    v_exp_f32 v49, v49
    v_exp_f32 v50, v50
    v_exp_f32 v51, v51
    v_exp_f32 v52, v52
    v_exp_f32 v53, v53
    v_mfma_f32_32x32x16_bf16 a[96:111], v[84:87], v[68:71], a[96:111]
    buffer_load_dwordx4 a[240:243], v236, s[44:47], s27 offen offset:2048 sc1
    s_add_u32 s54, s54, 2048
    v_cvt_pk_bf16_f32 v64, v48, v49
    v_cvt_pk_bf16_f32 v65, v50, v51
    v_exp_f32 v54, v54
    v_exp_f32 v55, v55
    v_cvt_pk_bf16_f32 v66, v52, v53
    v_cvt_pk_bf16_f32 v67, v54, v55
    v_exp_f32 v56, v56
    v_exp_f32 v57, v57
    v_mfma_f32_32x32x16_bf16 a[112:127], v[80:83], v[64:67], a[112:127]
    buffer_load_dwordx4 a[244:247], v237, s[44:47], s27 offen offset:2048 sc1
    v_exp_f32 v58, v58
    v_exp_f32 v59, v59
    v_cvt_pk_bf16_f32 v68, v56, v57
    v_cvt_pk_bf16_f32 v69, v58, v59
    v_exp_f32 v60, v60
    v_exp_f32 v61, v61
    v_exp_f32 v62, v62
    v_exp_f32 v63, v63
    v_cvt_pk_bf16_f32 v70, v60, v61
    v_cvt_pk_bf16_f32 v71, v62, v63
    s_waitcnt vmcnt(26)
.p2align 3
KA_L:
    v_mfma_f32_32x32x16_bf16 a[128:143], v[128:131], a[192:195], a[128:143]
    buffer_load_dwordx4 v[184:187], v238, s[44:47], s27 offen offset:3072 sc1
    v_exp_f32 v32, v32
    v_exp_f32 v33, v33
    v_exp_f32 v34, v34
    v_exp_f32 v35, v35
    v_mfma_f32_32x32x16_bf16 a[112:127], v[84:87], v[68:71], a[112:127]
    v_cvt_pk_bf16_f32 v64, v32, v33
    v_cvt_pk_bf16_f32 v65, v34, v35
    v_exp_f32 v36, v36
    v_exp_f32 v37, v37
    v_exp_f32 v38, v38
    v_mfma_f32_32x32x16_bf16 v[48:63], v[76:79], v[4:7], 0
    buffer_load_dwordx4 v[188:191], v239, s[44:47], s27 offen offset:3072 sc1
    v_exp_f32 v39, v39
    v_cvt_pk_bf16_f32 v66, v36, v37
    v_cvt_pk_bf16_f32 v67, v38, v39
    v_exp_f32 v40, v40
    v_exp_f32 v41, v41
    v_mfma_f32_32x32x16_bf16 a[0:15], v[88:91], v[64:67], a[0:15]
    v_exp_f32 v42, v42
    v_exp_f32 v43, v43
    v_cvt_pk_bf16_f32 v68, v40, v41
    v_cvt_pk_bf16_f32 v69, v42, v43
    v_exp_f32 v44, v44
    v_mfma_f32_32x32x16_bf16 a[144:159], v[128:131], a[196:199], a[144:159]
    v_exp_f32 v45, v45
    v_exp_f32 v46, v46
    v_exp_f32 v47, v47
    v_cvt_pk_bf16_f32 v70, v44, v45
    v_cvt_pk_bf16_f32 v71, v46, v47
    v_mfma_f32_32x32x16_bf16 a[160:175], v[132:135], a[192:195], a[160:175]
    buffer_load_dwordx4 a[248:251], v236, s[44:47], s27 offen offset:3072 sc1
    v_exp_f32 v48, v48
    v_exp_f32 v49, v49
    v_exp_f32 v50, v50
    v_exp_f32 v51, v51
    v_mfma_f32_32x32x16_bf16 a[0:15], v[92:95], v[68:71], a[0:15]
    v_cvt_pk_bf16_f32 v64, v48, v49
    v_cvt_pk_bf16_f32 v65, v50, v51
    v_exp_f32 v52, v52
    v_exp_f32 v53, v53
    v_exp_f32 v54, v54
    v_mfma_f32_32x32x16_bf16 v[32:47], v[76:79], v[8:11], 0
    buffer_load_dwordx4 a[252:255], v237, s[44:47], s27 offen offset:3072 sc1
    v_exp_f32 v55, v55
    v_cvt_pk_bf16_f32 v66, v52, v53
    v_cvt_pk_bf16_f32 v67, v54, v55
    v_exp_f32 v56, v56
    v_exp_f32 v57, v57
    v_mfma_f32_32x32x16_bf16 a[16:31], v[88:91], v[64:67], a[16:31]
    v_exp_f32 v58, v58
    v_exp_f32 v59, v59
    v_cvt_pk_bf16_f32 v68, v56, v57
    v_cvt_pk_bf16_f32 v69, v58, v59
    v_exp_f32 v60, v60
    v_mfma_f32_32x32x16_bf16 a[176:191], v[132:135], a[196:199], a[176:191]
    s_waitcnt vmcnt(26)
    v_exp_f32 v61, v61
    v_exp_f32 v62, v62
    v_exp_f32 v63, v63
    v_cvt_pk_bf16_f32 v70, v60, v61
    v_cvt_pk_bf16_f32 v71, v62, v63
    v_mfma_f32_32x32x16_bf16 a[128:143], v[136:139], a[200:203], a[128:143]
    s_add_u32 s27, s27, 4096
    buffer_load_dwordx4 v[128:131], v238, s[44:47], s27 offen offset:0 sc1
    v_exp_f32 v32, v32
    v_exp_f32 v33, v33
    v_exp_f32 v34, v34
    v_exp_f32 v35, v35
    v_xor_b32 v240, 4096, v240
    v_xor_b32 v241, 4096, v241
    v_mfma_f32_32x32x16_bf16 a[16:31], v[92:95], v[68:71], a[16:31]
    ds_read_b128 v[72:75], v240 offset:0
    v_cvt_pk_bf16_f32 v64, v32, v33
    v_cvt_pk_bf16_f32 v65, v34, v35
    v_exp_f32 v36, v36
    v_exp_f32 v37, v37
    v_exp_f32 v38, v38
    v_mfma_f32_32x32x16_bf16 v[48:63], v[76:79], v[12:15], 0
    buffer_load_dwordx4 v[132:135], v239, s[44:47], s27 offen offset:0 sc1
    v_exp_f32 v39, v39
    v_cvt_pk_bf16_f32 v66, v36, v37
    v_cvt_pk_bf16_f32 v67, v38, v39
    v_exp_f32 v40, v40
    v_exp_f32 v41, v41
    v_mfma_f32_32x32x16_bf16 a[32:47], v[88:91], v[64:67], a[32:47]
    s_mov_b64 exec, s[60:61]
    ds_read_b128 v[80:83], v241 offset:0
    ds_read_b128 v[84:87], v241 offset:512
    s_mov_b64 exec, -1
    v_exp_f32 v42, v42
    v_exp_f32 v43, v43
    v_cvt_pk_bf16_f32 v68, v40, v41
    v_cvt_pk_bf16_f32 v69, v42, v43
    v_exp_f32 v44, v44
    v_mfma_f32_32x32x16_bf16 a[144:159], v[136:139], a[204:207], a[144:159]
    v_exp_f32 v45, v45
    v_exp_f32 v46, v46
    v_exp_f32 v47, v47
    v_cvt_pk_bf16_f32 v70, v44, v45
    v_cvt_pk_bf16_f32 v71, v46, v47
    v_mfma_f32_32x32x16_bf16 a[160:175], v[140:143], a[200:203], a[160:175]
    buffer_load_dwordx4 a[192:195], v236, s[44:47], s27 offen offset:0 sc1
    v_exp_f32 v48, v48
    v_exp_f32 v49, v49
    v_exp_f32 v50, v50
    v_exp_f32 v51, v51
    v_mfma_f32_32x32x16_bf16 a[32:47], v[92:95], v[68:71], a[32:47]
    v_cvt_pk_bf16_f32 v64, v48, v49
    v_cvt_pk_bf16_f32 v65, v50, v51
    v_exp_f32 v52, v52
    v_exp_f32 v53, v53
    v_exp_f32 v54, v54
    v_mfma_f32_32x32x16_bf16 v[32:47], v[76:79], v[16:19], 0
    buffer_load_dwordx4 a[196:199], v237, s[44:47], s27 offen offset:0 sc1
    v_exp_f32 v55, v55
    v_cvt_pk_bf16_f32 v66, v52, v53
    v_cvt_pk_bf16_f32 v67, v54, v55
    v_exp_f32 v56, v56
    v_exp_f32 v57, v57
    v_mfma_f32_32x32x16_bf16 a[48:63], v[88:91], v[64:67], a[48:63]
    v_exp_f32 v58, v58
    v_exp_f32 v59, v59
    v_cvt_pk_bf16_f32 v68, v56, v57
    v_cvt_pk_bf16_f32 v69, v58, v59
    v_exp_f32 v60, v60
    v_mfma_f32_32x32x16_bf16 a[176:191], v[140:143], a[204:207], a[176:191]
    s_waitcnt vmcnt(26)
    v_exp_f32 v61, v61
    v_exp_f32 v62, v62
    v_exp_f32 v63, v63
    v_cvt_pk_bf16_f32 v70, v60, v61
    v_cvt_pk_bf16_f32 v71, v62, v63
    v_mfma_f32_32x32x16_bf16 a[128:143], v[144:147], a[208:211], a[128:143]
    buffer_load_dwordx4 v[136:139], v238, s[44:47], s27 offen offset:1024 sc1
    v_exp_f32 v32, v32
    v_exp_f32 v33, v33
    v_exp_f32 v34, v34
    v_exp_f32 v35, v35
    v_mfma_f32_32x32x16_bf16 a[48:63], v[92:95], v[68:71], a[48:63]
    v_cvt_pk_bf16_f32 v64, v32, v33
    v_cvt_pk_bf16_f32 v65, v34, v35
    v_exp_f32 v36, v36
    v_exp_f32 v37, v37
    v_exp_f32 v38, v38
    v_mfma_f32_32x32x16_bf16 v[48:63], v[76:79], v[20:23], 0
    buffer_load_dwordx4 v[140:143], v239, s[44:47], s27 offen offset:1024 sc1
    v_exp_f32 v39, v39
    v_cvt_pk_bf16_f32 v66, v36, v37
    v_cvt_pk_bf16_f32 v67, v38, v39
    v_exp_f32 v40, v40
    v_exp_f32 v41, v41
    v_mfma_f32_32x32x16_bf16 a[64:79], v[88:91], v[64:67], a[64:79]
    s_waitcnt lgkmcnt(0)
    v_exp_f32 v42, v42
    v_exp_f32 v43, v43
    v_cvt_pk_bf16_f32 v68, v40, v41
    v_cvt_pk_bf16_f32 v69, v42, v43
    v_exp_f32 v44, v44
    v_mfma_f32_32x32x16_bf16 a[144:159], v[144:147], a[212:215], a[144:159]
    s_add_u32 m0, s56, s55
    v_exp_f32 v45, v45
    v_exp_f32 v46, v46
    v_exp_f32 v47, v47
    v_cvt_pk_bf16_f32 v70, v44, v45
    v_cvt_pk_bf16_f32 v71, v46, v47
    v_mfma_f32_32x32x16_bf16 a[160:175], v[148:151], a[208:211], a[160:175]
    buffer_load_dwordx4 a[200:203], v236, s[44:47], s27 offen offset:1024 sc1
    v_exp_f32 v48, v48
    v_exp_f32 v49, v49
    v_exp_f32 v50, v50
    v_exp_f32 v51, v51
    v_mfma_f32_32x32x16_bf16 a[64:79], v[92:95], v[68:71], a[64:79]
    buffer_load_dwordx4 v232, s[48:51], s54 offen offset:0 sc1 lds
    v_cvt_pk_bf16_f32 v64, v48, v49
    v_cvt_pk_bf16_f32 v65, v50, v51
    v_exp_f32 v52, v52
    v_exp_f32 v53, v53
    v_exp_f32 v54, v54
    v_mfma_f32_32x32x16_bf16 v[32:47], v[76:79], v[24:27], 0
    buffer_load_dwordx4 a[204:207], v237, s[44:47], s27 offen offset:1024 sc1
    v_exp_f32 v55, v55
    v_cvt_pk_bf16_f32 v66, v52, v53
    v_cvt_pk_bf16_f32 v67, v54, v55
    v_exp_f32 v56, v56
    v_exp_f32 v57, v57
    v_mfma_f32_32x32x16_bf16 a[80:95], v[88:91], v[64:67], a[80:95]
    s_add_u32 s55, s55, 2048
    v_exp_f32 v58, v58
    v_exp_f32 v59, v59
    v_cvt_pk_bf16_f32 v68, v56, v57
    v_cvt_pk_bf16_f32 v69, v58, v59
    v_exp_f32 v60, v60
    v_mfma_f32_32x32x16_bf16 a[176:191], v[148:151], a[212:215], a[176:191]
    s_waitcnt vmcnt(27)
    v_exp_f32 v61, v61
    v_exp_f32 v62, v62
    v_exp_f32 v63, v63
    v_cvt_pk_bf16_f32 v70, v60, v61
    v_cvt_pk_bf16_f32 v71, v62, v63
    v_mfma_f32_32x32x16_bf16 a[128:143], v[152:155], a[216:219], a[128:143]
    buffer_load_dwordx4 v[144:147], v238, s[44:47], s27 offen offset:2048 sc1
    v_exp_f32 v32, v32
    v_exp_f32 v33, v33
    v_exp_f32 v34, v34
    v_exp_f32 v35, v35
    v_mfma_f32_32x32x16_bf16 a[80:95], v[92:95], v[68:71], a[80:95]
    buffer_load_dwordx4 v232, s[48:51], s54 offen offset:1024 sc1 lds
    v_cvt_pk_bf16_f32 v64, v32, v33
    v_cvt_pk_bf16_f32 v65, v34, v35
    v_exp_f32 v36, v36
    v_exp_f32 v37, v37
    v_exp_f32 v38, v38
    v_mfma_f32_32x32x16_bf16 v[48:63], v[76:79], v[28:31], 0
    buffer_load_dwordx4 v[148:151], v239, s[44:47], s27 offen offset:2048 sc1
    v_exp_f32 v39, v39
    v_cvt_pk_bf16_f32 v66, v36, v37
    v_cvt_pk_bf16_f32 v67, v38, v39
    v_exp_f32 v40, v40
    v_exp_f32 v41, v41
    v_mfma_f32_32x32x16_bf16 a[96:111], v[88:91], v[64:67], a[96:111]
    s_and_b32 s55, s55, 0x1fff
    v_exp_f32 v42, v42
    v_exp_f32 v43, v43
    v_cvt_pk_bf16_f32 v68, v40, v41
    v_cvt_pk_bf16_f32 v69, v42, v43
    v_exp_f32 v44, v44
    v_mfma_f32_32x32x16_bf16 a[144:159], v[152:155], a[220:223], a[144:159]
    s_add_u32 s54, s54, 2048
    v_exp_f32 v45, v45
    v_exp_f32 v46, v46
    v_exp_f32 v47, v47
    v_cvt_pk_bf16_f32 v70, v44, v45
    v_cvt_pk_bf16_f32 v71, v46, v47
    v_mfma_f32_32x32x16_bf16 a[160:175], v[156:159], a[216:219], a[160:175]
    buffer_load_dwordx4 a[208:211], v236, s[44:47], s27 offen offset:2048 sc1
    v_exp_f32 v48, v48
    v_exp_f32 v49, v49
    v_exp_f32 v50, v50
    v_exp_f32 v51, v51
    v_mfma_f32_32x32x16_bf16 a[96:111], v[92:95], v[68:71], a[96:111]
    v_cvt_pk_bf16_f32 v64, v48, v49
    v_cvt_pk_bf16_f32 v65, v50, v51
    v_exp_f32 v52, v52
    v_exp_f32 v53, v53
    v_exp_f32 v54, v54
    v_mfma_f32_32x32x16_bf16 v[32:47], v[72:75], v[0:3], 0
    buffer_load_dwordx4 a[212:215], v237, s[44:47], s27 offen offset:2048 sc1
    v_exp_f32 v55, v55
    v_cvt_pk_bf16_f32 v66, v52, v53
    v_cvt_pk_bf16_f32 v67, v54, v55
    v_exp_f32 v56, v56
    v_exp_f32 v57, v57
    v_mfma_f32_32x32x16_bf16 a[112:127], v[88:91], v[64:67], a[112:127]
    v_exp_f32 v58, v58
    v_exp_f32 v59, v59
    v_cvt_pk_bf16_f32 v68, v56, v57
    v_cvt_pk_bf16_f32 v69, v58, v59
    v_exp_f32 v60, v60
    v_mfma_f32_32x32x16_bf16 a[176:191], v[156:159], a[220:223], a[176:191]
    s_waitcnt vmcnt(28)
    v_exp_f32 v61, v61
    v_exp_f32 v62, v62
    v_exp_f32 v63, v63
    v_cvt_pk_bf16_f32 v70, v60, v61
    v_cvt_pk_bf16_f32 v71, v62, v63
    v_mfma_f32_32x32x16_bf16 a[128:143], v[160:163], a[224:227], a[128:143]
    buffer_load_dwordx4 v[152:155], v238, s[44:47], s27 offen offset:3072 sc1
    v_exp_f32 v32, v32
    v_exp_f32 v33, v33
    v_exp_f32 v34, v34
    v_exp_f32 v35, v35
    v_mfma_f32_32x32x16_bf16 a[112:127], v[92:95], v[68:71], a[112:127]
    v_cvt_pk_bf16_f32 v64, v32, v33
    v_cvt_pk_bf16_f32 v65, v34, v35
    v_exp_f32 v36, v36
    v_exp_f32 v37, v37
    v_exp_f32 v38, v38
    v_mfma_f32_32x32x16_bf16 v[48:63], v[72:75], v[4:7], 0
    buffer_load_dwordx4 v[156:159], v239, s[44:47], s27 offen offset:3072 sc1
    v_exp_f32 v39, v39
    v_cvt_pk_bf16_f32 v66, v36, v37
    v_cvt_pk_bf16_f32 v67, v38, v39
    v_exp_f32 v40, v40
    v_exp_f32 v41, v41
    v_mfma_f32_32x32x16_bf16 a[0:15], v[80:83], v[64:67], a[0:15]
    v_exp_f32 v42, v42
    v_exp_f32 v43, v43
    v_cvt_pk_bf16_f32 v68, v40, v41
    v_cvt_pk_bf16_f32 v69, v42, v43
    v_exp_f32 v44, v44
    v_mfma_f32_32x32x16_bf16 a[144:159], v[160:163], a[228:231], a[144:159]
    v_exp_f32 v45, v45
    v_exp_f32 v46, v46
    v_exp_f32 v47, v47
    v_cvt_pk_bf16_f32 v70, v44, v45
    v_cvt_pk_bf16_f32 v71, v46, v47
    v_mfma_f32_32x32x16_bf16 a[160:175], v[164:167], a[224:227], a[160:175]
    buffer_load_dwordx4 a[216:219], v236, s[44:47], s27 offen offset:3072 sc1
    v_exp_f32 v48, v48
    v_exp_f32 v49, v49
    v_exp_f32 v50, v50
    v_exp_f32 v51, v51
    v_mfma_f32_32x32x16_bf16 a[0:15], v[84:87], v[68:71], a[0:15]
    v_cvt_pk_bf16_f32 v64, v48, v49
    v_cvt_pk_bf16_f32 v65, v50, v51
    v_exp_f32 v52, v52
    v_exp_f32 v53, v53
    v_exp_f32 v54, v54
    v_mfma_f32_32x32x16_bf16 v[32:47], v[72:75], v[8:11], 0
    buffer_load_dwordx4 a[220:223], v237, s[44:47], s27 offen offset:3072 sc1
    v_exp_f32 v55, v55
    v_cvt_pk_bf16_f32 v66, v52, v53
    v_cvt_pk_bf16_f32 v67, v54, v55
    v_exp_f32 v56, v56
    v_exp_f32 v57, v57
    v_mfma_f32_32x32x16_bf16 a[16:31], v[80:83], v[64:67], a[16:31]
    v_exp_f32 v58, v58
    v_exp_f32 v59, v59
    v_cvt_pk_bf16_f32 v68, v56, v57
    v_cvt_pk_bf16_f32 v69, v58, v59
    v_exp_f32 v60, v60
    v_mfma_f32_32x32x16_bf16 a[176:191], v[164:167], a[228:231], a[176:191]
    s_waitcnt vmcnt(27)
    v_exp_f32 v61, v61
    v_exp_f32 v62, v62
    v_exp_f32 v63, v63
    v_cvt_pk_bf16_f32 v70, v60, v61
    v_cvt_pk_bf16_f32 v71, v62, v63
    v_mfma_f32_32x32x16_bf16 a[128:143], v[168:171], a[232:235], a[128:143]
    s_add_u32 s27, s27, 4096
    buffer_load_dwordx4 v[160:163], v238, s[44:47], s27 offen offset:0 sc1
    v_exp_f32 v32, v32
    v_exp_f32 v33, v33
    v_exp_f32 v34, v34
    v_exp_f32 v35, v35
    v_mfma_f32_32x32x16_bf16 a[16:31], v[84:87], v[68:71], a[16:31]
    ds_read_b128 v[76:79], v240 offset:2048
    v_cvt_pk_bf16_f32 v64, v32, v33
    v_cvt_pk_bf16_f32 v65, v34, v35
    v_exp_f32 v36, v36
    v_exp_f32 v37, v37
    v_exp_f32 v38, v38
    v_mfma_f32_32x32x16_bf16 v[48:63], v[72:75], v[12:15], 0
    buffer_load_dwordx4 v[164:167], v239, s[44:47], s27 offen offset:0 sc1
    v_exp_f32 v39, v39
    v_cvt_pk_bf16_f32 v66, v36, v37
    v_cvt_pk_bf16_f32 v67, v38, v39
    v_exp_f32 v40, v40
    v_exp_f32 v41, v41
    v_mfma_f32_32x32x16_bf16 a[32:47], v[80:83], v[64:67], a[32:47]
    s_mov_b64 exec, s[60:61]
    ds_read_b128 v[88:91], v241 offset:2048
    ds_read_b128 v[92:95], v241 offset:2560
    s_mov_b64 exec, -1
    v_exp_f32 v42, v42
    v_exp_f32 v43, v43
    v_cvt_pk_bf16_f32 v68, v40, v41
    v_cvt_pk_bf16_f32 v69, v42, v43
    v_exp_f32 v44, v44
    v_mfma_f32_32x32x16_bf16 a[144:159], v[168:171], a[236:239], a[144:159]
    v_exp_f32 v45, v45
    v_exp_f32 v46, v46
    v_exp_f32 v47, v47
    v_cvt_pk_bf16_f32 v70, v44, v45
    v_cvt_pk_bf16_f32 v71, v46, v47
    v_mfma_f32_32x32x16_bf16 a[160:175], v[172:175], a[232:235], a[160:175]
    buffer_load_dwordx4 a[224:227], v236, s[44:47], s27 offen offset:0 sc1
    v_exp_f32 v48, v48
    v_exp_f32 v49, v49
    v_exp_f32 v50, v50
    v_exp_f32 v51, v51
    v_mfma_f32_32x32x16_bf16 a[32:47], v[84:87], v[68:71], a[32:47]
    v_cvt_pk_bf16_f32 v64, v48, v49
    v_cvt_pk_bf16_f32 v65, v50, v51
    v_exp_f32 v52, v52
    v_exp_f32 v53, v53
    v_exp_f32 v54, v54
    v_mfma_f32_32x32x16_bf16 v[32:47], v[72:75], v[16:19], 0
    buffer_load_dwordx4 a[228:231], v237, s[44:47], s27 offen offset:0 sc1
    v_exp_f32 v55, v55
    v_cvt_pk_bf16_f32 v66, v52, v53
    v_cvt_pk_bf16_f32 v67, v54, v55
    v_exp_f32 v56, v56
    v_exp_f32 v57, v57
    v_mfma_f32_32x32x16_bf16 a[48:63], v[80:83], v[64:67], a[48:63]
    v_exp_f32 v58, v58
    v_exp_f32 v59, v59
    v_cvt_pk_bf16_f32 v68, v56, v57
    v_cvt_pk_bf16_f32 v69, v58, v59
    v_exp_f32 v60, v60
    v_mfma_f32_32x32x16_bf16 a[176:191], v[172:175], a[236:239], a[176:191]
    s_waitcnt vmcnt(26)
    v_exp_f32 v61, v61
    v_exp_f32 v62, v62
    v_exp_f32 v63, v63
    v_cvt_pk_bf16_f32 v70, v60, v61
    v_cvt_pk_bf16_f32 v71, v62, v63
    v_mfma_f32_32x32x16_bf16 a[128:143], v[176:179], a[240:243], a[128:143]
    buffer_load_dwordx4 v[168:171], v238, s[44:47], s27 offen offset:1024 sc1
    v_exp_f32 v32, v32
    v_exp_f32 v33, v33
    v_exp_f32 v34, v34
    v_exp_f32 v35, v35
    v_mfma_f32_32x32x16_bf16 a[48:63], v[84:87], v[68:71], a[48:63]
    v_cvt_pk_bf16_f32 v64, v32, v33
    v_cvt_pk_bf16_f32 v65, v34, v35
    v_exp_f32 v36, v36
    v_exp_f32 v37, v37
    v_exp_f32 v38, v38
    v_mfma_f32_32x32x16_bf16 v[48:63], v[72:75], v[20:23], 0
    buffer_load_dwordx4 v[172:175], v239, s[44:47], s27 offen offset:1024 sc1
    v_exp_f32 v39, v39
    v_cvt_pk_bf16_f32 v66, v36, v37
    v_cvt_pk_bf16_f32 v67, v38, v39
    v_exp_f32 v40, v40
    v_exp_f32 v41, v41
    v_mfma_f32_32x32x16_bf16 a[64:79], v[80:83], v[64:67], a[64:79]
    s_waitcnt lgkmcnt(0)
    v_exp_f32 v42, v42
    v_exp_f32 v43, v43
    v_cvt_pk_bf16_f32 v68, v40, v41
    v_cvt_pk_bf16_f32 v69, v42, v43
    v_exp_f32 v44, v44
    v_mfma_f32_32x32x16_bf16 a[144:159], v[176:179], a[244:247], a[144:159]
    s_add_u32 m0, s56, s55
    v_exp_f32 v45, v45
    v_exp_f32 v46, v46
    v_exp_f32 v47, v47
    v_cvt_pk_bf16_f32 v70, v44, v45
    v_cvt_pk_bf16_f32 v71, v46, v47
    v_mfma_f32_32x32x16_bf16 a[160:175], v[180:183], a[240:243], a[160:175]
    buffer_load_dwordx4 a[232:235], v236, s[44:47], s27 offen offset:1024 sc1
    v_exp_f32 v48, v48
    v_exp_f32 v49, v49
    v_exp_f32 v50, v50
    v_exp_f32 v51, v51
    v_mfma_f32_32x32x16_bf16 a[64:79], v[84:87], v[68:71], a[64:79]
    buffer_load_dwordx4 v232, s[48:51], s54 offen offset:0 sc1 lds
    v_cvt_pk_bf16_f32 v64, v48, v49
    v_cvt_pk_bf16_f32 v65, v50, v51
    v_exp_f32 v52, v52
    v_exp_f32 v53, v53
    v_exp_f32 v54, v54
    v_mfma_f32_32x32x16_bf16 v[32:47], v[72:75], v[24:27], 0
    buffer_load_dwordx4 a[236:239], v237, s[44:47], s27 offen offset:1024 sc1
    v_exp_f32 v55, v55
    v_cvt_pk_bf16_f32 v66, v52, v53
    v_cvt_pk_bf16_f32 v67, v54, v55
    v_exp_f32 v56, v56
    v_exp_f32 v57, v57
    v_mfma_f32_32x32x16_bf16 a[80:95], v[80:83], v[64:67], a[80:95]
    s_add_u32 s55, s55, 2048
    v_exp_f32 v58, v58
    v_exp_f32 v59, v59
    v_cvt_pk_bf16_f32 v68, v56, v57
    v_cvt_pk_bf16_f32 v69, v58, v59
    v_exp_f32 v60, v60
    v_mfma_f32_32x32x16_bf16 a[176:191], v[180:183], a[244:247], a[176:191]
    s_waitcnt vmcnt(27)
    v_exp_f32 v61, v61
    v_exp_f32 v62, v62
    v_exp_f32 v63, v63
    v_cvt_pk_bf16_f32 v70, v60, v61
    v_cvt_pk_bf16_f32 v71, v62, v63
    v_mfma_f32_32x32x16_bf16 a[128:143], v[184:187], a[248:251], a[128:143]
    buffer_load_dwordx4 v[176:179], v238, s[44:47], s27 offen offset:2048 sc1
    v_exp_f32 v32, v32
    v_exp_f32 v33, v33
    v_exp_f32 v34, v34
    v_exp_f32 v35, v35
    v_mfma_f32_32x32x16_bf16 a[80:95], v[84:87], v[68:71], a[80:95]
    buffer_load_dwordx4 v232, s[48:51], s54 offen offset:1024 sc1 lds
    v_cvt_pk_bf16_f32 v64, v32, v33
    v_cvt_pk_bf16_f32 v65, v34, v35
    v_exp_f32 v36, v36
    v_exp_f32 v37, v37
    v_exp_f32 v38, v38
    v_mfma_f32_32x32x16_bf16 v[48:63], v[72:75], v[28:31], 0
    buffer_load_dwordx4 v[180:183], v239, s[44:47], s27 offen offset:2048 sc1
    v_exp_f32 v39, v39
    v_cvt_pk_bf16_f32 v66, v36, v37
    v_cvt_pk_bf16_f32 v67, v38, v39
    v_exp_f32 v40, v40
    v_exp_f32 v41, v41
    v_mfma_f32_32x32x16_bf16 a[96:111], v[80:83], v[64:67], a[96:111]
    s_and_b32 s55, s55, 0x1fff
    v_exp_f32 v42, v42
    v_exp_f32 v43, v43
    v_cvt_pk_bf16_f32 v68, v40, v41
    v_cvt_pk_bf16_f32 v69, v42, v43
    v_exp_f32 v44, v44
    v_mfma_f32_32x32x16_bf16 a[144:159], v[184:187], a[252:255], a[144:159]
    s_add_u32 s54, s54, 2048
    v_exp_f32 v45, v45
    v_exp_f32 v46, v46
    v_exp_f32 v47, v47
    v_cvt_pk_bf16_f32 v70, v44, v45
    v_cvt_pk_bf16_f32 v71, v46, v47
    v_mfma_f32_32x32x16_bf16 a[160:175], v[188:191], a[248:251], a[160:175]
    buffer_load_dwordx4 a[240:243], v236, s[44:47], s27 offen offset:2048 sc1
    v_exp_f32 v48, v48
    v_exp_f32 v49, v49
    v_exp_f32 v50, v50
    v_exp_f32 v51, v51
    v_mfma_f32_32x32x16_bf16 a[96:111], v[84:87], v[68:71], a[96:111]
    s_sub_u32 s26, s26, 1
    v_cvt_pk_bf16_f32 v64, v48, v49
    v_cvt_pk_bf16_f32 v65, v50, v51
    v_exp_f32 v52, v52
    v_exp_f32 v53, v53
    v_exp_f32 v54, v54
    v_mfma_f32_32x32x16_bf16 v[32:47], v[76:79], v[0:3], 0
    buffer_load_dwordx4 a[244:247], v237, s[44:47], s27 offen offset:2048 sc1
    v_exp_f32 v55, v55
    v_cvt_pk_bf16_f32 v66, v52, v53
    v_cvt_pk_bf16_f32 v67, v54, v55
    v_exp_f32 v56, v56
    v_exp_f32 v57, v57
    v_mfma_f32_32x32x16_bf16 a[112:127], v[80:83], v[64:67], a[112:127]
    s_cmp_lg_u32 s26, 0
    v_exp_f32 v58, v58
    v_exp_f32 v59, v59
    v_cvt_pk_bf16_f32 v68, v56, v57
    v_cvt_pk_bf16_f32 v69, v58, v59
    v_exp_f32 v60, v60
    v_mfma_f32_32x32x16_bf16 a[176:191], v[188:191], a[252:255], a[176:191]
    s_waitcnt vmcnt(28)
    v_exp_f32 v61, v61
    v_exp_f32 v62, v62
    v_exp_f32 v63, v63
    v_cvt_pk_bf16_f32 v70, v60, v61
    v_cvt_pk_bf16_f32 v71, v62, v63
    s_cbranch_scc1 KA_L
KA_LAST:
    v_mfma_f32_32x32x16_bf16 a[128:143], v[128:131], a[192:195], a[128:143]
    buffer_load_dwordx4 v[184:187], v238, s[44:47], s27 offen offset:3072 sc1
    v_exp_f32 v32, v32
    v_exp_f32 v33, v33
    v_exp_f32 v34, v34
    v_exp_f32 v35, v35
    v_mfma_f32_32x32x16_bf16 a[112:127], v[84:87], v[68:71], a[112:127]
    v_add_u32 v246, s38, v232
    v_cvt_pk_bf16_f32 v64, v32, v33
    v_cvt_pk_bf16_f32 v65, v34, v35
    v_exp_f32 v36, v36
    v_exp_f32 v37, v37
    v_exp_f32 v38, v38
    v_mfma_f32_32x32x16_bf16 v[48:63], v[76:79], v[4:7], 0
    buffer_load_dwordx4 v[188:191], v239, s[44:47], s27 offen offset:3072 sc1
    v_exp_f32 v39, v39
    v_cvt_pk_bf16_f32 v66, v36, v37
    v_cvt_pk_bf16_f32 v67, v38, v39
    v_exp_f32 v40, v40
    v_exp_f32 v41, v41
    v_mfma_f32_32x32x16_bf16 a[0:15], v[88:91], v[64:67], a[0:15]
    v_lshrrev_b32 v247, 2, v232
    v_exp_f32 v42, v42
    v_exp_f32 v43, v43
    v_cvt_pk_bf16_f32 v68, v40, v41
    v_cvt_pk_bf16_f32 v69, v42, v43
    v_exp_f32 v44, v44
    v_mfma_f32_32x32x16_bf16 a[144:159], v[128:131], a[196:199], a[144:159]
    v_add_u32 v247, s38, v247
    v_exp_f32 v45, v45
    v_exp_f32 v46, v46
    v_exp_f32 v47, v47
    v_cvt_pk_bf16_f32 v70, v44, v45
    v_cvt_pk_bf16_f32 v71, v46, v47
    v_mfma_f32_32x32x16_bf16 a[160:175], v[132:135], a[192:195], a[160:175]
    buffer_load_dwordx4 a[248:251], v236, s[44:47], s27 offen offset:3072 sc1
    v_exp_f32 v48, v48
    v_exp_f32 v49, v49
    v_exp_f32 v50, v50
    v_exp_f32 v51, v51
    v_mfma_f32_32x32x16_bf16 a[0:15], v[92:95], v[68:71], a[0:15]
    v_cvt_pk_bf16_f32 v64, v48, v49
    v_cvt_pk_bf16_f32 v65, v50, v51
    v_exp_f32 v52, v52
    v_exp_f32 v53, v53
    v_exp_f32 v54, v54
    v_mfma_f32_32x32x16_bf16 v[32:47], v[76:79], v[8:11], 0
    buffer_load_dwordx4 a[252:255], v237, s[44:47], s27 offen offset:3072 sc1
    v_exp_f32 v55, v55
    v_cvt_pk_bf16_f32 v66, v52, v53
    v_cvt_pk_bf16_f32 v67, v54, v55
    v_exp_f32 v56, v56
    v_exp_f32 v57, v57
    v_mfma_f32_32x32x16_bf16 a[16:31], v[88:91], v[64:67], a[16:31]
    v_exp_f32 v58, v58
    v_exp_f32 v59, v59
    v_cvt_pk_bf16_f32 v68, v56, v57
    v_cvt_pk_bf16_f32 v69, v58, v59
    v_exp_f32 v60, v60
    v_mfma_f32_32x32x16_bf16 a[176:191], v[132:135], a[196:199], a[176:191]
    s_waitcnt vmcnt(27)
    ds_write_b128 v246, a[0:3] offset:0
    v_exp_f32 v61, v61
    v_exp_f32 v62, v62
    v_exp_f32 v63, v63
    v_cvt_pk_bf16_f32 v70, v60, v61
    v_cvt_pk_bf16_f32 v71, v62, v63
    v_mfma_f32_32x32x16_bf16 a[128:143], v[136:139], a[200:203], a[128:143]
    s_add_u32 s27, s27, 4096
    buffer_load_dwordx4 v[128:131], v238, s[44:47], s27 offen offset:0 sc1
    v_exp_f32 v32, v32
    v_exp_f32 v33, v33
    v_exp_f32 v34, v34
    v_exp_f32 v35, v35
    v_mfma_f32_32x32x16_bf16 a[16:31], v[92:95], v[68:71], a[16:31]
    ds_write_b128 v246, a[4:7] offset:1024
    v_cvt_pk_bf16_f32 v64, v32, v33
    v_cvt_pk_bf16_f32 v65, v34, v35
    v_exp_f32 v36, v36
    v_exp_f32 v37, v37
    v_exp_f32 v38, v38
    v_mfma_f32_32x32x16_bf16 v[48:63], v[76:79], v[12:15], 0
    buffer_load_dwordx4 v[132:135], v239, s[44:47], s27 offen offset:0 sc1
    v_exp_f32 v39, v39
    v_cvt_pk_bf16_f32 v66, v36, v37
    v_cvt_pk_bf16_f32 v67, v38, v39
    v_exp_f32 v40, v40
    v_exp_f32 v41, v41
    v_mfma_f32_32x32x16_bf16 a[32:47], v[88:91], v[64:67], a[32:47]
    ds_write_b32 v247, a8 offset:16384
    v_exp_f32 v42, v42
    v_exp_f32 v43, v43
    v_cvt_pk_bf16_f32 v68, v40, v41
    v_cvt_pk_bf16_f32 v69, v42, v43
    v_exp_f32 v44, v44
    v_mfma_f32_32x32x16_bf16 a[144:159], v[136:139], a[204:207], a[144:159]
    ds_write_b128 v246, a[16:19] offset:2048
    v_exp_f32 v45, v45
    v_exp_f32 v46, v46
    v_exp_f32 v47, v47
    v_cvt_pk_bf16_f32 v70, v44, v45
    v_cvt_pk_bf16_f32 v71, v46, v47
    v_mfma_f32_32x32x16_bf16 a[160:175], v[140:143], a[200:203], a[160:175]
    buffer_load_dwordx4 a[192:195], v236, s[44:47], s27 offen offset:0 sc1
    v_exp_f32 v48, v48
    v_exp_f32 v49, v49
    v_exp_f32 v50, v50
    v_exp_f32 v51, v51
    v_mfma_f32_32x32x16_bf16 a[32:47], v[92:95], v[68:71], a[32:47]
    ds_write_b128 v246, a[20:23] offset:3072
    v_cvt_pk_bf16_f32 v64, v48, v49
    v_cvt_pk_bf16_f32 v65, v50, v51
    v_exp_f32 v52, v52
    v_exp_f32 v53, v53
    v_exp_f32 v54, v54
    v_mfma_f32_32x32x16_bf16 v[32:47], v[76:79], v[16:19], 0
    buffer_load_dwordx4 a[196:199], v237, s[44:47], s27 offen offset:0 sc1
    v_exp_f32 v55, v55
    v_cvt_pk_bf16_f32 v66, v52, v53
    v_cvt_pk_bf16_f32 v67, v54, v55
    v_exp_f32 v56, v56
    v_exp_f32 v57, v57
    v_mfma_f32_32x32x16_bf16 a[48:63], v[88:91], v[64:67], a[48:63]
    ds_write_b32 v247, a24 offset:16640
    v_exp_f32 v58, v58
    v_exp_f32 v59, v59
    v_cvt_pk_bf16_f32 v68, v56, v57
    v_cvt_pk_bf16_f32 v69, v58, v59
    v_exp_f32 v60, v60
    v_mfma_f32_32x32x16_bf16 a[176:191], v[140:143], a[204:207], a[176:191]
    s_waitcnt vmcnt(26)
    ds_write_b128 v246, a[32:35] offset:4096
    v_exp_f32 v61, v61
    v_exp_f32 v62, v62
    v_exp_f32 v63, v63
    v_cvt_pk_bf16_f32 v70, v60, v61
    v_cvt_pk_bf16_f32 v71, v62, v63
    v_mfma_f32_32x32x16_bf16 a[128:143], v[144:147], a[208:211], a[128:143]
    buffer_load_dwordx4 v[136:139], v238, s[44:47], s27 offen offset:1024 sc1
    v_exp_f32 v32, v32
    v_exp_f32 v33, v33
    v_exp_f32 v34, v34
    v_exp_f32 v35, v35
    v_mfma_f32_32x32x16_bf16 a[48:63], v[92:95], v[68:71], a[48:63]
    ds_write_b128 v246, a[36:39] offset:5120
    v_cvt_pk_bf16_f32 v64, v32, v33
    v_cvt_pk_bf16_f32 v65, v34, v35
    v_exp_f32 v36, v36
    v_exp_f32 v37, v37
    v_exp_f32 v38, v38
    v_mfma_f32_32x32x16_bf16 v[48:63], v[76:79], v[20:23], 0
    buffer_load_dwordx4 v[140:143], v239, s[44:47], s27 offen offset:1024 sc1
    v_exp_f32 v39, v39
    v_cvt_pk_bf16_f32 v66, v36, v37
    v_cvt_pk_bf16_f32 v67, v38, v39
    v_exp_f32 v40, v40
    v_exp_f32 v41, v41
    v_mfma_f32_32x32x16_bf16 a[64:79], v[88:91], v[64:67], a[64:79]
    ds_write_b32 v247, a40 offset:16896
    v_exp_f32 v42, v42
    v_exp_f32 v43, v43
    v_cvt_pk_bf16_f32 v68, v40, v41
    v_cvt_pk_bf16_f32 v69, v42, v43
    v_exp_f32 v44, v44
    v_mfma_f32_32x32x16_bf16 a[144:159], v[144:147], a[212:215], a[144:159]
    ds_write_b128 v246, a[48:51] offset:6144
    v_exp_f32 v45, v45
    v_exp_f32 v46, v46
    v_exp_f32 v47, v47
    v_cvt_pk_bf16_f32 v70, v44, v45
    v_cvt_pk_bf16_f32 v71, v46, v47
    v_mfma_f32_32x32x16_bf16 a[160:175], v[148:151], a[208:211], a[160:175]
    buffer_load_dwordx4 a[200:203], v236, s[44:47], s27 offen offset:1024 sc1
    v_exp_f32 v48, v48
    v_exp_f32 v49, v49
    v_exp_f32 v50, v50
    v_exp_f32 v51, v51
    v_mfma_f32_32x32x16_bf16 a[64:79], v[92:95], v[68:71], a[64:79]
    ds_write_b128 v246, a[52:55] offset:7168
    v_cvt_pk_bf16_f32 v64, v48, v49
    v_cvt_pk_bf16_f32 v65, v50, v51
    v_exp_f32 v52, v52
    v_exp_f32 v53, v53
    v_exp_f32 v54, v54
    v_mfma_f32_32x32x16_bf16 v[32:47], v[76:79], v[24:27], 0
    buffer_load_dwordx4 a[204:207], v237, s[44:47], s27 offen offset:1024 sc1
    v_exp_f32 v55, v55
    v_cvt_pk_bf16_f32 v66, v52, v53
    v_cvt_pk_bf16_f32 v67, v54, v55
    v_exp_f32 v56, v56
    v_exp_f32 v57, v57
    v_mfma_f32_32x32x16_bf16 a[80:95], v[88:91], v[64:67], a[80:95]
    ds_write_b32 v247, a56 offset:17152
    v_exp_f32 v58, v58
    v_exp_f32 v59, v59
    v_cvt_pk_bf16_f32 v68, v56, v57
    v_cvt_pk_bf16_f32 v69, v58, v59
    v_exp_f32 v60, v60
    v_mfma_f32_32x32x16_bf16 a[176:191], v[148:151], a[212:215], a[176:191]
    s_waitcnt vmcnt(26)
    ds_write_b128 v246, a[64:67] offset:8192
    v_exp_f32 v61, v61
    v_exp_f32 v62, v62
    v_exp_f32 v63, v63
    v_cvt_pk_bf16_f32 v70, v60, v61
    v_cvt_pk_bf16_f32 v71, v62, v63
    v_mfma_f32_32x32x16_bf16 a[128:143], v[152:155], a[216:219], a[128:143]
    buffer_load_dwordx4 v[144:147], v238, s[44:47], s27 offen offset:2048 sc1
    v_exp_f32 v32, v32
    v_exp_f32 v33, v33
    v_exp_f32 v34, v34
    v_exp_f32 v35, v35
    v_mfma_f32_32x32x16_bf16 a[80:95], v[92:95], v[68:71], a[80:95]
    ds_write_b128 v246, a[68:71] offset:9216
    v_cvt_pk_bf16_f32 v64, v32, v33
    v_cvt_pk_bf16_f32 v65, v34, v35
    v_exp_f32 v36, v36
    v_exp_f32 v37, v37
    v_exp_f32 v38, v38
    v_mfma_f32_32x32x16_bf16 v[48:63], v[76:79], v[28:31], 0
    buffer_load_dwordx4 v[148:151], v239, s[44:47], s27 offen offset:2048 sc1
    v_exp_f32 v39, v39
    v_cvt_pk_bf16_f32 v66, v36, v37
    v_cvt_pk_bf16_f32 v67, v38, v39
    v_exp_f32 v40, v40
    v_exp_f32 v41, v41
    v_mfma_f32_32x32x16_bf16 a[96:111], v[88:91], v[64:67], a[96:111]
    ds_write_b32 v247, a72 offset:17408
    v_exp_f32 v42, v42
    v_exp_f32 v43, v43
    v_cvt_pk_bf16_f32 v68, v40, v41
    v_cvt_pk_bf16_f32 v69, v42, v43
    v_exp_f32 v44, v44
    v_mfma_f32_32x32x16_bf16 a[144:159], v[152:155], a[220:223], a[144:159]
    ds_write_b128 v246, a[80:83] offset:10240
    v_exp_f32 v45, v45
    v_exp_f32 v46, v46
    v_exp_f32 v47, v47
    v_cvt_pk_bf16_f32 v70, v44, v45
    v_cvt_pk_bf16_f32 v71, v46, v47
    v_mfma_f32_32x32x16_bf16 a[160:175], v[156:159], a[216:219], a[160:175]
    buffer_load_dwordx4 a[208:211], v236, s[44:47], s27 offen offset:2048 sc1
    v_exp_f32 v48, v48
    v_exp_f32 v49, v49
    v_exp_f32 v50, v50
    v_exp_f32 v51, v51
    v_mfma_f32_32x32x16_bf16 a[96:111], v[92:95], v[68:71], a[96:111]
    ds_write_b128 v246, a[84:87] offset:11264
    v_cvt_pk_bf16_f32 v64, v48, v49
    v_cvt_pk_bf16_f32 v65, v50, v51
    v_exp_f32 v52, v52
    v_exp_f32 v53, v53
    v_exp_f32 v54, v54
    s_nop 0
    buffer_load_dwordx4 a[212:215], v237, s[44:47], s27 offen offset:2048 sc1
    v_exp_f32 v55, v55
    v_cvt_pk_bf16_f32 v66, v52, v53
    v_cvt_pk_bf16_f32 v67, v54, v55
    v_exp_f32 v56, v56
    v_exp_f32 v57, v57
    v_mfma_f32_32x32x16_bf16 a[112:127], v[88:91], v[64:67], a[112:127]
    ds_write_b32 v247, a88 offset:17664
    v_exp_f32 v58, v58
    v_exp_f32 v59, v59
    v_cvt_pk_bf16_f32 v68, v56, v57
    v_cvt_pk_bf16_f32 v69, v58, v59
    v_exp_f32 v60, v60
    v_mfma_f32_32x32x16_bf16 a[176:191], v[156:159], a[220:223], a[176:191]
    s_waitcnt vmcnt(26)
    v_exp_f32 v61, v61
    v_exp_f32 v62, v62
    v_exp_f32 v63, v63
    v_cvt_pk_bf16_f32 v70, v60, v61
    v_cvt_pk_bf16_f32 v71, v62, v63
    s_nop 1
    v_mfma_f32_32x32x16_bf16 a[112:127], v[92:95], v[68:71], a[112:127]
    v_mfma_f32_32x32x16_bf16 a[128:143], v[160:163], a[224:227], a[128:143]
    buffer_load_dwordx4 v[152:155], v238, s[44:47], s27 offen offset:3072 sc1
    ds_write_b128 v246, a[96:99] offset:12288
    ds_write_b128 v246, a[100:103] offset:13312
    ds_write_b32 v247, a104 offset:17920
    v_mfma_f32_32x32x16_bf16 a[144:159], v[160:163], a[228:231], a[144:159]
    buffer_load_dwordx4 v[156:159], v239, s[44:47], s27 offen offset:3072 sc1
    s_nop 2
    v_mfma_f32_32x32x16_bf16 a[160:175], v[164:167], a[224:227], a[160:175]
    buffer_load_dwordx4 a[216:219], v236, s[44:47], s27 offen offset:3072 sc1
    ds_write_b128 v246, a[112:115] offset:14336
    ds_write_b128 v246, a[116:119] offset:15360
    ds_write_b32 v247, a120 offset:18176
    s_lshl_b32 s30, s3, 12
    s_lshl_b32 s31, s3, 9
    v_add_u32 v246, s30, v232
    v_lshrrev_b32 v247, 2, v232
    v_add_u32 v247, s31, v247
    v_add_u32 v248, 0x10000, v246
    v_add_u32 v249, 0x10000, v247
    v_mfma_f32_32x32x16_bf16 a[176:191], v[164:167], a[228:231], a[176:191]
    buffer_load_dwordx4 a[220:223], v237, s[44:47], s27 offen offset:3072 sc1
    s_waitcnt lgkmcnt(0)
    s_barrier
    s_waitcnt vmcnt(25)
    s_add_u32 s27, s27, 4096
    v_mfma_f32_32x32x16_bf16 a[128:143], v[168:171], a[232:235], a[128:143]
    buffer_load_dwordx4 v[160:163], v238, s[44:47], s27 offen offset:0 sc1
    ds_read_b128 v[0:3], v246 offset:0
    ds_read_b128 v[4:7], v246 offset:1024
    ds_read_b32 v8, v247 offset:16384
    v_mfma_f32_32x32x16_bf16 a[144:159], v[168:171], a[236:239], a[144:159]
    buffer_load_dwordx4 v[164:167], v239, s[44:47], s27 offen offset:0 sc1
    ds_read_b128 v[24:27], v246 offset:32768
    ds_read_b128 v[28:31], v246 offset:33792
    ds_read_b32 v32, v247 offset:49152
    v_mfma_f32_32x32x16_bf16 a[160:175], v[172:175], a[232:235], a[160:175]
    buffer_load_dwordx4 a[224:227], v236, s[44:47], s27 offen offset:0 sc1
    ds_read_b128 v[48:51], v248 offset:0
    ds_read_b128 v[52:55], v248 offset:1024
    ds_read_b32 v56, v249 offset:16384
    v_mfma_f32_32x32x16_bf16 a[176:191], v[172:175], a[236:239], a[176:191]
    buffer_load_dwordx4 a[228:231], v237, s[44:47], s27 offen offset:0 sc1
    ds_read_b128 v[72:75], v248 offset:32768
    ds_read_b128 v[76:79], v248 offset:33792
    ds_read_b32 v80, v249 offset:49152
    s_waitcnt vmcnt(24)
    v_mfma_f32_32x32x16_bf16 a[128:143], v[176:179], a[240:243], a[128:143]
    buffer_load_dwordx4 v[168:171], v238, s[44:47], s27 offen offset:1024 sc1
    s_waitcnt lgkmcnt(3)
    ds_read_b128 v[12:15], v246 offset:2048
    ds_read_b128 v[16:19], v246 offset:3072
    ds_read_b32 v20, v247 offset:16640
    ds_read_b128 v[36:39], v246 offset:34816
    ds_read_b128 v[40:43], v246 offset:35840
    ds_read_b32 v44, v247 offset:49408
    v_mfma_f32_32x32x16_bf16 a[144:159], v[176:179], a[244:247], a[144:159]
    buffer_load_dwordx4 v[172:175], v239, s[44:47], s27 offen offset:1024 sc1
    ds_read_b128 v[60:63], v248 offset:2048
    ds_read_b128 v[64:67], v248 offset:3072
    ds_read_b32 v68, v249 offset:16640
    ds_read_b128 v[84:87], v248 offset:34816
    ds_read_b128 v[88:91], v248 offset:35840
    ds_read_b32 v92, v249 offset:49408
    v_mov_b32 v250, 0x2b800000
    v_mov_b32 v251, 0x71800000
    s_lshl_b32 s58, s53, 3
    s_lshl_b32 s59, s3, 1
    s_add_u32 s58, s58, s59
    s_lshl_b32 s58, s58, 5
    s_add_u32 s58, s58, s52
    s_lshl_b32 s58, s58, 10
    s_add_u32 s58, s58, 75497472
    s_add_u32 s59, s58, 32768
    v_mfma_f32_32x32x16_bf16 a[160:175], v[180:183], a[240:243], a[160:175]
    buffer_load_dwordx4 a[232:235], v236, s[44:47], s27 offen offset:1024 sc1
    s_waitcnt lgkmcnt(12)
    v_add_f32 v0, v0, v24
    v_add_f32 v48, v48, v72
    v_add_f32 v1, v1, v25
    v_add_f32 v49, v49, v73
    v_add_f32 v2, v2, v26
    v_add_f32 v50, v50, v74
    v_add_f32 v3, v3, v27
    v_add_f32 v51, v51, v75
    v_add_f32 v4, v4, v28
    v_add_f32 v52, v52, v76
    v_add_f32 v5, v5, v29
    v_add_f32 v53, v53, v77
    v_add_f32 v6, v6, v30
    v_add_f32 v54, v54, v78
    v_mfma_f32_32x32x16_bf16 a[176:191], v[180:183], a[244:247], a[176:191]
    buffer_load_dwordx4 a[236:239], v237, s[44:47], s27 offen offset:1024 sc1
    v_add_f32 v7, v7, v31
    v_add_f32 v55, v55, v79
    v_add_f32 v8, v8, v32
    v_add_f32 v56, v56, v80
    v_add_f32 v96, v0, v48
    v_add_f32 v97, v1, v49
    v_add_f32 v98, v2, v50
    v_add_f32 v99, v3, v51
    v_add_f32 v100, v4, v52
    v_add_f32 v101, v5, v53
    v_add_f32 v102, v6, v54
    v_add_f32 v103, v7, v55
    v_add_f32 v104, v8, v56
    s_waitcnt vmcnt(24)
    v_mfma_f32_32x32x16_bf16 a[128:143], v[184:187], a[248:251], a[128:143]
    buffer_load_dwordx4 v[176:179], v238, s[44:47], s27 offen offset:2048 sc1
    s_waitcnt lgkmcnt(0)
    v_add_f32 v12, v12, v36
    v_add_f32 v60, v60, v84
    v_add_f32 v13, v13, v37
    v_add_f32 v61, v61, v85
    v_add_f32 v14, v14, v38
    v_add_f32 v62, v62, v86
    v_add_f32 v15, v15, v39
    v_mfma_f32_32x32x16_bf16 a[144:159], v[184:187], a[252:255], a[144:159]
    buffer_load_dwordx4 v[180:183], v239, s[44:47], s27 offen offset:2048 sc1
    v_add_f32 v63, v63, v87
    v_add_f32 v16, v16, v40
    v_add_f32 v64, v64, v88
    v_add_f32 v17, v17, v41
    v_add_f32 v65, v65, v89
    v_add_f32 v18, v18, v42
    v_add_f32 v66, v66, v90
    v_mfma_f32_32x32x16_bf16 a[160:175], v[188:191], a[248:251], a[160:175]
    buffer_load_dwordx4 a[240:243], v236, s[44:47], s27 offen offset:2048 sc1
    v_add_f32 v19, v19, v43
    v_add_f32 v67, v67, v91
    v_add_f32 v20, v20, v44
    v_add_f32 v68, v68, v92
    v_add_f32 v108, v12, v60
    v_add_f32 v109, v13, v61
    v_add_f32 v110, v14, v62
    v_mfma_f32_32x32x16_bf16 a[176:191], v[188:191], a[252:255], a[176:191]
    buffer_load_dwordx4 a[244:247], v237, s[44:47], s27 offen offset:2048 sc1
    v_add_f32 v111, v15, v63
    v_add_f32 v112, v16, v64
    v_add_f32 v113, v17, v65
    v_add_f32 v114, v18, v66
    v_add_f32 v115, v19, v67
    v_add_f32 v116, v20, v68
KA_EPI:
    v_mov_b32 v228, 0
    v_mov_b32 v229, 0
    v_mov_b32 v230, 0
    v_mov_b32 v231, 0
    s_mov_b64 s[40:41], 0
    v_cmp_ngt_f32 vcc, v104, v250
    v_rcp_f32 v247, v104
    s_or_b64 s[40:41], s[40:41], vcc
    v_cmp_nlt_f32 vcc, v104, v251
    v_mul_f32 v247, v247, v244
    s_or_b64 s[40:41], s[40:41], vcc
    v_mul_f32 v96, v96, v247
    v_mul_f32 v97, v97, v247
    v_mul_f32 v98, v98, v247
    v_mul_f32 v99, v99, v247
    v_mul_f32 v100, v100, v247
    v_mul_f32 v101, v101, v247
    v_mul_f32 v102, v102, v247
    v_mul_f32 v103, v103, v247
    v_cvt_pk_bf16_f32 v120, v96, v97
    v_cvt_pk_bf16_f32 v121, v98, v99
    v_cvt_pk_bf16_f32 v122, v100, v101
    v_cvt_pk_bf16_f32 v123, v102, v103
    s_nop 1
    v_mfma_f32_16x16x32_bf16 v[228:231], v[224:227], v[120:123], v[228:231]
    v_cmp_ngt_f32 vcc, v116, v250
    v_rcp_f32 v247, v116
    s_or_b64 s[40:41], s[40:41], vcc
    v_cmp_nlt_f32 vcc, v116, v251
    v_mul_f32 v247, v247, v245
    s_or_b64 s[40:41], s[40:41], vcc
    v_mul_f32 v108, v108, v247
    v_mul_f32 v109, v109, v247
    v_mul_f32 v110, v110, v247
    v_mul_f32 v111, v111, v247
    v_mul_f32 v112, v112, v247
    v_mul_f32 v113, v113, v247
    v_mul_f32 v114, v114, v247
    v_mul_f32 v115, v115, v247
    v_cvt_pk_bf16_f32 v124, v108, v109
    v_cvt_pk_bf16_f32 v125, v110, v111
    v_cvt_pk_bf16_f32 v126, v112, v113
    v_cvt_pk_bf16_f32 v127, v114, v115
    s_nop 1
    v_mfma_f32_16x16x32_bf16 v[228:231], v[224:227], v[124:127], v[228:231]
    s_nop 7
    v_cmp_u_f32 vcc, v228, v228
    s_nop 0
    s_or_b64 s[40:41], s[40:41], vcc
    s_cmp_lg_u64 s[40:41], 0
    s_cbranch_scc1 KA_FB
KA_OK:
    v_min_u32 v120, -2, v120
    v_min_u32 v121, -2, v121
    v_min_u32 v122, -2, v122
    v_min_u32 v123, -2, v123
    v_min_u32 v124, -2, v124
    v_min_u32 v125, -2, v125
    v_min_u32 v126, -2, v126
    v_min_u32 v127, -2, v127
    buffer_store_dwordx4 v[120:123], v232, s[44:47], s58 offen sc1
    buffer_store_dwordx4 v[124:127], v232, s[44:47], s59 offen sc1
    s_waitcnt vmcnt(26)
    v_mfma_f32_32x32x16_bf16 a[128:143], v[128:131], a[192:195], a[128:143]
    buffer_load_dwordx4 v[184:187], v238, s[44:47], s27 offen offset:3072 sc1
    v_mfma_f32_32x32x16_bf16 a[144:159], v[128:131], a[196:199], a[144:159]
    buffer_load_dwordx4 v[188:191], v239, s[44:47], s27 offen offset:3072 sc1
    v_mfma_f32_32x32x16_bf16 a[160:175], v[132:135], a[192:195], a[160:175]
    buffer_load_dwordx4 a[248:251], v236, s[44:47], s27 offen offset:3072 sc1
    v_mfma_f32_32x32x16_bf16 a[176:191], v[132:135], a[196:199], a[176:191]
    buffer_load_dwordx4 a[252:255], v237, s[44:47], s27 offen offset:3072 sc1
    s_lshl_b32 s30, s24, 16
    s_add_u32 s30, s30, 75497472
    v_add_u32 v236, s30, v232
    v_add_u32 v237, 0x8000, v236
    s_mov_b32 s28, 1048576
    v_and_b32 v246, 31, v235
    v_lshrrev_b32 v247, 5, v235
    v_mul_u32_u24 v248, 272, v246
    v_lshl_add_u32 v248, v247, 4, v248
    v_add_u32 v248, s38, v248
    s_lshl_b32 s30, s3, 4
    v_lshrrev_b32 v246, 3, v235
    v_add_u32 v246, s30, v246
    v_and_b32 v247, 7, v235
    v_mul_u32_u24 v249, 272, v246
    v_lshl_add_u32 v249, v247, 5, v249
    v_add_u32 v250, 0x10000, v249
    v_lshlrev_b32 v246, 10, v246
    v_lshl_add_u32 v246, v247, 4, v246
    s_lshl_b32 s31, s24, 16
    s_lshl_b32 s30, s25, 7
    s_add_u32 s31, s31, s30
    s_barrier
    s_waitcnt vmcnt(26)
    v_subrev_u32 v238, 32768, v238
    v_subrev_u32 v239, 32768, v239
    v_mfma_f32_32x32x16_bf16 a[128:143], v[136:139], a[200:203], a[128:143]
    buffer_load_dwordx4 v[128:131], v238, s[44:47], s36 offen offset:0 sc1
    v_mfma_f32_32x32x16_bf16 a[144:159], v[136:139], a[204:207], a[144:159]
    buffer_load_dwordx4 v[132:135], v239, s[44:47], s36 offen offset:0 sc1
    v_mfma_f32_32x32x16_bf16 a[160:175], v[140:143], a[200:203], a[160:175]
    v_mfma_f32_32x32x16_bf16 a[176:191], v[140:143], a[204:207], a[176:191]
    s_waitcnt vmcnt(24)
    v_mfma_f32_32x32x16_bf16 a[128:143], v[144:147], a[208:211], a[128:143]
    buffer_load_dwordx4 v[136:139], v238, s[44:47], s36 offen offset:1024 sc1
    v_mfma_f32_32x32x16_bf16 a[144:159], v[144:147], a[212:215], a[144:159]
    buffer_load_dwordx4 v[140:143], v239, s[44:47], s36 offen offset:1024 sc1
    v_mfma_f32_32x32x16_bf16 a[160:175], v[148:151], a[208:211], a[160:175]
    v_mfma_f32_32x32x16_bf16 a[176:191], v[148:151], a[212:215], a[176:191]
    s_waitcnt vmcnt(22)
    v_mfma_f32_32x32x16_bf16 a[128:143], v[152:155], a[216:219], a[128:143]
    buffer_load_dwordx4 v[144:147], v238, s[44:47], s36 offen offset:2048 sc1
    v_mfma_f32_32x32x16_bf16 a[144:159], v[152:155], a[220:223], a[144:159]
    buffer_load_dwordx4 v[148:151], v239, s[44:47], s36 offen offset:2048 sc1
    v_mfma_f32_32x32x16_bf16 a[160:175], v[156:159], a[216:219], a[160:175]
    v_mfma_f32_32x32x16_bf16 a[176:191], v[156:159], a[220:223], a[176:191]
    s_waitcnt vmcnt(20)
    v_mfma_f32_32x32x16_bf16 a[128:143], v[160:163], a[224:227], a[128:143]
    buffer_load_dwordx4 v[152:155], v238, s[44:47], s36 offen offset:3072 sc1
    v_mfma_f32_32x32x16_bf16 a[144:159], v[160:163], a[228:231], a[144:159]
    buffer_load_dwordx4 v[156:159], v239, s[44:47], s36 offen offset:3072 sc1
    v_mfma_f32_32x32x16_bf16 a[160:175], v[164:167], a[224:227], a[160:175]
    v_mfma_f32_32x32x16_bf16 a[176:191], v[164:167], a[228:231], a[176:191]
    s_waitcnt vmcnt(18)
    v_mfma_f32_32x32x16_bf16 a[128:143], v[168:171], a[232:235], a[128:143]
    buffer_load_dwordx4 v[160:163], v238, s[44:47], s37 offen offset:0 sc1
    v_mfma_f32_32x32x16_bf16 a[144:159], v[168:171], a[236:239], a[144:159]
    buffer_load_dwordx4 v[164:167], v239, s[44:47], s37 offen offset:0 sc1
    v_mfma_f32_32x32x16_bf16 a[160:175], v[172:175], a[232:235], a[160:175]
    v_mfma_f32_32x32x16_bf16 a[176:191], v[172:175], a[236:239], a[176:191]
    s_waitcnt vmcnt(16)
    v_mfma_f32_32x32x16_bf16 a[128:143], v[176:179], a[240:243], a[128:143]
    buffer_load_dwordx4 v[168:171], v238, s[44:47], s37 offen offset:1024 sc1
    v_mfma_f32_32x32x16_bf16 a[144:159], v[176:179], a[244:247], a[144:159]
    buffer_load_dwordx4 v[172:175], v239, s[44:47], s37 offen offset:1024 sc1
    v_mfma_f32_32x32x16_bf16 a[160:175], v[180:183], a[240:243], a[160:175]
    v_mfma_f32_32x32x16_bf16 a[176:191], v[180:183], a[244:247], a[176:191]
    s_waitcnt vmcnt(12)
    v_mfma_f32_32x32x16_bf16 a[128:143], v[184:187], a[248:251], a[128:143]
    buffer_load_dwordx4 v[176:179], v238, s[44:47], s37 offen offset:2048 sc1
    v_mfma_f32_32x32x16_bf16 a[144:159], v[184:187], a[252:255], a[144:159]
    buffer_load_dwordx4 v[180:183], v239, s[44:47], s37 offen offset:2048 sc1
    v_mfma_f32_32x32x16_bf16 a[160:175], v[188:191], a[248:251], a[160:175]
    v_mfma_f32_32x32x16_bf16 a[176:191], v[188:191], a[252:255], a[176:191]
    buffer_load_dwordx4 v[184:187], v238, s[44:47], s37 offen offset:3072 sc1
    buffer_load_dwordx4 v[188:191], v239, s[44:47], s37 offen offset:3072 sc1
KA_POLL:
    buffer_load_dwordx4 v[0:3], v236, s[44:47], s36 offen offset:0 sc1
    buffer_load_dwordx4 v[4:7], v237, s[44:47], s36 offen offset:0 sc1
    buffer_load_dwordx4 v[8:11], v236, s[44:47], s36 offen offset:1024 sc1
    buffer_load_dwordx4 v[12:15], v237, s[44:47], s36 offen offset:1024 sc1
    buffer_load_dwordx4 v[16:19], v236, s[44:47], s36 offen offset:2048 sc1
    buffer_load_dwordx4 v[20:23], v237, s[44:47], s36 offen offset:2048 sc1
    buffer_load_dwordx4 v[24:27], v236, s[44:47], s36 offen offset:3072 sc1
    buffer_load_dwordx4 v[28:31], v237, s[44:47], s36 offen offset:3072 sc1
    buffer_load_dwordx4 v[32:35], v236, s[44:47], s37 offen offset:0 sc1
    buffer_load_dwordx4 v[36:39], v237, s[44:47], s37 offen offset:0 sc1
    buffer_load_dwordx4 v[40:43], v236, s[44:47], s37 offen offset:1024 sc1
    buffer_load_dwordx4 v[44:47], v237, s[44:47], s37 offen offset:1024 sc1
    buffer_load_dwordx4 v[48:51], v236, s[44:47], s37 offen offset:2048 sc1
    buffer_load_dwordx4 v[52:55], v237, s[44:47], s37 offen offset:2048 sc1
    buffer_load_dwordx4 v[56:59], v236, s[44:47], s37 offen offset:3072 sc1
    buffer_load_dwordx4 v[60:63], v237, s[44:47], s37 offen offset:3072 sc1
    s_waitcnt vmcnt(14)
    v_mfma_f32_32x32x16_bf16 a[0:15], v[128:131], v[0:3], a[128:143]
    v_max3_u32 v254, v0, v1, 0
    v_mfma_f32_32x32x16_bf16 a[16:31], v[128:131], v[4:7], a[144:159]
    v_max3_u32 v254, v2, v3, v254
    v_mfma_f32_32x32x16_bf16 a[32:47], v[132:135], v[0:3], a[160:175]
    v_max3_u32 v254, v4, v5, v254
    v_mfma_f32_32x32x16_bf16 a[48:63], v[132:135], v[4:7], a[176:191]
    v_max3_u32 v254, v6, v7, v254
    s_waitcnt vmcnt(12)
    v_mfma_f32_32x32x16_bf16 a[0:15], v[136:139], v[8:11], a[0:15]
    v_max3_u32 v254, v8, v9, v254
    v_mfma_f32_32x32x16_bf16 a[16:31], v[136:139], v[12:15], a[16:31]
    v_max3_u32 v254, v10, v11, v254
    v_mfma_f32_32x32x16_bf16 a[32:47], v[140:143], v[8:11], a[32:47]
    v_max3_u32 v254, v12, v13, v254
    v_mfma_f32_32x32x16_bf16 a[48:63], v[140:143], v[12:15], a[48:63]
    v_max3_u32 v254, v14, v15, v254
    s_waitcnt vmcnt(10)
    v_mfma_f32_32x32x16_bf16 a[0:15], v[144:147], v[16:19], a[0:15]
    v_max3_u32 v254, v16, v17, v254
    v_mfma_f32_32x32x16_bf16 a[16:31], v[144:147], v[20:23], a[16:31]
    v_max3_u32 v254, v18, v19, v254
    v_mfma_f32_32x32x16_bf16 a[32:47], v[148:151], v[16:19], a[32:47]
    v_max3_u32 v254, v20, v21, v254
    v_mfma_f32_32x32x16_bf16 a[48:63], v[148:151], v[20:23], a[48:63]
    v_max3_u32 v254, v22, v23, v254
    s_waitcnt vmcnt(8)
    v_mfma_f32_32x32x16_bf16 a[0:15], v[152:155], v[24:27], a[0:15]
    v_max3_u32 v254, v24, v25, v254
    v_mfma_f32_32x32x16_bf16 a[16:31], v[152:155], v[28:31], a[16:31]
    v_max3_u32 v254, v26, v27, v254
    v_mfma_f32_32x32x16_bf16 a[32:47], v[156:159], v[24:27], a[32:47]
    v_max3_u32 v254, v28, v29, v254
    v_mfma_f32_32x32x16_bf16 a[48:63], v[156:159], v[28:31], a[48:63]
    v_max3_u32 v254, v30, v31, v254
    s_waitcnt vmcnt(6)
    v_mfma_f32_32x32x16_bf16 a[0:15], v[160:163], v[32:35], a[0:15]
    v_max3_u32 v254, v32, v33, v254
    v_mfma_f32_32x32x16_bf16 a[16:31], v[160:163], v[36:39], a[16:31]
    v_max3_u32 v254, v34, v35, v254
    v_mfma_f32_32x32x16_bf16 a[32:47], v[164:167], v[32:35], a[32:47]
    v_max3_u32 v254, v36, v37, v254
    v_mfma_f32_32x32x16_bf16 a[48:63], v[164:167], v[36:39], a[48:63]
    v_max3_u32 v254, v38, v39, v254
    s_waitcnt vmcnt(4)
    v_mfma_f32_32x32x16_bf16 a[0:15], v[168:171], v[40:43], a[0:15]
    v_max3_u32 v254, v40, v41, v254
    v_mfma_f32_32x32x16_bf16 a[16:31], v[168:171], v[44:47], a[16:31]
    v_max3_u32 v254, v42, v43, v254
    v_mfma_f32_32x32x16_bf16 a[32:47], v[172:175], v[40:43], a[32:47]
    v_max3_u32 v254, v44, v45, v254
    v_mfma_f32_32x32x16_bf16 a[48:63], v[172:175], v[44:47], a[48:63]
    v_max3_u32 v254, v46, v47, v254
    s_waitcnt vmcnt(2)
    v_mfma_f32_32x32x16_bf16 a[0:15], v[176:179], v[48:51], a[0:15]
    v_max3_u32 v254, v48, v49, v254
    v_mfma_f32_32x32x16_bf16 a[16:31], v[176:179], v[52:55], a[16:31]
    v_max3_u32 v254, v50, v51, v254
    v_mfma_f32_32x32x16_bf16 a[32:47], v[180:183], v[48:51], a[32:47]
    v_max3_u32 v254, v52, v53, v254
    v_mfma_f32_32x32x16_bf16 a[48:63], v[180:183], v[52:55], a[48:63]
    v_max3_u32 v254, v54, v55, v254
    s_waitcnt vmcnt(0)
    v_mfma_f32_32x32x16_bf16 a[0:15], v[184:187], v[56:59], a[0:15]
    v_max3_u32 v254, v56, v57, v254
    v_mfma_f32_32x32x16_bf16 a[16:31], v[184:187], v[60:63], a[16:31]
    v_max3_u32 v254, v58, v59, v254
    v_mfma_f32_32x32x16_bf16 a[32:47], v[188:191], v[56:59], a[32:47]
    v_max3_u32 v254, v60, v61, v254
    v_mfma_f32_32x32x16_bf16 a[48:63], v[188:191], v[60:63], a[48:63]
    v_max3_u32 v254, v62, v63, v254
    v_cmp_eq_u32 vcc, -1, v254
    s_sub_u32 s28, s28, 1
    s_cmp_eq_u32 s28, 0
    s_cselect_b64 vcc, 0, vcc
    s_cmp_lg_u64 vcc, 0
    s_cbranch_scc1 KA_POLL
    s_nop 2
    ds_write_b128 v248, a[0:3] offset:0
    ds_write_b128 v248, a[4:7] offset:32
    ds_write_b128 v248, a[8:11] offset:64
    ds_write_b128 v248, a[12:15] offset:96
    ds_write_b128 v248, a[16:19] offset:8704
    ds_write_b128 v248, a[20:23] offset:8736
    ds_write_b128 v248, a[24:27] offset:8768
    ds_write_b128 v248, a[28:31] offset:8800
    ds_write_b128 v248, a[32:35] offset:128
    ds_write_b128 v248, a[36:39] offset:160
    ds_write_b128 v248, a[40:43] offset:192
    ds_write_b128 v248, a[44:47] offset:224
    ds_write_b128 v248, a[48:51] offset:8832
    ds_write_b128 v248, a[52:55] offset:8864
    ds_write_b128 v248, a[56:59] offset:8896
    ds_write_b128 v248, a[60:63] offset:8928
    s_waitcnt lgkmcnt(0)
    s_barrier
    ds_read_b128 v[0:3], v249 offset:0
    ds_read_b128 v[4:7], v249 offset:16
    ds_read_b128 v[8:11], v249 offset:2176
    ds_read_b128 v[12:15], v249 offset:2192
    ds_read_b128 v[16:19], v249 offset:32768
    ds_read_b128 v[20:23], v249 offset:32784
    ds_read_b128 v[24:27], v249 offset:34944
    ds_read_b128 v[28:31], v249 offset:34960
    ds_read_b128 v[32:35], v250 offset:0
    ds_read_b128 v[36:39], v250 offset:16
    ds_read_b128 v[40:43], v250 offset:2176
    ds_read_b128 v[44:47], v250 offset:2192
    s_waitcnt lgkmcnt(4)
    v_add_f32 v0, v0, v16
    v_add_f32 v1, v1, v17
    v_add_f32 v2, v2, v18
    v_add_f32 v3, v3, v19
    v_add_f32 v4, v4, v20
    v_add_f32 v5, v5, v21
    v_add_f32 v6, v6, v22
    v_add_f32 v7, v7, v23
    v_add_f32 v8, v8, v24
    v_add_f32 v9, v9, v25
    v_add_f32 v10, v10, v26
    v_add_f32 v11, v11, v27
    v_add_f32 v12, v12, v28
    v_add_f32 v13, v13, v29
    v_add_f32 v14, v14, v30
    v_add_f32 v15, v15, v31
    ds_read_b128 v[48:51], v250 offset:32768
    ds_read_b128 v[52:55], v250 offset:32784
    ds_read_b128 v[56:59], v250 offset:34944
    ds_read_b128 v[60:63], v250 offset:34960
    s_waitcnt lgkmcnt(4)
    v_add_f32 v0, v0, v32
    v_add_f32 v1, v1, v33
    v_add_f32 v2, v2, v34
    v_add_f32 v3, v3, v35
    v_add_f32 v4, v4, v36
    v_add_f32 v5, v5, v37
    v_add_f32 v6, v6, v38
    v_add_f32 v7, v7, v39
    v_add_f32 v8, v8, v40
    v_add_f32 v9, v9, v41
    v_add_f32 v10, v10, v42
    v_add_f32 v11, v11, v43
    v_add_f32 v12, v12, v44
    v_add_f32 v13, v13, v45
    v_add_f32 v14, v14, v46
    v_add_f32 v15, v15, v47
    s_waitcnt lgkmcnt(0)
    v_add_f32 v0, v0, v48
    v_add_f32 v1, v1, v49
    v_add_f32 v2, v2, v50
    v_add_f32 v3, v3, v51
    v_add_f32 v4, v4, v52
    v_add_f32 v5, v5, v53
    v_add_f32 v6, v6, v54
    v_add_f32 v7, v7, v55
    v_add_f32 v8, v8, v56
    v_add_f32 v9, v9, v57
    v_add_f32 v10, v10, v58
    v_add_f32 v11, v11, v59
    v_add_f32 v12, v12, v60
    v_add_f32 v13, v13, v61
    v_add_f32 v14, v14, v62
    v_add_f32 v15, v15, v63
    v_cvt_pk_bf16_f32 v16, v0, v1
    v_cvt_pk_bf16_f32 v17, v2, v3
    v_cvt_pk_bf16_f32 v18, v4, v5
    v_cvt_pk_bf16_f32 v19, v6, v7
    v_cvt_pk_bf16_f32 v20, v8, v9
    v_cvt_pk_bf16_f32 v21, v10, v11
    v_cvt_pk_bf16_f32 v22, v12, v13
    v_cvt_pk_bf16_f32 v23, v14, v15
    s_add_u32 s30, s31, 8192
    buffer_store_dwordx4 v[16:19], v246, s[20:23], s31 offen sc1
    buffer_store_dwordx4 v[20:23], v246, s[20:23], s30 offen sc1
ALL_EXIT:
    s_endpgm
K1_FN:
    v_mfma_f32_16x16x32_bf16 v[144:147], a[0:3], v[64:67], 0
    ds_read_b64_tr_b16 v[80:81], v105 offset:0
    v_mfma_f32_16x16x32_bf16 v[144:147], a[4:7], v[68:71], v[144:147]
    ds_read_b64_tr_b16 v[82:83], v105 offset:2048
    s_add_u32 s62, s63, 256
    v_mfma_f32_16x16x32_bf16 v[144:147], a[8:11], v[72:75], v[144:147]
    ds_read_b64_tr_b16 v[84:85], v105 offset:4096
    s_add_u32 m0, s64, 0
    v_mfma_f32_16x16x32_bf16 v[144:147], a[12:15], v[76:79], v[144:147]
    s_nop 0
    v_mfma_f32_16x16x32_bf16 v[148:151], a[64:67], v[64:67], 0
    ds_read_b64_tr_b16 v[86:87], v105 offset:6144
    v_mfma_f32_16x16x32_bf16 v[148:151], a[68:71], v[68:71], v[148:151]
    ds_read_b64_tr_b16 v[88:89], v105 offset:8192
    v_mfma_f32_16x16x32_bf16 v[148:151], a[72:75], v[72:75], v[148:151]
    ds_read_b64_tr_b16 v[90:91], v105 offset:10240
    v_mfma_f32_16x16x32_bf16 v[148:151], a[76:79], v[76:79], v[148:151]
    buffer_load_dwordx4 v112, s[20:23], s62 offen offset:0 lds
    v_mfma_f32_16x16x32_bf16 v[160:163], a[128:131], v[64:67], 0
    ds_read_b64_tr_b16 v[92:93], v105 offset:12288
    s_add_u32 s62, s62, 7168
    v_mfma_f32_16x16x32_bf16 v[160:163], a[132:135], v[68:71], v[160:163]
    ds_read_b64_tr_b16 v[94:95], v105 offset:14336
    v_mfma_f32_16x16x32_bf16 v[160:163], a[136:139], v[72:75], v[160:163]
    v_mfma_f32_16x16x32_bf16 v[160:163], a[140:143], v[76:79], v[160:163]
    buffer_load_dwordx4 v113, s[20:23], s62 offen offset:1024 lds
    v_mfma_f32_16x16x32_bf16 v[164:167], a[192:195], v[64:67], 0
    s_add_u32 s62, s62, 7168
    v_mfma_f32_16x16x32_bf16 v[164:167], a[196:199], v[68:71], v[164:167]
    v_mfma_f32_16x16x32_bf16 v[164:167], a[200:203], v[72:75], v[164:167]
    v_mfma_f32_16x16x32_bf16 v[164:167], a[204:207], v[76:79], v[164:167]
    s_waitcnt lgkmcnt(0)
    buffer_load_dwordx4 v112, s[20:23], s62 offen offset:2048 lds
    v_mfma_f32_16x16x32_bf16 v[152:155], a[0:3], v[80:83], 0
    ds_read_b64_tr_b16 v[64:65], v106 offset:0
    s_add_u32 s62, s62, 7168
    v_mfma_f32_16x16x32_bf16 v[152:155], a[4:7], v[84:87], v[152:155]
    ds_read_b64_tr_b16 v[66:67], v106 offset:2048
    v_mfma_f32_16x16x32_bf16 v[152:155], a[8:11], v[88:91], v[152:155]
    ds_read_b64_tr_b16 v[68:69], v106 offset:4096
    v_mfma_f32_16x16x32_bf16 v[152:155], a[12:15], v[92:95], v[152:155]
    buffer_load_dwordx4 v113, s[20:23], s62 offen offset:3072 lds
    v_mfma_f32_16x16x32_bf16 v[156:159], a[64:67], v[80:83], 0
    ds_read_b64_tr_b16 v[70:71], v106 offset:6144
    s_add_u32 m0, s64, 4096
    v_mfma_f32_16x16x32_bf16 v[156:159], a[68:71], v[84:87], v[156:159]
    ds_read_b64_tr_b16 v[72:73], v106 offset:8192
    s_add_u32 s62, s62, 11264
    v_mfma_f32_16x16x32_bf16 v[156:159], a[72:75], v[88:91], v[156:159]
    ds_read_b64_tr_b16 v[74:75], v106 offset:10240
    v_mfma_f32_16x16x32_bf16 v[156:159], a[76:79], v[92:95], v[156:159]
    buffer_load_dwordx4 v112, s[20:23], s62 offen offset:0 lds
    v_mfma_f32_16x16x32_bf16 v[168:171], a[128:131], v[80:83], 0
    ds_read_b64_tr_b16 v[76:77], v106 offset:12288
    s_add_u32 s62, s62, 7168
    v_mfma_f32_16x16x32_bf16 v[168:171], a[132:135], v[84:87], v[168:171]
    ds_read_b64_tr_b16 v[78:79], v106 offset:14336
    v_mfma_f32_16x16x32_bf16 v[168:171], a[136:139], v[88:91], v[168:171]
    v_mfma_f32_16x16x32_bf16 v[168:171], a[140:143], v[92:95], v[168:171]
    buffer_load_dwordx4 v113, s[20:23], s62 offen offset:1024 lds
    v_mfma_f32_16x16x32_bf16 v[172:175], a[192:195], v[80:83], 0
    s_add_u32 s62, s62, 7168
    v_mfma_f32_16x16x32_bf16 v[172:175], a[196:199], v[84:87], v[172:175]
    v_mfma_f32_16x16x32_bf16 v[172:175], a[200:203], v[88:91], v[172:175]
    v_mfma_f32_16x16x32_bf16 v[172:175], a[204:207], v[92:95], v[172:175]
    s_waitcnt lgkmcnt(0)
    buffer_load_dwordx4 v112, s[20:23], s62 offen offset:2048 lds
    v_mfma_f32_16x16x32_bf16 v[176:179], a[0:3], v[64:67], 0
    ds_read_b64_tr_b16 v[80:81], v107 offset:0
    s_add_u32 s62, s62, 7168
    v_mfma_f32_16x16x32_bf16 v[176:179], a[4:7], v[68:71], v[176:179]
    ds_read_b64_tr_b16 v[82:83], v107 offset:2048
    v_mfma_f32_16x16x32_bf16 v[176:179], a[8:11], v[72:75], v[176:179]
    ds_read_b64_tr_b16 v[84:85], v107 offset:4096
    v_mfma_f32_16x16x32_bf16 v[176:179], a[12:15], v[76:79], v[176:179]
    buffer_load_dwordx4 v113, s[20:23], s62 offen offset:3072 lds
    v_mfma_f32_16x16x32_bf16 v[180:183], a[64:67], v[64:67], 0
    ds_read_b64_tr_b16 v[86:87], v107 offset:6144
    s_add_u32 s62, s63, 384
    v_mfma_f32_16x16x32_bf16 v[180:183], a[68:71], v[68:71], v[180:183]
    ds_read_b64_tr_b16 v[88:89], v107 offset:8192
    s_add_u32 m0, s64, 32768
    v_mfma_f32_16x16x32_bf16 v[180:183], a[72:75], v[72:75], v[180:183]
    ds_read_b64_tr_b16 v[90:91], v107 offset:10240
    s_nop 0
    v_mfma_f32_16x16x32_bf16 v[180:183], a[76:79], v[76:79], v[180:183]
    buffer_load_dwordx4 v112, s[20:23], s62 offen offset:0 lds
    v_mfma_f32_16x16x32_bf16 v[192:195], a[128:131], v[64:67], 0
    ds_read_b64_tr_b16 v[92:93], v107 offset:12288
    s_add_u32 s62, s62, 7168
    v_mfma_f32_16x16x32_bf16 v[192:195], a[132:135], v[68:71], v[192:195]
    ds_read_b64_tr_b16 v[94:95], v107 offset:14336
    v_mfma_f32_16x16x32_bf16 v[192:195], a[136:139], v[72:75], v[192:195]
    s_waitcnt vmcnt(10)
    s_barrier
    v_mfma_f32_16x16x32_bf16 v[192:195], a[140:143], v[76:79], v[192:195]
    buffer_load_dwordx4 v113, s[20:23], s62 offen offset:1024 lds
    v_mfma_f32_16x16x32_bf16 v[196:199], a[192:195], v[64:67], 0
    s_add_u32 s62, s62, 7168
    v_mfma_f32_16x16x32_bf16 v[196:199], a[196:199], v[68:71], v[196:199]
    v_mfma_f32_16x16x32_bf16 v[196:199], a[200:203], v[72:75], v[196:199]
    v_mfma_f32_16x16x32_bf16 v[196:199], a[204:207], v[76:79], v[196:199]
    s_waitcnt lgkmcnt(0)
    buffer_load_dwordx4 v112, s[20:23], s62 offen offset:2048 lds
    v_mfma_f32_16x16x32_bf16 v[184:187], a[0:3], v[80:83], 0
    ds_read_b64_tr_b16 v[64:65], v118 offset:0
    s_add_u32 s62, s62, 7168
    v_mfma_f32_16x16x32_bf16 v[184:187], a[4:7], v[84:87], v[184:187]
    ds_read_b64_tr_b16 v[66:67], v118 offset:2048
    v_mfma_f32_16x16x32_bf16 v[184:187], a[8:11], v[88:91], v[184:187]
    ds_read_b64_tr_b16 v[68:69], v118 offset:4096
    v_mfma_f32_16x16x32_bf16 v[184:187], a[12:15], v[92:95], v[184:187]
    buffer_load_dwordx4 v113, s[20:23], s62 offen offset:3072 lds
    v_mfma_f32_16x16x32_bf16 v[188:191], a[64:67], v[80:83], 0
    ds_read_b64_tr_b16 v[70:71], v118 offset:6144
    s_add_u32 m0, s64, 36864
    v_mfma_f32_16x16x32_bf16 v[188:191], a[68:71], v[84:87], v[188:191]
    ds_read_b64_tr_b16 v[72:73], v118 offset:8192
    s_add_u32 s62, s62, 11264
    v_mfma_f32_16x16x32_bf16 v[188:191], a[72:75], v[88:91], v[188:191]
    ds_read_b64_tr_b16 v[74:75], v118 offset:10240
    v_mfma_f32_16x16x32_bf16 v[188:191], a[76:79], v[92:95], v[188:191]
    buffer_load_dwordx4 v112, s[20:23], s62 offen offset:0 lds
    v_mfma_f32_16x16x32_bf16 v[200:203], a[128:131], v[80:83], 0
    ds_read_b64_tr_b16 v[76:77], v118 offset:12288
    s_add_u32 s62, s62, 7168
    v_mfma_f32_16x16x32_bf16 v[200:203], a[132:135], v[84:87], v[200:203]
    ds_read_b64_tr_b16 v[78:79], v118 offset:14336
    v_mfma_f32_16x16x32_bf16 v[200:203], a[136:139], v[88:91], v[200:203]
    v_mfma_f32_16x16x32_bf16 v[200:203], a[140:143], v[92:95], v[200:203]
    buffer_load_dwordx4 v113, s[20:23], s62 offen offset:1024 lds
    v_mfma_f32_16x16x32_bf16 v[204:207], a[192:195], v[80:83], 0
    s_add_u32 s62, s62, 7168
    v_mfma_f32_16x16x32_bf16 v[204:207], a[196:199], v[84:87], v[204:207]
    v_mfma_f32_16x16x32_bf16 v[204:207], a[200:203], v[88:91], v[204:207]
    v_mfma_f32_16x16x32_bf16 v[204:207], a[204:207], v[92:95], v[204:207]
    s_waitcnt lgkmcnt(0)
    buffer_load_dwordx4 v112, s[20:23], s62 offen offset:2048 lds
    v_mfma_f32_16x16x32_bf16 v[0:3], a[0:3], v[64:67], 0
    ds_read_b64_tr_b16 v[80:81], v119 offset:0
    s_add_u32 s62, s62, 7168
    v_mfma_f32_16x16x32_bf16 v[0:3], a[4:7], v[68:71], v[0:3]
    ds_read_b64_tr_b16 v[82:83], v119 offset:2048
    v_mfma_f32_16x16x32_bf16 v[0:3], a[8:11], v[72:75], v[0:3]
    ds_read_b64_tr_b16 v[84:85], v119 offset:4096
    v_mfma_f32_16x16x32_bf16 v[0:3], a[12:15], v[76:79], v[0:3]
    buffer_load_dwordx4 v113, s[20:23], s62 offen offset:3072 lds
    v_mfma_f32_16x16x32_bf16 v[4:7], a[64:67], v[64:67], 0
    ds_read_b64_tr_b16 v[86:87], v119 offset:6144
    s_add_u32 s62, s63, 512
    v_mfma_f32_16x16x32_bf16 v[4:7], a[68:71], v[68:71], v[4:7]
    ds_read_b64_tr_b16 v[88:89], v119 offset:8192
    s_add_u32 m0, s64, 65536
    v_mfma_f32_16x16x32_bf16 v[4:7], a[72:75], v[72:75], v[4:7]
    ds_read_b64_tr_b16 v[90:91], v119 offset:10240
    s_nop 0
    v_mfma_f32_16x16x32_bf16 v[4:7], a[76:79], v[76:79], v[4:7]
    buffer_load_dwordx4 v112, s[20:23], s62 offen offset:0 lds
    v_mfma_f32_16x16x32_bf16 v[16:19], a[128:131], v[64:67], 0
    ds_read_b64_tr_b16 v[92:93], v119 offset:12288
    s_add_u32 s62, s62, 7168
    v_mfma_f32_16x16x32_bf16 v[16:19], a[132:135], v[68:71], v[16:19]
    ds_read_b64_tr_b16 v[94:95], v119 offset:14336
    v_mfma_f32_16x16x32_bf16 v[16:19], a[136:139], v[72:75], v[16:19]
    v_mfma_f32_16x16x32_bf16 v[16:19], a[140:143], v[76:79], v[16:19]
    buffer_load_dwordx4 v113, s[20:23], s62 offen offset:1024 lds
    v_mfma_f32_16x16x32_bf16 v[20:23], a[192:195], v[64:67], 0
    s_add_u32 s62, s62, 7168
    v_mfma_f32_16x16x32_bf16 v[20:23], a[196:199], v[68:71], v[20:23]
    v_mfma_f32_16x16x32_bf16 v[20:23], a[200:203], v[72:75], v[20:23]
    v_mfma_f32_16x16x32_bf16 v[20:23], a[204:207], v[76:79], v[20:23]
    s_waitcnt lgkmcnt(0)
    buffer_load_dwordx4 v112, s[20:23], s62 offen offset:2048 lds
    v_mfma_f32_16x16x32_bf16 v[8:11], a[0:3], v[80:83], 0
    ds_read_b64_tr_b16 v[64:65], v120 offset:0
    s_add_u32 s62, s62, 7168
    v_mfma_f32_16x16x32_bf16 v[8:11], a[4:7], v[84:87], v[8:11]
    ds_read_b64_tr_b16 v[66:67], v120 offset:2048
    v_mfma_f32_16x16x32_bf16 v[8:11], a[8:11], v[88:91], v[8:11]
    ds_read_b64_tr_b16 v[68:69], v120 offset:4096
    s_waitcnt vmcnt(11)
    v_mfma_f32_16x16x32_bf16 v[8:11], a[12:15], v[92:95], v[8:11]
    ds_read_b128 a[16:19], v114 offset:0
    ds_read_b128 a[80:83], v114 offset:2048
    v_mfma_f32_16x16x32_bf16 v[12:15], a[64:67], v[80:83], 0
    ds_read_b64_tr_b16 v[70:71], v120 offset:6144
    v_mfma_f32_16x16x32_bf16 v[12:15], a[68:71], v[84:87], v[12:15]
    ds_read_b64_tr_b16 v[72:73], v120 offset:8192
    v_mfma_f32_16x16x32_bf16 v[12:15], a[72:75], v[88:91], v[12:15]
    ds_read_b64_tr_b16 v[74:75], v120 offset:10240
    v_mfma_f32_16x16x32_bf16 v[12:15], a[76:79], v[92:95], v[12:15]
    ds_read_b128 a[144:147], v114 offset:4096
    ds_read_b128 a[208:211], v114 offset:6144
    v_mfma_f32_16x16x32_bf16 v[24:27], a[128:131], v[80:83], 0
    ds_read_b64_tr_b16 v[76:77], v120 offset:12288
    v_mfma_f32_16x16x32_bf16 v[24:27], a[132:135], v[84:87], v[24:27]
    ds_read_b64_tr_b16 v[78:79], v120 offset:14336
    v_mfma_f32_16x16x32_bf16 v[24:27], a[136:139], v[88:91], v[24:27]
    ds_read_b128 a[20:23], v115 offset:0
    ds_read_b128 a[84:87], v115 offset:2048
    v_mfma_f32_16x16x32_bf16 v[24:27], a[140:143], v[92:95], v[24:27]
    ds_read_b128 a[148:151], v115 offset:4096
    ds_read_b128 a[212:215], v115 offset:6144
    v_mfma_f32_16x16x32_bf16 v[28:31], a[192:195], v[80:83], 0
    buffer_load_dwordx4 v113, s[20:23], s62 offen offset:3072 lds
    v_mfma_f32_16x16x32_bf16 v[28:31], a[196:199], v[84:87], v[28:31]
    s_add_u32 m0, s64, 69632
    s_add_u32 s62, s62, 11264
    v_mfma_f32_16x16x32_bf16 v[28:31], a[200:203], v[88:91], v[28:31]
    v_mfma_f32_16x16x32_bf16 v[28:31], a[204:207], v[92:95], v[28:31]
    s_waitcnt lgkmcnt(0)
    v_mfma_f32_16x16x32_bf16 v[32:35], a[0:3], v[64:67], 0
    ds_read_b64_tr_b16 v[80:81], v121 offset:0
    v_mfma_f32_16x16x32_bf16 v[32:35], a[4:7], v[68:71], v[32:35]
    ds_read_b64_tr_b16 v[82:83], v121 offset:2048
    v_mfma_f32_16x16x32_bf16 v[32:35], a[8:11], v[72:75], v[32:35]
    ds_read_b64_tr_b16 v[84:85], v121 offset:4096
    v_mfma_f32_16x16x32_bf16 v[32:35], a[12:15], v[76:79], v[32:35]
    buffer_load_dwordx4 v112, s[20:23], s62 offen offset:0 lds
    v_mfma_f32_16x16x32_bf16 v[36:39], a[64:67], v[64:67], 0
    ds_read_b64_tr_b16 v[86:87], v121 offset:6144
    s_add_u32 s62, s62, 7168
    v_mfma_f32_16x16x32_bf16 v[36:39], a[68:71], v[68:71], v[36:39]
    ds_read_b64_tr_b16 v[88:89], v121 offset:8192
    v_mfma_f32_16x16x32_bf16 v[36:39], a[72:75], v[72:75], v[36:39]
    ds_read_b64_tr_b16 v[90:91], v121 offset:10240
    v_mfma_f32_16x16x32_bf16 v[36:39], a[76:79], v[76:79], v[36:39]
    buffer_load_dwordx4 v113, s[20:23], s62 offen offset:1024 lds
    v_mfma_f32_16x16x32_bf16 v[48:51], a[128:131], v[64:67], 0
    ds_read_b64_tr_b16 v[92:93], v121 offset:12288
    s_add_u32 s62, s62, 7168
    v_mfma_f32_16x16x32_bf16 v[48:51], a[132:135], v[68:71], v[48:51]
    ds_read_b64_tr_b16 v[94:95], v121 offset:14336
    v_mfma_f32_16x16x32_bf16 v[48:51], a[136:139], v[72:75], v[48:51]
    v_mfma_f32_16x16x32_bf16 v[48:51], a[140:143], v[76:79], v[48:51]
    buffer_load_dwordx4 v112, s[20:23], s62 offen offset:2048 lds
    v_mfma_f32_16x16x32_bf16 v[52:55], a[192:195], v[64:67], 0
    s_add_u32 s62, s62, 7168
    v_mfma_f32_16x16x32_bf16 v[52:55], a[196:199], v[68:71], v[52:55]
    v_mfma_f32_16x16x32_bf16 v[52:55], a[200:203], v[72:75], v[52:55]
    v_mfma_f32_16x16x32_bf16 v[52:55], a[204:207], v[76:79], v[52:55]
    s_waitcnt lgkmcnt(0)
    buffer_load_dwordx4 v113, s[20:23], s62 offen offset:3072 lds
    v_mfma_f32_16x16x32_bf16 v[40:43], a[0:3], v[80:83], 0
    ds_read_b64_tr_b16 v[64:65], v104 offset:16384
    s_add_u32 s62, s63, 640
    v_mfma_f32_16x16x32_bf16 v[40:43], a[4:7], v[84:87], v[40:43]
    ds_read_b64_tr_b16 v[66:67], v104 offset:18432
    s_add_u32 m0, s64, 0
    v_mfma_f32_16x16x32_bf16 v[40:43], a[8:11], v[88:91], v[40:43]
    ds_read_b64_tr_b16 v[68:69], v104 offset:20480
    s_waitcnt vmcnt(8)
    v_mfma_f32_16x16x32_bf16 v[40:43], a[12:15], v[92:95], v[40:43]
    ds_read_b128 a[24:27], v114 offset:32768
    ds_read_b128 a[88:91], v114 offset:34816
    v_mfma_f32_16x16x32_bf16 v[44:47], a[64:67], v[80:83], 0
    ds_read_b64_tr_b16 v[70:71], v104 offset:22528
    s_nop 0
    v_mfma_f32_16x16x32_bf16 v[44:47], a[68:71], v[84:87], v[44:47]
    ds_read_b64_tr_b16 v[72:73], v104 offset:24576
    v_mfma_f32_16x16x32_bf16 v[44:47], a[72:75], v[88:91], v[44:47]
    ds_read_b64_tr_b16 v[74:75], v104 offset:26624
    v_mfma_f32_16x16x32_bf16 v[44:47], a[76:79], v[92:95], v[44:47]
    ds_read_b128 a[152:155], v114 offset:36864
    ds_read_b128 a[216:219], v114 offset:38912
    v_mfma_f32_16x16x32_bf16 v[56:59], a[128:131], v[80:83], 0
    ds_read_b64_tr_b16 v[76:77], v104 offset:28672
    v_mfma_f32_16x16x32_bf16 v[56:59], a[132:135], v[84:87], v[56:59]
    ds_read_b64_tr_b16 v[78:79], v104 offset:30720
    v_mfma_f32_16x16x32_bf16 v[56:59], a[136:139], v[88:91], v[56:59]
    ds_read_b128 a[28:31], v115 offset:32768
    ds_read_b128 a[92:95], v115 offset:34816
    v_mfma_f32_16x16x32_bf16 v[56:59], a[140:143], v[92:95], v[56:59]
    ds_read_b128 a[156:159], v115 offset:36864
    ds_read_b128 a[220:223], v115 offset:38912
    v_mfma_f32_16x16x32_bf16 v[60:63], a[192:195], v[80:83], 0
    buffer_load_dwordx4 v112, s[20:23], s62 offen offset:0 lds
    v_mfma_f32_16x16x32_bf16 v[60:63], a[196:199], v[84:87], v[60:63]
    s_add_u32 s62, s62, 7168
    v_mfma_f32_16x16x32_bf16 v[60:63], a[200:203], v[88:91], v[60:63]
    v_mfma_f32_16x16x32_bf16 v[60:63], a[204:207], v[92:95], v[60:63]
    s_waitcnt lgkmcnt(0)
    v_mfma_f32_16x16x32_bf16 v[144:147], a[16:19], v[64:67], v[144:147]
    ds_read_b64_tr_b16 v[80:81], v105 offset:16384
    v_mfma_f32_16x16x32_bf16 v[144:147], a[20:23], v[68:71], v[144:147]
    ds_read_b64_tr_b16 v[82:83], v105 offset:18432
    v_mfma_f32_16x16x32_bf16 v[144:147], a[24:27], v[72:75], v[144:147]
    ds_read_b64_tr_b16 v[84:85], v105 offset:20480
    v_mfma_f32_16x16x32_bf16 v[144:147], a[28:31], v[76:79], v[144:147]
    buffer_load_dwordx4 v113, s[20:23], s62 offen offset:1024 lds
    v_mfma_f32_16x16x32_bf16 v[148:151], a[80:83], v[64:67], v[148:151]
    ds_read_b64_tr_b16 v[86:87], v105 offset:22528
    s_add_u32 s62, s62, 7168
    v_mfma_f32_16x16x32_bf16 v[148:151], a[84:87], v[68:71], v[148:151]
    ds_read_b64_tr_b16 v[88:89], v105 offset:24576
    v_mfma_f32_16x16x32_bf16 v[148:151], a[88:91], v[72:75], v[148:151]
    ds_read_b64_tr_b16 v[90:91], v105 offset:26624
    v_mfma_f32_16x16x32_bf16 v[148:151], a[92:95], v[76:79], v[148:151]
    buffer_load_dwordx4 v112, s[20:23], s62 offen offset:2048 lds
    v_mfma_f32_16x16x32_bf16 v[160:163], a[144:147], v[64:67], v[160:163]
    ds_read_b64_tr_b16 v[92:93], v105 offset:28672
    s_add_u32 s62, s62, 7168
    v_mfma_f32_16x16x32_bf16 v[160:163], a[148:151], v[68:71], v[160:163]
    ds_read_b64_tr_b16 v[94:95], v105 offset:30720
    v_mfma_f32_16x16x32_bf16 v[160:163], a[152:155], v[72:75], v[160:163]
    v_mfma_f32_16x16x32_bf16 v[160:163], a[156:159], v[76:79], v[160:163]
    buffer_load_dwordx4 v113, s[20:23], s62 offen offset:3072 lds
    v_mfma_f32_16x16x32_bf16 v[164:167], a[208:211], v[64:67], v[164:167]
    s_add_u32 m0, s64, 4096
    s_add_u32 s62, s62, 11264
    v_mfma_f32_16x16x32_bf16 v[164:167], a[212:215], v[68:71], v[164:167]
    v_mfma_f32_16x16x32_bf16 v[164:167], a[216:219], v[72:75], v[164:167]
    v_mfma_f32_16x16x32_bf16 v[164:167], a[220:223], v[76:79], v[164:167]
    s_waitcnt lgkmcnt(0)
    buffer_load_dwordx4 v112, s[20:23], s62 offen offset:0 lds
    v_mfma_f32_16x16x32_bf16 v[152:155], a[16:19], v[80:83], v[152:155]
    ds_read_b64_tr_b16 v[64:65], v106 offset:16384
    s_add_u32 s62, s62, 7168
    v_mfma_f32_16x16x32_bf16 v[152:155], a[20:23], v[84:87], v[152:155]
    ds_read_b64_tr_b16 v[66:67], v106 offset:18432
    v_mfma_f32_16x16x32_bf16 v[152:155], a[24:27], v[88:91], v[152:155]
    ds_read_b64_tr_b16 v[68:69], v106 offset:20480
    v_mfma_f32_16x16x32_bf16 v[152:155], a[28:31], v[92:95], v[152:155]
    buffer_load_dwordx4 v113, s[20:23], s62 offen offset:1024 lds
    v_mfma_f32_16x16x32_bf16 v[156:159], a[80:83], v[80:83], v[156:159]
    ds_read_b64_tr_b16 v[70:71], v106 offset:22528
    s_add_u32 s62, s62, 7168
    v_mfma_f32_16x16x32_bf16 v[156:159], a[84:87], v[84:87], v[156:159]
    ds_read_b64_tr_b16 v[72:73], v106 offset:24576
    v_mfma_f32_16x16x32_bf16 v[156:159], a[88:91], v[88:91], v[156:159]
    ds_read_b64_tr_b16 v[74:75], v106 offset:26624
    v_mfma_f32_16x16x32_bf16 v[156:159], a[92:95], v[92:95], v[156:159]
    buffer_load_dwordx4 v112, s[20:23], s62 offen offset:2048 lds
    v_mfma_f32_16x16x32_bf16 v[168:171], a[144:147], v[80:83], v[168:171]
    ds_read_b64_tr_b16 v[76:77], v106 offset:28672
    s_add_u32 s62, s62, 7168
    v_mfma_f32_16x16x32_bf16 v[168:171], a[148:151], v[84:87], v[168:171]
    ds_read_b64_tr_b16 v[78:79], v106 offset:30720
    v_mfma_f32_16x16x32_bf16 v[168:171], a[152:155], v[88:91], v[168:171]
    v_mfma_f32_16x16x32_bf16 v[168:171], a[156:159], v[92:95], v[168:171]
    buffer_load_dwordx4 v113, s[20:23], s62 offen offset:3072 lds
    v_mfma_f32_16x16x32_bf16 v[172:175], a[208:211], v[80:83], v[172:175]
    s_add_u32 m0, s64, 32768
    s_mul_i32 s35, s100, 0
    v_mfma_f32_16x16x32_bf16 v[172:175], a[212:215], v[84:87], v[172:175]
    s_add_u32 s35, s35, s38
    s_add_u32 s35, s35, s65
    v_mfma_f32_16x16x32_bf16 v[172:175], a[216:219], v[88:91], v[172:175]
    buffer_load_dwordx4 v108, s[24:27], s35 offen offset:0 lds
    v_mfma_f32_16x16x32_bf16 v[172:175], a[220:223], v[92:95], v[172:175]
    s_waitcnt lgkmcnt(0)
    s_add_u32 s35, s35, s36
    v_mfma_f32_16x16x32_bf16 v[176:179], a[16:19], v[64:67], v[176:179]
    ds_read_b64_tr_b16 v[80:81], v107 offset:16384
    v_mfma_f32_16x16x32_bf16 v[176:179], a[20:23], v[68:71], v[176:179]
    ds_read_b64_tr_b16 v[82:83], v107 offset:18432
    v_mfma_f32_16x16x32_bf16 v[176:179], a[24:27], v[72:75], v[176:179]
    ds_read_b64_tr_b16 v[84:85], v107 offset:20480
    s_waitcnt vmcnt(9)
    v_mfma_f32_16x16x32_bf16 v[176:179], a[28:31], v[76:79], v[176:179]
    ds_read_b128 a[32:35], v116 offset:0
    ds_read_b128 a[96:99], v116 offset:2048
    v_mfma_f32_16x16x32_bf16 v[180:183], a[80:83], v[64:67], v[180:183]
    ds_read_b64_tr_b16 v[86:87], v107 offset:22528
    v_mfma_f32_16x16x32_bf16 v[180:183], a[84:87], v[68:71], v[180:183]
    ds_read_b64_tr_b16 v[88:89], v107 offset:24576
    v_mfma_f32_16x16x32_bf16 v[180:183], a[88:91], v[72:75], v[180:183]
    ds_read_b64_tr_b16 v[90:91], v107 offset:26624
    v_mfma_f32_16x16x32_bf16 v[180:183], a[92:95], v[76:79], v[180:183]
    ds_read_b128 a[160:163], v116 offset:4096
    ds_read_b128 a[224:227], v116 offset:6144
    v_mfma_f32_16x16x32_bf16 v[192:195], a[144:147], v[64:67], v[192:195]
    ds_read_b64_tr_b16 v[92:93], v107 offset:28672
    v_mfma_f32_16x16x32_bf16 v[192:195], a[148:151], v[68:71], v[192:195]
    ds_read_b64_tr_b16 v[94:95], v107 offset:30720
    v_mfma_f32_16x16x32_bf16 v[192:195], a[152:155], v[72:75], v[192:195]
    ds_read_b128 a[36:39], v117 offset:0
    ds_read_b128 a[100:103], v117 offset:2048
    v_mfma_f32_16x16x32_bf16 v[192:195], a[156:159], v[76:79], v[192:195]
    ds_read_b128 a[164:167], v117 offset:4096
    ds_read_b128 a[228:231], v117 offset:6144
    v_mfma_f32_16x16x32_bf16 v[196:199], a[208:211], v[64:67], v[196:199]
    buffer_load_dwordx4 v109, s[24:27], s35 offen offset:1024 lds
    v_mfma_f32_16x16x32_bf16 v[196:199], a[212:215], v[68:71], v[196:199]
    s_sub_u32 s35, s35, s37
    v_mfma_f32_16x16x32_bf16 v[196:199], a[216:219], v[72:75], v[196:199]
    buffer_load_dwordx4 v108, s[24:27], s35 offen offset:2048 lds
    v_mfma_f32_16x16x32_bf16 v[196:199], a[220:223], v[76:79], v[196:199]
    s_waitcnt lgkmcnt(0)
    s_add_u32 s35, s35, s36
    v_mfma_f32_16x16x32_bf16 v[184:187], a[16:19], v[80:83], v[184:187]
    ds_read_b64_tr_b16 v[64:65], v118 offset:16384
    v_mfma_f32_16x16x32_bf16 v[184:187], a[20:23], v[84:87], v[184:187]
    ds_read_b64_tr_b16 v[66:67], v118 offset:18432
    v_mfma_f32_16x16x32_bf16 v[184:187], a[24:27], v[88:91], v[184:187]
    ds_read_b64_tr_b16 v[68:69], v118 offset:20480
    v_mfma_f32_16x16x32_bf16 v[184:187], a[28:31], v[92:95], v[184:187]
    buffer_load_dwordx4 v109, s[24:27], s35 offen offset:3072 lds
    v_mfma_f32_16x16x32_bf16 v[188:191], a[80:83], v[80:83], v[188:191]
    ds_read_b64_tr_b16 v[70:71], v118 offset:22528
    s_add_u32 m0, m0, 4096
    v_mfma_f32_16x16x32_bf16 v[188:191], a[84:87], v[84:87], v[188:191]
    ds_read_b64_tr_b16 v[72:73], v118 offset:24576
    s_add_u32 s35, s35, s47
    v_mfma_f32_16x16x32_bf16 v[188:191], a[88:91], v[88:91], v[188:191]
    ds_read_b64_tr_b16 v[74:75], v118 offset:26624
    v_mfma_f32_16x16x32_bf16 v[188:191], a[92:95], v[92:95], v[188:191]
    buffer_load_dwordx4 v108, s[24:27], s35 offen offset:0 lds
    v_mfma_f32_16x16x32_bf16 v[200:203], a[144:147], v[80:83], v[200:203]
    ds_read_b64_tr_b16 v[76:77], v118 offset:28672
    s_add_u32 s35, s35, s36
    v_mfma_f32_16x16x32_bf16 v[200:203], a[148:151], v[84:87], v[200:203]
    ds_read_b64_tr_b16 v[78:79], v118 offset:30720
    v_mfma_f32_16x16x32_bf16 v[200:203], a[152:155], v[88:91], v[200:203]
    buffer_load_dwordx4 v109, s[24:27], s35 offen offset:1024 lds
    v_mfma_f32_16x16x32_bf16 v[200:203], a[156:159], v[92:95], v[200:203]
    s_sub_u32 s35, s35, s37
    v_mfma_f32_16x16x32_bf16 v[204:207], a[208:211], v[80:83], v[204:207]
    buffer_load_dwordx4 v108, s[24:27], s35 offen offset:2048 lds
    v_mfma_f32_16x16x32_bf16 v[204:207], a[212:215], v[84:87], v[204:207]
    s_add_u32 s35, s35, s36
    v_mfma_f32_16x16x32_bf16 v[204:207], a[216:219], v[88:91], v[204:207]
    buffer_load_dwordx4 v109, s[24:27], s35 offen offset:3072 lds
    v_mfma_f32_16x16x32_bf16 v[204:207], a[220:223], v[92:95], v[204:207]
    s_waitcnt lgkmcnt(0)
    s_add_u32 m0, s64, 65536
    s_mul_i32 s35, s100, 1
    v_mfma_f32_16x16x32_bf16 v[0:3], a[16:19], v[64:67], v[0:3]
    ds_read_b64_tr_b16 v[80:81], v119 offset:16384
    s_add_u32 s35, s35, s38
    v_mfma_f32_16x16x32_bf16 v[0:3], a[20:23], v[68:71], v[0:3]
    ds_read_b64_tr_b16 v[82:83], v119 offset:18432
    s_add_u32 s35, s35, s65
    v_mfma_f32_16x16x32_bf16 v[0:3], a[24:27], v[72:75], v[0:3]
    ds_read_b64_tr_b16 v[84:85], v119 offset:20480
    s_waitcnt vmcnt(8)
    v_mfma_f32_16x16x32_bf16 v[0:3], a[28:31], v[76:79], v[0:3]
    ds_read_b128 a[40:43], v114 offset:0
    ds_read_b128 a[104:107], v114 offset:2048
    v_mfma_f32_16x16x32_bf16 v[4:7], a[80:83], v[64:67], v[4:7]
    ds_read_b64_tr_b16 v[86:87], v119 offset:22528
    v_mfma_f32_16x16x32_bf16 v[4:7], a[84:87], v[68:71], v[4:7]
    ds_read_b64_tr_b16 v[88:89], v119 offset:24576
    v_mfma_f32_16x16x32_bf16 v[4:7], a[88:91], v[72:75], v[4:7]
    ds_read_b64_tr_b16 v[90:91], v119 offset:26624
    v_mfma_f32_16x16x32_bf16 v[4:7], a[92:95], v[76:79], v[4:7]
    ds_read_b128 a[168:171], v114 offset:4096
    ds_read_b128 a[232:235], v114 offset:6144
    v_mfma_f32_16x16x32_bf16 v[16:19], a[144:147], v[64:67], v[16:19]
    ds_read_b64_tr_b16 v[92:93], v119 offset:28672
    v_mfma_f32_16x16x32_bf16 v[16:19], a[148:151], v[68:71], v[16:19]
    ds_read_b64_tr_b16 v[94:95], v119 offset:30720
    v_mfma_f32_16x16x32_bf16 v[16:19], a[152:155], v[72:75], v[16:19]
    ds_read_b128 a[44:47], v115 offset:0
    ds_read_b128 a[108:111], v115 offset:2048
    v_mfma_f32_16x16x32_bf16 v[16:19], a[156:159], v[76:79], v[16:19]
    ds_read_b128 a[172:175], v115 offset:4096
    ds_read_b128 a[236:239], v115 offset:6144
    v_mfma_f32_16x16x32_bf16 v[20:23], a[208:211], v[64:67], v[20:23]
    buffer_load_dwordx4 v108, s[24:27], s35 offen offset:0 lds
    v_mfma_f32_16x16x32_bf16 v[20:23], a[212:215], v[68:71], v[20:23]
    s_add_u32 s35, s35, s36
    v_mfma_f32_16x16x32_bf16 v[20:23], a[216:219], v[72:75], v[20:23]
    buffer_load_dwordx4 v109, s[24:27], s35 offen offset:1024 lds
    v_mfma_f32_16x16x32_bf16 v[20:23], a[220:223], v[76:79], v[20:23]
    s_waitcnt lgkmcnt(0)
    s_sub_u32 s35, s35, s37
    v_mfma_f32_16x16x32_bf16 v[8:11], a[16:19], v[80:83], v[8:11]
    ds_read_b64_tr_b16 v[64:65], v120 offset:16384
    v_mfma_f32_16x16x32_bf16 v[8:11], a[20:23], v[84:87], v[8:11]
    ds_read_b64_tr_b16 v[66:67], v120 offset:18432
    v_mfma_f32_16x16x32_bf16 v[8:11], a[24:27], v[88:91], v[8:11]
    ds_read_b64_tr_b16 v[68:69], v120 offset:20480
    v_mfma_f32_16x16x32_bf16 v[8:11], a[28:31], v[92:95], v[8:11]
    buffer_load_dwordx4 v108, s[24:27], s35 offen offset:2048 lds
    v_mfma_f32_16x16x32_bf16 v[12:15], a[80:83], v[80:83], v[12:15]
    ds_read_b64_tr_b16 v[70:71], v120 offset:22528
    s_add_u32 s35, s35, s36
    v_mfma_f32_16x16x32_bf16 v[12:15], a[84:87], v[84:87], v[12:15]
    ds_read_b64_tr_b16 v[72:73], v120 offset:24576
    v_mfma_f32_16x16x32_bf16 v[12:15], a[88:91], v[88:91], v[12:15]
    ds_read_b64_tr_b16 v[74:75], v120 offset:26624
    v_mfma_f32_16x16x32_bf16 v[12:15], a[92:95], v[92:95], v[12:15]
    buffer_load_dwordx4 v109, s[24:27], s35 offen offset:3072 lds
    v_mfma_f32_16x16x32_bf16 v[24:27], a[144:147], v[80:83], v[24:27]
    ds_read_b64_tr_b16 v[76:77], v120 offset:28672
    s_add_u32 m0, m0, 4096
    v_mfma_f32_16x16x32_bf16 v[24:27], a[148:151], v[84:87], v[24:27]
    ds_read_b64_tr_b16 v[78:79], v120 offset:30720
    s_add_u32 s35, s35, s47
    v_mfma_f32_16x16x32_bf16 v[24:27], a[152:155], v[88:91], v[24:27]
    buffer_load_dwordx4 v108, s[24:27], s35 offen offset:0 lds
    v_mfma_f32_16x16x32_bf16 v[24:27], a[156:159], v[92:95], v[24:27]
    s_add_u32 s35, s35, s36
    v_mfma_f32_16x16x32_bf16 v[28:31], a[208:211], v[80:83], v[28:31]
    buffer_load_dwordx4 v109, s[24:27], s35 offen offset:1024 lds
    v_mfma_f32_16x16x32_bf16 v[28:31], a[212:215], v[84:87], v[28:31]
    s_sub_u32 s35, s35, s37
    v_mfma_f32_16x16x32_bf16 v[28:31], a[216:219], v[88:91], v[28:31]
    buffer_load_dwordx4 v108, s[24:27], s35 offen offset:2048 lds
    v_mfma_f32_16x16x32_bf16 v[28:31], a[220:223], v[92:95], v[28:31]
    s_waitcnt lgkmcnt(0)
    s_add_u32 s35, s35, s36
    v_mfma_f32_16x16x32_bf16 v[32:35], a[16:19], v[64:67], v[32:35]
    ds_read_b64_tr_b16 v[80:81], v121 offset:16384
    v_mfma_f32_16x16x32_bf16 v[32:35], a[20:23], v[68:71], v[32:35]
    ds_read_b64_tr_b16 v[82:83], v121 offset:18432
    v_mfma_f32_16x16x32_bf16 v[32:35], a[24:27], v[72:75], v[32:35]
    ds_read_b64_tr_b16 v[84:85], v121 offset:20480
    v_mfma_f32_16x16x32_bf16 v[32:35], a[28:31], v[76:79], v[32:35]
    buffer_load_dwordx4 v109, s[24:27], s35 offen offset:3072 lds
    v_mfma_f32_16x16x32_bf16 v[36:39], a[80:83], v[64:67], v[36:39]
    ds_read_b64_tr_b16 v[86:87], v121 offset:22528
    s_add_u32 s62, s63, 768
    v_mfma_f32_16x16x32_bf16 v[36:39], a[84:87], v[68:71], v[36:39]
    ds_read_b64_tr_b16 v[88:89], v121 offset:24576
    s_add_u32 m0, s64, 0
    v_mfma_f32_16x16x32_bf16 v[36:39], a[88:91], v[72:75], v[36:39]
    ds_read_b64_tr_b16 v[90:91], v121 offset:26624
    s_nop 0
    v_mfma_f32_16x16x32_bf16 v[36:39], a[92:95], v[76:79], v[36:39]
    buffer_load_dwordx4 v112, s[20:23], s62 offen offset:0 lds
    v_mfma_f32_16x16x32_bf16 v[48:51], a[144:147], v[64:67], v[48:51]
    ds_read_b64_tr_b16 v[92:93], v121 offset:28672
    s_add_u32 s62, s62, 7168
    v_mfma_f32_16x16x32_bf16 v[48:51], a[148:151], v[68:71], v[48:51]
    ds_read_b64_tr_b16 v[94:95], v121 offset:30720
    v_mfma_f32_16x16x32_bf16 v[48:51], a[152:155], v[72:75], v[48:51]
    s_waitcnt vmcnt(9)
    s_barrier
    v_mfma_f32_16x16x32_bf16 v[48:51], a[156:159], v[76:79], v[48:51]
    buffer_load_dwordx4 v113, s[20:23], s62 offen offset:1024 lds
    v_mfma_f32_16x16x32_bf16 v[52:55], a[208:211], v[64:67], v[52:55]
    s_add_u32 s62, s62, 7168
    v_mfma_f32_16x16x32_bf16 v[52:55], a[212:215], v[68:71], v[52:55]
    buffer_load_dwordx4 v112, s[20:23], s62 offen offset:2048 lds
    v_mfma_f32_16x16x32_bf16 v[52:55], a[216:219], v[72:75], v[52:55]
    s_add_u32 s62, s62, 7168
    v_mfma_f32_16x16x32_bf16 v[52:55], a[220:223], v[76:79], v[52:55]
    s_waitcnt lgkmcnt(0)
    buffer_load_dwordx4 v113, s[20:23], s62 offen offset:3072 lds
    v_mfma_f32_16x16x32_bf16 v[40:43], a[16:19], v[80:83], v[40:43]
    ds_read_b64_tr_b16 v[64:65], v122 offset:0
    s_add_u32 m0, s64, 4096
    v_mfma_f32_16x16x32_bf16 v[40:43], a[20:23], v[84:87], v[40:43]
    ds_read_b64_tr_b16 v[66:67], v122 offset:2048
    s_add_u32 s62, s62, 11264
    v_mfma_f32_16x16x32_bf16 v[40:43], a[24:27], v[88:91], v[40:43]
    ds_read_b64_tr_b16 v[68:69], v122 offset:4096
    v_mfma_f32_16x16x32_bf16 v[40:43], a[28:31], v[92:95], v[40:43]
    buffer_load_dwordx4 v112, s[20:23], s62 offen offset:0 lds
    v_mfma_f32_16x16x32_bf16 v[44:47], a[80:83], v[80:83], v[44:47]
    ds_read_b64_tr_b16 v[70:71], v122 offset:6144
    s_add_u32 s62, s62, 7168
    v_mfma_f32_16x16x32_bf16 v[44:47], a[84:87], v[84:87], v[44:47]
    ds_read_b64_tr_b16 v[72:73], v122 offset:8192
    v_mfma_f32_16x16x32_bf16 v[44:47], a[88:91], v[88:91], v[44:47]
    ds_read_b64_tr_b16 v[74:75], v122 offset:10240
    v_mfma_f32_16x16x32_bf16 v[44:47], a[92:95], v[92:95], v[44:47]
    buffer_load_dwordx4 v113, s[20:23], s62 offen offset:1024 lds
    v_mfma_f32_16x16x32_bf16 v[56:59], a[144:147], v[80:83], v[56:59]
    ds_read_b64_tr_b16 v[76:77], v122 offset:12288
    s_add_u32 s62, s62, 7168
    v_mfma_f32_16x16x32_bf16 v[56:59], a[148:151], v[84:87], v[56:59]
    ds_read_b64_tr_b16 v[78:79], v122 offset:14336
    v_mfma_f32_16x16x32_bf16 v[56:59], a[152:155], v[88:91], v[56:59]
    buffer_load_dwordx4 v112, s[20:23], s62 offen offset:2048 lds
    v_mfma_f32_16x16x32_bf16 v[56:59], a[156:159], v[92:95], v[56:59]
    s_add_u32 s62, s62, 7168
    v_mfma_f32_16x16x32_bf16 v[60:63], a[208:211], v[80:83], v[60:63]
    buffer_load_dwordx4 v113, s[20:23], s62 offen offset:3072 lds
    v_mfma_f32_16x16x32_bf16 v[60:63], a[212:215], v[84:87], v[60:63]
    s_add_u32 m0, s64, 98304
    s_mul_i32 s35, s100, 2
    v_mfma_f32_16x16x32_bf16 v[60:63], a[216:219], v[88:91], v[60:63]
    s_add_u32 s35, s35, s38
    v_mfma_f32_16x16x32_bf16 v[60:63], a[220:223], v[92:95], v[60:63]
    s_waitcnt lgkmcnt(0)
    buffer_load_dwordx4 v108, s[24:27], s35 offen offset:0 lds
    v_mfma_f32_16x16x32_bf16 v[144:147], a[32:35], v[64:67], v[144:147]
    ds_read_b64_tr_b16 v[80:81], v123 offset:0
    s_add_u32 s35, s35, s36
    v_mfma_f32_16x16x32_bf16 v[144:147], a[36:39], v[68:71], v[144:147]
    ds_read_b64_tr_b16 v[82:83], v123 offset:2048
    v_mfma_f32_16x16x32_bf16 v[144:147], a[40:43], v[72:75], v[144:147]
    ds_read_b64_tr_b16 v[84:85], v123 offset:4096
    v_mfma_f32_16x16x32_bf16 v[144:147], a[44:47], v[76:79], v[144:147]
    buffer_load_dwordx4 v109, s[24:27], s35 offen offset:1024 lds
    v_mfma_f32_16x16x32_bf16 v[148:151], a[96:99], v[64:67], v[148:151]
    ds_read_b64_tr_b16 v[86:87], v123 offset:6144
    s_sub_u32 s35, s35, s37
    v_mfma_f32_16x16x32_bf16 v[148:151], a[100:103], v[68:71], v[148:151]
    ds_read_b64_tr_b16 v[88:89], v123 offset:8192
    v_mfma_f32_16x16x32_bf16 v[148:151], a[104:107], v[72:75], v[148:151]
    ds_read_b64_tr_b16 v[90:91], v123 offset:10240
    v_mfma_f32_16x16x32_bf16 v[148:151], a[108:111], v[76:79], v[148:151]
    buffer_load_dwordx4 v108, s[24:27], s35 offen offset:2048 lds
    v_mfma_f32_16x16x32_bf16 v[160:163], a[160:163], v[64:67], v[160:163]
    ds_read_b64_tr_b16 v[92:93], v123 offset:12288
    s_add_u32 s35, s35, s36
    v_mfma_f32_16x16x32_bf16 v[160:163], a[164:167], v[68:71], v[160:163]
    ds_read_b64_tr_b16 v[94:95], v123 offset:14336
    v_mfma_f32_16x16x32_bf16 v[160:163], a[168:171], v[72:75], v[160:163]
    buffer_load_dwordx4 v109, s[24:27], s35 offen offset:3072 lds
    v_mfma_f32_16x16x32_bf16 v[160:163], a[172:175], v[76:79], v[160:163]
    s_add_u32 m0, m0, 4096
    s_add_u32 s35, s35, s47
    v_mfma_f32_16x16x32_bf16 v[164:167], a[224:227], v[64:67], v[164:167]
    buffer_load_dwordx4 v108, s[24:27], s35 offen offset:0 lds
    v_mfma_f32_16x16x32_bf16 v[164:167], a[228:231], v[68:71], v[164:167]
    s_add_u32 s35, s35, s36
    v_mfma_f32_16x16x32_bf16 v[164:167], a[232:235], v[72:75], v[164:167]
    buffer_load_dwordx4 v109, s[24:27], s35 offen offset:1024 lds
    v_mfma_f32_16x16x32_bf16 v[164:167], a[236:239], v[76:79], v[164:167]
    s_waitcnt lgkmcnt(0)
    s_sub_u32 s35, s35, s37
    v_mfma_f32_16x16x32_bf16 v[152:155], a[32:35], v[80:83], v[152:155]
    ds_read_b64_tr_b16 v[64:65], v124 offset:0
    v_mfma_f32_16x16x32_bf16 v[152:155], a[36:39], v[84:87], v[152:155]
    ds_read_b64_tr_b16 v[66:67], v124 offset:2048
    v_mfma_f32_16x16x32_bf16 v[152:155], a[40:43], v[88:91], v[152:155]
    ds_read_b64_tr_b16 v[68:69], v124 offset:4096
    s_waitcnt vmcnt(6)
    v_mfma_f32_16x16x32_bf16 v[152:155], a[44:47], v[92:95], v[152:155]
    ds_read_b128 a[48:51], v114 offset:0
    ds_read_b128 a[112:115], v114 offset:2048
    v_mfma_f32_16x16x32_bf16 v[156:159], a[96:99], v[80:83], v[156:159]
    ds_read_b64_tr_b16 v[70:71], v124 offset:6144
    v_mfma_f32_16x16x32_bf16 v[156:159], a[100:103], v[84:87], v[156:159]
    ds_read_b64_tr_b16 v[72:73], v124 offset:8192
    v_mfma_f32_16x16x32_bf16 v[156:159], a[104:107], v[88:91], v[156:159]
    ds_read_b64_tr_b16 v[74:75], v124 offset:10240
    v_mfma_f32_16x16x32_bf16 v[156:159], a[108:111], v[92:95], v[156:159]
    ds_read_b128 a[176:179], v114 offset:4096
    ds_read_b128 a[240:243], v114 offset:6144
    v_mfma_f32_16x16x32_bf16 v[168:171], a[160:163], v[80:83], v[168:171]
    ds_read_b64_tr_b16 v[76:77], v124 offset:12288
    v_mfma_f32_16x16x32_bf16 v[168:171], a[164:167], v[84:87], v[168:171]
    ds_read_b64_tr_b16 v[78:79], v124 offset:14336
    v_mfma_f32_16x16x32_bf16 v[168:171], a[168:171], v[88:91], v[168:171]
    ds_read_b128 a[52:55], v115 offset:0
    ds_read_b128 a[116:119], v115 offset:2048
    v_mfma_f32_16x16x32_bf16 v[168:171], a[172:175], v[92:95], v[168:171]
    ds_read_b128 a[180:183], v115 offset:4096
    ds_read_b128 a[244:247], v115 offset:6144
    v_mfma_f32_16x16x32_bf16 v[172:175], a[224:227], v[80:83], v[172:175]
    buffer_load_dwordx4 v108, s[24:27], s35 offen offset:2048 lds
    v_mfma_f32_16x16x32_bf16 v[172:175], a[228:231], v[84:87], v[172:175]
    s_add_u32 s35, s35, s36
    v_mfma_f32_16x16x32_bf16 v[172:175], a[232:235], v[88:91], v[172:175]
    buffer_load_dwordx4 v109, s[24:27], s35 offen offset:3072 lds
    v_mfma_f32_16x16x32_bf16 v[172:175], a[236:239], v[92:95], v[172:175]
    s_waitcnt lgkmcnt(0)
    v_mfma_f32_16x16x32_bf16 v[176:179], a[32:35], v[64:67], v[176:179]
    ds_read_b64_tr_b16 v[80:81], v125 offset:0
    s_add_u32 s62, s63, 896
    v_mfma_f32_16x16x32_bf16 v[176:179], a[36:39], v[68:71], v[176:179]
    ds_read_b64_tr_b16 v[82:83], v125 offset:2048
    s_add_u32 m0, s64, 0
    v_mfma_f32_16x16x32_bf16 v[176:179], a[40:43], v[72:75], v[176:179]
    ds_read_b64_tr_b16 v[84:85], v125 offset:4096
    s_nop 0
    v_mfma_f32_16x16x32_bf16 v[176:179], a[44:47], v[76:79], v[176:179]
    buffer_load_dwordx4 v112, s[20:23], s62 offen offset:0 lds
    v_mfma_f32_16x16x32_bf16 v[180:183], a[96:99], v[64:67], v[180:183]
    ds_read_b64_tr_b16 v[86:87], v125 offset:6144
    s_add_u32 s62, s62, 7168
    v_mfma_f32_16x16x32_bf16 v[180:183], a[100:103], v[68:71], v[180:183]
    ds_read_b64_tr_b16 v[88:89], v125 offset:8192
    v_mfma_f32_16x16x32_bf16 v[180:183], a[104:107], v[72:75], v[180:183]
    ds_read_b64_tr_b16 v[90:91], v125 offset:10240
    v_mfma_f32_16x16x32_bf16 v[180:183], a[108:111], v[76:79], v[180:183]
    buffer_load_dwordx4 v113, s[20:23], s62 offen offset:1024 lds
    v_mfma_f32_16x16x32_bf16 v[192:195], a[160:163], v[64:67], v[192:195]
    ds_read_b64_tr_b16 v[92:93], v125 offset:12288
    s_add_u32 s62, s62, 7168
    v_mfma_f32_16x16x32_bf16 v[192:195], a[164:167], v[68:71], v[192:195]
    ds_read_b64_tr_b16 v[94:95], v125 offset:14336
    v_mfma_f32_16x16x32_bf16 v[192:195], a[168:171], v[72:75], v[192:195]
    buffer_load_dwordx4 v112, s[20:23], s62 offen offset:2048 lds
    v_mfma_f32_16x16x32_bf16 v[192:195], a[172:175], v[76:79], v[192:195]
    s_add_u32 s62, s62, 7168
    v_mfma_f32_16x16x32_bf16 v[196:199], a[224:227], v[64:67], v[196:199]
    buffer_load_dwordx4 v113, s[20:23], s62 offen offset:3072 lds
    v_mfma_f32_16x16x32_bf16 v[196:199], a[228:231], v[68:71], v[196:199]
    s_add_u32 m0, s64, 4096
    s_add_u32 s62, s62, 11264
    v_mfma_f32_16x16x32_bf16 v[196:199], a[232:235], v[72:75], v[196:199]
    s_waitcnt vmcnt(20)
    s_barrier
    v_mfma_f32_16x16x32_bf16 v[196:199], a[236:239], v[76:79], v[196:199]
    s_waitcnt lgkmcnt(0)
    buffer_load_dwordx4 v112, s[20:23], s62 offen offset:0 lds
    v_mfma_f32_16x16x32_bf16 v[184:187], a[32:35], v[80:83], v[184:187]
    ds_read_b64_tr_b16 v[64:65], v122 offset:32768
    s_add_u32 s62, s62, 7168
    v_mfma_f32_16x16x32_bf16 v[184:187], a[36:39], v[84:87], v[184:187]
    ds_read_b64_tr_b16 v[66:67], v122 offset:34816
    v_mfma_f32_16x16x32_bf16 v[184:187], a[40:43], v[88:91], v[184:187]
    ds_read_b64_tr_b16 v[68:69], v122 offset:36864
    v_mfma_f32_16x16x32_bf16 v[184:187], a[44:47], v[92:95], v[184:187]
    buffer_load_dwordx4 v113, s[20:23], s62 offen offset:1024 lds
    v_mfma_f32_16x16x32_bf16 v[188:191], a[96:99], v[80:83], v[188:191]
    ds_read_b64_tr_b16 v[70:71], v122 offset:38912
    s_add_u32 s62, s62, 7168
    v_mfma_f32_16x16x32_bf16 v[188:191], a[100:103], v[84:87], v[188:191]
    ds_read_b64_tr_b16 v[72:73], v122 offset:40960
    v_mfma_f32_16x16x32_bf16 v[188:191], a[104:107], v[88:91], v[188:191]
    ds_read_b64_tr_b16 v[74:75], v122 offset:43008
    v_mfma_f32_16x16x32_bf16 v[188:191], a[108:111], v[92:95], v[188:191]
    buffer_load_dwordx4 v112, s[20:23], s62 offen offset:2048 lds
    v_mfma_f32_16x16x32_bf16 v[200:203], a[160:163], v[80:83], v[200:203]
    ds_read_b64_tr_b16 v[76:77], v122 offset:45056
    s_add_u32 s62, s62, 7168
    v_mfma_f32_16x16x32_bf16 v[200:203], a[164:167], v[84:87], v[200:203]
    ds_read_b64_tr_b16 v[78:79], v122 offset:47104
    v_mfma_f32_16x16x32_bf16 v[200:203], a[168:171], v[88:91], v[200:203]
    buffer_load_dwordx4 v113, s[20:23], s62 offen offset:3072 lds
    v_mfma_f32_16x16x32_bf16 v[200:203], a[172:175], v[92:95], v[200:203]
    s_add_u32 m0, s64, 4294934528
    s_mul_i32 s35, s100, 2
    v_mfma_f32_16x16x32_bf16 v[204:207], a[224:227], v[80:83], v[204:207]
    s_add_u32 s35, s35, s38
    s_add_u32 s35, s35, s65
    v_mfma_f32_16x16x32_bf16 v[204:207], a[228:231], v[84:87], v[204:207]
    v_mfma_f32_16x16x32_bf16 v[204:207], a[232:235], v[88:91], v[204:207]
    buffer_load_dwordx4 v108, s[24:27], s35 offen offset:0 lds
    v_mfma_f32_16x16x32_bf16 v[204:207], a[236:239], v[92:95], v[204:207]
    s_waitcnt lgkmcnt(0)
    s_add_u32 s35, s35, s36
    v_mfma_f32_16x16x32_bf16 v[0:3], a[32:35], v[64:67], v[0:3]
    ds_read_b64_tr_b16 v[80:81], v123 offset:32768
    v_mfma_f32_16x16x32_bf16 v[0:3], a[36:39], v[68:71], v[0:3]
    ds_read_b64_tr_b16 v[82:83], v123 offset:34816
    v_mfma_f32_16x16x32_bf16 v[0:3], a[40:43], v[72:75], v[0:3]
    ds_read_b64_tr_b16 v[84:85], v123 offset:36864
    v_mfma_f32_16x16x32_bf16 v[0:3], a[44:47], v[76:79], v[0:3]
    buffer_load_dwordx4 v109, s[24:27], s35 offen offset:1024 lds
    v_mfma_f32_16x16x32_bf16 v[4:7], a[96:99], v[64:67], v[4:7]
    ds_read_b64_tr_b16 v[86:87], v123 offset:38912
    s_sub_u32 s35, s35, s37
    v_mfma_f32_16x16x32_bf16 v[4:7], a[100:103], v[68:71], v[4:7]
    ds_read_b64_tr_b16 v[88:89], v123 offset:40960
    v_mfma_f32_16x16x32_bf16 v[4:7], a[104:107], v[72:75], v[4:7]
    ds_read_b64_tr_b16 v[90:91], v123 offset:43008
    v_mfma_f32_16x16x32_bf16 v[4:7], a[108:111], v[76:79], v[4:7]
    buffer_load_dwordx4 v108, s[24:27], s35 offen offset:2048 lds
    v_mfma_f32_16x16x32_bf16 v[16:19], a[160:163], v[64:67], v[16:19]
    ds_read_b64_tr_b16 v[92:93], v123 offset:45056
    s_add_u32 s35, s35, s36
    v_mfma_f32_16x16x32_bf16 v[16:19], a[164:167], v[68:71], v[16:19]
    ds_read_b64_tr_b16 v[94:95], v123 offset:47104
    v_mfma_f32_16x16x32_bf16 v[16:19], a[168:171], v[72:75], v[16:19]
    v_mfma_f32_16x16x32_bf16 v[16:19], a[172:175], v[76:79], v[16:19]
    buffer_load_dwordx4 v109, s[24:27], s35 offen offset:3072 lds
    v_mfma_f32_16x16x32_bf16 v[20:23], a[224:227], v[64:67], v[20:23]
    s_add_u32 m0, m0, 4096
    s_add_u32 s35, s35, s47
    v_mfma_f32_16x16x32_bf16 v[20:23], a[228:231], v[68:71], v[20:23]
    v_mfma_f32_16x16x32_bf16 v[20:23], a[232:235], v[72:75], v[20:23]
    v_mfma_f32_16x16x32_bf16 v[20:23], a[236:239], v[76:79], v[20:23]
    s_waitcnt lgkmcnt(0)
    buffer_load_dwordx4 v108, s[24:27], s35 offen offset:0 lds
    v_mfma_f32_16x16x32_bf16 v[8:11], a[32:35], v[80:83], v[8:11]
    ds_read_b64_tr_b16 v[64:65], v124 offset:32768
    s_add_u32 s35, s35, s36
    v_mfma_f32_16x16x32_bf16 v[8:11], a[36:39], v[84:87], v[8:11]
    ds_read_b64_tr_b16 v[66:67], v124 offset:34816
    v_mfma_f32_16x16x32_bf16 v[8:11], a[40:43], v[88:91], v[8:11]
    ds_read_b64_tr_b16 v[68:69], v124 offset:36864
    v_mfma_f32_16x16x32_bf16 v[8:11], a[44:47], v[92:95], v[8:11]
    buffer_load_dwordx4 v109, s[24:27], s35 offen offset:1024 lds
    v_mfma_f32_16x16x32_bf16 v[12:15], a[96:99], v[80:83], v[12:15]
    ds_read_b64_tr_b16 v[70:71], v124 offset:38912
    s_sub_u32 s35, s35, s37
    v_mfma_f32_16x16x32_bf16 v[12:15], a[100:103], v[84:87], v[12:15]
    ds_read_b64_tr_b16 v[72:73], v124 offset:40960
    v_mfma_f32_16x16x32_bf16 v[12:15], a[104:107], v[88:91], v[12:15]
    ds_read_b64_tr_b16 v[74:75], v124 offset:43008
    v_mfma_f32_16x16x32_bf16 v[12:15], a[108:111], v[92:95], v[12:15]
    buffer_load_dwordx4 v108, s[24:27], s35 offen offset:2048 lds
    v_mfma_f32_16x16x32_bf16 v[24:27], a[160:163], v[80:83], v[24:27]
    ds_read_b64_tr_b16 v[76:77], v124 offset:45056
    s_add_u32 s35, s35, s36
    v_mfma_f32_16x16x32_bf16 v[24:27], a[164:167], v[84:87], v[24:27]
    ds_read_b64_tr_b16 v[78:79], v124 offset:47104
    v_mfma_f32_16x16x32_bf16 v[24:27], a[168:171], v[88:91], v[24:27]
    v_mfma_f32_16x16x32_bf16 v[24:27], a[172:175], v[92:95], v[24:27]
    buffer_load_dwordx4 v109, s[24:27], s35 offen offset:3072 lds
    v_mfma_f32_16x16x32_bf16 v[28:31], a[224:227], v[80:83], v[28:31]
    v_mfma_f32_16x16x32_bf16 v[28:31], a[228:231], v[84:87], v[28:31]
    v_mfma_f32_16x16x32_bf16 v[28:31], a[232:235], v[88:91], v[28:31]
    v_mfma_f32_16x16x32_bf16 v[28:31], a[236:239], v[92:95], v[28:31]
    s_waitcnt lgkmcnt(0)
    buffer_load_dword v136, v138, s[24:27], 0 offen
    v_mfma_f32_16x16x32_bf16 v[32:35], a[32:35], v[64:67], v[32:35]
    ds_read_b64_tr_b16 v[80:81], v125 offset:32768
    v_mfma_f32_16x16x32_bf16 v[32:35], a[36:39], v[68:71], v[32:35]
    ds_read_b64_tr_b16 v[82:83], v125 offset:34816
    v_mfma_f32_16x16x32_bf16 v[32:35], a[40:43], v[72:75], v[32:35]
    ds_read_b64_tr_b16 v[84:85], v125 offset:36864
    v_mfma_f32_16x16x32_bf16 v[32:35], a[44:47], v[76:79], v[32:35]
    v_mfma_f32_16x16x32_bf16 v[36:39], a[96:99], v[64:67], v[36:39]
    ds_read_b64_tr_b16 v[86:87], v125 offset:38912
    v_mfma_f32_16x16x32_bf16 v[36:39], a[100:103], v[68:71], v[36:39]
    ds_read_b64_tr_b16 v[88:89], v125 offset:40960
    v_mfma_f32_16x16x32_bf16 v[36:39], a[104:107], v[72:75], v[36:39]
    ds_read_b64_tr_b16 v[90:91], v125 offset:43008
    v_mfma_f32_16x16x32_bf16 v[36:39], a[108:111], v[76:79], v[36:39]
    v_mfma_f32_16x16x32_bf16 v[48:51], a[160:163], v[64:67], v[48:51]
    ds_read_b64_tr_b16 v[92:93], v125 offset:45056
    v_mfma_f32_16x16x32_bf16 v[48:51], a[164:167], v[68:71], v[48:51]
    ds_read_b64_tr_b16 v[94:95], v125 offset:47104
    v_mfma_f32_16x16x32_bf16 v[48:51], a[168:171], v[72:75], v[48:51]
    v_mfma_f32_16x16x32_bf16 v[48:51], a[172:175], v[76:79], v[48:51]
    v_mfma_f32_16x16x32_bf16 v[52:55], a[224:227], v[64:67], v[52:55]
    v_mfma_f32_16x16x32_bf16 v[52:55], a[228:231], v[68:71], v[52:55]
    v_mfma_f32_16x16x32_bf16 v[52:55], a[232:235], v[72:75], v[52:55]
    v_mfma_f32_16x16x32_bf16 v[52:55], a[236:239], v[76:79], v[52:55]
    s_waitcnt lgkmcnt(0)
    v_mfma_f32_16x16x32_bf16 v[40:43], a[32:35], v[80:83], v[40:43]
    ds_read_b64_tr_b16 v[64:65], v122 offset:16384
    v_mfma_f32_16x16x32_bf16 v[40:43], a[36:39], v[84:87], v[40:43]
    ds_read_b64_tr_b16 v[66:67], v122 offset:18432
    v_mfma_f32_16x16x32_bf16 v[40:43], a[40:43], v[88:91], v[40:43]
    ds_read_b64_tr_b16 v[68:69], v122 offset:20480
    s_waitcnt vmcnt(9)
    v_mfma_f32_16x16x32_bf16 v[40:43], a[44:47], v[92:95], v[40:43]
    ds_read_b128 a[56:59], v114 offset:0
    ds_read_b128 a[120:123], v114 offset:2048
    v_mfma_f32_16x16x32_bf16 v[44:47], a[96:99], v[80:83], v[44:47]
    ds_read_b64_tr_b16 v[70:71], v122 offset:22528
    v_mfma_f32_16x16x32_bf16 v[44:47], a[100:103], v[84:87], v[44:47]
    ds_read_b64_tr_b16 v[72:73], v122 offset:24576
    v_mfma_f32_16x16x32_bf16 v[44:47], a[104:107], v[88:91], v[44:47]
    ds_read_b64_tr_b16 v[74:75], v122 offset:26624
    v_mfma_f32_16x16x32_bf16 v[44:47], a[108:111], v[92:95], v[44:47]
    ds_read_b128 a[184:187], v114 offset:4096
    ds_read_b128 a[248:251], v114 offset:6144
    v_mfma_f32_16x16x32_bf16 v[56:59], a[160:163], v[80:83], v[56:59]
    ds_read_b64_tr_b16 v[76:77], v122 offset:28672
    v_mfma_f32_16x16x32_bf16 v[56:59], a[164:167], v[84:87], v[56:59]
    ds_read_b64_tr_b16 v[78:79], v122 offset:30720
    v_mfma_f32_16x16x32_bf16 v[56:59], a[168:171], v[88:91], v[56:59]
    ds_read_b128 a[60:63], v115 offset:0
    ds_read_b128 a[124:127], v115 offset:2048
    v_mfma_f32_16x16x32_bf16 v[56:59], a[172:175], v[92:95], v[56:59]
    ds_read_b128 a[188:191], v115 offset:4096
    ds_read_b128 a[252:255], v115 offset:6144
    v_mfma_f32_16x16x32_bf16 v[60:63], a[224:227], v[80:83], v[60:63]
    v_mfma_f32_16x16x32_bf16 v[60:63], a[228:231], v[84:87], v[60:63]
    v_mfma_f32_16x16x32_bf16 v[60:63], a[232:235], v[88:91], v[60:63]
    v_mfma_f32_16x16x32_bf16 v[60:63], a[236:239], v[92:95], v[60:63]
    s_waitcnt lgkmcnt(0)
    v_mfma_f32_16x16x32_bf16 v[144:147], a[48:51], v[64:67], v[144:147]
    ds_read_b64_tr_b16 v[80:81], v123 offset:16384
    s_add_u32 m0, s64, 0
    v_mfma_f32_16x16x32_bf16 v[144:147], a[52:55], v[68:71], v[144:147]
    ds_read_b64_tr_b16 v[82:83], v123 offset:18432
    s_mul_i32 s35, s100, 3
    v_mfma_f32_16x16x32_bf16 v[144:147], a[56:59], v[72:75], v[144:147]
    ds_read_b64_tr_b16 v[84:85], v123 offset:20480
    s_add_u32 s35, s35, s38
    v_mfma_f32_16x16x32_bf16 v[144:147], a[60:63], v[76:79], v[144:147]
    buffer_load_dwordx4 v108, s[24:27], s35 offen offset:0 lds
    v_mfma_f32_16x16x32_bf16 v[148:151], a[112:115], v[64:67], v[148:151]
    ds_read_b64_tr_b16 v[86:87], v123 offset:22528
    s_add_u32 s35, s35, s36
    v_mfma_f32_16x16x32_bf16 v[148:151], a[116:119], v[68:71], v[148:151]
    ds_read_b64_tr_b16 v[88:89], v123 offset:24576
    v_mfma_f32_16x16x32_bf16 v[148:151], a[120:123], v[72:75], v[148:151]
    ds_read_b64_tr_b16 v[90:91], v123 offset:26624
    v_mfma_f32_16x16x32_bf16 v[148:151], a[124:127], v[76:79], v[148:151]
    buffer_load_dwordx4 v109, s[24:27], s35 offen offset:1024 lds
    v_mfma_f32_16x16x32_bf16 v[160:163], a[176:179], v[64:67], v[160:163]
    ds_read_b64_tr_b16 v[92:93], v123 offset:28672
    s_sub_u32 s35, s35, s37
    v_mfma_f32_16x16x32_bf16 v[160:163], a[180:183], v[68:71], v[160:163]
    ds_read_b64_tr_b16 v[94:95], v123 offset:30720
    v_mfma_f32_16x16x32_bf16 v[160:163], a[184:187], v[72:75], v[160:163]
    v_mfma_f32_16x16x32_bf16 v[160:163], a[188:191], v[76:79], v[160:163]
    buffer_load_dwordx4 v108, s[24:27], s35 offen offset:2048 lds
    v_mfma_f32_16x16x32_bf16 v[164:167], a[240:243], v[64:67], v[164:167]
    s_add_u32 s35, s35, s36
    v_cvt_pk_bf16_f32 v96, v144, v145
    v_cvt_pk_bf16_f32 v97, v146, v147
    v_mfma_f32_16x16x32_bf16 v[164:167], a[244:247], v[68:71], v[164:167]
    v_cvt_pk_bf16_f32 v98, v148, v149
    v_cvt_pk_bf16_f32 v99, v150, v151
    v_mfma_f32_16x16x32_bf16 v[164:167], a[248:251], v[72:75], v[164:167]
    v_mfma_f32_16x16x32_bf16 v[164:167], a[252:255], v[76:79], v[164:167]
    s_waitcnt lgkmcnt(0)
    buffer_load_dwordx4 v109, s[24:27], s35 offen offset:3072 lds
    v_mfma_f32_16x16x32_bf16 v[152:155], a[48:51], v[80:83], v[152:155]
    ds_read_b64_tr_b16 v[64:65], v124 offset:16384
    s_add_u32 m0, m0, 4096
    v_mfma_f32_16x16x32_bf16 v[152:155], a[52:55], v[84:87], v[152:155]
    ds_read_b64_tr_b16 v[66:67], v124 offset:18432
    s_add_u32 s35, s35, s47
    v_mfma_f32_16x16x32_bf16 v[152:155], a[56:59], v[88:91], v[152:155]
    ds_read_b64_tr_b16 v[68:69], v124 offset:20480
    v_mfma_f32_16x16x32_bf16 v[152:155], a[60:63], v[92:95], v[152:155]
    buffer_load_dwordx4 v108, s[24:27], s35 offen offset:0 lds
    v_mfma_f32_16x16x32_bf16 v[156:159], a[112:115], v[80:83], v[156:159]
    ds_read_b64_tr_b16 v[70:71], v124 offset:22528
    s_add_u32 s35, s35, s36
    v_mfma_f32_16x16x32_bf16 v[156:159], a[116:119], v[84:87], v[156:159]
    ds_read_b64_tr_b16 v[72:73], v124 offset:24576
    v_mfma_f32_16x16x32_bf16 v[156:159], a[120:123], v[88:91], v[156:159]
    ds_read_b64_tr_b16 v[74:75], v124 offset:26624
    v_mfma_f32_16x16x32_bf16 v[156:159], a[124:127], v[92:95], v[156:159]
    buffer_load_dwordx4 v109, s[24:27], s35 offen offset:1024 lds
    v_mfma_f32_16x16x32_bf16 v[168:171], a[176:179], v[80:83], v[168:171]
    ds_read_b64_tr_b16 v[76:77], v124 offset:28672
    s_sub_u32 s35, s35, s37
    v_mfma_f32_16x16x32_bf16 v[168:171], a[180:183], v[84:87], v[168:171]
    ds_read_b64_tr_b16 v[78:79], v124 offset:30720
    v_mfma_f32_16x16x32_bf16 v[168:171], a[184:187], v[88:91], v[168:171]
    v_mfma_f32_16x16x32_bf16 v[168:171], a[188:191], v[92:95], v[168:171]
    buffer_load_dwordx4 v108, s[24:27], s35 offen offset:2048 lds
    v_mfma_f32_16x16x32_bf16 v[172:175], a[240:243], v[80:83], v[172:175]
    s_add_u32 s35, s35, s36
    v_cvt_pk_bf16_f32 v100, v152, v153
    v_cvt_pk_bf16_f32 v101, v154, v155
    v_mfma_f32_16x16x32_bf16 v[172:175], a[244:247], v[84:87], v[172:175]
    buffer_store_dwordx4 v[96:99], v110, s[28:31], s40 offen sc1
    v_mfma_f32_16x16x32_bf16 v[172:175], a[248:251], v[88:91], v[172:175]
    v_cvt_pk_bf16_f32 v102, v156, v157
    v_cvt_pk_bf16_f32 v103, v158, v159
    v_mfma_f32_16x16x32_bf16 v[172:175], a[252:255], v[92:95], v[172:175]
    s_waitcnt lgkmcnt(0)
    buffer_load_dwordx4 v109, s[24:27], s35 offen offset:3072 lds
    v_mfma_f32_16x16x32_bf16 v[176:179], a[48:51], v[64:67], v[176:179]
    ds_read_b64_tr_b16 v[80:81], v125 offset:16384
    v_cvt_pk_bf16_f32 v96, v160, v161
    v_mfma_f32_16x16x32_bf16 v[176:179], a[52:55], v[68:71], v[176:179]
    ds_read_b64_tr_b16 v[82:83], v125 offset:18432
    v_cvt_pk_bf16_f32 v97, v162, v163
    v_mfma_f32_16x16x32_bf16 v[176:179], a[56:59], v[72:75], v[176:179]
    ds_read_b64_tr_b16 v[84:85], v125 offset:20480
    v_cvt_pk_bf16_f32 v98, v164, v165
    v_mfma_f32_16x16x32_bf16 v[176:179], a[60:63], v[76:79], v[176:179]
    buffer_store_dwordx4 v[100:103], v111, s[28:31], s40 offen sc1
    v_mfma_f32_16x16x32_bf16 v[180:183], a[112:115], v[64:67], v[180:183]
    ds_read_b64_tr_b16 v[86:87], v125 offset:22528
    v_cvt_pk_bf16_f32 v99, v166, v167
    v_mfma_f32_16x16x32_bf16 v[180:183], a[116:119], v[68:71], v[180:183]
    ds_read_b64_tr_b16 v[88:89], v125 offset:24576
    v_cvt_pk_bf16_f32 v100, v168, v169
    v_mfma_f32_16x16x32_bf16 v[180:183], a[120:123], v[72:75], v[180:183]
    ds_read_b64_tr_b16 v[90:91], v125 offset:26624
    v_cvt_pk_bf16_f32 v101, v170, v171
    v_mfma_f32_16x16x32_bf16 v[180:183], a[124:127], v[76:79], v[180:183]
    buffer_store_dwordx4 v[96:99], v110, s[28:31], s41 offen sc1
    v_mfma_f32_16x16x32_bf16 v[192:195], a[176:179], v[64:67], v[192:195]
    ds_read_b64_tr_b16 v[92:93], v125 offset:28672
    v_cvt_pk_bf16_f32 v102, v172, v173
    v_mfma_f32_16x16x32_bf16 v[192:195], a[180:183], v[68:71], v[192:195]
    ds_read_b64_tr_b16 v[94:95], v125 offset:30720
    v_cvt_pk_bf16_f32 v103, v174, v175
    v_mfma_f32_16x16x32_bf16 v[192:195], a[184:187], v[72:75], v[192:195]
    buffer_store_dwordx4 v[100:103], v111, s[28:31], s41 offen sc1
    v_mfma_f32_16x16x32_bf16 v[192:195], a[188:191], v[76:79], v[192:195]
    v_mfma_f32_16x16x32_bf16 v[196:199], a[240:243], v[64:67], v[196:199]
    s_add_u32 s52, s52, s53
    s_xor_b32 s53, s53, s54
    v_cvt_pk_bf16_f32 v96, v176, v177
    v_mfma_f32_16x16x32_bf16 v[196:199], a[244:247], v[68:71], v[196:199]
    s_mov_b32 s40, s52
    s_add_u32 s41, s52, s42
    v_cvt_pk_bf16_f32 v97, v178, v179
    v_mfma_f32_16x16x32_bf16 v[196:199], a[248:251], v[72:75], v[196:199]
    v_cvt_pk_bf16_f32 v98, v180, v181
    v_cvt_pk_bf16_f32 v99, v182, v183
    v_mfma_f32_16x16x32_bf16 v[196:199], a[252:255], v[76:79], v[196:199]
    s_waitcnt lgkmcnt(0)
    buffer_store_dwordx4 v[96:99], v110, s[28:31], s45 offen sc1
    v_mfma_f32_16x16x32_bf16 v[184:187], a[48:51], v[80:83], v[184:187]
    ds_read_b64_tr_b16 v[64:65], v122 offset:49152
    v_mfma_f32_16x16x32_bf16 v[184:187], a[52:55], v[84:87], v[184:187]
    ds_read_b64_tr_b16 v[66:67], v122 offset:51200
    v_mfma_f32_16x16x32_bf16 v[184:187], a[56:59], v[88:91], v[184:187]
    ds_read_b64_tr_b16 v[68:69], v122 offset:53248
    v_mfma_f32_16x16x32_bf16 v[184:187], a[60:63], v[92:95], v[184:187]
    s_barrier
    v_mfma_f32_16x16x32_bf16 v[188:191], a[112:115], v[80:83], v[188:191]
    ds_read_b64_tr_b16 v[70:71], v122 offset:55296
    s_add_u32 m0, s64, 32768
    v_mfma_f32_16x16x32_bf16 v[188:191], a[116:119], v[84:87], v[188:191]
    ds_read_b64_tr_b16 v[72:73], v122 offset:57344
    s_mul_i32 s35, s100, 3
    v_mfma_f32_16x16x32_bf16 v[188:191], a[120:123], v[88:91], v[188:191]
    ds_read_b64_tr_b16 v[74:75], v122 offset:59392
    s_add_u32 s35, s35, s38
    v_mfma_f32_16x16x32_bf16 v[188:191], a[124:127], v[92:95], v[188:191]
    s_add_u32 s35, s35, s65
    v_mfma_f32_16x16x32_bf16 v[200:203], a[176:179], v[80:83], v[200:203]
    ds_read_b64_tr_b16 v[76:77], v122 offset:61440
    v_mfma_f32_16x16x32_bf16 v[200:203], a[180:183], v[84:87], v[200:203]
    ds_read_b64_tr_b16 v[78:79], v122 offset:63488
    v_mfma_f32_16x16x32_bf16 v[200:203], a[184:187], v[88:91], v[200:203]
    buffer_load_dwordx4 v108, s[24:27], s35 offen offset:0 lds
    v_mfma_f32_16x16x32_bf16 v[200:203], a[188:191], v[92:95], v[200:203]
    s_add_u32 s35, s35, s36
    v_mfma_f32_16x16x32_bf16 v[204:207], a[240:243], v[80:83], v[204:207]
    v_cvt_pk_bf16_f32 v100, v184, v185
    v_cvt_pk_bf16_f32 v101, v186, v187
    v_mfma_f32_16x16x32_bf16 v[204:207], a[244:247], v[84:87], v[204:207]
    v_cvt_pk_bf16_f32 v102, v188, v189
    v_cvt_pk_bf16_f32 v103, v190, v191
    v_mfma_f32_16x16x32_bf16 v[204:207], a[248:251], v[88:91], v[204:207]
    buffer_load_dwordx4 v109, s[24:27], s35 offen offset:1024 lds
    v_mfma_f32_16x16x32_bf16 v[204:207], a[252:255], v[92:95], v[204:207]
    s_waitcnt lgkmcnt(0)
    s_sub_u32 s35, s35, s37
    v_cvt_pk_bf16_f32 v96, v192, v193
    v_mfma_f32_16x16x32_bf16 v[0:3], a[48:51], v[64:67], v[0:3]
    ds_read_b64_tr_b16 v[80:81], v123 offset:49152
    v_cvt_pk_bf16_f32 v97, v194, v195
    v_mfma_f32_16x16x32_bf16 v[0:3], a[52:55], v[68:71], v[0:3]
    ds_read_b64_tr_b16 v[82:83], v123 offset:51200
    v_cvt_pk_bf16_f32 v98, v196, v197
    v_mfma_f32_16x16x32_bf16 v[0:3], a[56:59], v[72:75], v[0:3]
    ds_read_b64_tr_b16 v[84:85], v123 offset:53248
    v_cvt_pk_bf16_f32 v99, v198, v199
    v_mfma_f32_16x16x32_bf16 v[0:3], a[60:63], v[76:79], v[0:3]
    buffer_load_dwordx4 v108, s[24:27], s35 offen offset:2048 lds
    v_mfma_f32_16x16x32_bf16 v[4:7], a[112:115], v[64:67], v[4:7]
    ds_read_b64_tr_b16 v[86:87], v123 offset:55296
    s_add_u32 s35, s35, s36
    v_mfma_f32_16x16x32_bf16 v[4:7], a[116:119], v[68:71], v[4:7]
    ds_read_b64_tr_b16 v[88:89], v123 offset:57344
    v_mfma_f32_16x16x32_bf16 v[4:7], a[120:123], v[72:75], v[4:7]
    ds_read_b64_tr_b16 v[90:91], v123 offset:59392
    v_mfma_f32_16x16x32_bf16 v[4:7], a[124:127], v[76:79], v[4:7]
    buffer_load_dwordx4 v109, s[24:27], s35 offen offset:3072 lds
    v_mfma_f32_16x16x32_bf16 v[16:19], a[176:179], v[64:67], v[16:19]
    ds_read_b64_tr_b16 v[92:93], v123 offset:61440
    s_add_u32 m0, m0, 4096
    v_mfma_f32_16x16x32_bf16 v[16:19], a[180:183], v[68:71], v[16:19]
    ds_read_b64_tr_b16 v[94:95], v123 offset:63488
    s_add_u32 s35, s35, s47
    v_mfma_f32_16x16x32_bf16 v[16:19], a[184:187], v[72:75], v[16:19]
    v_mfma_f32_16x16x32_bf16 v[16:19], a[188:191], v[76:79], v[16:19]
    buffer_load_dwordx4 v108, s[24:27], s35 offen offset:0 lds
    v_mfma_f32_16x16x32_bf16 v[20:23], a[240:243], v[64:67], v[20:23]
    s_add_u32 s35, s35, s36
    v_mfma_f32_16x16x32_bf16 v[20:23], a[244:247], v[68:71], v[20:23]
    buffer_store_dwordx4 v[100:103], v111, s[28:31], s45 offen sc1
    v_mfma_f32_16x16x32_bf16 v[20:23], a[248:251], v[72:75], v[20:23]
    v_mfma_f32_16x16x32_bf16 v[20:23], a[252:255], v[76:79], v[20:23]
    s_waitcnt lgkmcnt(0)
    buffer_load_dwordx4 v109, s[24:27], s35 offen offset:1024 lds
    v_mfma_f32_16x16x32_bf16 v[8:11], a[48:51], v[80:83], v[8:11]
    ds_read_b64_tr_b16 v[64:65], v124 offset:49152
    s_sub_u32 s35, s35, s37
    v_mfma_f32_16x16x32_bf16 v[8:11], a[52:55], v[84:87], v[8:11]
    ds_read_b64_tr_b16 v[66:67], v124 offset:51200
    v_cvt_pk_bf16_f32 v100, v200, v201
    v_mfma_f32_16x16x32_bf16 v[8:11], a[56:59], v[88:91], v[8:11]
    ds_read_b64_tr_b16 v[68:69], v124 offset:53248
    v_cvt_pk_bf16_f32 v101, v202, v203
    v_mfma_f32_16x16x32_bf16 v[8:11], a[60:63], v[92:95], v[8:11]
    buffer_load_dwordx4 v108, s[24:27], s35 offen offset:2048 lds
    v_mfma_f32_16x16x32_bf16 v[12:15], a[112:115], v[80:83], v[12:15]
    ds_read_b64_tr_b16 v[70:71], v124 offset:55296
    s_add_u32 s35, s35, s36
    v_mfma_f32_16x16x32_bf16 v[12:15], a[116:119], v[84:87], v[12:15]
    ds_read_b64_tr_b16 v[72:73], v124 offset:57344
    v_cvt_pk_bf16_f32 v102, v204, v205
    v_mfma_f32_16x16x32_bf16 v[12:15], a[120:123], v[88:91], v[12:15]
    ds_read_b64_tr_b16 v[74:75], v124 offset:59392
    v_cvt_pk_bf16_f32 v103, v206, v207
    v_mfma_f32_16x16x32_bf16 v[12:15], a[124:127], v[92:95], v[12:15]
    buffer_load_dwordx4 v109, s[24:27], s35 offen offset:3072 lds
    v_mfma_f32_16x16x32_bf16 v[24:27], a[176:179], v[80:83], v[24:27]
    ds_read_b64_tr_b16 v[76:77], v124 offset:61440
    s_lshl_b32 s35, s100, 2
    v_mfma_f32_16x16x32_bf16 v[24:27], a[180:183], v[84:87], v[24:27]
    ds_read_b64_tr_b16 v[78:79], v124 offset:63488
    s_add_u32 s38, s38, s35
    v_mfma_f32_16x16x32_bf16 v[24:27], a[184:187], v[88:91], v[24:27]
    buffer_store_dwordx4 v[96:99], v110, s[28:31], s46 offen sc1
    v_mfma_f32_16x16x32_bf16 v[24:27], a[188:191], v[92:95], v[24:27]
    v_mfma_f32_16x16x32_bf16 v[28:31], a[240:243], v[80:83], v[28:31]
    buffer_store_dwordx4 v[100:103], v111, s[28:31], s46 offen sc1
    v_mfma_f32_16x16x32_bf16 v[28:31], a[244:247], v[84:87], v[28:31]
    v_cvt_pk_bf16_f32 v96, v0, v1
    v_cvt_pk_bf16_f32 v97, v2, v3
    v_mfma_f32_16x16x32_bf16 v[28:31], a[248:251], v[88:91], v[28:31]
    s_add_u32 s45, s52, s43
    s_add_u32 s46, s41, s43
    v_cvt_pk_bf16_f32 v98, v4, v5
    v_mfma_f32_16x16x32_bf16 v[28:31], a[252:255], v[92:95], v[28:31]
    s_waitcnt lgkmcnt(0)
    v_cvt_pk_bf16_f32 v99, v6, v7
    v_cvt_pk_bf16_f32 v100, v8, v9
    v_mfma_f32_16x16x32_bf16 v[32:35], a[48:51], v[64:67], v[32:35]
    ds_read_b64_tr_b16 v[80:81], v125 offset:49152
    v_cvt_pk_bf16_f32 v101, v10, v11
    v_mfma_f32_16x16x32_bf16 v[32:35], a[52:55], v[68:71], v[32:35]
    ds_read_b64_tr_b16 v[82:83], v125 offset:51200
    v_cvt_pk_bf16_f32 v102, v12, v13
    v_mfma_f32_16x16x32_bf16 v[32:35], a[56:59], v[72:75], v[32:35]
    ds_read_b64_tr_b16 v[84:85], v125 offset:53248
    v_cvt_pk_bf16_f32 v103, v14, v15
    v_mfma_f32_16x16x32_bf16 v[32:35], a[60:63], v[76:79], v[32:35]
    buffer_store_dwordx4 v[96:99], v110, s[28:31], s40 offen sc1
    v_mfma_f32_16x16x32_bf16 v[36:39], a[112:115], v[64:67], v[36:39]
    ds_read_b64_tr_b16 v[86:87], v125 offset:55296
    v_mfma_f32_16x16x32_bf16 v[36:39], a[116:119], v[68:71], v[36:39]
    ds_read_b64_tr_b16 v[88:89], v125 offset:57344
    v_cvt_pk_bf16_f32 v96, v16, v17
    v_mfma_f32_16x16x32_bf16 v[36:39], a[120:123], v[72:75], v[36:39]
    ds_read_b64_tr_b16 v[90:91], v125 offset:59392
    v_cvt_pk_bf16_f32 v97, v18, v19
    v_mfma_f32_16x16x32_bf16 v[36:39], a[124:127], v[76:79], v[36:39]
    buffer_store_dwordx4 v[100:103], v111, s[28:31], s40 offen sc1
    v_mfma_f32_16x16x32_bf16 v[48:51], a[176:179], v[64:67], v[48:51]
    ds_read_b64_tr_b16 v[92:93], v125 offset:61440
    v_cvt_pk_bf16_f32 v98, v20, v21
    v_mfma_f32_16x16x32_bf16 v[48:51], a[180:183], v[68:71], v[48:51]
    ds_read_b64_tr_b16 v[94:95], v125 offset:63488
    v_cvt_pk_bf16_f32 v99, v22, v23
    v_mfma_f32_16x16x32_bf16 v[48:51], a[184:187], v[72:75], v[48:51]
    s_waitcnt vmcnt(43)
    s_barrier
    v_cvt_pk_bf16_f32 v100, v24, v25
    v_mfma_f32_16x16x32_bf16 v[48:51], a[188:191], v[76:79], v[48:51]
    buffer_store_dwordx4 v[96:99], v110, s[28:31], s41 offen sc1
    v_mfma_f32_16x16x32_bf16 v[52:55], a[240:243], v[64:67], v[52:55]
    v_cvt_pk_bf16_f32 v101, v26, v27
    v_cvt_pk_bf16_f32 v102, v28, v29
    v_mfma_f32_16x16x32_bf16 v[52:55], a[244:247], v[68:71], v[52:55]
    v_cvt_pk_bf16_f32 v103, v30, v31
    v_mfma_f32_16x16x32_bf16 v[52:55], a[248:251], v[72:75], v[52:55]
    buffer_store_dwordx4 v[100:103], v111, s[28:31], s41 offen sc1
    v_mfma_f32_16x16x32_bf16 v[52:55], a[252:255], v[76:79], v[52:55]
    s_waitcnt lgkmcnt(0)
    v_mfma_f32_16x16x32_bf16 v[40:43], a[48:51], v[80:83], v[40:43]
    ds_read_b64_tr_b16 v[64:65], v104 offset:0
    v_mfma_f32_16x16x32_bf16 v[40:43], a[52:55], v[84:87], v[40:43]
    ds_read_b64_tr_b16 v[66:67], v104 offset:2048
    v_mfma_f32_16x16x32_bf16 v[40:43], a[56:59], v[88:91], v[40:43]
    ds_read_b64_tr_b16 v[68:69], v104 offset:4096
    v_mfma_f32_16x16x32_bf16 v[40:43], a[60:63], v[92:95], v[40:43]
    v_mfma_f32_16x16x32_bf16 v[44:47], a[112:115], v[80:83], v[44:47]
    ds_read_b64_tr_b16 v[70:71], v104 offset:6144
    v_mfma_f32_16x16x32_bf16 v[44:47], a[116:119], v[84:87], v[44:47]
    ds_read_b64_tr_b16 v[72:73], v104 offset:8192
    v_mfma_f32_16x16x32_bf16 v[44:47], a[120:123], v[88:91], v[44:47]
    ds_read_b64_tr_b16 v[74:75], v104 offset:10240
    v_mfma_f32_16x16x32_bf16 v[44:47], a[124:127], v[92:95], v[44:47]
    v_mfma_f32_16x16x32_bf16 v[56:59], a[176:179], v[80:83], v[56:59]
    ds_read_b64_tr_b16 v[76:77], v104 offset:12288
    v_mfma_f32_16x16x32_bf16 v[56:59], a[180:183], v[84:87], v[56:59]
    ds_read_b64_tr_b16 v[78:79], v104 offset:14336
    v_mfma_f32_16x16x32_bf16 v[56:59], a[184:187], v[88:91], v[56:59]
    v_mfma_f32_16x16x32_bf16 v[56:59], a[188:191], v[92:95], v[56:59]
    v_mfma_f32_16x16x32_bf16 v[60:63], a[240:243], v[80:83], v[60:63]
    v_mfma_f32_16x16x32_bf16 v[60:63], a[244:247], v[84:87], v[60:63]
    v_mfma_f32_16x16x32_bf16 v[60:63], a[248:251], v[88:91], v[60:63]
    v_mfma_f32_16x16x32_bf16 v[60:63], a[252:255], v[92:95], v[60:63]
    s_waitcnt lgkmcnt(0)
.p2align 3
K1_N:
    v_mfma_f32_16x16x32_bf16 v[0:3], a[0:3], v[64:67], 0
    ds_read_b64_tr_b16 v[80:81], v105 offset:0
    v_mfma_f32_16x16x32_bf16 v[0:3], a[4:7], v[68:71], v[0:3]
    ds_read_b64_tr_b16 v[82:83], v105 offset:2048
    v_mfma_f32_16x16x32_bf16 v[0:3], a[8:11], v[72:75], v[0:3]
    ds_read_b64_tr_b16 v[84:85], v105 offset:4096
    v_mfma_f32_16x16x32_bf16 v[0:3], a[12:15], v[76:79], v[0:3]
    v_cvt_pk_bf16_f32 v96, v32, v33
    v_cvt_pk_bf16_f32 v97, v34, v35
    v_mfma_f32_16x16x32_bf16 v[4:7], a[64:67], v[64:67], 0
    ds_read_b64_tr_b16 v[86:87], v105 offset:6144
    v_cvt_pk_bf16_f32 v98, v36, v37
    v_mfma_f32_16x16x32_bf16 v[4:7], a[68:71], v[68:71], v[4:7]
    ds_read_b64_tr_b16 v[88:89], v105 offset:8192
    v_cvt_pk_bf16_f32 v99, v38, v39
    v_mfma_f32_16x16x32_bf16 v[4:7], a[72:75], v[72:75], v[4:7]
    ds_read_b64_tr_b16 v[90:91], v105 offset:10240
    v_cvt_pk_bf16_f32 v100, v40, v41
    v_mfma_f32_16x16x32_bf16 v[4:7], a[76:79], v[76:79], v[4:7]
    buffer_store_dwordx4 v[96:99], v110, s[28:31], s45 offen sc1
    v_mfma_f32_16x16x32_bf16 v[16:19], a[128:131], v[64:67], 0
    ds_read_b64_tr_b16 v[92:93], v105 offset:12288
    v_cvt_pk_bf16_f32 v101, v42, v43
    v_mfma_f32_16x16x32_bf16 v[16:19], a[132:135], v[68:71], v[16:19]
    ds_read_b64_tr_b16 v[94:95], v105 offset:14336
    v_cvt_pk_bf16_f32 v102, v44, v45
    v_mfma_f32_16x16x32_bf16 v[16:19], a[136:139], v[72:75], v[16:19]
    v_cvt_pk_bf16_f32 v103, v46, v47
    v_cvt_pk_bf16_f32 v96, v48, v49
    v_mfma_f32_16x16x32_bf16 v[16:19], a[140:143], v[76:79], v[16:19]
    buffer_store_dwordx4 v[100:103], v111, s[28:31], s45 offen sc1
    v_mfma_f32_16x16x32_bf16 v[20:23], a[192:195], v[64:67], 0
    v_cvt_pk_bf16_f32 v97, v50, v51
    v_cvt_pk_bf16_f32 v98, v52, v53
    v_mfma_f32_16x16x32_bf16 v[20:23], a[196:199], v[68:71], v[20:23]
    v_cvt_pk_bf16_f32 v99, v54, v55
    v_cvt_pk_bf16_f32 v100, v56, v57
    v_mfma_f32_16x16x32_bf16 v[20:23], a[200:203], v[72:75], v[20:23]
    v_cvt_pk_bf16_f32 v101, v58, v59
    v_cvt_pk_bf16_f32 v102, v60, v61
    v_mfma_f32_16x16x32_bf16 v[20:23], a[204:207], v[76:79], v[20:23]
    s_waitcnt lgkmcnt(0)
    buffer_store_dwordx4 v[96:99], v110, s[28:31], s46 offen sc1
    v_mfma_f32_16x16x32_bf16 v[8:11], a[0:3], v[80:83], 0
    ds_read_b64_tr_b16 v[64:65], v106 offset:0
    v_cvt_pk_bf16_f32 v103, v62, v63
    v_mfma_f32_16x16x32_bf16 v[8:11], a[4:7], v[84:87], v[8:11]
    ds_read_b64_tr_b16 v[66:67], v106 offset:2048
    v_mfma_f32_16x16x32_bf16 v[8:11], a[8:11], v[88:91], v[8:11]
    ds_read_b64_tr_b16 v[68:69], v106 offset:4096
    v_mfma_f32_16x16x32_bf16 v[8:11], a[12:15], v[92:95], v[8:11]
    buffer_store_dwordx4 v[100:103], v111, s[28:31], s46 offen sc1
    v_mfma_f32_16x16x32_bf16 v[12:15], a[64:67], v[80:83], 0
    ds_read_b64_tr_b16 v[70:71], v106 offset:6144
    v_mfma_f32_16x16x32_bf16 v[12:15], a[68:71], v[84:87], v[12:15]
    ds_read_b64_tr_b16 v[72:73], v106 offset:8192
    v_mfma_f32_16x16x32_bf16 v[12:15], a[72:75], v[88:91], v[12:15]
    ds_read_b64_tr_b16 v[74:75], v106 offset:10240
    v_mfma_f32_16x16x32_bf16 v[12:15], a[76:79], v[92:95], v[12:15]
    v_mfma_f32_16x16x32_bf16 v[24:27], a[128:131], v[80:83], 0
    ds_read_b64_tr_b16 v[76:77], v106 offset:12288
    v_mfma_f32_16x16x32_bf16 v[24:27], a[132:135], v[84:87], v[24:27]
    ds_read_b64_tr_b16 v[78:79], v106 offset:14336
    v_mfma_f32_16x16x32_bf16 v[24:27], a[136:139], v[88:91], v[24:27]
    v_mfma_f32_16x16x32_bf16 v[24:27], a[140:143], v[92:95], v[24:27]
    v_mfma_f32_16x16x32_bf16 v[28:31], a[192:195], v[80:83], 0
    v_mfma_f32_16x16x32_bf16 v[28:31], a[196:199], v[84:87], v[28:31]
    v_mfma_f32_16x16x32_bf16 v[28:31], a[200:203], v[88:91], v[28:31]
    v_mfma_f32_16x16x32_bf16 v[28:31], a[204:207], v[92:95], v[28:31]
    s_waitcnt lgkmcnt(0)
    v_mfma_f32_16x16x32_bf16 v[32:35], a[0:3], v[64:67], 0
    ds_read_b64_tr_b16 v[80:81], v107 offset:0
    v_mfma_f32_16x16x32_bf16 v[32:35], a[4:7], v[68:71], v[32:35]
    ds_read_b64_tr_b16 v[82:83], v107 offset:2048
    v_mfma_f32_16x16x32_bf16 v[32:35], a[8:11], v[72:75], v[32:35]
    ds_read_b64_tr_b16 v[84:85], v107 offset:4096
    v_mfma_f32_16x16x32_bf16 v[32:35], a[12:15], v[76:79], v[32:35]
    v_mfma_f32_16x16x32_bf16 v[36:39], a[64:67], v[64:67], 0
    ds_read_b64_tr_b16 v[86:87], v107 offset:6144
    v_mfma_f32_16x16x32_bf16 v[36:39], a[68:71], v[68:71], v[36:39]
    ds_read_b64_tr_b16 v[88:89], v107 offset:8192
    v_mfma_f32_16x16x32_bf16 v[36:39], a[72:75], v[72:75], v[36:39]
    ds_read_b64_tr_b16 v[90:91], v107 offset:10240
    v_mfma_f32_16x16x32_bf16 v[36:39], a[76:79], v[76:79], v[36:39]
    v_mfma_f32_16x16x32_bf16 v[48:51], a[128:131], v[64:67], 0
    ds_read_b64_tr_b16 v[92:93], v107 offset:12288
    v_mfma_f32_16x16x32_bf16 v[48:51], a[132:135], v[68:71], v[48:51]
    ds_read_b64_tr_b16 v[94:95], v107 offset:14336
    v_mfma_f32_16x16x32_bf16 v[48:51], a[136:139], v[72:75], v[48:51]
    v_mfma_f32_16x16x32_bf16 v[48:51], a[140:143], v[76:79], v[48:51]
    v_mfma_f32_16x16x32_bf16 v[52:55], a[192:195], v[64:67], 0
    v_mfma_f32_16x16x32_bf16 v[52:55], a[196:199], v[68:71], v[52:55]
    v_mfma_f32_16x16x32_bf16 v[52:55], a[200:203], v[72:75], v[52:55]
    v_mfma_f32_16x16x32_bf16 v[52:55], a[204:207], v[76:79], v[52:55]
    s_waitcnt lgkmcnt(0)
    v_mfma_f32_16x16x32_bf16 v[40:43], a[0:3], v[80:83], 0
    ds_read_b64_tr_b16 v[64:65], v104 offset:16384
    s_add_u32 s66, s66, 1
    v_mfma_f32_16x16x32_bf16 v[40:43], a[4:7], v[84:87], v[40:43]
    ds_read_b64_tr_b16 v[66:67], v104 offset:18432
    s_cmp_eq_u32 s66, 5
    v_mfma_f32_16x16x32_bf16 v[40:43], a[8:11], v[88:91], v[40:43]
    ds_read_b64_tr_b16 v[68:69], v104 offset:20480
    s_cselect_b32 s32, 0xfffe0000, s67
    v_mfma_f32_16x16x32_bf16 v[40:43], a[12:15], v[92:95], v[40:43]
    v_mfma_f32_16x16x32_bf16 v[44:47], a[64:67], v[80:83], 0
    ds_read_b64_tr_b16 v[70:71], v104 offset:22528
    s_cselect_b32 s66, 0, s66
    v_mfma_f32_16x16x32_bf16 v[44:47], a[68:71], v[84:87], v[44:47]
    ds_read_b64_tr_b16 v[72:73], v104 offset:24576
    v_mfma_f32_16x16x32_bf16 v[44:47], a[72:75], v[88:91], v[44:47]
    ds_read_b64_tr_b16 v[74:75], v104 offset:26624
    v_mfma_f32_16x16x32_bf16 v[44:47], a[76:79], v[92:95], v[44:47]
    v_mfma_f32_16x16x32_bf16 v[56:59], a[128:131], v[80:83], 0
    ds_read_b64_tr_b16 v[76:77], v104 offset:28672
    v_mfma_f32_16x16x32_bf16 v[56:59], a[132:135], v[84:87], v[56:59]
    ds_read_b64_tr_b16 v[78:79], v104 offset:30720
    v_mfma_f32_16x16x32_bf16 v[56:59], a[136:139], v[88:91], v[56:59]
    s_waitcnt vmcnt(24)
    s_barrier
    v_mfma_f32_16x16x32_bf16 v[56:59], a[140:143], v[92:95], v[56:59]
    s_cmp_lt_u32 s55, s34
    s_cbranch_scc0 K1_VN0
    s_mov_b32 s35, s38
K1_RN0:
    v_mfma_f32_16x16x32_bf16 v[60:63], a[192:195], v[80:83], 0
    s_mov_b32 m0, s51
    s_add_u32 s51, s51, 32768
    v_mfma_f32_16x16x32_bf16 v[60:63], a[196:199], v[84:87], v[60:63]
    buffer_load_dwordx4 v108, s[24:27], s35 offen offset:0 lds
    v_mfma_f32_16x16x32_bf16 v[60:63], a[200:203], v[88:91], v[60:63]
    s_add_u32 s35, s35, s36
    v_mfma_f32_16x16x32_bf16 v[60:63], a[204:207], v[92:95], v[60:63]
    s_waitcnt lgkmcnt(0)
    v_mfma_f32_16x16x32_bf16 v[0:3], a[16:19], v[64:67], v[0:3]
    ds_read_b64_tr_b16 v[80:81], v105 offset:16384
    v_mfma_f32_16x16x32_bf16 v[0:3], a[20:23], v[68:71], v[0:3]
    ds_read_b64_tr_b16 v[82:83], v105 offset:18432
    v_mfma_f32_16x16x32_bf16 v[0:3], a[24:27], v[72:75], v[0:3]
    ds_read_b64_tr_b16 v[84:85], v105 offset:20480
    v_mfma_f32_16x16x32_bf16 v[0:3], a[28:31], v[76:79], v[0:3]
    buffer_load_dwordx4 v109, s[24:27], s35 offen offset:1024 lds
    v_mfma_f32_16x16x32_bf16 v[4:7], a[80:83], v[64:67], v[4:7]
    ds_read_b64_tr_b16 v[86:87], v105 offset:22528
    s_sub_u32 s35, s35, s37
    v_mfma_f32_16x16x32_bf16 v[4:7], a[84:87], v[68:71], v[4:7]
    ds_read_b64_tr_b16 v[88:89], v105 offset:24576
    v_mfma_f32_16x16x32_bf16 v[4:7], a[88:91], v[72:75], v[4:7]
    ds_read_b64_tr_b16 v[90:91], v105 offset:26624
    v_mfma_f32_16x16x32_bf16 v[4:7], a[92:95], v[76:79], v[4:7]
    buffer_load_dwordx4 v108, s[24:27], s35 offen offset:2048 lds
    v_mfma_f32_16x16x32_bf16 v[16:19], a[144:147], v[64:67], v[16:19]
    ds_read_b64_tr_b16 v[92:93], v105 offset:28672
    s_add_u32 s35, s35, s36
    v_mfma_f32_16x16x32_bf16 v[16:19], a[148:151], v[68:71], v[16:19]
    ds_read_b64_tr_b16 v[94:95], v105 offset:30720
    v_mfma_f32_16x16x32_bf16 v[16:19], a[152:155], v[72:75], v[16:19]
    v_add_u32 v104, s32, v104
    v_mfma_f32_16x16x32_bf16 v[16:19], a[156:159], v[76:79], v[16:19]
    buffer_load_dwordx4 v109, s[24:27], s35 offen offset:3072 lds
    v_mfma_f32_16x16x32_bf16 v[20:23], a[208:211], v[64:67], v[20:23]
    s_add_u32 m0, m0, 4096
    s_add_u32 s35, s35, s47
    v_mfma_f32_16x16x32_bf16 v[20:23], a[212:215], v[68:71], v[20:23]
    v_mfma_f32_16x16x32_bf16 v[20:23], a[216:219], v[72:75], v[20:23]
    v_mfma_f32_16x16x32_bf16 v[20:23], a[220:223], v[76:79], v[20:23]
    s_waitcnt lgkmcnt(0)
    buffer_load_dwordx4 v108, s[24:27], s35 offen offset:0 lds
    v_mfma_f32_16x16x32_bf16 v[8:11], a[16:19], v[80:83], v[8:11]
    ds_read_b64_tr_b16 v[64:65], v106 offset:16384
    s_add_u32 s35, s35, s36
    v_mfma_f32_16x16x32_bf16 v[8:11], a[20:23], v[84:87], v[8:11]
    ds_read_b64_tr_b16 v[66:67], v106 offset:18432
    v_mfma_f32_16x16x32_bf16 v[8:11], a[24:27], v[88:91], v[8:11]
    ds_read_b64_tr_b16 v[68:69], v106 offset:20480
    v_mfma_f32_16x16x32_bf16 v[8:11], a[28:31], v[92:95], v[8:11]
    buffer_load_dwordx4 v109, s[24:27], s35 offen offset:1024 lds
    v_mfma_f32_16x16x32_bf16 v[12:15], a[80:83], v[80:83], v[12:15]
    ds_read_b64_tr_b16 v[70:71], v106 offset:22528
    s_sub_u32 s35, s35, s37
    v_mfma_f32_16x16x32_bf16 v[12:15], a[84:87], v[84:87], v[12:15]
    ds_read_b64_tr_b16 v[72:73], v106 offset:24576
    v_mfma_f32_16x16x32_bf16 v[12:15], a[88:91], v[88:91], v[12:15]
    ds_read_b64_tr_b16 v[74:75], v106 offset:26624
    v_mfma_f32_16x16x32_bf16 v[12:15], a[92:95], v[92:95], v[12:15]
    buffer_load_dwordx4 v108, s[24:27], s35 offen offset:2048 lds
    v_mfma_f32_16x16x32_bf16 v[24:27], a[144:147], v[80:83], v[24:27]
    ds_read_b64_tr_b16 v[76:77], v106 offset:28672
    s_add_u32 s35, s35, s36
    v_mfma_f32_16x16x32_bf16 v[24:27], a[148:151], v[84:87], v[24:27]
    ds_read_b64_tr_b16 v[78:79], v106 offset:30720
    v_mfma_f32_16x16x32_bf16 v[24:27], a[152:155], v[88:91], v[24:27]
    v_add_u32 v105, s32, v105
    v_mfma_f32_16x16x32_bf16 v[24:27], a[156:159], v[92:95], v[24:27]
    buffer_load_dwordx4 v109, s[24:27], s35 offen offset:3072 lds
    v_mfma_f32_16x16x32_bf16 v[28:31], a[208:211], v[80:83], v[28:31]
    s_cmp_ge_u32 s51, 163840
    s_cselect_b32 s49, 163840, 0
    v_mfma_f32_16x16x32_bf16 v[28:31], a[212:215], v[84:87], v[28:31]
    s_sub_u32 s51, s51, s49
    s_add_u32 s55, s55, 1
    v_mfma_f32_16x16x32_bf16 v[28:31], a[216:219], v[88:91], v[28:31]
    s_add_u32 s52, s52, s53
    v_mfma_f32_16x16x32_bf16 v[28:31], a[220:223], v[92:95], v[28:31]
    s_waitcnt lgkmcnt(0)
    s_xor_b32 s53, s53, s54
    v_mfma_f32_16x16x32_bf16 v[32:35], a[16:19], v[64:67], v[32:35]
    ds_read_b64_tr_b16 v[80:81], v107 offset:16384
    s_mov_b32 s40, s52
    v_mfma_f32_16x16x32_bf16 v[32:35], a[20:23], v[68:71], v[32:35]
    ds_read_b64_tr_b16 v[82:83], v107 offset:18432
    s_add_u32 s41, s52, s42
    v_mfma_f32_16x16x32_bf16 v[32:35], a[24:27], v[72:75], v[32:35]
    ds_read_b64_tr_b16 v[84:85], v107 offset:20480
    s_add_u32 s45, s52, s43
    v_mfma_f32_16x16x32_bf16 v[32:35], a[28:31], v[76:79], v[32:35]
    s_add_u32 s46, s41, s43
    v_mfma_f32_16x16x32_bf16 v[36:39], a[80:83], v[64:67], v[36:39]
    ds_read_b64_tr_b16 v[86:87], v107 offset:22528
    s_add_u32 s33, s33, 2
    v_mfma_f32_16x16x32_bf16 v[36:39], a[84:87], v[68:71], v[36:39]
    ds_read_b64_tr_b16 v[88:89], v107 offset:24576
    v_mfma_f32_16x16x32_bf16 v[36:39], a[88:91], v[72:75], v[36:39]
    ds_read_b64_tr_b16 v[90:91], v107 offset:26624
    v_mfma_f32_16x16x32_bf16 v[36:39], a[92:95], v[76:79], v[36:39]
    v_mfma_f32_16x16x32_bf16 v[48:51], a[144:147], v[64:67], v[48:51]
    ds_read_b64_tr_b16 v[92:93], v107 offset:28672
    v_mfma_f32_16x16x32_bf16 v[48:51], a[148:151], v[68:71], v[48:51]
    ds_read_b64_tr_b16 v[94:95], v107 offset:30720
    v_mfma_f32_16x16x32_bf16 v[48:51], a[152:155], v[72:75], v[48:51]
    v_add_u32 v106, s32, v106
    v_mfma_f32_16x16x32_bf16 v[48:51], a[156:159], v[76:79], v[48:51]
    v_mfma_f32_16x16x32_bf16 v[52:55], a[208:211], v[64:67], v[52:55]
    v_mfma_f32_16x16x32_bf16 v[52:55], a[212:215], v[68:71], v[52:55]
    v_mfma_f32_16x16x32_bf16 v[52:55], a[216:219], v[72:75], v[52:55]
    v_mfma_f32_16x16x32_bf16 v[52:55], a[220:223], v[76:79], v[52:55]
    s_waitcnt lgkmcnt(0)
    v_mfma_f32_16x16x32_bf16 v[40:43], a[16:19], v[80:83], v[40:43]
    ds_read_b64_tr_b16 v[64:65], v104 offset:0
    v_mfma_f32_16x16x32_bf16 v[40:43], a[20:23], v[84:87], v[40:43]
    ds_read_b64_tr_b16 v[66:67], v104 offset:2048
    v_mfma_f32_16x16x32_bf16 v[40:43], a[24:27], v[88:91], v[40:43]
    ds_read_b64_tr_b16 v[68:69], v104 offset:4096
    v_mfma_f32_16x16x32_bf16 v[40:43], a[28:31], v[92:95], v[40:43]
    v_mfma_f32_16x16x32_bf16 v[44:47], a[80:83], v[80:83], v[44:47]
    ds_read_b64_tr_b16 v[70:71], v104 offset:6144
    v_mfma_f32_16x16x32_bf16 v[44:47], a[84:87], v[84:87], v[44:47]
    ds_read_b64_tr_b16 v[72:73], v104 offset:8192
    v_mfma_f32_16x16x32_bf16 v[44:47], a[88:91], v[88:91], v[44:47]
    ds_read_b64_tr_b16 v[74:75], v104 offset:10240
    v_mfma_f32_16x16x32_bf16 v[44:47], a[92:95], v[92:95], v[44:47]
    v_mfma_f32_16x16x32_bf16 v[56:59], a[144:147], v[80:83], v[56:59]
    ds_read_b64_tr_b16 v[76:77], v104 offset:12288
    v_mfma_f32_16x16x32_bf16 v[56:59], a[148:151], v[84:87], v[56:59]
    ds_read_b64_tr_b16 v[78:79], v104 offset:14336
    v_mfma_f32_16x16x32_bf16 v[56:59], a[152:155], v[88:91], v[56:59]
    v_add_u32 v107, s32, v107
    v_mfma_f32_16x16x32_bf16 v[56:59], a[156:159], v[92:95], v[56:59]
    v_mfma_f32_16x16x32_bf16 v[60:63], a[208:211], v[80:83], v[60:63]
    v_mfma_f32_16x16x32_bf16 v[60:63], a[212:215], v[84:87], v[60:63]
    v_mfma_f32_16x16x32_bf16 v[60:63], a[216:219], v[88:91], v[60:63]
    v_mfma_f32_16x16x32_bf16 v[60:63], a[220:223], v[92:95], v[60:63]
    s_waitcnt lgkmcnt(0)
    v_mfma_f32_16x16x32_bf16 v[0:3], a[32:35], v[64:67], v[0:3]
    ds_read_b64_tr_b16 v[80:81], v105 offset:0
    s_add_u32 s66, s66, 1
    v_mfma_f32_16x16x32_bf16 v[0:3], a[36:39], v[68:71], v[0:3]
    ds_read_b64_tr_b16 v[82:83], v105 offset:2048
    s_cmp_eq_u32 s66, 5
    v_mfma_f32_16x16x32_bf16 v[0:3], a[40:43], v[72:75], v[0:3]
    ds_read_b64_tr_b16 v[84:85], v105 offset:4096
    s_cselect_b32 s32, 0xfffe0000, s67
    v_mfma_f32_16x16x32_bf16 v[0:3], a[44:47], v[76:79], v[0:3]
    v_mfma_f32_16x16x32_bf16 v[4:7], a[96:99], v[64:67], v[4:7]
    ds_read_b64_tr_b16 v[86:87], v105 offset:6144
    s_cselect_b32 s66, 0, s66
    v_mfma_f32_16x16x32_bf16 v[4:7], a[100:103], v[68:71], v[4:7]
    ds_read_b64_tr_b16 v[88:89], v105 offset:8192
    v_mfma_f32_16x16x32_bf16 v[4:7], a[104:107], v[72:75], v[4:7]
    ds_read_b64_tr_b16 v[90:91], v105 offset:10240
    v_mfma_f32_16x16x32_bf16 v[4:7], a[108:111], v[76:79], v[4:7]
    v_mfma_f32_16x16x32_bf16 v[16:19], a[160:163], v[64:67], v[16:19]
    ds_read_b64_tr_b16 v[92:93], v105 offset:12288
    v_mfma_f32_16x16x32_bf16 v[16:19], a[164:167], v[68:71], v[16:19]
    ds_read_b64_tr_b16 v[94:95], v105 offset:14336
    v_mfma_f32_16x16x32_bf16 v[16:19], a[168:171], v[72:75], v[16:19]
    s_waitcnt vmcnt(24)
    s_barrier
    v_mfma_f32_16x16x32_bf16 v[16:19], a[172:175], v[76:79], v[16:19]
    s_cmp_lt_u32 s55, s34
    s_cbranch_scc0 K1_VN1
    s_add_u32 s35, s38, s65
K1_RN1:
    v_mfma_f32_16x16x32_bf16 v[20:23], a[224:227], v[64:67], v[20:23]
    s_mov_b32 m0, s51
    s_add_u32 s51, s51, 32768
    v_mfma_f32_16x16x32_bf16 v[20:23], a[228:231], v[68:71], v[20:23]
    buffer_load_dwordx4 v108, s[24:27], s35 offen offset:0 lds
    v_mfma_f32_16x16x32_bf16 v[20:23], a[232:235], v[72:75], v[20:23]
    s_add_u32 s35, s35, s36
    v_mfma_f32_16x16x32_bf16 v[20:23], a[236:239], v[76:79], v[20:23]
    s_waitcnt lgkmcnt(0)
    v_mfma_f32_16x16x32_bf16 v[8:11], a[32:35], v[80:83], v[8:11]
    ds_read_b64_tr_b16 v[64:65], v106 offset:0
    v_mfma_f32_16x16x32_bf16 v[8:11], a[36:39], v[84:87], v[8:11]
    ds_read_b64_tr_b16 v[66:67], v106 offset:2048
    v_mfma_f32_16x16x32_bf16 v[8:11], a[40:43], v[88:91], v[8:11]
    ds_read_b64_tr_b16 v[68:69], v106 offset:4096
    v_mfma_f32_16x16x32_bf16 v[8:11], a[44:47], v[92:95], v[8:11]
    buffer_load_dwordx4 v109, s[24:27], s35 offen offset:1024 lds
    v_mfma_f32_16x16x32_bf16 v[12:15], a[96:99], v[80:83], v[12:15]
    ds_read_b64_tr_b16 v[70:71], v106 offset:6144
    s_sub_u32 s35, s35, s37
    v_mfma_f32_16x16x32_bf16 v[12:15], a[100:103], v[84:87], v[12:15]
    ds_read_b64_tr_b16 v[72:73], v106 offset:8192
    v_mfma_f32_16x16x32_bf16 v[12:15], a[104:107], v[88:91], v[12:15]
    ds_read_b64_tr_b16 v[74:75], v106 offset:10240
    v_mfma_f32_16x16x32_bf16 v[12:15], a[108:111], v[92:95], v[12:15]
    buffer_load_dwordx4 v108, s[24:27], s35 offen offset:2048 lds
    v_mfma_f32_16x16x32_bf16 v[24:27], a[160:163], v[80:83], v[24:27]
    ds_read_b64_tr_b16 v[76:77], v106 offset:12288
    s_add_u32 s35, s35, s36
    v_mfma_f32_16x16x32_bf16 v[24:27], a[164:167], v[84:87], v[24:27]
    ds_read_b64_tr_b16 v[78:79], v106 offset:14336
    v_mfma_f32_16x16x32_bf16 v[24:27], a[168:171], v[88:91], v[24:27]
    v_mfma_f32_16x16x32_bf16 v[24:27], a[172:175], v[92:95], v[24:27]
    buffer_load_dwordx4 v109, s[24:27], s35 offen offset:3072 lds
    v_mfma_f32_16x16x32_bf16 v[28:31], a[224:227], v[80:83], v[28:31]
    s_add_u32 m0, m0, 4096
    s_add_u32 s35, s35, s47
    v_mfma_f32_16x16x32_bf16 v[28:31], a[228:231], v[84:87], v[28:31]
    v_mfma_f32_16x16x32_bf16 v[28:31], a[232:235], v[88:91], v[28:31]
    v_mfma_f32_16x16x32_bf16 v[28:31], a[236:239], v[92:95], v[28:31]
    s_waitcnt lgkmcnt(0)
    buffer_load_dwordx4 v108, s[24:27], s35 offen offset:0 lds
    v_mfma_f32_16x16x32_bf16 v[32:35], a[32:35], v[64:67], v[32:35]
    ds_read_b64_tr_b16 v[80:81], v107 offset:0
    s_add_u32 s35, s35, s36
    v_mfma_f32_16x16x32_bf16 v[32:35], a[36:39], v[68:71], v[32:35]
    ds_read_b64_tr_b16 v[82:83], v107 offset:2048
    v_mfma_f32_16x16x32_bf16 v[32:35], a[40:43], v[72:75], v[32:35]
    ds_read_b64_tr_b16 v[84:85], v107 offset:4096
    v_mfma_f32_16x16x32_bf16 v[32:35], a[44:47], v[76:79], v[32:35]
    buffer_load_dwordx4 v109, s[24:27], s35 offen offset:1024 lds
    v_mfma_f32_16x16x32_bf16 v[36:39], a[96:99], v[64:67], v[36:39]
    ds_read_b64_tr_b16 v[86:87], v107 offset:6144
    s_sub_u32 s35, s35, s37
    v_mfma_f32_16x16x32_bf16 v[36:39], a[100:103], v[68:71], v[36:39]
    ds_read_b64_tr_b16 v[88:89], v107 offset:8192
    v_mfma_f32_16x16x32_bf16 v[36:39], a[104:107], v[72:75], v[36:39]
    ds_read_b64_tr_b16 v[90:91], v107 offset:10240
    v_mfma_f32_16x16x32_bf16 v[36:39], a[108:111], v[76:79], v[36:39]
    buffer_load_dwordx4 v108, s[24:27], s35 offen offset:2048 lds
    v_mfma_f32_16x16x32_bf16 v[48:51], a[160:163], v[64:67], v[48:51]
    ds_read_b64_tr_b16 v[92:93], v107 offset:12288
    s_add_u32 s35, s35, s36
    v_mfma_f32_16x16x32_bf16 v[48:51], a[164:167], v[68:71], v[48:51]
    ds_read_b64_tr_b16 v[94:95], v107 offset:14336
    v_mfma_f32_16x16x32_bf16 v[48:51], a[168:171], v[72:75], v[48:51]
    v_mfma_f32_16x16x32_bf16 v[48:51], a[172:175], v[76:79], v[48:51]
    buffer_load_dwordx4 v109, s[24:27], s35 offen offset:3072 lds
    v_mfma_f32_16x16x32_bf16 v[52:55], a[224:227], v[64:67], v[52:55]
    s_cmp_ge_u32 s51, 163840
    s_cselect_b32 s49, 163840, 0
    v_mfma_f32_16x16x32_bf16 v[52:55], a[228:231], v[68:71], v[52:55]
    s_sub_u32 s51, s51, s49
    s_add_u32 s55, s55, 1
    v_mfma_f32_16x16x32_bf16 v[52:55], a[232:235], v[72:75], v[52:55]
    s_add_u32 s38, s38, s100
    v_mfma_f32_16x16x32_bf16 v[52:55], a[236:239], v[76:79], v[52:55]
    s_waitcnt lgkmcnt(0)
    v_mfma_f32_16x16x32_bf16 v[40:43], a[32:35], v[80:83], v[40:43]
    ds_read_b64_tr_b16 v[64:65], v104 offset:16384
    v_mfma_f32_16x16x32_bf16 v[40:43], a[36:39], v[84:87], v[40:43]
    ds_read_b64_tr_b16 v[66:67], v104 offset:18432
    v_mfma_f32_16x16x32_bf16 v[40:43], a[40:43], v[88:91], v[40:43]
    ds_read_b64_tr_b16 v[68:69], v104 offset:20480
    v_mfma_f32_16x16x32_bf16 v[40:43], a[44:47], v[92:95], v[40:43]
    v_mfma_f32_16x16x32_bf16 v[44:47], a[96:99], v[80:83], v[44:47]
    ds_read_b64_tr_b16 v[70:71], v104 offset:22528
    v_mfma_f32_16x16x32_bf16 v[44:47], a[100:103], v[84:87], v[44:47]
    ds_read_b64_tr_b16 v[72:73], v104 offset:24576
    v_mfma_f32_16x16x32_bf16 v[44:47], a[104:107], v[88:91], v[44:47]
    ds_read_b64_tr_b16 v[74:75], v104 offset:26624
    v_mfma_f32_16x16x32_bf16 v[44:47], a[108:111], v[92:95], v[44:47]
    v_mfma_f32_16x16x32_bf16 v[56:59], a[160:163], v[80:83], v[56:59]
    ds_read_b64_tr_b16 v[76:77], v104 offset:28672
    v_mfma_f32_16x16x32_bf16 v[56:59], a[164:167], v[84:87], v[56:59]
    ds_read_b64_tr_b16 v[78:79], v104 offset:30720
    v_mfma_f32_16x16x32_bf16 v[56:59], a[168:171], v[88:91], v[56:59]
    v_mfma_f32_16x16x32_bf16 v[56:59], a[172:175], v[92:95], v[56:59]
    v_mfma_f32_16x16x32_bf16 v[60:63], a[224:227], v[80:83], v[60:63]
    v_mfma_f32_16x16x32_bf16 v[60:63], a[228:231], v[84:87], v[60:63]
    v_mfma_f32_16x16x32_bf16 v[60:63], a[232:235], v[88:91], v[60:63]
    v_mfma_f32_16x16x32_bf16 v[60:63], a[236:239], v[92:95], v[60:63]
    s_waitcnt lgkmcnt(0)
    v_mfma_f32_16x16x32_bf16 v[0:3], a[48:51], v[64:67], v[0:3]
    ds_read_b64_tr_b16 v[80:81], v105 offset:16384
    v_mfma_f32_16x16x32_bf16 v[0:3], a[52:55], v[68:71], v[0:3]
    ds_read_b64_tr_b16 v[82:83], v105 offset:18432
    v_mfma_f32_16x16x32_bf16 v[0:3], a[56:59], v[72:75], v[0:3]
    ds_read_b64_tr_b16 v[84:85], v105 offset:20480
    v_mfma_f32_16x16x32_bf16 v[0:3], a[60:63], v[76:79], v[0:3]
    v_mfma_f32_16x16x32_bf16 v[4:7], a[112:115], v[64:67], v[4:7]
    ds_read_b64_tr_b16 v[86:87], v105 offset:22528
    v_mfma_f32_16x16x32_bf16 v[4:7], a[116:119], v[68:71], v[4:7]
    ds_read_b64_tr_b16 v[88:89], v105 offset:24576
    v_mfma_f32_16x16x32_bf16 v[4:7], a[120:123], v[72:75], v[4:7]
    ds_read_b64_tr_b16 v[90:91], v105 offset:26624
    v_mfma_f32_16x16x32_bf16 v[4:7], a[124:127], v[76:79], v[4:7]
    v_mfma_f32_16x16x32_bf16 v[16:19], a[176:179], v[64:67], v[16:19]
    ds_read_b64_tr_b16 v[92:93], v105 offset:28672
    v_mfma_f32_16x16x32_bf16 v[16:19], a[180:183], v[68:71], v[16:19]
    ds_read_b64_tr_b16 v[94:95], v105 offset:30720
    v_mfma_f32_16x16x32_bf16 v[16:19], a[184:187], v[72:75], v[16:19]
    v_add_u32 v104, s32, v104
    v_mfma_f32_16x16x32_bf16 v[16:19], a[188:191], v[76:79], v[16:19]
    v_mfma_f32_16x16x32_bf16 v[20:23], a[240:243], v[64:67], v[20:23]
    v_cvt_pk_bf16_f32 v96, v0, v1
    v_cvt_pk_bf16_f32 v97, v2, v3
    v_mfma_f32_16x16x32_bf16 v[20:23], a[244:247], v[68:71], v[20:23]
    v_cvt_pk_bf16_f32 v98, v4, v5
    v_cvt_pk_bf16_f32 v99, v6, v7
    v_mfma_f32_16x16x32_bf16 v[20:23], a[248:251], v[72:75], v[20:23]
    buffer_store_dwordx4 v[96:99], v110, s[28:31], s40 offen sc1
    v_mfma_f32_16x16x32_bf16 v[20:23], a[252:255], v[76:79], v[20:23]
    s_waitcnt lgkmcnt(0)
    v_mfma_f32_16x16x32_bf16 v[8:11], a[48:51], v[80:83], v[8:11]
    ds_read_b64_tr_b16 v[64:65], v106 offset:16384
    v_mfma_f32_16x16x32_bf16 v[8:11], a[52:55], v[84:87], v[8:11]
    ds_read_b64_tr_b16 v[66:67], v106 offset:18432
    v_mfma_f32_16x16x32_bf16 v[8:11], a[56:59], v[88:91], v[8:11]
    ds_read_b64_tr_b16 v[68:69], v106 offset:20480
    v_mfma_f32_16x16x32_bf16 v[8:11], a[60:63], v[92:95], v[8:11]
    v_mfma_f32_16x16x32_bf16 v[12:15], a[112:115], v[80:83], v[12:15]
    ds_read_b64_tr_b16 v[70:71], v106 offset:22528
    v_mfma_f32_16x16x32_bf16 v[12:15], a[116:119], v[84:87], v[12:15]
    ds_read_b64_tr_b16 v[72:73], v106 offset:24576
    v_mfma_f32_16x16x32_bf16 v[12:15], a[120:123], v[88:91], v[12:15]
    ds_read_b64_tr_b16 v[74:75], v106 offset:26624
    v_mfma_f32_16x16x32_bf16 v[12:15], a[124:127], v[92:95], v[12:15]
    v_mfma_f32_16x16x32_bf16 v[24:27], a[176:179], v[80:83], v[24:27]
    ds_read_b64_tr_b16 v[76:77], v106 offset:28672
    v_mfma_f32_16x16x32_bf16 v[24:27], a[180:183], v[84:87], v[24:27]
    ds_read_b64_tr_b16 v[78:79], v106 offset:30720
    v_mfma_f32_16x16x32_bf16 v[24:27], a[184:187], v[88:91], v[24:27]
    v_add_u32 v105, s32, v105
    v_mfma_f32_16x16x32_bf16 v[24:27], a[188:191], v[92:95], v[24:27]
    v_mfma_f32_16x16x32_bf16 v[28:31], a[240:243], v[80:83], v[28:31]
    v_cvt_pk_bf16_f32 v100, v8, v9
    v_cvt_pk_bf16_f32 v101, v10, v11
    v_mfma_f32_16x16x32_bf16 v[28:31], a[244:247], v[84:87], v[28:31]
    v_cvt_pk_bf16_f32 v102, v12, v13
    v_cvt_pk_bf16_f32 v103, v14, v15
    v_mfma_f32_16x16x32_bf16 v[28:31], a[248:251], v[88:91], v[28:31]
    buffer_store_dwordx4 v[100:103], v111, s[28:31], s40 offen sc1
    v_mfma_f32_16x16x32_bf16 v[28:31], a[252:255], v[92:95], v[28:31]
    s_waitcnt lgkmcnt(0)
    v_cvt_pk_bf16_f32 v96, v16, v17
    v_cvt_pk_bf16_f32 v97, v18, v19
    v_mfma_f32_16x16x32_bf16 v[32:35], a[48:51], v[64:67], v[32:35]
    ds_read_b64_tr_b16 v[80:81], v107 offset:16384
    v_cvt_pk_bf16_f32 v98, v20, v21
    v_mfma_f32_16x16x32_bf16 v[32:35], a[52:55], v[68:71], v[32:35]
    ds_read_b64_tr_b16 v[82:83], v107 offset:18432
    v_cvt_pk_bf16_f32 v99, v22, v23
    v_mfma_f32_16x16x32_bf16 v[32:35], a[56:59], v[72:75], v[32:35]
    ds_read_b64_tr_b16 v[84:85], v107 offset:20480
    v_mfma_f32_16x16x32_bf16 v[32:35], a[60:63], v[76:79], v[32:35]
    buffer_store_dwordx4 v[96:99], v110, s[28:31], s41 offen sc1
    v_mfma_f32_16x16x32_bf16 v[36:39], a[112:115], v[64:67], v[36:39]
    ds_read_b64_tr_b16 v[86:87], v107 offset:22528
    v_cvt_pk_bf16_f32 v100, v24, v25
    v_mfma_f32_16x16x32_bf16 v[36:39], a[116:119], v[68:71], v[36:39]
    ds_read_b64_tr_b16 v[88:89], v107 offset:24576
    v_cvt_pk_bf16_f32 v101, v26, v27
    v_mfma_f32_16x16x32_bf16 v[36:39], a[120:123], v[72:75], v[36:39]
    ds_read_b64_tr_b16 v[90:91], v107 offset:26624
    v_cvt_pk_bf16_f32 v102, v28, v29
    v_mfma_f32_16x16x32_bf16 v[36:39], a[124:127], v[76:79], v[36:39]
    v_cvt_pk_bf16_f32 v103, v30, v31
    v_mfma_f32_16x16x32_bf16 v[48:51], a[176:179], v[64:67], v[48:51]
    ds_read_b64_tr_b16 v[92:93], v107 offset:28672
    v_mfma_f32_16x16x32_bf16 v[48:51], a[180:183], v[68:71], v[48:51]
    ds_read_b64_tr_b16 v[94:95], v107 offset:30720
    v_mfma_f32_16x16x32_bf16 v[48:51], a[184:187], v[72:75], v[48:51]
    v_add_u32 v106, s32, v106
    v_mfma_f32_16x16x32_bf16 v[48:51], a[188:191], v[76:79], v[48:51]
    buffer_store_dwordx4 v[100:103], v111, s[28:31], s41 offen sc1
    v_mfma_f32_16x16x32_bf16 v[52:55], a[240:243], v[64:67], v[52:55]
    v_mfma_f32_16x16x32_bf16 v[52:55], a[244:247], v[68:71], v[52:55]
    v_mfma_f32_16x16x32_bf16 v[52:55], a[248:251], v[72:75], v[52:55]
    v_mfma_f32_16x16x32_bf16 v[52:55], a[252:255], v[76:79], v[52:55]
    s_waitcnt lgkmcnt(0)
    v_mfma_f32_16x16x32_bf16 v[40:43], a[48:51], v[80:83], v[40:43]
    ds_read_b64_tr_b16 v[64:65], v104 offset:0
    s_cmp_lt_u32 s33, s34
    v_mfma_f32_16x16x32_bf16 v[40:43], a[52:55], v[84:87], v[40:43]
    ds_read_b64_tr_b16 v[66:67], v104 offset:2048
    v_mfma_f32_16x16x32_bf16 v[40:43], a[56:59], v[88:91], v[40:43]
    ds_read_b64_tr_b16 v[68:69], v104 offset:4096
    v_mfma_f32_16x16x32_bf16 v[40:43], a[60:63], v[92:95], v[40:43]
    v_mfma_f32_16x16x32_bf16 v[44:47], a[112:115], v[80:83], v[44:47]
    ds_read_b64_tr_b16 v[70:71], v104 offset:6144
    v_mfma_f32_16x16x32_bf16 v[44:47], a[116:119], v[84:87], v[44:47]
    ds_read_b64_tr_b16 v[72:73], v104 offset:8192
    v_mfma_f32_16x16x32_bf16 v[44:47], a[120:123], v[88:91], v[44:47]
    ds_read_b64_tr_b16 v[74:75], v104 offset:10240
    v_mfma_f32_16x16x32_bf16 v[44:47], a[124:127], v[92:95], v[44:47]
    v_mfma_f32_16x16x32_bf16 v[56:59], a[176:179], v[80:83], v[56:59]
    ds_read_b64_tr_b16 v[76:77], v104 offset:12288
    v_mfma_f32_16x16x32_bf16 v[56:59], a[180:183], v[84:87], v[56:59]
    ds_read_b64_tr_b16 v[78:79], v104 offset:14336
    v_mfma_f32_16x16x32_bf16 v[56:59], a[184:187], v[88:91], v[56:59]
    v_add_u32 v107, s32, v107
    v_mfma_f32_16x16x32_bf16 v[56:59], a[188:191], v[92:95], v[56:59]
    v_mfma_f32_16x16x32_bf16 v[60:63], a[240:243], v[80:83], v[60:63]
    v_mfma_f32_16x16x32_bf16 v[60:63], a[244:247], v[84:87], v[60:63]
    v_mfma_f32_16x16x32_bf16 v[60:63], a[248:251], v[88:91], v[60:63]
    v_mfma_f32_16x16x32_bf16 v[60:63], a[252:255], v[92:95], v[60:63]
    s_waitcnt lgkmcnt(0)
    s_cbranch_scc1 K1_N
    s_branch K1_FIN
K1_VS0:
    s_mov_b32 s26, 0
    s_cmp_lg_u32 s55, s34
    s_cbranch_scc1 K1_YS0
    s_mov_b64 s[20:21], s[10:11]
    s_mov_b32 s22, 0x400000
    buffer_load_dword v136, v139, s[20:23], 0 offen
K1_YS0:
    s_cmp_lg_u32 s34, 10
    s_cbranch_scc1 K1_RS0
    s_cmp_lg_u32 s55, 10
    s_cbranch_scc1 K1_XS0
    s_mov_b64 s[24:25], s[10:11]
    s_mov_b32 s26, 0x400000
    v_mov_b32 v108, v126
    v_xor_b32 v109, 128, v126
    s_mov_b32 s35, s56
    s_mov_b32 s36, 64512
    s_mov_b32 s37, 4294902784
    s_mov_b32 s47, 4294806528
    s_branch K1_RS0
K1_XS0:
    s_mov_b64 s[24:25], s[4:5]
    s_mov_b32 s26, 0x200000
    v_mov_b32 v108, v112
    v_mov_b32 v109, v113
    s_sub_u32 s35, s55, 11
    s_min_u32 s35, s35, 2
    s_lshl_b32 s35, s35, 7
    s_add_u32 s35, s35, s57
    s_mov_b32 s36, 7168
    s_mov_b32 s37, s59
    s_mov_b32 s47, s58
    s_branch K1_RS0
K1_VS1:
    s_mov_b32 s26, 0
    s_cmp_lg_u32 s55, s34
    s_cbranch_scc1 K1_YS1
    s_mov_b64 s[20:21], s[10:11]
    s_mov_b32 s22, 0x400000
    buffer_load_dword v136, v139, s[20:23], 0 offen
K1_YS1:
    s_cmp_lg_u32 s34, 10
    s_cbranch_scc1 K1_RS1
    s_cmp_lg_u32 s55, 10
    s_cbranch_scc1 K1_XS1
    s_mov_b64 s[24:25], s[10:11]
    s_mov_b32 s26, 0x400000
    v_mov_b32 v108, v126
    v_xor_b32 v109, 128, v126
    s_mov_b32 s35, s56
    s_mov_b32 s36, 64512
    s_mov_b32 s37, 4294902784
    s_mov_b32 s47, 4294806528
    s_branch K1_RS1
K1_XS1:
    s_mov_b64 s[24:25], s[4:5]
    s_mov_b32 s26, 0x200000
    v_mov_b32 v108, v112
    v_mov_b32 v109, v113
    s_sub_u32 s35, s55, 11
    s_min_u32 s35, s35, 2
    s_lshl_b32 s35, s35, 7
    s_add_u32 s35, s35, s57
    s_mov_b32 s36, 7168
    s_mov_b32 s37, s59
    s_mov_b32 s47, s58
    s_branch K1_RS1
K1_VN0:
    s_mov_b32 s26, 0
    s_cmp_lg_u32 s55, s34
    s_cbranch_scc1 K1_YN0
    s_mov_b64 s[20:21], s[10:11]
    s_mov_b32 s22, 0x400000
    buffer_load_dword v136, v139, s[20:23], 0 offen
K1_YN0:
    s_cmp_lg_u32 s34, 10
    s_cbranch_scc1 K1_RN0
    s_cmp_lg_u32 s55, 10
    s_cbranch_scc1 K1_XN0
    s_mov_b64 s[24:25], s[10:11]
    s_mov_b32 s26, 0x400000
    v_mov_b32 v108, v126
    v_xor_b32 v109, 128, v126
    s_mov_b32 s35, s56
    s_mov_b32 s36, 64512
    s_mov_b32 s37, 4294902784
    s_mov_b32 s47, 4294806528
    s_branch K1_RN0
K1_XN0:
    s_mov_b64 s[24:25], s[4:5]
    s_mov_b32 s26, 0x200000
    v_mov_b32 v108, v112
    v_mov_b32 v109, v113
    s_sub_u32 s35, s55, 11
    s_min_u32 s35, s35, 2
    s_lshl_b32 s35, s35, 7
    s_add_u32 s35, s35, s57
    s_mov_b32 s36, 7168
    s_mov_b32 s37, s59
    s_mov_b32 s47, s58
    s_branch K1_RN0
K1_VN1:
    s_mov_b32 s26, 0
    s_cmp_lg_u32 s55, s34
    s_cbranch_scc1 K1_YN1
    s_mov_b64 s[20:21], s[10:11]
    s_mov_b32 s22, 0x400000
    buffer_load_dword v136, v139, s[20:23], 0 offen
K1_YN1:
    s_cmp_lg_u32 s34, 10
    s_cbranch_scc1 K1_RN1
    s_cmp_lg_u32 s55, 10
    s_cbranch_scc1 K1_XN1
    s_mov_b64 s[24:25], s[10:11]
    s_mov_b32 s26, 0x400000
    v_mov_b32 v108, v126
    v_xor_b32 v109, 128, v126
    s_mov_b32 s35, s56
    s_mov_b32 s36, 64512
    s_mov_b32 s37, 4294902784
    s_mov_b32 s47, 4294806528
    s_branch K1_RN1
K1_XN1:
    s_mov_b64 s[24:25], s[4:5]
    s_mov_b32 s26, 0x200000
    v_mov_b32 v108, v112
    v_mov_b32 v109, v113
    s_sub_u32 s35, s55, 11
    s_min_u32 s35, s35, 2
    s_lshl_b32 s35, s35, 7
    s_add_u32 s35, s35, s57
    s_mov_b32 s36, 7168
    s_mov_b32 s37, s59
    s_mov_b32 s47, s58
    s_branch K1_RN1
CODE1:
KB_FB:
    s_waitcnt vmcnt(0)
    s_mov_b32 s37, 0
    s_add_u32 s38, s34, s43
    s_mov_b32 s39, 0
    v_mov_b32 v250, 0xff800000
    v_mov_b32 v251, 0xff800000
    v_mov_b32 v192, 0
    v_mov_b32 v193, 0
    v_mov_b32 v194, 0
    v_mov_b32 v195, 0
    v_mov_b32 v196, 0
    v_mov_b32 v197, 0
    v_mov_b32 v198, 0
    v_mov_b32 v199, 0
    v_mov_b32 v0, 0
    v_mov_b32 v1, 0
    v_mov_b32 v2, 0
    v_mov_b32 v3, 0
    v_mov_b32 v4, 0
    v_mov_b32 v5, 0
    v_mov_b32 v6, 0
    v_mov_b32 v7, 0
    v_mov_b32 v8, 0
    v_mov_b32 v9, 0
    v_mov_b32 v10, 0
    v_mov_b32 v11, 0
    v_mov_b32 v12, 0
    v_mov_b32 v13, 0
    v_mov_b32 v14, 0
    v_mov_b32 v15, 0
    v_mov_b32 v16, 0
    v_mov_b32 v17, 0
    v_mov_b32 v18, 0
    v_mov_b32 v19, 0
    v_mov_b32 v20, 0
    v_mov_b32 v21, 0
    v_mov_b32 v22, 0
    v_mov_b32 v23, 0
    v_mov_b32 v24, 0
    v_mov_b32 v25, 0
    v_mov_b32 v26, 0
    v_mov_b32 v27, 0
    v_mov_b32 v28, 0
    v_mov_b32 v29, 0
    v_mov_b32 v30, 0
    v_mov_b32 v31, 0
    v_mov_b32 v32, 0
    v_mov_b32 v33, 0
    v_mov_b32 v34, 0
    v_mov_b32 v35, 0
    v_mov_b32 v36, 0
    v_mov_b32 v37, 0
    v_mov_b32 v38, 0
    v_mov_b32 v39, 0
    v_mov_b32 v40, 0
    v_mov_b32 v41, 0
    v_mov_b32 v42, 0
    v_mov_b32 v43, 0
    v_mov_b32 v44, 0
    v_mov_b32 v45, 0
    v_mov_b32 v46, 0
    v_mov_b32 v47, 0
    v_mov_b32 v48, 0
    v_mov_b32 v49, 0
    v_mov_b32 v50, 0
    v_mov_b32 v51, 0
    v_mov_b32 v52, 0
    v_mov_b32 v53, 0
    v_mov_b32 v54, 0
    v_mov_b32 v55, 0
    v_mov_b32 v56, 0
    v_mov_b32 v57, 0
    v_mov_b32 v58, 0
    v_mov_b32 v59, 0
    v_mov_b32 v60, 0
    v_mov_b32 v61, 0
    v_mov_b32 v62, 0
    v_mov_b32 v63, 0
KB_FB_A:
    buffer_load_dwordx4 a[64:67], v232, s[64:67], s39 offen offset:0 sc1
    buffer_load_dwordx4 a[68:71], v232, s[64:67], s39 offen offset:1024 sc1
    buffer_load_dwordx4 a[72:75], v232, s[64:67], s39 offen offset:2048 sc1
    buffer_load_dwordx4 a[76:79], v232, s[64:67], s39 offen offset:3072 sc1
    s_add_u32 s39, s39, 4096
    buffer_load_dwordx4 a[80:83], v232, s[64:67], s39 offen offset:0 sc1
    buffer_load_dwordx4 a[84:87], v232, s[64:67], s39 offen offset:1024 sc1
    buffer_load_dwordx4 a[88:91], v232, s[64:67], s39 offen offset:2048 sc1
    buffer_load_dwordx4 a[92:95], v232, s[64:67], s39 offen offset:3072 sc1
    s_add_u32 s39, s39, 4096
    buffer_load_dwordx4 a[96:99], v232, s[64:67], s39 offen offset:0 sc1
    buffer_load_dwordx4 a[100:103], v232, s[64:67], s39 offen offset:1024 sc1
    buffer_load_dwordx4 a[104:107], v232, s[64:67], s39 offen offset:2048 sc1
    buffer_load_dwordx4 a[108:111], v232, s[64:67], s39 offen offset:3072 sc1
    s_add_u32 s39, s39, 4096
    buffer_load_dwordx4 a[112:115], v232, s[64:67], s39 offen offset:0 sc1
    buffer_load_dwordx4 a[116:119], v232, s[64:67], s39 offen offset:1024 sc1
    buffer_load_dwordx4 a[120:123], v232, s[64:67], s39 offen offset:2048 sc1
    buffer_load_dwordx4 a[124:127], v232, s[64:67], s39 offen offset:3072 sc1
    s_add_u32 s39, s39, 4096
    s_add_u32 s31, s37, 0
    s_cmp_lt_u32 s31, s34
    s_cselect_b32 s30, 0, 0xff800000
    s_cmp_eq_u32 s31, s34
    s_cselect_b64 vcc, -1, 0
    v_mov_b32 v187, s30
    v_cndmask_b32 v184, v187, v188, vcc
    v_cndmask_b32 v185, v187, v189, vcc
    v_cndmask_b32 v186, v187, v190, vcc
    v_cndmask_b32 v187, v187, v191, vcc
    s_add_u32 s31, s37, 1
    s_cmp_lt_u32 s31, s34
    s_cselect_b32 s30, 0, 0xff800000
    s_cmp_eq_u32 s31, s34
    s_cselect_b64 vcc, -1, 0
    v_mov_b32 v223, s30
    v_cndmask_b32 v220, v223, v188, vcc
    v_cndmask_b32 v221, v223, v189, vcc
    v_cndmask_b32 v222, v223, v190, vcc
    v_cndmask_b32 v223, v223, v191, vcc
    s_add_u32 s31, s37, 0
    s_cmp_lt_u32 s31, s38
    s_cselect_b32 s30, 0, 0xff800000
    s_cmp_eq_u32 s31, s38
    s_cselect_b64 vcc, -1, 0
    v_mov_b32 v179, s30
    v_cndmask_b32 v176, v179, v188, vcc
    v_cndmask_b32 v177, v179, v189, vcc
    v_cndmask_b32 v178, v179, v190, vcc
    v_cndmask_b32 v179, v179, v191, vcc
    s_add_u32 s31, s37, 1
    s_cmp_lt_u32 s31, s38
    s_cselect_b32 s30, 0, 0xff800000
    s_cmp_eq_u32 s31, s38
    s_cselect_b64 vcc, -1, 0
    v_mov_b32 v183, s30
    v_cndmask_b32 v180, v183, v188, vcc
    v_cndmask_b32 v181, v183, v189, vcc
    v_cndmask_b32 v182, v183, v190, vcc
    v_cndmask_b32 v183, v183, v191, vcc
    s_nop 0
    s_waitcnt vmcnt(0)
    v_mfma_f32_16x16x32_bf16 v[128:131], a[64:67], a[0:3], v[184:187]
    v_mfma_f32_16x16x32_bf16 v[128:131], a[68:71], a[4:7], v[128:131]
    v_mfma_f32_16x16x32_bf16 v[128:131], a[72:75], a[8:11], v[128:131]
    v_mfma_f32_16x16x32_bf16 v[128:131], a[76:79], a[12:15], v[128:131]
    v_mfma_f32_16x16x32_bf16 v[132:135], a[80:83], a[0:3], v[220:223]
    v_mfma_f32_16x16x32_bf16 v[132:135], a[84:87], a[4:7], v[132:135]
    v_mfma_f32_16x16x32_bf16 v[132:135], a[88:91], a[8:11], v[132:135]
    v_mfma_f32_16x16x32_bf16 v[132:135], a[92:95], a[12:15], v[132:135]
    v_mfma_f32_16x16x32_bf16 v[136:139], a[64:67], a[16:19], v[176:179]
    v_mfma_f32_16x16x32_bf16 v[136:139], a[68:71], a[20:23], v[136:139]
    v_mfma_f32_16x16x32_bf16 v[136:139], a[72:75], a[24:27], v[136:139]
    v_mfma_f32_16x16x32_bf16 v[136:139], a[76:79], a[28:31], v[136:139]
    v_mfma_f32_16x16x32_bf16 v[140:143], a[80:83], a[16:19], v[180:183]
    v_mfma_f32_16x16x32_bf16 v[140:143], a[84:87], a[20:23], v[140:143]
    v_mfma_f32_16x16x32_bf16 v[140:143], a[88:91], a[24:27], v[140:143]
    v_mfma_f32_16x16x32_bf16 v[140:143], a[92:95], a[28:31], v[140:143]
    s_nop 7
    v_max3_f32 v238, v128, v129, v250
    v_max3_f32 v238, v130, v131, v238
    v_max3_f32 v238, v132, v133, v238
    v_max3_f32 v238, v134, v135, v238
    v_mov_b32 v239, v238
    s_nop 1
    v_permlane16_swap_b32 v238, v239
    v_max_f32 v238, v238, v239
    v_mov_b32 v239, v238
    s_nop 1
    v_permlane32_swap_b32 v238, v239
    v_max_f32 v238, v238, v239
    v_sub_f32 v240, v250, v238
    v_exp_f32 v240, v240
    v_mov_b32 v250, v238
    v_sub_f32 v128, v128, v238
    v_sub_f32 v129, v129, v238
    v_sub_f32 v130, v130, v238
    v_sub_f32 v131, v131, v238
    v_sub_f32 v132, v132, v238
    v_sub_f32 v133, v133, v238
    v_sub_f32 v134, v134, v238
    v_sub_f32 v135, v135, v238
    v_exp_f32 v128, v128
    v_exp_f32 v129, v129
    v_exp_f32 v130, v130
    v_exp_f32 v131, v131
    v_exp_f32 v132, v132
    v_exp_f32 v133, v133
    v_exp_f32 v134, v134
    v_exp_f32 v135, v135
    v_mul_f32 v192, v192, v240
    v_mul_f32 v193, v193, v240
    v_mul_f32 v194, v194, v240
    v_mul_f32 v195, v195, v240
    v_mul_f32 v0, v0, v240
    v_mul_f32 v1, v1, v240
    v_mul_f32 v2, v2, v240
    v_mul_f32 v3, v3, v240
    v_mul_f32 v4, v4, v240
    v_mul_f32 v5, v5, v240
    v_mul_f32 v6, v6, v240
    v_mul_f32 v7, v7, v240
    v_mul_f32 v8, v8, v240
    v_mul_f32 v9, v9, v240
    v_mul_f32 v10, v10, v240
    v_mul_f32 v11, v11, v240
    v_mul_f32 v12, v12, v240
    v_mul_f32 v13, v13, v240
    v_mul_f32 v14, v14, v240
    v_mul_f32 v15, v15, v240
    v_mul_f32 v16, v16, v240
    v_mul_f32 v17, v17, v240
    v_mul_f32 v18, v18, v240
    v_mul_f32 v19, v19, v240
    v_mul_f32 v20, v20, v240
    v_mul_f32 v21, v21, v240
    v_mul_f32 v22, v22, v240
    v_mul_f32 v23, v23, v240
    v_mul_f32 v24, v24, v240
    v_mul_f32 v25, v25, v240
    v_mul_f32 v26, v26, v240
    v_mul_f32 v27, v27, v240
    v_mul_f32 v28, v28, v240
    v_mul_f32 v29, v29, v240
    v_mul_f32 v30, v30, v240
    v_mul_f32 v31, v31, v240
    v_cvt_pk_bf16_f32 v160, v128, v129
    v_cvt_pk_bf16_f32 v161, v130, v131
    v_cvt_pk_bf16_f32 v162, v132, v133
    v_cvt_pk_bf16_f32 v163, v134, v135
    v_max3_f32 v238, v136, v137, v251
    v_max3_f32 v238, v138, v139, v238
    v_max3_f32 v238, v140, v141, v238
    v_max3_f32 v238, v142, v143, v238
    v_mov_b32 v239, v238
    s_nop 1
    v_permlane16_swap_b32 v238, v239
    v_max_f32 v238, v238, v239
    v_mov_b32 v239, v238
    s_nop 1
    v_permlane32_swap_b32 v238, v239
    v_max_f32 v238, v238, v239
    v_sub_f32 v240, v251, v238
    v_exp_f32 v240, v240
    v_mov_b32 v251, v238
    v_sub_f32 v136, v136, v238
    v_sub_f32 v137, v137, v238
    v_sub_f32 v138, v138, v238
    v_sub_f32 v139, v139, v238
    v_sub_f32 v140, v140, v238
    v_sub_f32 v141, v141, v238
    v_sub_f32 v142, v142, v238
    v_sub_f32 v143, v143, v238
    v_exp_f32 v136, v136
    v_exp_f32 v137, v137
    v_exp_f32 v138, v138
    v_exp_f32 v139, v139
    v_exp_f32 v140, v140
    v_exp_f32 v141, v141
    v_exp_f32 v142, v142
    v_exp_f32 v143, v143
    v_mul_f32 v196, v196, v240
    v_mul_f32 v197, v197, v240
    v_mul_f32 v198, v198, v240
    v_mul_f32 v199, v199, v240
    v_mul_f32 v32, v32, v240
    v_mul_f32 v33, v33, v240
    v_mul_f32 v34, v34, v240
    v_mul_f32 v35, v35, v240
    v_mul_f32 v36, v36, v240
    v_mul_f32 v37, v37, v240
    v_mul_f32 v38, v38, v240
    v_mul_f32 v39, v39, v240
    v_mul_f32 v40, v40, v240
    v_mul_f32 v41, v41, v240
    v_mul_f32 v42, v42, v240
    v_mul_f32 v43, v43, v240
    v_mul_f32 v44, v44, v240
    v_mul_f32 v45, v45, v240
    v_mul_f32 v46, v46, v240
    v_mul_f32 v47, v47, v240
    v_mul_f32 v48, v48, v240
    v_mul_f32 v49, v49, v240
    v_mul_f32 v50, v50, v240
    v_mul_f32 v51, v51, v240
    v_mul_f32 v52, v52, v240
    v_mul_f32 v53, v53, v240
    v_mul_f32 v54, v54, v240
    v_mul_f32 v55, v55, v240
    v_mul_f32 v56, v56, v240
    v_mul_f32 v57, v57, v240
    v_mul_f32 v58, v58, v240
    v_mul_f32 v59, v59, v240
    v_mul_f32 v60, v60, v240
    v_mul_f32 v61, v61, v240
    v_mul_f32 v62, v62, v240
    v_mul_f32 v63, v63, v240
    v_cvt_pk_bf16_f32 v164, v136, v137
    v_cvt_pk_bf16_f32 v165, v138, v139
    v_cvt_pk_bf16_f32 v166, v140, v141
    v_cvt_pk_bf16_f32 v167, v142, v143
    s_nop 1
    v_mfma_f32_16x16x32_bf16 v[0:3], a[96:99], v[160:163], v[0:3]
    v_mfma_f32_16x16x32_bf16 v[32:35], a[96:99], v[164:167], v[32:35]
    v_mfma_f32_16x16x32_bf16 v[4:7], a[100:103], v[160:163], v[4:7]
    v_mfma_f32_16x16x32_bf16 v[36:39], a[100:103], v[164:167], v[36:39]
    v_mfma_f32_16x16x32_bf16 v[8:11], a[104:107], v[160:163], v[8:11]
    v_mfma_f32_16x16x32_bf16 v[40:43], a[104:107], v[164:167], v[40:43]
    v_mfma_f32_16x16x32_bf16 v[12:15], a[108:111], v[160:163], v[12:15]
    v_mfma_f32_16x16x32_bf16 v[44:47], a[108:111], v[164:167], v[44:47]
    v_mfma_f32_16x16x32_bf16 v[16:19], a[112:115], v[160:163], v[16:19]
    v_mfma_f32_16x16x32_bf16 v[48:51], a[112:115], v[164:167], v[48:51]
    v_mfma_f32_16x16x32_bf16 v[20:23], a[116:119], v[160:163], v[20:23]
    v_mfma_f32_16x16x32_bf16 v[52:55], a[116:119], v[164:167], v[52:55]
    v_mfma_f32_16x16x32_bf16 v[24:27], a[120:123], v[160:163], v[24:27]
    v_mfma_f32_16x16x32_bf16 v[56:59], a[120:123], v[164:167], v[56:59]
    v_mfma_f32_16x16x32_bf16 v[28:31], a[124:127], v[160:163], v[28:31]
    v_mfma_f32_16x16x32_bf16 v[60:63], a[124:127], v[164:167], v[60:63]
    v_mfma_f32_16x16x32_bf16 v[192:195], v[208:211], v[160:163], v[192:195]
    v_mfma_f32_16x16x32_bf16 v[196:199], v[208:211], v[164:167], v[196:199]
    s_add_u32 s37, s37, 2
    s_cmp_le_u32 s37, s38
    s_nop 7
    s_cbranch_scc1 KB_FB_A
    s_mov_b32 s37, 0
    s_add_u32 s38, s35, s43
    s_mov_b32 s39, 0
    v_mov_b32 v250, 0xff800000
    v_mov_b32 v251, 0xff800000
    v_mov_b32 v200, 0
    v_mov_b32 v201, 0
    v_mov_b32 v202, 0
    v_mov_b32 v203, 0
    v_mov_b32 v204, 0
    v_mov_b32 v205, 0
    v_mov_b32 v206, 0
    v_mov_b32 v207, 0
    v_mov_b32 v64, 0
    v_mov_b32 v65, 0
    v_mov_b32 v66, 0
    v_mov_b32 v67, 0
    v_mov_b32 v68, 0
    v_mov_b32 v69, 0
    v_mov_b32 v70, 0
    v_mov_b32 v71, 0
    v_mov_b32 v72, 0
    v_mov_b32 v73, 0
    v_mov_b32 v74, 0
    v_mov_b32 v75, 0
    v_mov_b32 v76, 0
    v_mov_b32 v77, 0
    v_mov_b32 v78, 0
    v_mov_b32 v79, 0
    v_mov_b32 v80, 0
    v_mov_b32 v81, 0
    v_mov_b32 v82, 0
    v_mov_b32 v83, 0
    v_mov_b32 v84, 0
    v_mov_b32 v85, 0
    v_mov_b32 v86, 0
    v_mov_b32 v87, 0
    v_mov_b32 v88, 0
    v_mov_b32 v89, 0
    v_mov_b32 v90, 0
    v_mov_b32 v91, 0
    v_mov_b32 v92, 0
    v_mov_b32 v93, 0
    v_mov_b32 v94, 0
    v_mov_b32 v95, 0
    v_mov_b32 v96, 0
    v_mov_b32 v97, 0
    v_mov_b32 v98, 0
    v_mov_b32 v99, 0
    v_mov_b32 v100, 0
    v_mov_b32 v101, 0
    v_mov_b32 v102, 0
    v_mov_b32 v103, 0
    v_mov_b32 v104, 0
    v_mov_b32 v105, 0
    v_mov_b32 v106, 0
    v_mov_b32 v107, 0
    v_mov_b32 v108, 0
    v_mov_b32 v109, 0
    v_mov_b32 v110, 0
    v_mov_b32 v111, 0
    v_mov_b32 v112, 0
    v_mov_b32 v113, 0
    v_mov_b32 v114, 0
    v_mov_b32 v115, 0
    v_mov_b32 v116, 0
    v_mov_b32 v117, 0
    v_mov_b32 v118, 0
    v_mov_b32 v119, 0
    v_mov_b32 v120, 0
    v_mov_b32 v121, 0
    v_mov_b32 v122, 0
    v_mov_b32 v123, 0
    v_mov_b32 v124, 0
    v_mov_b32 v125, 0
    v_mov_b32 v126, 0
    v_mov_b32 v127, 0
KB_FB_B:
    buffer_load_dwordx4 a[64:67], v232, s[64:67], s39 offen offset:0 sc1
    buffer_load_dwordx4 a[68:71], v232, s[64:67], s39 offen offset:1024 sc1
    buffer_load_dwordx4 a[72:75], v232, s[64:67], s39 offen offset:2048 sc1
    buffer_load_dwordx4 a[76:79], v232, s[64:67], s39 offen offset:3072 sc1
    s_add_u32 s39, s39, 4096
    buffer_load_dwordx4 a[80:83], v232, s[64:67], s39 offen offset:0 sc1
    buffer_load_dwordx4 a[84:87], v232, s[64:67], s39 offen offset:1024 sc1
    buffer_load_dwordx4 a[88:91], v232, s[64:67], s39 offen offset:2048 sc1
    buffer_load_dwordx4 a[92:95], v232, s[64:67], s39 offen offset:3072 sc1
    s_add_u32 s39, s39, 4096
    buffer_load_dwordx4 a[96:99], v232, s[64:67], s39 offen offset:0 sc1
    buffer_load_dwordx4 a[100:103], v232, s[64:67], s39 offen offset:1024 sc1
    buffer_load_dwordx4 a[104:107], v232, s[64:67], s39 offen offset:2048 sc1
    buffer_load_dwordx4 a[108:111], v232, s[64:67], s39 offen offset:3072 sc1
    s_add_u32 s39, s39, 4096
    buffer_load_dwordx4 a[112:115], v232, s[64:67], s39 offen offset:0 sc1
    buffer_load_dwordx4 a[116:119], v232, s[64:67], s39 offen offset:1024 sc1
    buffer_load_dwordx4 a[120:123], v232, s[64:67], s39 offen offset:2048 sc1
    buffer_load_dwordx4 a[124:127], v232, s[64:67], s39 offen offset:3072 sc1
    s_add_u32 s39, s39, 4096
    s_add_u32 s31, s37, 0
    s_cmp_lt_u32 s31, s35
    s_cselect_b32 s30, 0, 0xff800000
    s_cmp_eq_u32 s31, s35
    s_cselect_b64 vcc, -1, 0
    v_mov_b32 v187, s30
    v_cndmask_b32 v184, v187, v188, vcc
    v_cndmask_b32 v185, v187, v189, vcc
    v_cndmask_b32 v186, v187, v190, vcc
    v_cndmask_b32 v187, v187, v191, vcc
    s_add_u32 s31, s37, 1
    s_cmp_lt_u32 s31, s35
    s_cselect_b32 s30, 0, 0xff800000
    s_cmp_eq_u32 s31, s35
    s_cselect_b64 vcc, -1, 0
    v_mov_b32 v223, s30
    v_cndmask_b32 v220, v223, v188, vcc
    v_cndmask_b32 v221, v223, v189, vcc
    v_cndmask_b32 v222, v223, v190, vcc
    v_cndmask_b32 v223, v223, v191, vcc
    s_add_u32 s31, s37, 0
    s_cmp_lt_u32 s31, s38
    s_cselect_b32 s30, 0, 0xff800000
    s_cmp_eq_u32 s31, s38
    s_cselect_b64 vcc, -1, 0
    v_mov_b32 v179, s30
    v_cndmask_b32 v176, v179, v188, vcc
    v_cndmask_b32 v177, v179, v189, vcc
    v_cndmask_b32 v178, v179, v190, vcc
    v_cndmask_b32 v179, v179, v191, vcc
    s_add_u32 s31, s37, 1
    s_cmp_lt_u32 s31, s38
    s_cselect_b32 s30, 0, 0xff800000
    s_cmp_eq_u32 s31, s38
    s_cselect_b64 vcc, -1, 0
    v_mov_b32 v183, s30
    v_cndmask_b32 v180, v183, v188, vcc
    v_cndmask_b32 v181, v183, v189, vcc
    v_cndmask_b32 v182, v183, v190, vcc
    v_cndmask_b32 v183, v183, v191, vcc
    s_nop 0
    s_waitcnt vmcnt(0)
    v_mfma_f32_16x16x32_bf16 v[128:131], a[64:67], a[32:35], v[184:187]
    v_mfma_f32_16x16x32_bf16 v[128:131], a[68:71], a[36:39], v[128:131]
    v_mfma_f32_16x16x32_bf16 v[128:131], a[72:75], a[40:43], v[128:131]
    v_mfma_f32_16x16x32_bf16 v[128:131], a[76:79], a[44:47], v[128:131]
    v_mfma_f32_16x16x32_bf16 v[132:135], a[80:83], a[32:35], v[220:223]
    v_mfma_f32_16x16x32_bf16 v[132:135], a[84:87], a[36:39], v[132:135]
    v_mfma_f32_16x16x32_bf16 v[132:135], a[88:91], a[40:43], v[132:135]
    v_mfma_f32_16x16x32_bf16 v[132:135], a[92:95], a[44:47], v[132:135]
    v_mfma_f32_16x16x32_bf16 v[136:139], a[64:67], a[48:51], v[176:179]
    v_mfma_f32_16x16x32_bf16 v[136:139], a[68:71], a[52:55], v[136:139]
    v_mfma_f32_16x16x32_bf16 v[136:139], a[72:75], a[56:59], v[136:139]
    v_mfma_f32_16x16x32_bf16 v[136:139], a[76:79], a[60:63], v[136:139]
    v_mfma_f32_16x16x32_bf16 v[140:143], a[80:83], a[48:51], v[180:183]
    v_mfma_f32_16x16x32_bf16 v[140:143], a[84:87], a[52:55], v[140:143]
    v_mfma_f32_16x16x32_bf16 v[140:143], a[88:91], a[56:59], v[140:143]
    v_mfma_f32_16x16x32_bf16 v[140:143], a[92:95], a[60:63], v[140:143]
    s_nop 7
    v_max3_f32 v238, v128, v129, v250
    v_max3_f32 v238, v130, v131, v238
    v_max3_f32 v238, v132, v133, v238
    v_max3_f32 v238, v134, v135, v238
    v_mov_b32 v239, v238
    s_nop 1
    v_permlane16_swap_b32 v238, v239
    v_max_f32 v238, v238, v239
    v_mov_b32 v239, v238
    s_nop 1
    v_permlane32_swap_b32 v238, v239
    v_max_f32 v238, v238, v239
    v_sub_f32 v240, v250, v238
    v_exp_f32 v240, v240
    v_mov_b32 v250, v238
    v_sub_f32 v128, v128, v238
    v_sub_f32 v129, v129, v238
    v_sub_f32 v130, v130, v238
    v_sub_f32 v131, v131, v238
    v_sub_f32 v132, v132, v238
    v_sub_f32 v133, v133, v238
    v_sub_f32 v134, v134, v238
    v_sub_f32 v135, v135, v238
    v_exp_f32 v128, v128
    v_exp_f32 v129, v129
    v_exp_f32 v130, v130
    v_exp_f32 v131, v131
    v_exp_f32 v132, v132
    v_exp_f32 v133, v133
    v_exp_f32 v134, v134
    v_exp_f32 v135, v135
    v_mul_f32 v200, v200, v240
    v_mul_f32 v201, v201, v240
    v_mul_f32 v202, v202, v240
    v_mul_f32 v203, v203, v240
    v_mul_f32 v64, v64, v240
    v_mul_f32 v65, v65, v240
    v_mul_f32 v66, v66, v240
    v_mul_f32 v67, v67, v240
    v_mul_f32 v68, v68, v240
    v_mul_f32 v69, v69, v240
    v_mul_f32 v70, v70, v240
    v_mul_f32 v71, v71, v240
    v_mul_f32 v72, v72, v240
    v_mul_f32 v73, v73, v240
    v_mul_f32 v74, v74, v240
    v_mul_f32 v75, v75, v240
    v_mul_f32 v76, v76, v240
    v_mul_f32 v77, v77, v240
    v_mul_f32 v78, v78, v240
    v_mul_f32 v79, v79, v240
    v_mul_f32 v80, v80, v240
    v_mul_f32 v81, v81, v240
    v_mul_f32 v82, v82, v240
    v_mul_f32 v83, v83, v240
    v_mul_f32 v84, v84, v240
    v_mul_f32 v85, v85, v240
    v_mul_f32 v86, v86, v240
    v_mul_f32 v87, v87, v240
    v_mul_f32 v88, v88, v240
    v_mul_f32 v89, v89, v240
    v_mul_f32 v90, v90, v240
    v_mul_f32 v91, v91, v240
    v_mul_f32 v92, v92, v240
    v_mul_f32 v93, v93, v240
    v_mul_f32 v94, v94, v240
    v_mul_f32 v95, v95, v240
    v_cvt_pk_bf16_f32 v160, v128, v129
    v_cvt_pk_bf16_f32 v161, v130, v131
    v_cvt_pk_bf16_f32 v162, v132, v133
    v_cvt_pk_bf16_f32 v163, v134, v135
    v_max3_f32 v238, v136, v137, v251
    v_max3_f32 v238, v138, v139, v238
    v_max3_f32 v238, v140, v141, v238
    v_max3_f32 v238, v142, v143, v238
    v_mov_b32 v239, v238
    s_nop 1
    v_permlane16_swap_b32 v238, v239
    v_max_f32 v238, v238, v239
    v_mov_b32 v239, v238
    s_nop 1
    v_permlane32_swap_b32 v238, v239
    v_max_f32 v238, v238, v239
    v_sub_f32 v240, v251, v238
    v_exp_f32 v240, v240
    v_mov_b32 v251, v238
    v_sub_f32 v136, v136, v238
    v_sub_f32 v137, v137, v238
    v_sub_f32 v138, v138, v238
    v_sub_f32 v139, v139, v238
    v_sub_f32 v140, v140, v238
    v_sub_f32 v141, v141, v238
    v_sub_f32 v142, v142, v238
    v_sub_f32 v143, v143, v238
    v_exp_f32 v136, v136
    v_exp_f32 v137, v137
    v_exp_f32 v138, v138
    v_exp_f32 v139, v139
    v_exp_f32 v140, v140
    v_exp_f32 v141, v141
    v_exp_f32 v142, v142
    v_exp_f32 v143, v143
    v_mul_f32 v204, v204, v240
    v_mul_f32 v205, v205, v240
    v_mul_f32 v206, v206, v240
    v_mul_f32 v207, v207, v240
    v_mul_f32 v96, v96, v240
    v_mul_f32 v97, v97, v240
    v_mul_f32 v98, v98, v240
    v_mul_f32 v99, v99, v240
    v_mul_f32 v100, v100, v240
    v_mul_f32 v101, v101, v240
    v_mul_f32 v102, v102, v240
    v_mul_f32 v103, v103, v240
    v_mul_f32 v104, v104, v240
    v_mul_f32 v105, v105, v240
    v_mul_f32 v106, v106, v240
    v_mul_f32 v107, v107, v240
    v_mul_f32 v108, v108, v240
    v_mul_f32 v109, v109, v240
    v_mul_f32 v110, v110, v240
    v_mul_f32 v111, v111, v240
    v_mul_f32 v112, v112, v240
    v_mul_f32 v113, v113, v240
    v_mul_f32 v114, v114, v240
    v_mul_f32 v115, v115, v240
    v_mul_f32 v116, v116, v240
    v_mul_f32 v117, v117, v240
    v_mul_f32 v118, v118, v240
    v_mul_f32 v119, v119, v240
    v_mul_f32 v120, v120, v240
    v_mul_f32 v121, v121, v240
    v_mul_f32 v122, v122, v240
    v_mul_f32 v123, v123, v240
    v_mul_f32 v124, v124, v240
    v_mul_f32 v125, v125, v240
    v_mul_f32 v126, v126, v240
    v_mul_f32 v127, v127, v240
    v_cvt_pk_bf16_f32 v164, v136, v137
    v_cvt_pk_bf16_f32 v165, v138, v139
    v_cvt_pk_bf16_f32 v166, v140, v141
    v_cvt_pk_bf16_f32 v167, v142, v143
    s_nop 1
    v_mfma_f32_16x16x32_bf16 v[64:67], a[96:99], v[160:163], v[64:67]
    v_mfma_f32_16x16x32_bf16 v[96:99], a[96:99], v[164:167], v[96:99]
    v_mfma_f32_16x16x32_bf16 v[68:71], a[100:103], v[160:163], v[68:71]
    v_mfma_f32_16x16x32_bf16 v[100:103], a[100:103], v[164:167], v[100:103]
    v_mfma_f32_16x16x32_bf16 v[72:75], a[104:107], v[160:163], v[72:75]
    v_mfma_f32_16x16x32_bf16 v[104:107], a[104:107], v[164:167], v[104:107]
    v_mfma_f32_16x16x32_bf16 v[76:79], a[108:111], v[160:163], v[76:79]
    v_mfma_f32_16x16x32_bf16 v[108:111], a[108:111], v[164:167], v[108:111]
    v_mfma_f32_16x16x32_bf16 v[80:83], a[112:115], v[160:163], v[80:83]
    v_mfma_f32_16x16x32_bf16 v[112:115], a[112:115], v[164:167], v[112:115]
    v_mfma_f32_16x16x32_bf16 v[84:87], a[116:119], v[160:163], v[84:87]
    v_mfma_f32_16x16x32_bf16 v[116:119], a[116:119], v[164:167], v[116:119]
    v_mfma_f32_16x16x32_bf16 v[88:91], a[120:123], v[160:163], v[88:91]
    v_mfma_f32_16x16x32_bf16 v[120:123], a[120:123], v[164:167], v[120:123]
    v_mfma_f32_16x16x32_bf16 v[92:95], a[124:127], v[160:163], v[92:95]
    v_mfma_f32_16x16x32_bf16 v[124:127], a[124:127], v[164:167], v[124:127]
    v_mfma_f32_16x16x32_bf16 v[200:203], v[208:211], v[160:163], v[200:203]
    v_mfma_f32_16x16x32_bf16 v[204:207], v[208:211], v[164:167], v[204:207]
    s_add_u32 s37, s37, 2
    s_cmp_le_u32 s37, s38
    s_nop 7
    s_cbranch_scc1 KB_FB_B
    v_mov_b32 v242, 0x2b800000
    v_mov_b32 v243, 0x71800000
    s_lshl_b32 s39, s26, 13
    s_add_u32 s31, s34, 0
    s_lshr_b32 s30, s31, 1
    s_lshl_b32 s30, s30, 10
    s_and_b32 s31, s31, 1
    s_add_u32 s30, s30, s31
    s_lshl_b32 s30, s30, 8
    s_add_u32 s30, s30, s39
    s_add_u32 s31, s30, 4096
    v_cmp_ngt_f32 vcc, v192, v242
    v_rcp_f32 v239, v192
    s_or_b64 s[40:41], s[40:41], vcc
    v_cmp_nlt_f32 vcc, v192, v243
    v_sub_f32 v238, 1.0, v228
    s_or_b64 s[40:41], s[40:41], vcc
    v_mul_f32 v238, v238, v239
    v_mul_f32 v0, v0, v238
    v_mul_f32 v1, v1, v238
    v_mul_f32 v2, v2, v238
    v_mul_f32 v3, v3, v238
    v_mul_f32 v4, v4, v238
    v_mul_f32 v5, v5, v238
    v_mul_f32 v6, v6, v238
    v_mul_f32 v7, v7, v238
    v_cvt_pk_bf16_f32 v220, v0, v1
    v_cvt_pk_bf16_f32 v221, v2, v3
    v_cvt_pk_bf16_f32 v222, v4, v5
    v_cvt_pk_bf16_f32 v223, v6, v7
    buffer_store_dwordx4 v[220:223], v236, s[20:23], s30 offen offset:0 sc1
    v_mul_f32 v8, v8, v238
    v_mul_f32 v9, v9, v238
    v_mul_f32 v10, v10, v238
    v_mul_f32 v11, v11, v238
    v_mul_f32 v12, v12, v238
    v_mul_f32 v13, v13, v238
    v_mul_f32 v14, v14, v238
    v_mul_f32 v15, v15, v238
    v_mfma_f32_16x16x32_bf16 v[216:219], v[212:215], v[220:223], 0
    v_cvt_pk_bf16_f32 v224, v8, v9
    v_cvt_pk_bf16_f32 v225, v10, v11
    v_cvt_pk_bf16_f32 v226, v12, v13
    v_cvt_pk_bf16_f32 v227, v14, v15
    buffer_store_dwordx4 v[224:227], v236, s[20:23], s30 offen offset:2048 sc1
    v_mul_f32 v16, v16, v238
    v_mul_f32 v17, v17, v238
    v_mul_f32 v18, v18, v238
    v_mul_f32 v19, v19, v238
    v_mul_f32 v20, v20, v238
    v_mul_f32 v21, v21, v238
    v_mul_f32 v22, v22, v238
    v_mul_f32 v23, v23, v238
    v_mfma_f32_16x16x32_bf16 v[216:219], v[212:215], v[224:227], v[216:219]
    v_cvt_pk_bf16_f32 v220, v16, v17
    v_cvt_pk_bf16_f32 v221, v18, v19
    v_cvt_pk_bf16_f32 v222, v20, v21
    v_cvt_pk_bf16_f32 v223, v22, v23
    buffer_store_dwordx4 v[220:223], v236, s[20:23], s31 offen offset:0 sc1
    v_mul_f32 v24, v24, v238
    v_mul_f32 v25, v25, v238
    v_mul_f32 v26, v26, v238
    v_mul_f32 v27, v27, v238
    v_mul_f32 v28, v28, v238
    v_mul_f32 v29, v29, v238
    v_mul_f32 v30, v30, v238
    v_mul_f32 v31, v31, v238
    v_mfma_f32_16x16x32_bf16 v[216:219], v[212:215], v[220:223], v[216:219]
    v_cvt_pk_bf16_f32 v224, v24, v25
    v_cvt_pk_bf16_f32 v225, v26, v27
    v_cvt_pk_bf16_f32 v226, v28, v29
    v_cvt_pk_bf16_f32 v227, v30, v31
    buffer_store_dwordx4 v[224:227], v236, s[20:23], s31 offen offset:2048 sc1
    s_add_u32 s31, s34, s43
    s_lshr_b32 s30, s31, 1
    s_lshl_b32 s30, s30, 10
    s_and_b32 s31, s31, 1
    s_add_u32 s30, s30, s31
    s_lshl_b32 s30, s30, 8
    s_add_u32 s30, s30, s39
    s_add_u32 s31, s30, 4096
    v_cmp_ngt_f32 vcc, v196, v242
    v_rcp_f32 v239, v196
    s_or_b64 s[40:41], s[40:41], vcc
    v_cmp_nlt_f32 vcc, v196, v243
    v_sub_f32 v238, 1.0, v229
    s_or_b64 s[40:41], s[40:41], vcc
    v_mul_f32 v238, v238, v239
    v_mul_f32 v32, v32, v238
    v_mul_f32 v33, v33, v238
    v_mul_f32 v34, v34, v238
    v_mul_f32 v35, v35, v238
    v_mul_f32 v36, v36, v238
    v_mul_f32 v37, v37, v238
    v_mul_f32 v38, v38, v238
    v_mul_f32 v39, v39, v238
    v_mfma_f32_16x16x32_bf16 v[216:219], v[212:215], v[224:227], v[216:219]
    v_cvt_pk_bf16_f32 v220, v32, v33
    v_cvt_pk_bf16_f32 v221, v34, v35
    v_cvt_pk_bf16_f32 v222, v36, v37
    v_cvt_pk_bf16_f32 v223, v38, v39
    buffer_store_dwordx4 v[220:223], v236, s[20:23], s30 offen offset:0 sc1
    v_mul_f32 v40, v40, v238
    v_mul_f32 v41, v41, v238
    v_mul_f32 v42, v42, v238
    v_mul_f32 v43, v43, v238
    v_mul_f32 v44, v44, v238
    v_mul_f32 v45, v45, v238
    v_mul_f32 v46, v46, v238
    v_mul_f32 v47, v47, v238
    v_mfma_f32_16x16x32_bf16 v[216:219], v[212:215], v[220:223], v[216:219]
    v_cvt_pk_bf16_f32 v224, v40, v41
    v_cvt_pk_bf16_f32 v225, v42, v43
    v_cvt_pk_bf16_f32 v226, v44, v45
    v_cvt_pk_bf16_f32 v227, v46, v47
    buffer_store_dwordx4 v[224:227], v236, s[20:23], s30 offen offset:2048 sc1
    v_mul_f32 v48, v48, v238
    v_mul_f32 v49, v49, v238
    v_mul_f32 v50, v50, v238
    v_mul_f32 v51, v51, v238
    v_mul_f32 v52, v52, v238
    v_mul_f32 v53, v53, v238
    v_mul_f32 v54, v54, v238
    v_mul_f32 v55, v55, v238
    v_mfma_f32_16x16x32_bf16 v[216:219], v[212:215], v[224:227], v[216:219]
    v_cvt_pk_bf16_f32 v220, v48, v49
    v_cvt_pk_bf16_f32 v221, v50, v51
    v_cvt_pk_bf16_f32 v222, v52, v53
    v_cvt_pk_bf16_f32 v223, v54, v55
    buffer_store_dwordx4 v[220:223], v236, s[20:23], s31 offen offset:0 sc1
    v_mul_f32 v56, v56, v238
    v_mul_f32 v57, v57, v238
    v_mul_f32 v58, v58, v238
    v_mul_f32 v59, v59, v238
    v_mul_f32 v60, v60, v238
    v_mul_f32 v61, v61, v238
    v_mul_f32 v62, v62, v238
    v_mul_f32 v63, v63, v238
    v_mfma_f32_16x16x32_bf16 v[216:219], v[212:215], v[220:223], v[216:219]
    v_cvt_pk_bf16_f32 v224, v56, v57
    v_cvt_pk_bf16_f32 v225, v58, v59
    v_cvt_pk_bf16_f32 v226, v60, v61
    v_cvt_pk_bf16_f32 v227, v62, v63
    buffer_store_dwordx4 v[224:227], v236, s[20:23], s31 offen offset:2048 sc1
    s_nop 0
    v_mfma_f32_16x16x32_bf16 v[216:219], v[212:215], v[224:227], v[216:219]
    s_nop 7
    v_cmp_u_f32 vcc, v216, v216
    s_nop 0
    s_or_b64 s[40:41], s[40:41], vcc
    v_mov_b32 v242, 0x2b800000
    v_mov_b32 v243, 0x71800000
    s_lshl_b32 s39, s26, 13
    s_add_u32 s31, s35, 0
    s_lshr_b32 s30, s31, 1
    s_lshl_b32 s30, s30, 10
    s_and_b32 s31, s31, 1
    s_add_u32 s30, s30, s31
    s_lshl_b32 s30, s30, 8
    s_add_u32 s30, s30, s39
    s_add_u32 s31, s30, 4096
    v_cmp_ngt_f32 vcc, v200, v242
    v_rcp_f32 v239, v200
    s_or_b64 s[40:41], s[40:41], vcc
    v_cmp_nlt_f32 vcc, v200, v243
    v_sub_f32 v238, 1.0, v230
    s_or_b64 s[40:41], s[40:41], vcc
    v_mul_f32 v238, v238, v239
    v_mul_f32 v64, v64, v238
    v_mul_f32 v65, v65, v238
    v_mul_f32 v66, v66, v238
    v_mul_f32 v67, v67, v238
    v_mul_f32 v68, v68, v238
    v_mul_f32 v69, v69, v238
    v_mul_f32 v70, v70, v238
    v_mul_f32 v71, v71, v238
    v_cvt_pk_bf16_f32 v220, v64, v65
    v_cvt_pk_bf16_f32 v221, v66, v67
    v_cvt_pk_bf16_f32 v222, v68, v69
    v_cvt_pk_bf16_f32 v223, v70, v71
    buffer_store_dwordx4 v[220:223], v236, s[20:23], s30 offen offset:0 sc1
    v_mul_f32 v72, v72, v238
    v_mul_f32 v73, v73, v238
    v_mul_f32 v74, v74, v238
    v_mul_f32 v75, v75, v238
    v_mul_f32 v76, v76, v238
    v_mul_f32 v77, v77, v238
    v_mul_f32 v78, v78, v238
    v_mul_f32 v79, v79, v238
    v_mfma_f32_16x16x32_bf16 v[216:219], v[212:215], v[220:223], 0
    v_cvt_pk_bf16_f32 v224, v72, v73
    v_cvt_pk_bf16_f32 v225, v74, v75
    v_cvt_pk_bf16_f32 v226, v76, v77
    v_cvt_pk_bf16_f32 v227, v78, v79
    buffer_store_dwordx4 v[224:227], v236, s[20:23], s30 offen offset:2048 sc1
    v_mul_f32 v80, v80, v238
    v_mul_f32 v81, v81, v238
    v_mul_f32 v82, v82, v238
    v_mul_f32 v83, v83, v238
    v_mul_f32 v84, v84, v238
    v_mul_f32 v85, v85, v238
    v_mul_f32 v86, v86, v238
    v_mul_f32 v87, v87, v238
    v_mfma_f32_16x16x32_bf16 v[216:219], v[212:215], v[224:227], v[216:219]
    v_cvt_pk_bf16_f32 v220, v80, v81
    v_cvt_pk_bf16_f32 v221, v82, v83
    v_cvt_pk_bf16_f32 v222, v84, v85
    v_cvt_pk_bf16_f32 v223, v86, v87
    buffer_store_dwordx4 v[220:223], v236, s[20:23], s31 offen offset:0 sc1
    v_mul_f32 v88, v88, v238
    v_mul_f32 v89, v89, v238
    v_mul_f32 v90, v90, v238
    v_mul_f32 v91, v91, v238
    v_mul_f32 v92, v92, v238
    v_mul_f32 v93, v93, v238
    v_mul_f32 v94, v94, v238
    v_mul_f32 v95, v95, v238
    v_mfma_f32_16x16x32_bf16 v[216:219], v[212:215], v[220:223], v[216:219]
    v_cvt_pk_bf16_f32 v224, v88, v89
    v_cvt_pk_bf16_f32 v225, v90, v91
    v_cvt_pk_bf16_f32 v226, v92, v93
    v_cvt_pk_bf16_f32 v227, v94, v95
    buffer_store_dwordx4 v[224:227], v236, s[20:23], s31 offen offset:2048 sc1
    s_add_u32 s31, s35, s43
    s_lshr_b32 s30, s31, 1
    s_lshl_b32 s30, s30, 10
    s_and_b32 s31, s31, 1
    s_add_u32 s30, s30, s31
    s_lshl_b32 s30, s30, 8
    s_add_u32 s30, s30, s39
    s_add_u32 s31, s30, 4096
    v_cmp_ngt_f32 vcc, v204, v242
    v_rcp_f32 v239, v204
    s_or_b64 s[40:41], s[40:41], vcc
    v_cmp_nlt_f32 vcc, v204, v243
    v_sub_f32 v238, 1.0, v231
    s_or_b64 s[40:41], s[40:41], vcc
    v_mul_f32 v238, v238, v239
    v_mul_f32 v96, v96, v238
    v_mul_f32 v97, v97, v238
    v_mul_f32 v98, v98, v238
    v_mul_f32 v99, v99, v238
    v_mul_f32 v100, v100, v238
    v_mul_f32 v101, v101, v238
    v_mul_f32 v102, v102, v238
    v_mul_f32 v103, v103, v238
    v_mfma_f32_16x16x32_bf16 v[216:219], v[212:215], v[224:227], v[216:219]
    v_cvt_pk_bf16_f32 v220, v96, v97
    v_cvt_pk_bf16_f32 v221, v98, v99
    v_cvt_pk_bf16_f32 v222, v100, v101
    v_cvt_pk_bf16_f32 v223, v102, v103
    buffer_store_dwordx4 v[220:223], v236, s[20:23], s30 offen offset:0 sc1
    v_mul_f32 v104, v104, v238
    v_mul_f32 v105, v105, v238
    v_mul_f32 v106, v106, v238
    v_mul_f32 v107, v107, v238
    v_mul_f32 v108, v108, v238
    v_mul_f32 v109, v109, v238
    v_mul_f32 v110, v110, v238
    v_mul_f32 v111, v111, v238
    v_mfma_f32_16x16x32_bf16 v[216:219], v[212:215], v[220:223], v[216:219]
    v_cvt_pk_bf16_f32 v224, v104, v105
    v_cvt_pk_bf16_f32 v225, v106, v107
    v_cvt_pk_bf16_f32 v226, v108, v109
    v_cvt_pk_bf16_f32 v227, v110, v111
    buffer_store_dwordx4 v[224:227], v236, s[20:23], s30 offen offset:2048 sc1
    v_mul_f32 v112, v112, v238
    v_mul_f32 v113, v113, v238
    v_mul_f32 v114, v114, v238
    v_mul_f32 v115, v115, v238
    v_mul_f32 v116, v116, v238
    v_mul_f32 v117, v117, v238
    v_mul_f32 v118, v118, v238
    v_mul_f32 v119, v119, v238
    v_mfma_f32_16x16x32_bf16 v[216:219], v[212:215], v[224:227], v[216:219]
    v_cvt_pk_bf16_f32 v220, v112, v113
    v_cvt_pk_bf16_f32 v221, v114, v115
    v_cvt_pk_bf16_f32 v222, v116, v117
    v_cvt_pk_bf16_f32 v223, v118, v119
    buffer_store_dwordx4 v[220:223], v236, s[20:23], s31 offen offset:0 sc1
    v_mul_f32 v120, v120, v238
    v_mul_f32 v121, v121, v238
    v_mul_f32 v122, v122, v238
    v_mul_f32 v123, v123, v238
    v_mul_f32 v124, v124, v238
    v_mul_f32 v125, v125, v238
    v_mul_f32 v126, v126, v238
    v_mul_f32 v127, v127, v238
    v_mfma_f32_16x16x32_bf16 v[216:219], v[212:215], v[220:223], v[216:219]
    v_cvt_pk_bf16_f32 v224, v120, v121
    v_cvt_pk_bf16_f32 v225, v122, v123
    v_cvt_pk_bf16_f32 v226, v124, v125
    v_cvt_pk_bf16_f32 v227, v126, v127
    buffer_store_dwordx4 v[224:227], v236, s[20:23], s31 offen offset:2048 sc1
    s_nop 0
    v_mfma_f32_16x16x32_bf16 v[216:219], v[212:215], v[224:227], v[216:219]
    s_nop 7
    v_cmp_u_f32 vcc, v216, v216
    s_nop 0
    s_or_b64 s[40:41], s[40:41], vcc
    s_and_b32 s52, s2, 7
    s_lshl_b32 s52, s52, 2
    s_lshr_b32 s58, s2, 6
    s_add_u32 s52, s52, s58
    s_lshr_b32 s53, s2, 3
    s_and_b32 s53, s53, 7
    s_mov_b64 s[44:45], s[18:19]
    s_mov_b32 s46, 87031808
    s_mov_b32 s47, 0x20000
    s_mov_b64 s[48:49], s[18:19]
    s_mov_b32 s51, 0x20000
    s_lshl_b32 s58, s52, 2
    s_add_u32 s58, s58, s3
    s_lshl_b32 s58, s58, 15
    s_add_u32 s54, s58, 52428800
    s_add_u32 s50, s54, 32768
    s_mov_b32 s55, 0
    s_lshl_b32 s56, s3, 13
    s_add_u32 s56, s56, 131072
    s_lshl_b32 s58, s53, 10
    s_lshl_b32 s59, s3, 8
    s_add_u32 s58, s58, s59
    s_add_u32 s62, s58, 56623104
    s_lshl_b32 s58, s52, 16
    s_lshl_b32 s59, s53, 13
    s_add_u32 s58, s58, s59
    s_add_u32 s58, s58, 50331648
    s_add_u32 s59, s58, 4096
    s_mov_b32 m0, s56
    v_and_b32 v246, 31, v235
    buffer_load_dwordx4 v232, s[48:51], s54 offen offset:0 sc1 lds
    v_lshlrev_b32 v246, 2, v246
    buffer_load_dwordx4 v232, s[48:51], s54 offen offset:1024 sc1 lds
    buffer_load_dwordx4 v232, s[48:51], s54 offen offset:2048 sc1 lds
    buffer_load_dwordx4 v232, s[48:51], s54 offen offset:3072 sc1 lds
    s_add_u32 m0, m0, 4096
    s_add_u32 s54, s54, 4096
    buffer_load_dwordx4 v232, s[48:51], s54 offen offset:0 sc1 lds
    buffer_load_dwordx4 v232, s[48:51], s54 offen offset:1024 sc1 lds
    buffer_load_dwordx4 v232, s[48:51], s54 offen offset:2048 sc1 lds
    buffer_load_dwordx4 v232, s[48:51], s54 offen offset:3072 sc1 lds
    s_add_u32 s54, s54, 4096
    buffer_load_dwordx4 v[0:3], v232, s[44:47], s58 offen offset:0 sc1
    buffer_load_dwordx4 v[4:7], v232, s[44:47], s58 offen offset:1024 sc1
    buffer_load_dwordx4 v[8:11], v232, s[44:47], s58 offen offset:2048 sc1
    buffer_load_dwordx4 v[12:15], v232, s[44:47], s58 offen offset:3072 sc1
    buffer_load_dwordx4 v[16:19], v232, s[44:47], s59 offen offset:0 sc1
    buffer_load_dwordx4 v[20:23], v232, s[44:47], s59 offen offset:1024 sc1
    buffer_load_dwordx4 v[24:27], v232, s[44:47], s59 offen offset:2048 sc1
    buffer_load_dwordx4 v[28:31], v232, s[44:47], s59 offen offset:3072 sc1
    buffer_load_dword v244, v246, s[44:47], s62 offen offset:0 sc1
    buffer_load_dword v245, v246, s[44:47], s62 offen offset:128 sc1
    s_waitcnt vmcnt(0)
    s_branch KB_END
KA_FB:
    s_cmp_lg_u32 s32, 0
    s_cbranch_scc1 KA_OK
    s_mov_b32 s32, 1
    v_subrev_u32 v253, s56, v241
    v_and_b32 v253, 0xfff, v253
    v_and_b32 v246, 27, v235
    v_cmp_eq_u32 vcc, 16, v246
    v_mov_b32 v247, 0x3f803f80
    s_nop 0
    v_cndmask_b32 v80, 0, v247, vcc
    v_cndmask_b32 v81, 0, v247, vcc
    v_cndmask_b32 v82, 0, v247, vcc
    v_cndmask_b32 v83, 0, v247, vcc
    v_cndmask_b32 v84, 0, v247, vcc
    v_cndmask_b32 v85, 0, v247, vcc
    v_cndmask_b32 v86, 0, v247, vcc
    v_cndmask_b32 v87, 0, v247, vcc
    s_lshl_b32 s30, s52, 6
    s_lshl_b32 s31, s53, 3
    s_add_u32 s30, s30, s31
    s_lshl_b32 s31, s3, 1
    s_add_u32 s30, s30, s31
    s_lshl_b32 s30, s30, 10
    s_add_u32 s30, s30, 50331648
    buffer_load_dwordx4 v[0:3], v232, s[44:47], s30 offen sc1
    s_lshl_b32 s34, s52, 17
    s_add_u32 s34, s34, 52428800
    s_mov_b32 s33, 64
    v_mov_b32 v252, 0xff800000
    v_mov_b32 v192, 0
    v_mov_b32 v193, 0
    v_mov_b32 v194, 0
    v_mov_b32 v195, 0
    v_mov_b32 v196, 0
    v_mov_b32 v197, 0
    v_mov_b32 v198, 0
    v_mov_b32 v199, 0
    v_mov_b32 v200, 0
    v_mov_b32 v201, 0
    v_mov_b32 v202, 0
    v_mov_b32 v203, 0
    v_mov_b32 v204, 0
    v_mov_b32 v205, 0
    v_mov_b32 v206, 0
    v_mov_b32 v207, 0
KA_FB_0:
    buffer_load_dwordx4 v[72:75], v232, s[44:47], s34 offen sc1
    s_mov_b64 exec, s[60:61]
    buffer_load_dwordx4 v[80:83], v253, s[44:47], s34 offen sc1
    buffer_load_dwordx4 v[84:87], v253, s[44:47], s34 offen offset:512 sc1
    s_mov_b64 exec, -1
    s_add_u32 s34, s34, 2048
    s_waitcnt vmcnt(0)
    v_mfma_f32_32x32x16_bf16 v[32:47], v[72:75], v[0:3], 0
    s_nop 11
    v_max3_f32 v246, v32, v33, v252
    v_max3_f32 v246, v34, v35, v246
    v_max3_f32 v246, v36, v37, v246
    v_max3_f32 v246, v38, v39, v246
    v_max3_f32 v246, v40, v41, v246
    v_max3_f32 v246, v42, v43, v246
    v_max3_f32 v246, v44, v45, v246
    v_max3_f32 v246, v46, v47, v246
    v_mov_b32 v247, v246
    s_nop 1
    v_permlane32_swap_b32 v246, v247
    v_max_f32 v246, v246, v247
    v_sub_f32 v248, v252, v246
    v_exp_f32 v248, v248
    v_mov_b32 v252, v246
    v_sub_f32 v32, v32, v246
    v_sub_f32 v33, v33, v246
    v_sub_f32 v34, v34, v246
    v_sub_f32 v35, v35, v246
    v_sub_f32 v36, v36, v246
    v_sub_f32 v37, v37, v246
    v_sub_f32 v38, v38, v246
    v_sub_f32 v39, v39, v246
    v_sub_f32 v40, v40, v246
    v_sub_f32 v41, v41, v246
    v_sub_f32 v42, v42, v246
    v_sub_f32 v43, v43, v246
    v_sub_f32 v44, v44, v246
    v_sub_f32 v45, v45, v246
    v_sub_f32 v46, v46, v246
    v_sub_f32 v47, v47, v246
    v_exp_f32 v32, v32
    v_exp_f32 v33, v33
    v_exp_f32 v34, v34
    v_exp_f32 v35, v35
    v_exp_f32 v36, v36
    v_exp_f32 v37, v37
    v_exp_f32 v38, v38
    v_exp_f32 v39, v39
    v_exp_f32 v40, v40
    v_exp_f32 v41, v41
    v_exp_f32 v42, v42
    v_exp_f32 v43, v43
    v_exp_f32 v44, v44
    v_exp_f32 v45, v45
    v_exp_f32 v46, v46
    v_exp_f32 v47, v47
    v_mul_f32 v192, v192, v248
    v_mul_f32 v193, v193, v248
    v_mul_f32 v194, v194, v248
    v_mul_f32 v195, v195, v248
    v_mul_f32 v196, v196, v248
    v_mul_f32 v197, v197, v248
    v_mul_f32 v198, v198, v248
    v_mul_f32 v199, v199, v248
    v_mul_f32 v200, v200, v248
    v_cvt_pk_bf16_f32 v64, v32, v33
    v_cvt_pk_bf16_f32 v65, v34, v35
    v_cvt_pk_bf16_f32 v66, v36, v37
    v_cvt_pk_bf16_f32 v67, v38, v39
    v_cvt_pk_bf16_f32 v68, v40, v41
    v_cvt_pk_bf16_f32 v69, v42, v43
    v_cvt_pk_bf16_f32 v70, v44, v45
    v_cvt_pk_bf16_f32 v71, v46, v47
    s_nop 1
    v_mfma_f32_32x32x16_bf16 v[192:207], v[80:83], v[64:67], v[192:207]
    v_mfma_f32_32x32x16_bf16 v[192:207], v[84:87], v[68:71], v[192:207]
    s_sub_u32 s33, s33, 1
    s_cmp_lg_u32 s33, 0
    s_nop 11
    s_cbranch_scc1 KA_FB_0
    v_mov_b32 v96, v192
    v_mov_b32 v97, v193
    v_mov_b32 v98, v194
    v_mov_b32 v99, v195
    v_mov_b32 v100, v196
    v_mov_b32 v101, v197
    v_mov_b32 v102, v198
    v_mov_b32 v103, v199
    v_mov_b32 v104, v200
    s_lshl_b32 s30, s52, 6
    s_lshl_b32 s31, s53, 3
    s_add_u32 s30, s30, s31
    s_lshl_b32 s31, s3, 1
    s_add_u32 s30, s30, s31
    s_lshl_b32 s30, s30, 10
    s_add_u32 s30, s30, 50332672
    buffer_load_dwordx4 v[0:3], v232, s[44:47], s30 offen sc1
    s_lshl_b32 s34, s52, 17
    s_add_u32 s34, s34, 52428800
    s_mov_b32 s33, 64
    v_mov_b32 v252, 0xff800000
    v_mov_b32 v192, 0
    v_mov_b32 v193, 0
    v_mov_b32 v194, 0
    v_mov_b32 v195, 0
    v_mov_b32 v196, 0
    v_mov_b32 v197, 0
    v_mov_b32 v198, 0
    v_mov_b32 v199, 0
    v_mov_b32 v200, 0
    v_mov_b32 v201, 0
    v_mov_b32 v202, 0
    v_mov_b32 v203, 0
    v_mov_b32 v204, 0
    v_mov_b32 v205, 0
    v_mov_b32 v206, 0
    v_mov_b32 v207, 0
KA_FB_1:
    buffer_load_dwordx4 v[72:75], v232, s[44:47], s34 offen sc1
    s_mov_b64 exec, s[60:61]
    buffer_load_dwordx4 v[80:83], v253, s[44:47], s34 offen sc1
    buffer_load_dwordx4 v[84:87], v253, s[44:47], s34 offen offset:512 sc1
    s_mov_b64 exec, -1
    s_add_u32 s34, s34, 2048
    s_waitcnt vmcnt(0)
    v_mfma_f32_32x32x16_bf16 v[32:47], v[72:75], v[0:3], 0
    s_nop 11
    v_max3_f32 v246, v32, v33, v252
    v_max3_f32 v246, v34, v35, v246
    v_max3_f32 v246, v36, v37, v246
    v_max3_f32 v246, v38, v39, v246
    v_max3_f32 v246, v40, v41, v246
    v_max3_f32 v246, v42, v43, v246
    v_max3_f32 v246, v44, v45, v246
    v_max3_f32 v246, v46, v47, v246
    v_mov_b32 v247, v246
    s_nop 1
    v_permlane32_swap_b32 v246, v247
    v_max_f32 v246, v246, v247
    v_sub_f32 v248, v252, v246
    v_exp_f32 v248, v248
    v_mov_b32 v252, v246
    v_sub_f32 v32, v32, v246
    v_sub_f32 v33, v33, v246
    v_sub_f32 v34, v34, v246
    v_sub_f32 v35, v35, v246
    v_sub_f32 v36, v36, v246
    v_sub_f32 v37, v37, v246
    v_sub_f32 v38, v38, v246
    v_sub_f32 v39, v39, v246
    v_sub_f32 v40, v40, v246
    v_sub_f32 v41, v41, v246
    v_sub_f32 v42, v42, v246
    v_sub_f32 v43, v43, v246
    v_sub_f32 v44, v44, v246
    v_sub_f32 v45, v45, v246
    v_sub_f32 v46, v46, v246
    v_sub_f32 v47, v47, v246
    v_exp_f32 v32, v32
    v_exp_f32 v33, v33
    v_exp_f32 v34, v34
    v_exp_f32 v35, v35
    v_exp_f32 v36, v36
    v_exp_f32 v37, v37
    v_exp_f32 v38, v38
    v_exp_f32 v39, v39
    v_exp_f32 v40, v40
    v_exp_f32 v41, v41
    v_exp_f32 v42, v42
    v_exp_f32 v43, v43
    v_exp_f32 v44, v44
    v_exp_f32 v45, v45
    v_exp_f32 v46, v46
    v_exp_f32 v47, v47
    v_mul_f32 v192, v192, v248
    v_mul_f32 v193, v193, v248
    v_mul_f32 v194, v194, v248
    v_mul_f32 v195, v195, v248
    v_mul_f32 v196, v196, v248
    v_mul_f32 v197, v197, v248
    v_mul_f32 v198, v198, v248
    v_mul_f32 v199, v199, v248
    v_mul_f32 v200, v200, v248
    v_cvt_pk_bf16_f32 v64, v32, v33
    v_cvt_pk_bf16_f32 v65, v34, v35
    v_cvt_pk_bf16_f32 v66, v36, v37
    v_cvt_pk_bf16_f32 v67, v38, v39
    v_cvt_pk_bf16_f32 v68, v40, v41
    v_cvt_pk_bf16_f32 v69, v42, v43
    v_cvt_pk_bf16_f32 v70, v44, v45
    v_cvt_pk_bf16_f32 v71, v46, v47
    s_nop 1
    v_mfma_f32_32x32x16_bf16 v[192:207], v[80:83], v[64:67], v[192:207]
    v_mfma_f32_32x32x16_bf16 v[192:207], v[84:87], v[68:71], v[192:207]
    s_sub_u32 s33, s33, 1
    s_cmp_lg_u32 s33, 0
    s_nop 11
    s_cbranch_scc1 KA_FB_1
    v_mov_b32 v108, v192
    v_mov_b32 v109, v193
    v_mov_b32 v110, v194
    v_mov_b32 v111, v195
    v_mov_b32 v112, v196
    v_mov_b32 v113, v197
    v_mov_b32 v114, v198
    v_mov_b32 v115, v199
    v_mov_b32 v116, v200
    s_branch KA_EPI
CODE2:
.section .rodata,"a"
.p2align 6
.amdhsa_kernel gated_mix__softmax_full_mha__compressed_kv_cla__prompt_kernel
  .amdhsa_next_free_vgpr 512
  .amdhsa_next_free_sgpr 102
  .amdhsa_accum_offset 256
  .amdhsa_group_segment_fixed_size 0
  .amdhsa_kernarg_size 104
  .amdhsa_user_sgpr_count 2
  .amdhsa_user_sgpr_kernarg_segment_ptr 1
  .amdhsa_system_sgpr_workgroup_id_x 1
.end_amdhsa_kernel
.text
```
